```python
import torch

def _softmax(x, axis=-1):
    return torch.softmax(x, dim=axis)
def _gelu(x):
    return torch.nn.functional.gelu(x, approximate="tanh")
def _silu(x):
    return torch.nn.functional.silu(x)
def _sigmoid(x):
    return torch.sigmoid(x)
def _layernorm(x, axis=-1, eps=1e-5):
    m = x.mean(dim=axis, keepdim=True)
    v = x.var(dim=axis, keepdim=True, unbiased=False)
    return (x - m) / torch.sqrt(v + eps)
def _scatter_add(tgt, idx, src, axis=0):
    return tgt.clone().index_add_(axis, idx, src)
def _segment_sum(src, seg, n):
    out = torch.zeros((n,) + src.shape[1:], dtype=src.dtype)
    return out.index_add_(0, seg, src)
def _pad(x, pw):
    flat = tuple(v for pair in reversed(pw) for v in pair)
    return torch.nn.functional.pad(x, flat)

kernel_name = 'sequential_preLN__sliding_local_dilated__glu_gated_glu__prompt'

def setup_inputs():

    _w = (lambda a: (lambda t: t.to(torch.bfloat16) if t.is_floating_point() else t)(torch.as_tensor(a)))
    def _A_setup():
        B, S, D = 1, 2048, 1024
        return {
            "x": _w((lambda *s: torch.randn(*s, dtype=torch.bfloat16) * 0.05)(B, S, D)),
            "wqkv": _w((lambda *s: torch.randn(*s, dtype=torch.bfloat16) * 0.05)(D, 3 * D)),
            "wo": _w((lambda *s: torch.randn(*s, dtype=torch.bfloat16) * 0.05)(D, D)),
        }
    _A_in = _A_setup()

    def _B_setup():
        B, S, D, F = 1, 2048, 1024, 3584
        return {
            "x": _w((lambda *s: torch.randn(*s, dtype=torch.bfloat16) * 0.05)(B, S, D)),
            "w_gate": _w((lambda *s: torch.randn(*s, dtype=torch.bfloat16) * 0.05)(D, F)),
            "w_up": _w((lambda *s: torch.randn(*s, dtype=torch.bfloat16) * 0.05)(D, F)),
            "w_down": _w((lambda *s: torch.randn(*s, dtype=torch.bfloat16) * 0.05)(F, D)),
        }
    _B_in = _B_setup()

    return {
        "A_x": _A_in["x"],
        "A_wqkv": _A_in["wqkv"],
        "A_wo": _A_in["wo"],
        "B_x": _B_in["x"],
        "B_w_gate": _B_in["w_gate"],
        "B_w_up": _B_in["w_up"],
        "B_w_down": _B_in["w_down"],
    }

def reference(A_x, A_wqkv, A_wo, B_x, B_w_gate, B_w_up, B_w_down):
    def _A_ref(x, wqkv, wo):
        B, S, D = x.shape
        H = 32; Dh = D // H
        W, dil = 8, 2
        qkv = (lambda x, *d: x.permute(*d))((x @ wqkv).reshape(B, S, 3, H, Dh), 2, 0, 3, 1, 4)
        q, k, v = qkv[0], qkv[1], qkv[2]
        scale = Dh ** -0.5
        pos = torch.arange(S)
        off = torch.arange(W) * dil
        idx = pos[:, None] - off[None, :]
        mask = idx >= 0
        idx_c = torch.where(mask, idx, 0).reshape(-1)
        kg = k[:, :, idx_c, :].reshape(B, H, S, W, Dh)
        vg = v[:, :, idx_c, :].reshape(B, H, S, W, Dh)
        logits = torch.einsum("bhsd,bhswd->bhsw", q, kg) * scale
        logits = torch.where(mask[None, None, :, :], logits, -1e9)
        attn = _softmax(logits, axis=-1)
        o = torch.einsum("bhsw,bhswd->bhsd", attn, vg)
        return (lambda x, *d: x.permute(*d))(o, 0, 2, 1, 3).reshape(B, S, D) @ wo

    def _B_ref(x, w_gate, w_up, w_down):
        g = torch.einsum("bsd,df->bsf", x, w_gate)
        u = torch.einsum("bsd,df->bsf", x, w_up)
        h = _sigmoid(g) * u
        return torch.einsum("bsf,fd->bsd", h, w_down)

    x = A_x
    h = x + _A_ref(_layernorm(x, axis=-1), A_wqkv, A_wo)
    h2 = h + _B_ref(_layernorm(h, axis=-1), B_w_gate, B_w_up, B_w_down)
    return h2
```

```asm
; @launch grid=(256,1,1) block=(256,1,1) lds=163840
.amdgcn_target "amdgcn-amd-amdhsa--gfx950"
.text
.globl sequential_preLN__sliding_local_dilated__glu_gated_glu__prompt_kernel
.p2align 8
.type sequential_preLN__sliding_local_dilated__glu_gated_glu__prompt_kernel,@function
sequential_preLN__sliding_local_dilated__glu_gated_glu__prompt_kernel:
    s_cmp_ge_u32 s2, 256
    s_cbranch_scc1 L_end
    s_load_dwordx16 s[80:95], s[0:1], 0
    s_load_dwordx4 s[96:99], s[0:1], 64
    v_lshrrev_b32 v1, 6, v0
    v_and_b32 v0, 63, v0
    v_readfirstlane_b32 s3, v1
    s_getpc_b64 s[72:73]
L_cp1:
    s_lshr_b32 s74, s2, 3
    s_lshl2_add_u32 s74, s74, s3
    s_lshl_b32 s74, s74, 10
    s_add_u32 s74, s74, 0
    s_min_u32 s74, s74, L_end-L_cp1
    s_add_u32 s72, s72, s74
    s_addc_u32 s73, s73, 0
    v_and_b32 v2, 7, v0
    v_lshlrev_b32 v2, 7, v2
    v_mov_b32 v3, s73
    v_add_co_u32 v2, vcc, s72, v2
    s_nop 1
    v_addc_co_u32 v3, vcc, 0, v3, vcc
    global_load_dword a251, v[2:3], off
    s_and_b32 s13, s2, 1
    s_lshl_b32 s13, s13, 3
    s_bfe_u32 s16, s2, 0x30003
    s_add_u32 s13, s13, s16
    s_lshr_b32 s14, s2, 6
    s_and_b32 s16, s2, 6
    s_lshl_b32 s16, s16, 1
    s_add_u32 s14, s14, s16
    s_lshr_b32 s18, s3, 1
    s_and_b32 s19, s3, 1
    s_bfe_u32 s15, s2, 0x20001
    s_lshl1_add_u32 s60, s2, s15
    s_lshl_b32 s60, s60, 2
    s_add_u32 s61, s13, s14
    s_and_b32 s61, s61, 3
    v_and_b32 v4, 15, v0
    v_lshrrev_b32 v5, 4, v0
    v_lshrrev_b32 v1, 3, v0
    s_mul_i32 s15, s3, 98304
    s_lshl_b32 s16, s14, 7
    s_add_u32 s15, s15, s16
    v_mul_u32_u24 v2, 6144, v1
    v_and_b32 v3, 1, v5
    v_lshlrev_b32 v3, 1, v3
    v_and_b32 v6, 7, v0
    v_xor_b32 v3, v3, v6
    v_lshl_add_u32 v2, v3, 4, v2
    v_add_u32 v12, s15, v2
    v_xor_b32 v13, 64, v12
    v_add_u32 v13, 48128, v13
    v_add_u32 v14, 2048, v12
    v_add_u32 v15, 2048, v13
    v_add_u32 v16, 4096, v12
    v_add_u32 v17, 4096, v13
    s_lshl_b32 s51, s3, 12
    s_mul_i32 s52, s18, 12288
    s_lshl_b32 s15, s19, 11
    s_add_u32 s52, s52, s15
    s_lshl_b32 s53, s3, 9
    s_waitcnt lgkmcnt(0)
    s_mov_b32 s24, s82
    s_mov_b32 s25, s83
    s_mov_b32 s26, 0x600000
    s_mov_b32 s27, 0x00020000
    s_cmp_eq_u32 s61, 0
    s_cselect_b32 s67, 4, 0
    s_add_u32 s67, s67, s60
    s_and_b32 s67, s67, 15
    s_lshl_b32 s48, s67, 7
    s_mul_i32 s49, s67, 393216
    s_add_u32 m0, s52, 55296
    s_nop 0
    buffer_load_dwordx4 v12, s[24:27], s49 offen offset:0 lds
    buffer_load_dwordx4 v13, s[24:27], s49 offen offset:1024 lds
    s_add_u32 m0, s52, 59392
    s_nop 0
    buffer_load_dwordx4 v14, s[24:27], s49 offen offset:0 lds
    buffer_load_dwordx4 v15, s[24:27], s49 offen offset:1024 lds
    s_add_u32 m0, s52, 63488
    s_nop 0
    buffer_load_dwordx4 v16, s[24:27], s49 offen offset:0 lds
    buffer_load_dwordx4 v17, s[24:27], s49 offen offset:1024 lds
    s_mov_b32 s20, s80
    s_mov_b32 s21, s81
    s_mov_b32 s22, 0x400000
    s_mov_b32 s23, 0x00020000
    s_lshl_b32 s15, s13, 7
    s_lshl_b32 s16, s19, 6
    s_add_u32 s15, s15, s16
    s_add_u32 s15, s15, s18
    s_lshl_b32 s15, s15, 11
    v_lshlrev_b32 v2, 12, v1
    v_and_b32 v3, 7, v0
    v_xor_b32 v3, v3, v5
    v_lshl_add_u32 v2, v3, 4, v2
    v_add_u32 v7, s15, v2
    v_xor_b32 v8, 64, v7
    v_add_u32 v8, 0x7c00, v8
    v_add_u32 v9, 0xf800, v7
    v_add_u32 v10, 0xf800, v8
    s_add_u32 m0, s51, 0
    s_nop 0
    buffer_load_dwordx4 v7, s[20:23], s48 offen offset:0 lds
    buffer_load_dwordx4 v8, s[20:23], s48 offen offset:1024 lds
    buffer_load_dwordx4 v9, s[20:23], s48 offen offset:2048 lds
    buffer_load_dwordx4 v10, s[20:23], s48 offen offset:3072 lds
    s_lshl_b32 s15, s13, 7
    s_sub_i32 s15, s15, 16
    s_max_i32 s15, s15, 0
    s_lshl_b32 s16, s19, 3
    s_add_u32 s15, s15, s16
    s_add_u32 s15, s15, s18
    s_lshl_b32 s15, s15, 11
    s_lshl_b32 s16, s3, 1
    v_add_u32 v3, s16, v5
    v_and_b32 v3, 7, v3
    v_xor_b32 v3, v3, v6
    v_lshlrev_b32 v2, 12, v1
    v_lshl_add_u32 v2, v3, 4, v2
    v_add_u32 v11, s15, v2
    s_cmp_eq_u32 s3, 0
    s_cselect_b32 s54, 0xffffff00, -1
    s_mov_b32 s55, 0
    s_add_u32 m0, s53, 16384
    s_mov_b64 exec, s[54:55]
    buffer_load_dwordx4 v11, s[20:23], s48 offen lds
    s_mov_b64 exec, -1
    s_cmp_eq_u32 s61, 1
    s_cselect_b32 s67, 5, 1
    s_add_u32 s67, s67, s60
    s_and_b32 s67, s67, 15
    s_lshl_b32 s48, s67, 7
    s_mul_i32 s49, s67, 393216
    s_add_u32 m0, s52, 79872
    s_nop 0
    buffer_load_dwordx4 v12, s[24:27], s49 offen offset:0 lds
    buffer_load_dwordx4 v13, s[24:27], s49 offen offset:1024 lds
    s_add_u32 m0, s52, 83968
    s_nop 0
    buffer_load_dwordx4 v14, s[24:27], s49 offen offset:0 lds
    buffer_load_dwordx4 v15, s[24:27], s49 offen offset:1024 lds
    s_add_u32 m0, s52, 88064
    s_nop 0
    buffer_load_dwordx4 v16, s[24:27], s49 offen offset:0 lds
    buffer_load_dwordx4 v17, s[24:27], s49 offen offset:1024 lds
    s_lshl_b32 s15, s13, 4
    s_add_u32 s15, s15, s14
    s_lshl_b32 s15, s15, 2
    s_add_u32 s15, s15, s3
    s_lshl_b32 s15, s15, 12
    v_lshlrev_b32 v1, 4, v0
    s_mov_b32 s40, s96
    s_mov_b32 s41, s97
    s_mov_b32 s42, 0x100
    s_mov_b32 s43, 0x00020000
    s_add_u32 s16, s2, s3
    s_cmp_lg_u32 s16, 0
    s_cbranch_scc1 L_p1_notag
    s_memrealtime s[62:63]
    s_waitcnt lgkmcnt(0)
    s_or_b32 s16, s62, 1
    v_mov_b32 v2, s16
    s_mov_b64 exec, 1
    buffer_store_dword v2, v0, s[40:43], 0 offen sc1
    s_mov_b64 exec, -1
L_p1_notag:
    s_mov_b32 s36, s84
    s_mov_b32 s37, s85
    s_mov_b32 s38, 0x200000
    s_mov_b32 s39, 0x00020000
    s_mov_b32 s68, s15
    s_mov_b32 s28, s98
    s_mov_b32 s29, s99
    s_mov_b32 s30, 0x400000
    s_mov_b32 s31, 0x00020000
    s_add_u32 s76, s98, 0x1a40000
    s_addc_u32 s77, s99, 0
    s_mov_b32 s78, 0x200000
    s_mov_b32 s79, 0x00020000
    v_and_b32 v2, 3, v0
    v_lshlrev_b32 v2, 15, v2
    s_lshl_b32 s16, s3, 19
    s_lshl_b32 s17, s2, 7
    s_add_u32 s16, s16, s17
    buffer_load_dword a250, v2, s[76:79], s16 offen sc1
    v_mov_b32 v28, 0x3f803f80
    v_mov_b32 v29, 0x3f803f80
    v_mov_b32 v30, 0x3f803f80
    v_mov_b32 v31, 0x3f803f80
    s_mov_b64 exec, 0xff
    ds_write_b128 v1, v[28:31] offset:16384
    ds_write_b128 v1, v[28:31] offset:34816
    ds_write_b128 v1, v[28:31] offset:53248
    s_mov_b64 exec, -1
    v_lshrrev_b32 v1, 1, v4
    v_xor_b32 v1, v1, v5
    v_lshlrev_b32 v2, 7, v4
    v_lshl_add_u32 v2, v1, 4, v2
    v_add_u32 v19, 16384, v2
    s_lshl_b32 s15, s18, 13
    v_add_u32 v18, s15, v2
    v_xor_b32 v22, 64, v18
    v_xor_b32 v23, 64, v19
    v_lshrrev_b32 v1, 2, v4
    v_lshl_add_u32 v1, v5, 3, v1
    v_lshlrev_b32 v1, 7, v1
    v_and_b32 v2, 3, v4
    v_lshl_add_u32 v1, v2, 3, v1
    v_lshrrev_b32 v2, 3, v4
    v_and_b32 v3, 1, v5
    v_lshl_add_u32 v2, v3, 1, v2
    s_lshl_b32 s15, s19, 1
    s_add_u32 s15, s15, s18
    v_xor_b32 v2, s15, v2
    v_lshl_add_u32 v1, v2, 5, v1
    v_xor_b32 v2, 32, v1
    v_add_u32 v20, 55296, v1
    v_add_u32 v21, 55296, v2
    v_add_u32 v24, 67584, v1
    v_add_u32 v25, 67584, v2
    s_cmp_lt_u32 s3, 2
    s_cselect_b32 s32, s88, s90
    s_cselect_b32 s33, s89, s91
    s_mov_b32 s34, 0x700000
    s_mov_b32 s35, 0x00020000
    s_bfe_u32 s15, s2, 0x10002
    s_xor_b32 s15, s15, s2
    s_and_b32 s15, s15, 1
    s_lshl_b32 s15, s15, 9
    s_and_b32 s16, s2, 0xf8
    s_mul_i32 s16, s16, 2
    s_add_u32 s15, s15, s16
    s_mul_i32 s16, s19, 8
    s_add_u32 s15, s15, s16
    s_mul_i32 s15, s15, 7168
    s_bfe_u32 s16, s2, 0x20001
    s_mul_i32 s16, s16, 1792
    s_add_u32 s15, s15, s16
    v_mul_u32_u24 v236, 7168, v5
    v_min_u32 v237, 13, v4
    v_lshl_add_u32 v236, v237, 7, v236
    v_add_u32 v236, s15, v236
    v_add_u32 v237, 28672, v236
    v_add_u32 v238, 57344, v236
    s_lshr_b32 s45, s2, 3
    s_mul_i32 s44, s45, 5
    s_lshr_b32 s44, s44, 5
    s_add_u32 s44, s44, 3
    s_cmp_ge_u32 s45, 32
    s_cselect_b32 s44, 99, s44
    s_and_b32 s45, s14, 7
    s_cmp_eq_u32 s45, 3
    s_cselect_b32 s44, 99, s44
    s_and_b32 s47, s2, 2
    s_lshl_b32 s47, s47, 2
    s_lshr_b32 s46, s2, 6
    s_lshl1_add_u32 s47, s46, s47
    s_bfe_u32 s46, s2, 0x10002
    s_add_u32 s47, s47, s46
    s_lshl_b32 s47, s47, 7
    v_lshlrev_b32 v208, 2, v5
    v_sub_u32 v208, v4, v208
    v_mov_b32 v209, 0xff800000
    s_cmp_eq_u32 s13, 0
    s_cselect_b32 s16, 64, 0
    v_lshrrev_b32 v216, 1, v5
    v_xor_b32 v216, s18, v216
    v_lshlrev_b32 v216, 6, v216
    v_and_b32 v217, 1, v5
    v_lshlrev_b32 v217, 2, v217
    v_sub_u32 v217, v217, v4
    v_sub_u32 v217, v217, v216
    v_subrev_u32 v210, 0, v208
    v_mov_b32 v211, 0xffff
    v_cmp_gt_u32 vcc, 8, v210
    v_add_u32 v218, 0, v217
    s_nop 0
    v_cndmask_b32 v192, v209, 0, vcc
    v_cmp_gt_i32 vcc, -8, v210
    s_nop 1
    v_cndmask_b32 v196, v209, 0, vcc
    v_cmp_le_i32 vcc, 0, v210
    s_nop 1
    v_cndmask_b32 v212, 0, v211, vcc
    v_cmp_lt_i32 vcc, s16, v218
    s_nop 1
    v_cndmask_b32 v200, v209, 0, vcc
    v_subrev_u32 v210, 1, v208
    v_mov_b32 v211, 0xffff0000
    v_cmp_gt_u32 vcc, 8, v210
    v_add_u32 v218, 1, v217
    s_nop 0
    v_cndmask_b32 v193, v209, 0, vcc
    v_cmp_gt_i32 vcc, -8, v210
    s_nop 1
    v_cndmask_b32 v197, v209, 0, vcc
    v_cmp_le_i32 vcc, 0, v210
    s_nop 1
    v_cndmask_b32 v213, 0, v211, vcc
    v_cmp_lt_i32 vcc, s16, v218
    s_nop 1
    v_cndmask_b32 v201, v209, 0, vcc
    v_subrev_u32 v210, 2, v208
    v_mov_b32 v211, 0xffff
    v_cmp_gt_u32 vcc, 8, v210
    v_add_u32 v218, 2, v217
    s_nop 0
    v_cndmask_b32 v194, v209, 0, vcc
    v_cmp_gt_i32 vcc, -8, v210
    s_nop 1
    v_cndmask_b32 v198, v209, 0, vcc
    v_cmp_le_i32 vcc, 0, v210
    s_nop 1
    v_cndmask_b32 v214, 0, v211, vcc
    v_cmp_lt_i32 vcc, s16, v218
    s_nop 1
    v_cndmask_b32 v202, v209, 0, vcc
    v_subrev_u32 v210, 3, v208
    v_mov_b32 v211, 0xffff0000
    v_cmp_gt_u32 vcc, 8, v210
    v_add_u32 v218, 3, v217
    s_nop 0
    v_cndmask_b32 v195, v209, 0, vcc
    v_cmp_gt_i32 vcc, -8, v210
    s_nop 1
    v_cndmask_b32 v199, v209, 0, vcc
    v_cmp_le_i32 vcc, 0, v210
    s_nop 1
    v_cndmask_b32 v215, 0, v211, vcc
    v_cmp_lt_i32 vcc, s16, v218
    s_nop 1
    v_cndmask_b32 v203, v209, 0, vcc
    v_or_b32 v204, v212, v213
    v_or_b32 v205, v214, v215
    v_not_b32 v206, v204
    v_not_b32 v207, v205
    v_lshrrev_b32 v232, 2, v4
    v_and_b32 v233, 3, v4
    v_lshlrev_b32 v233, 2, v233
    v_lshl_add_u32 v228, v232, 7, v233
    v_lshlrev_b32 v229, 7, v5
    v_lshrrev_b32 v232, 3, v4
    v_mul_u32_u24 v232, 224, v232
    v_sub_u32 v230, v228, v232
    v_lshrrev_b32 v232, 1, v5
    v_mul_u32_u24 v232, 224, v232
    v_sub_u32 v231, v229, v232
    v_cmp_eq_u32 vcc, 0, v208
    s_nop 1
    v_cndmask_b32 v240, 0, 1.0, vcc
    v_cmp_eq_u32 vcc, 1, v208
    s_nop 1
    v_cndmask_b32 v241, 0, 1.0, vcc
    v_cmp_eq_u32 vcc, 2, v208
    s_nop 1
    v_cndmask_b32 v242, 0, 1.0, vcc
    v_cmp_eq_u32 vcc, 3, v208
    s_nop 1
    v_cndmask_b32 v243, 0, 1.0, vcc
    v_lshlrev_b32 v2, 4, v0
    v_mov_b32 v3, 0
    s_lshr_b32 s50, s68, 1
    s_add_u32 m0, s51, 18432
    s_nop 0
    buffer_load_dwordx4 v7, s[20:23], s48 offen offset:0 lds
    buffer_load_dwordx4 v8, s[20:23], s48 offen offset:1024 lds
    buffer_load_dwordx4 v9, s[20:23], s48 offen offset:2048 lds
    buffer_load_dwordx4 v10, s[20:23], s48 offen offset:3072 lds
    s_add_u32 m0, s53, 34816
    s_mov_b64 exec, s[54:55]
    buffer_load_dwordx4 v11, s[20:23], s48 offen lds
    s_mov_b64 exec, -1
    s_cmp_eq_u32 s61, 2
    s_cselect_b32 s67, 6, 2
    s_add_u32 s67, s67, s60
    s_and_b32 s67, s67, 15
    s_lshl_b32 s48, s67, 7
    s_mul_i32 s49, s67, 393216
    s_add_u32 m0, s52, 104448
    s_nop 0
    buffer_load_dwordx4 v12, s[24:27], s49 offen offset:0 lds
    buffer_load_dwordx4 v13, s[24:27], s49 offen offset:1024 lds
    s_add_u32 m0, s52, 108544
    s_nop 0
    buffer_load_dwordx4 v14, s[24:27], s49 offen offset:0 lds
    buffer_load_dwordx4 v15, s[24:27], s49 offen offset:1024 lds
    s_add_u32 m0, s52, 112640
    s_nop 0
    buffer_load_dwordx4 v16, s[24:27], s49 offen offset:0 lds
    buffer_load_dwordx4 v17, s[24:27], s49 offen offset:1024 lds
    s_waitcnt vmcnt(17) lgkmcnt(0)
    s_barrier
    ds_read_b64_tr_b16 a[20:21], v20 offset:0
    ds_read_b64_tr_b16 a[22:23], v20 offset:512
    ds_read_b64_tr_b16 a[24:25], v21 offset:0
    ds_read_b64_tr_b16 a[26:27], v21 offset:512
    ds_read_b128 a[0:3], v18 offset:0
    ds_read_b128 a[4:7], v18 offset:2048
    ds_read_b128 a[8:11], v18 offset:4096
    ds_read_b128 a[12:15], v18 offset:6144
    ds_read_b128 a[16:19], v19 offset:0
    ds_read_b64_tr_b16 a[28:29], v20 offset:4096
    ds_read_b64_tr_b16 a[30:31], v20 offset:4608
    ds_read_b64_tr_b16 a[32:33], v21 offset:4096
    ds_read_b64_tr_b16 a[34:35], v21 offset:4608
    ds_read_b64_tr_b16 a[36:37], v20 offset:8192
    ds_read_b64_tr_b16 a[38:39], v20 offset:8704
    ds_read_b64_tr_b16 a[40:41], v21 offset:8192
    ds_read_b64_tr_b16 a[42:43], v21 offset:8704
    s_waitcnt lgkmcnt(0)
    v_mfma_f32_16x16x32_bf16 v[32:35], a[20:23], a[0:3], 0
    s_add_u32 m0, s51, 36864
    ds_read_b64_tr_b16 a[64:65], v24 offset:0
    v_mfma_f32_16x16x32_bf16 v[36:39], a[20:23], a[4:7], 0
    buffer_load_dwordx4 v7, s[20:23], s48 offen offset:0 lds
    ds_read_b64_tr_b16 a[66:67], v24 offset:512
    v_mfma_f32_16x16x32_bf16 v[128:131], a[20:23], a[16:19], 0
    ds_read_b64_tr_b16 a[68:69], v25 offset:0
    v_mfma_f32_16x16x32_bf16 v[40:43], a[20:23], a[8:11], 0
    ds_read_b64_tr_b16 a[70:71], v25 offset:512
    v_mfma_f32_16x16x32_bf16 v[44:47], a[20:23], a[12:15], 0
    ds_read_b128 a[44:47], v22 offset:0
    v_mfma_f32_16x16x32_bf16 v[60:63], a[24:27], a[12:15], 0
    buffer_load_dwordx4 v8, s[20:23], s48 offen offset:1024 lds
    ds_read_b128 a[48:51], v22 offset:2048
    v_mfma_f32_16x16x32_bf16 v[56:59], a[24:27], a[8:11], 0
    ds_read_b128 a[52:55], v22 offset:4096
    v_mfma_f32_16x16x32_bf16 v[52:55], a[24:27], a[4:7], 0
    ds_read_b128 a[56:59], v22 offset:6144
    v_mfma_f32_16x16x32_bf16 v[48:51], a[24:27], a[0:3], 0
    ds_read_b128 a[60:63], v23 offset:0
    v_mfma_f32_16x16x32_bf16 v[64:67], a[28:31], a[0:3], 0
    ds_read_b64_tr_b16 a[72:73], v24 offset:4096
    v_mfma_f32_16x16x32_bf16 v[68:71], a[28:31], a[4:7], 0
    buffer_load_dwordx4 v9, s[20:23], s48 offen offset:2048 lds
    ds_read_b64_tr_b16 a[74:75], v24 offset:4608
    v_mfma_f32_16x16x32_bf16 v[132:135], a[28:31], a[16:19], 0
    ds_read_b64_tr_b16 a[76:77], v25 offset:4096
    v_mfma_f32_16x16x32_bf16 v[72:75], a[28:31], a[8:11], 0
    ds_read_b64_tr_b16 a[78:79], v25 offset:4608
    v_mfma_f32_16x16x32_bf16 v[76:79], a[28:31], a[12:15], 0
    ds_read_b64_tr_b16 a[80:81], v24 offset:8192
    v_mfma_f32_16x16x32_bf16 v[92:95], a[32:35], a[12:15], 0
    ds_read_b64_tr_b16 a[82:83], v24 offset:8704
    v_mfma_f32_16x16x32_bf16 v[88:91], a[32:35], a[8:11], 0
    buffer_load_dwordx4 v10, s[20:23], s48 offen offset:3072 lds
    ds_read_b64_tr_b16 a[84:85], v25 offset:8192
    v_mfma_f32_16x16x32_bf16 v[84:87], a[32:35], a[4:7], 0
    ds_read_b64_tr_b16 a[86:87], v25 offset:8704
    v_mfma_f32_16x16x32_bf16 v[80:83], a[32:35], a[0:3], 0
    v_mfma_f32_16x16x32_bf16 v[96:99], a[0:3], a[36:39], 0
    v_mfma_f32_16x16x32_bf16 v[100:103], a[4:7], a[36:39], 0
    s_add_u32 m0, s53, 53248
    v_mfma_f32_16x16x32_bf16 v[136:139], a[16:19], a[36:39], 0
    s_mov_b64 exec, s[54:55]
    buffer_load_dwordx4 v11, s[20:23], s48 offen lds
    s_mov_b64 exec, -1
    v_mfma_f32_16x16x32_bf16 v[104:107], a[8:11], a[36:39], 0
    v_mfma_f32_16x16x32_bf16 v[108:111], a[12:15], a[36:39], 0
    v_mfma_f32_16x16x32_bf16 v[124:127], a[12:15], a[40:43], 0
    v_mfma_f32_16x16x32_bf16 v[120:123], a[8:11], a[40:43], 0
    v_mfma_f32_16x16x32_bf16 v[116:119], a[4:7], a[40:43], 0
    v_mfma_f32_16x16x32_bf16 v[112:115], a[0:3], a[40:43], 0
    s_waitcnt vmcnt(11) lgkmcnt(0)
    s_barrier
    v_mfma_f32_16x16x32_bf16 v[32:35], a[64:67], a[44:47], v[32:35]
    ds_read_b64_tr_b16 a[20:21], v20 offset:24576
    v_mfma_f32_16x16x32_bf16 v[36:39], a[64:67], a[48:51], v[36:39]
    ds_read_b64_tr_b16 a[22:23], v20 offset:25088
    v_mfma_f32_16x16x32_bf16 v[128:131], a[64:67], a[60:63], v[128:131]
    s_cmp_eq_u32 s61, 3
    s_cselect_b32 s67, 7, 3
    v_mfma_f32_16x16x32_bf16 v[40:43], a[64:67], a[52:55], v[40:43]
    s_add_u32 s67, s67, s60
    s_and_b32 s67, s67, 15
    v_mfma_f32_16x16x32_bf16 v[44:47], a[64:67], a[56:59], v[44:47]
    s_lshl_b32 s48, s67, 7
    s_mul_i32 s49, s67, 393216
    v_mfma_f32_16x16x32_bf16 v[60:63], a[68:71], a[56:59], v[60:63]
    s_add_u32 m0, s52, 55296
    ds_read_b64_tr_b16 a[24:25], v21 offset:24576
    v_mfma_f32_16x16x32_bf16 v[56:59], a[68:71], a[52:55], v[56:59]
    buffer_load_dwordx4 v12, s[24:27], s49 offen offset:0 lds
    buffer_load_dwordx4 v13, s[24:27], s49 offen offset:1024 lds
    v_mfma_f32_16x16x32_bf16 v[52:55], a[68:71], a[48:51], v[52:55]
    ds_read_b64_tr_b16 a[26:27], v21 offset:25088
    ds_read_b128 a[0:3], v18 offset:18432
    v_mfma_f32_16x16x32_bf16 v[48:51], a[68:71], a[44:47], v[48:51]
    ds_read_b128 a[4:7], v18 offset:20480
    ds_read_b128 a[8:11], v18 offset:22528
    v_mfma_f32_16x16x32_bf16 v[64:67], a[72:75], a[44:47], v[64:67]
    s_add_u32 m0, s52, 59392
    ds_read_b128 a[12:15], v18 offset:24576
    v_mfma_f32_16x16x32_bf16 v[68:71], a[72:75], a[48:51], v[68:71]
    buffer_load_dwordx4 v14, s[24:27], s49 offen offset:0 lds
    ds_read_b128 a[16:19], v19 offset:18432
    v_mfma_f32_16x16x32_bf16 v[132:135], a[72:75], a[60:63], v[132:135]
    ds_read_b64_tr_b16 a[28:29], v20 offset:28672
    ds_read_b64_tr_b16 a[30:31], v20 offset:29184
    v_mfma_f32_16x16x32_bf16 v[72:75], a[72:75], a[52:55], v[72:75]
    ds_read_b64_tr_b16 a[32:33], v21 offset:28672
    ds_read_b64_tr_b16 a[34:35], v21 offset:29184
    v_mfma_f32_16x16x32_bf16 v[76:79], a[72:75], a[56:59], v[76:79]
    ds_read_b64_tr_b16 a[36:37], v20 offset:32768
    v_mfma_f32_16x16x32_bf16 v[92:95], a[76:79], a[56:59], v[92:95]
    buffer_load_dwordx4 v15, s[24:27], s49 offen offset:1024 lds
    ds_read_b64_tr_b16 a[38:39], v20 offset:33280
    v_mfma_f32_16x16x32_bf16 v[88:91], a[76:79], a[52:55], v[88:91]
    ds_read_b64_tr_b16 a[40:41], v21 offset:32768
    v_mfma_f32_16x16x32_bf16 v[84:87], a[76:79], a[48:51], v[84:87]
    ds_read_b64_tr_b16 a[42:43], v21 offset:33280
    v_mfma_f32_16x16x32_bf16 v[80:83], a[76:79], a[44:47], v[80:83]
    s_add_u32 m0, s52, 63488
    v_mfma_f32_16x16x32_bf16 v[96:99], a[44:47], a[80:83], v[96:99]
    buffer_load_dwordx4 v16, s[24:27], s49 offen offset:0 lds
    v_mfma_f32_16x16x32_bf16 v[100:103], a[48:51], a[80:83], v[100:103]
    v_mfma_f32_16x16x32_bf16 v[136:139], a[60:63], a[80:83], v[136:139]
    v_mfma_f32_16x16x32_bf16 v[104:107], a[52:55], a[80:83], v[104:107]
    v_mfma_f32_16x16x32_bf16 v[108:111], a[56:59], a[80:83], v[108:111]
    buffer_load_dwordx4 v17, s[24:27], s49 offen offset:1024 lds
    v_mfma_f32_16x16x32_bf16 v[124:127], a[56:59], a[84:87], v[124:127]
    v_mfma_f32_16x16x32_bf16 v[120:123], a[52:55], a[84:87], v[120:123]
    v_mfma_f32_16x16x32_bf16 v[116:119], a[48:51], a[84:87], v[116:119]
    v_mfma_f32_16x16x32_bf16 v[112:115], a[44:47], a[84:87], v[112:115]
    s_waitcnt lgkmcnt(0)
    v_mfma_f32_16x16x32_bf16 v[32:35], a[20:23], a[0:3], v[32:35]
    s_add_u32 m0, s51, 0
    ds_read_b64_tr_b16 a[64:65], v24 offset:24576
    v_mfma_f32_16x16x32_bf16 v[36:39], a[20:23], a[4:7], v[36:39]
    buffer_load_dwordx4 v7, s[20:23], s48 offen offset:0 lds
    ds_read_b64_tr_b16 a[66:67], v24 offset:25088
    v_mfma_f32_16x16x32_bf16 v[128:131], a[20:23], a[16:19], v[128:131]
    ds_read_b64_tr_b16 a[68:69], v25 offset:24576
    v_mfma_f32_16x16x32_bf16 v[40:43], a[20:23], a[8:11], v[40:43]
    buffer_load_dwordx4 v8, s[20:23], s48 offen offset:1024 lds
    ds_read_b64_tr_b16 a[70:71], v25 offset:25088
    v_mfma_f32_16x16x32_bf16 v[44:47], a[20:23], a[12:15], v[44:47]
    ds_read_b128 a[44:47], v22 offset:18432
    v_mfma_f32_16x16x32_bf16 v[60:63], a[24:27], a[12:15], v[60:63]
    ds_read_b128 a[48:51], v22 offset:20480
    v_mfma_f32_16x16x32_bf16 v[56:59], a[24:27], a[8:11], v[56:59]
    buffer_load_dwordx4 v9, s[20:23], s48 offen offset:2048 lds
    ds_read_b128 a[52:55], v22 offset:22528
    v_mfma_f32_16x16x32_bf16 v[52:55], a[24:27], a[4:7], v[52:55]
    ds_read_b128 a[56:59], v22 offset:24576
    v_mfma_f32_16x16x32_bf16 v[48:51], a[24:27], a[0:3], v[48:51]
    ds_read_b128 a[60:63], v23 offset:18432
    v_mfma_f32_16x16x32_bf16 v[64:67], a[28:31], a[0:3], v[64:67]
    buffer_load_dwordx4 v10, s[20:23], s48 offen offset:3072 lds
    ds_read_b64_tr_b16 a[72:73], v24 offset:28672
    v_mfma_f32_16x16x32_bf16 v[68:71], a[28:31], a[4:7], v[68:71]
    ds_read_b64_tr_b16 a[74:75], v24 offset:29184
    v_mfma_f32_16x16x32_bf16 v[132:135], a[28:31], a[16:19], v[132:135]
    ds_read_b64_tr_b16 a[76:77], v25 offset:28672
    v_mfma_f32_16x16x32_bf16 v[72:75], a[28:31], a[8:11], v[72:75]
    s_add_u32 m0, s53, 16384
    ds_read_b64_tr_b16 a[78:79], v25 offset:29184
    v_mfma_f32_16x16x32_bf16 v[76:79], a[28:31], a[12:15], v[76:79]
    s_mov_b64 exec, s[54:55]
    buffer_load_dwordx4 v11, s[20:23], s48 offen lds
    s_mov_b64 exec, -1
    v_mfma_f32_16x16x32_bf16 v[92:95], a[32:35], a[12:15], v[92:95]
    ds_read_b64_tr_b16 a[80:81], v24 offset:32768
    v_mfma_f32_16x16x32_bf16 v[88:91], a[32:35], a[8:11], v[88:91]
    ds_read_b64_tr_b16 a[82:83], v24 offset:33280
    ds_read_b64_tr_b16 a[84:85], v25 offset:32768
    v_mfma_f32_16x16x32_bf16 v[84:87], a[32:35], a[4:7], v[84:87]
    buffer_load_dwordx4 v[152:155], v2, s[20:23], s68 offen offset:0
    ds_read_b64_tr_b16 a[86:87], v25 offset:33280
    v_mfma_f32_16x16x32_bf16 v[80:83], a[32:35], a[0:3], v[80:83]
    v_mfma_f32_16x16x32_bf16 v[96:99], a[0:3], a[36:39], v[96:99]
    v_mfma_f32_16x16x32_bf16 v[100:103], a[4:7], a[36:39], v[100:103]
    buffer_load_dwordx4 v[156:159], v2, s[20:23], s68 offen offset:1024
    v_mfma_f32_16x16x32_bf16 v[136:139], a[16:19], a[36:39], v[136:139]
    v_mfma_f32_16x16x32_bf16 v[104:107], a[8:11], a[36:39], v[104:107]
    v_mfma_f32_16x16x32_bf16 v[108:111], a[12:15], a[36:39], v[108:111]
    buffer_load_dwordx4 v[160:163], v2, s[20:23], s68 offen offset:2048
    v_mfma_f32_16x16x32_bf16 v[124:127], a[12:15], a[40:43], v[124:127]
    v_mfma_f32_16x16x32_bf16 v[120:123], a[8:11], a[40:43], v[120:123]
    v_mfma_f32_16x16x32_bf16 v[116:119], a[4:7], a[40:43], v[116:119]
    v_mfma_f32_16x16x32_bf16 v[112:115], a[0:3], a[40:43], v[112:115]
    s_waitcnt vmcnt(14) lgkmcnt(0)
    s_barrier
    v_mfma_f32_16x16x32_bf16 v[32:35], a[64:67], a[44:47], v[32:35]
    ds_read_b64_tr_b16 a[20:21], v20 offset:49152
    v_mfma_f32_16x16x32_bf16 v[36:39], a[64:67], a[48:51], v[36:39]
    ds_read_b64_tr_b16 a[22:23], v20 offset:49664
    v_mfma_f32_16x16x32_bf16 v[128:131], a[64:67], a[60:63], v[128:131]
    s_cmp_eq_u32 s61, 0
    s_cselect_b32 s67, 8, 4
    v_mfma_f32_16x16x32_bf16 v[40:43], a[64:67], a[52:55], v[40:43]
    s_add_u32 s67, s67, s60
    s_and_b32 s67, s67, 15
    v_mfma_f32_16x16x32_bf16 v[44:47], a[64:67], a[56:59], v[44:47]
    s_lshl_b32 s48, s67, 7
    s_mul_i32 s49, s67, 393216
    v_mfma_f32_16x16x32_bf16 v[60:63], a[68:71], a[56:59], v[60:63]
    s_add_u32 m0, s52, 79872
    ds_read_b64_tr_b16 a[24:25], v21 offset:49152
    v_mfma_f32_16x16x32_bf16 v[56:59], a[68:71], a[52:55], v[56:59]
    buffer_load_dwordx4 v12, s[24:27], s49 offen offset:0 lds
    buffer_load_dwordx4 v13, s[24:27], s49 offen offset:1024 lds
    v_mfma_f32_16x16x32_bf16 v[52:55], a[68:71], a[48:51], v[52:55]
    s_add_u32 m0, s52, 83968
    ds_read_b64_tr_b16 a[26:27], v21 offset:49664
    v_mfma_f32_16x16x32_bf16 v[48:51], a[68:71], a[44:47], v[48:51]
    buffer_load_dwordx4 v14, s[24:27], s49 offen offset:0 lds
    ds_read_b128 a[0:3], v18 offset:36864
    v_mfma_f32_16x16x32_bf16 v[64:67], a[72:75], a[44:47], v[64:67]
    buffer_load_dwordx4 v15, s[24:27], s49 offen offset:1024 lds
    ds_read_b128 a[4:7], v18 offset:38912
    v_mfma_f32_16x16x32_bf16 v[68:71], a[72:75], a[48:51], v[68:71]
    ds_read_b128 a[8:11], v18 offset:40960
    ds_read_b128 a[12:15], v18 offset:43008
    v_mfma_f32_16x16x32_bf16 v[132:135], a[72:75], a[60:63], v[132:135]
    s_add_u32 m0, s52, 88064
    ds_read_b128 a[16:19], v19 offset:36864
    v_mfma_f32_16x16x32_bf16 v[72:75], a[72:75], a[52:55], v[72:75]
    buffer_load_dwordx4 v16, s[24:27], s49 offen offset:0 lds
    ds_read_b64_tr_b16 a[28:29], v20 offset:53248
    v_mfma_f32_16x16x32_bf16 v[76:79], a[72:75], a[56:59], v[76:79]
    ds_read_b64_tr_b16 a[30:31], v20 offset:53760
    ds_read_b64_tr_b16 a[32:33], v21 offset:53248
    v_mfma_f32_16x16x32_bf16 v[92:95], a[76:79], a[56:59], v[92:95]
    buffer_load_dwordx4 v17, s[24:27], s49 offen offset:1024 lds
    ds_read_b64_tr_b16 a[34:35], v21 offset:53760
    v_mfma_f32_16x16x32_bf16 v[88:91], a[76:79], a[52:55], v[88:91]
    ds_read_b64_tr_b16 a[36:37], v20 offset:57344
    ds_read_b64_tr_b16 a[38:39], v20 offset:57856
    v_mfma_f32_16x16x32_bf16 v[84:87], a[76:79], a[48:51], v[84:87]
    buffer_load_dwordx4 v[164:167], v2, s[20:23], s68 offen offset:3072
    ds_read_b64_tr_b16 a[40:41], v21 offset:57344
    v_mfma_f32_16x16x32_bf16 v[80:83], a[76:79], a[44:47], v[80:83]
    ds_read_b64_tr_b16 a[42:43], v21 offset:57856
    v_mfma_f32_16x16x32_bf16 v[96:99], a[44:47], a[80:83], v[96:99]
    v_mfma_f32_16x16x32_bf16 v[100:103], a[48:51], a[80:83], v[100:103]
    buffer_load_dwordx4 v[168:171], v2, s[36:39], s50 offen offset:0
    v_mfma_f32_16x16x32_bf16 v[136:139], a[60:63], a[80:83], v[136:139]
    v_mfma_f32_16x16x32_bf16 v[104:107], a[52:55], a[80:83], v[104:107]
    buffer_load_dwordx4 v[172:175], v2, s[36:39], s50 offen offset:1024
    v_mfma_f32_16x16x32_bf16 v[108:111], a[56:59], a[80:83], v[108:111]
    v_mfma_f32_16x16x32_bf16 v[124:127], a[56:59], a[84:87], v[124:127]
    buffer_load_dword v6, v3, s[40:43], 0 offen sc1
    v_mfma_f32_16x16x32_bf16 v[120:123], a[52:55], a[84:87], v[120:123]
    v_mfma_f32_16x16x32_bf16 v[116:119], a[48:51], a[84:87], v[116:119]
    v_mfma_f32_16x16x32_bf16 v[112:115], a[44:47], a[84:87], v[112:115]
    s_waitcnt lgkmcnt(0)
    v_mfma_f32_16x16x32_bf16 v[32:35], a[20:23], a[0:3], v[32:35]
    s_add_u32 m0, s51, 18432
    ds_read_b64_tr_b16 a[64:65], v24 offset:49152
    v_mfma_f32_16x16x32_bf16 v[36:39], a[20:23], a[4:7], v[36:39]
    buffer_load_dwordx4 v7, s[20:23], s48 offen offset:0 lds
    ds_read_b64_tr_b16 a[66:67], v24 offset:49664
    v_mfma_f32_16x16x32_bf16 v[128:131], a[20:23], a[16:19], v[128:131]
    ds_read_b64_tr_b16 a[68:69], v25 offset:49152
    v_mfma_f32_16x16x32_bf16 v[40:43], a[20:23], a[8:11], v[40:43]
    ds_read_b64_tr_b16 a[70:71], v25 offset:49664
    v_mfma_f32_16x16x32_bf16 v[44:47], a[20:23], a[12:15], v[44:47]
    ds_read_b128 a[44:47], v22 offset:36864
    v_mfma_f32_16x16x32_bf16 v[60:63], a[24:27], a[12:15], v[60:63]
    buffer_load_dwordx4 v8, s[20:23], s48 offen offset:1024 lds
    ds_read_b128 a[48:51], v22 offset:38912
    v_mfma_f32_16x16x32_bf16 v[56:59], a[24:27], a[8:11], v[56:59]
    ds_read_b128 a[52:55], v22 offset:40960
    v_mfma_f32_16x16x32_bf16 v[52:55], a[24:27], a[4:7], v[52:55]
    ds_read_b128 a[56:59], v22 offset:43008
    v_mfma_f32_16x16x32_bf16 v[48:51], a[24:27], a[0:3], v[48:51]
    ds_read_b128 a[60:63], v23 offset:36864
    v_mfma_f32_16x16x32_bf16 v[64:67], a[28:31], a[0:3], v[64:67]
    ds_read_b64_tr_b16 a[72:73], v24 offset:53248
    v_mfma_f32_16x16x32_bf16 v[68:71], a[28:31], a[4:7], v[68:71]
    buffer_load_dwordx4 v9, s[20:23], s48 offen offset:2048 lds
    ds_read_b64_tr_b16 a[74:75], v24 offset:53760
    v_mfma_f32_16x16x32_bf16 v[132:135], a[28:31], a[16:19], v[132:135]
    ds_read_b64_tr_b16 a[76:77], v25 offset:53248
    v_mfma_f32_16x16x32_bf16 v[72:75], a[28:31], a[8:11], v[72:75]
    ds_read_b64_tr_b16 a[78:79], v25 offset:53760
    v_mfma_f32_16x16x32_bf16 v[76:79], a[28:31], a[12:15], v[76:79]
    ds_read_b64_tr_b16 a[80:81], v24 offset:57344
    v_mfma_f32_16x16x32_bf16 v[92:95], a[32:35], a[12:15], v[92:95]
    ds_read_b64_tr_b16 a[82:83], v24 offset:57856
    v_mfma_f32_16x16x32_bf16 v[88:91], a[32:35], a[8:11], v[88:91]
    buffer_load_dwordx4 v10, s[20:23], s48 offen offset:3072 lds
    ds_read_b64_tr_b16 a[84:85], v25 offset:57344
    v_mfma_f32_16x16x32_bf16 v[84:87], a[32:35], a[4:7], v[84:87]
    ds_read_b64_tr_b16 a[86:87], v25 offset:57856
    v_mfma_f32_16x16x32_bf16 v[80:83], a[32:35], a[0:3], v[80:83]
    v_mfma_f32_16x16x32_bf16 v[96:99], a[0:3], a[36:39], v[96:99]
    v_mfma_f32_16x16x32_bf16 v[100:103], a[4:7], a[36:39], v[100:103]
    s_add_u32 m0, s53, 34816
    v_mfma_f32_16x16x32_bf16 v[136:139], a[16:19], a[36:39], v[136:139]
    s_mov_b64 exec, s[54:55]
    buffer_load_dwordx4 v11, s[20:23], s48 offen lds
    s_mov_b64 exec, -1
    v_mfma_f32_16x16x32_bf16 v[104:107], a[8:11], a[36:39], v[104:107]
    v_mfma_f32_16x16x32_bf16 v[108:111], a[12:15], a[36:39], v[108:111]
    v_mfma_f32_16x16x32_bf16 v[124:127], a[12:15], a[40:43], v[124:127]
    v_mfma_f32_16x16x32_bf16 v[120:123], a[8:11], a[40:43], v[120:123]
    v_mfma_f32_16x16x32_bf16 v[116:119], a[4:7], a[40:43], v[116:119]
    v_mfma_f32_16x16x32_bf16 v[112:115], a[0:3], a[40:43], v[112:115]
    s_waitcnt vmcnt(18) lgkmcnt(0)
    s_barrier
    s_cmp_lg_u32 s44, 3
    s_cbranch_scc1 L_p1_nopf2_0
    buffer_load_dword a248, v236, s[32:35], 0 offen
L_p1_nopf2_0:
    v_mfma_f32_16x16x32_bf16 v[32:35], a[64:67], a[44:47], v[32:35]
    ds_read_b64_tr_b16 a[20:21], v20 offset:0
    v_mfma_f32_16x16x32_bf16 v[36:39], a[64:67], a[48:51], v[36:39]
    ds_read_b64_tr_b16 a[22:23], v20 offset:512
    v_mfma_f32_16x16x32_bf16 v[128:131], a[64:67], a[60:63], v[128:131]
    s_cmp_eq_u32 s61, 1
    s_cselect_b32 s67, 9, 5
    v_mfma_f32_16x16x32_bf16 v[40:43], a[64:67], a[52:55], v[40:43]
    s_add_u32 s67, s67, s60
    s_and_b32 s67, s67, 15
    v_mfma_f32_16x16x32_bf16 v[44:47], a[64:67], a[56:59], v[44:47]
    s_lshl_b32 s48, s67, 7
    s_mul_i32 s49, s67, 393216
    v_mfma_f32_16x16x32_bf16 v[60:63], a[68:71], a[56:59], v[60:63]
    s_add_u32 m0, s52, 104448
    ds_read_b64_tr_b16 a[24:25], v21 offset:0
    v_mfma_f32_16x16x32_bf16 v[56:59], a[68:71], a[52:55], v[56:59]
    buffer_load_dwordx4 v12, s[24:27], s49 offen offset:0 lds
    buffer_load_dwordx4 v13, s[24:27], s49 offen offset:1024 lds
    v_mfma_f32_16x16x32_bf16 v[52:55], a[68:71], a[48:51], v[52:55]
    ds_read_b64_tr_b16 a[26:27], v21 offset:512
    ds_read_b128 a[0:3], v18 offset:0
    v_mfma_f32_16x16x32_bf16 v[48:51], a[68:71], a[44:47], v[48:51]
    ds_read_b128 a[4:7], v18 offset:2048
    ds_read_b128 a[8:11], v18 offset:4096
    v_mfma_f32_16x16x32_bf16 v[64:67], a[72:75], a[44:47], v[64:67]
    s_add_u32 m0, s52, 108544
    ds_read_b128 a[12:15], v18 offset:6144
    v_mfma_f32_16x16x32_bf16 v[68:71], a[72:75], a[48:51], v[68:71]
    buffer_load_dwordx4 v14, s[24:27], s49 offen offset:0 lds
    ds_read_b128 a[16:19], v19 offset:0
    v_mfma_f32_16x16x32_bf16 v[132:135], a[72:75], a[60:63], v[132:135]
    ds_read_b64_tr_b16 a[28:29], v20 offset:4096
    ds_read_b64_tr_b16 a[30:31], v20 offset:4608
    v_mfma_f32_16x16x32_bf16 v[72:75], a[72:75], a[52:55], v[72:75]
    ds_read_b64_tr_b16 a[32:33], v21 offset:4096
    ds_read_b64_tr_b16 a[34:35], v21 offset:4608
    v_mfma_f32_16x16x32_bf16 v[76:79], a[72:75], a[56:59], v[76:79]
    ds_read_b64_tr_b16 a[36:37], v20 offset:8192
    v_mfma_f32_16x16x32_bf16 v[92:95], a[76:79], a[56:59], v[92:95]
    buffer_load_dwordx4 v15, s[24:27], s49 offen offset:1024 lds
    ds_read_b64_tr_b16 a[38:39], v20 offset:8704
    v_mfma_f32_16x16x32_bf16 v[88:91], a[76:79], a[52:55], v[88:91]
    ds_read_b64_tr_b16 a[40:41], v21 offset:8192
    v_mfma_f32_16x16x32_bf16 v[84:87], a[76:79], a[48:51], v[84:87]
    ds_read_b64_tr_b16 a[42:43], v21 offset:8704
    v_mfma_f32_16x16x32_bf16 v[80:83], a[76:79], a[44:47], v[80:83]
    s_add_u32 m0, s52, 112640
    v_mfma_f32_16x16x32_bf16 v[96:99], a[44:47], a[80:83], v[96:99]
    buffer_load_dwordx4 v16, s[24:27], s49 offen offset:0 lds
    v_mfma_f32_16x16x32_bf16 v[100:103], a[48:51], a[80:83], v[100:103]
    v_mfma_f32_16x16x32_bf16 v[136:139], a[60:63], a[80:83], v[136:139]
    v_mfma_f32_16x16x32_bf16 v[104:107], a[52:55], a[80:83], v[104:107]
    v_mfma_f32_16x16x32_bf16 v[108:111], a[56:59], a[80:83], v[108:111]
    buffer_load_dwordx4 v17, s[24:27], s49 offen offset:1024 lds
    v_mfma_f32_16x16x32_bf16 v[124:127], a[56:59], a[84:87], v[124:127]
    v_mfma_f32_16x16x32_bf16 v[120:123], a[52:55], a[84:87], v[120:123]
    v_mfma_f32_16x16x32_bf16 v[116:119], a[48:51], a[84:87], v[116:119]
    v_mfma_f32_16x16x32_bf16 v[112:115], a[44:47], a[84:87], v[112:115]
    s_waitcnt lgkmcnt(0)
    v_mfma_f32_16x16x32_bf16 v[32:35], a[20:23], a[0:3], v[32:35]
    s_add_u32 m0, s51, 36864
    ds_read_b64_tr_b16 a[64:65], v24 offset:0
    v_mfma_f32_16x16x32_bf16 v[36:39], a[20:23], a[4:7], v[36:39]
    buffer_load_dwordx4 v7, s[20:23], s48 offen offset:0 lds
    ds_read_b64_tr_b16 a[66:67], v24 offset:512
    v_mfma_f32_16x16x32_bf16 v[128:131], a[20:23], a[16:19], v[128:131]
    ds_read_b64_tr_b16 a[68:69], v25 offset:0
    v_mfma_f32_16x16x32_bf16 v[40:43], a[20:23], a[8:11], v[40:43]
    ds_read_b64_tr_b16 a[70:71], v25 offset:512
    v_mfma_f32_16x16x32_bf16 v[44:47], a[20:23], a[12:15], v[44:47]
    ds_read_b128 a[44:47], v22 offset:0
    v_mfma_f32_16x16x32_bf16 v[60:63], a[24:27], a[12:15], v[60:63]
    buffer_load_dwordx4 v8, s[20:23], s48 offen offset:1024 lds
    ds_read_b128 a[48:51], v22 offset:2048
    v_mfma_f32_16x16x32_bf16 v[56:59], a[24:27], a[8:11], v[56:59]
    ds_read_b128 a[52:55], v22 offset:4096
    v_mfma_f32_16x16x32_bf16 v[52:55], a[24:27], a[4:7], v[52:55]
    ds_read_b128 a[56:59], v22 offset:6144
    v_mfma_f32_16x16x32_bf16 v[48:51], a[24:27], a[0:3], v[48:51]
    ds_read_b128 a[60:63], v23 offset:0
    v_mfma_f32_16x16x32_bf16 v[64:67], a[28:31], a[0:3], v[64:67]
    ds_read_b64_tr_b16 a[72:73], v24 offset:4096
    v_mfma_f32_16x16x32_bf16 v[68:71], a[28:31], a[4:7], v[68:71]
    buffer_load_dwordx4 v9, s[20:23], s48 offen offset:2048 lds
    ds_read_b64_tr_b16 a[74:75], v24 offset:4608
    v_mfma_f32_16x16x32_bf16 v[132:135], a[28:31], a[16:19], v[132:135]
    ds_read_b64_tr_b16 a[76:77], v25 offset:4096
    v_mfma_f32_16x16x32_bf16 v[72:75], a[28:31], a[8:11], v[72:75]
    ds_read_b64_tr_b16 a[78:79], v25 offset:4608
    v_mfma_f32_16x16x32_bf16 v[76:79], a[28:31], a[12:15], v[76:79]
    ds_read_b64_tr_b16 a[80:81], v24 offset:8192
    v_mfma_f32_16x16x32_bf16 v[92:95], a[32:35], a[12:15], v[92:95]
    ds_read_b64_tr_b16 a[82:83], v24 offset:8704
    v_mfma_f32_16x16x32_bf16 v[88:91], a[32:35], a[8:11], v[88:91]
    buffer_load_dwordx4 v10, s[20:23], s48 offen offset:3072 lds
    ds_read_b64_tr_b16 a[84:85], v25 offset:8192
    v_mfma_f32_16x16x32_bf16 v[84:87], a[32:35], a[4:7], v[84:87]
    ds_read_b64_tr_b16 a[86:87], v25 offset:8704
    v_mfma_f32_16x16x32_bf16 v[80:83], a[32:35], a[0:3], v[80:83]
    v_mfma_f32_16x16x32_bf16 v[96:99], a[0:3], a[36:39], v[96:99]
    v_mfma_f32_16x16x32_bf16 v[100:103], a[4:7], a[36:39], v[100:103]
    s_add_u32 m0, s53, 53248
    v_mfma_f32_16x16x32_bf16 v[136:139], a[16:19], a[36:39], v[136:139]
    s_mov_b64 exec, s[54:55]
    buffer_load_dwordx4 v11, s[20:23], s48 offen lds
    s_mov_b64 exec, -1
    v_mfma_f32_16x16x32_bf16 v[104:107], a[8:11], a[36:39], v[104:107]
    v_mfma_f32_16x16x32_bf16 v[108:111], a[12:15], a[36:39], v[108:111]
    v_mfma_f32_16x16x32_bf16 v[124:127], a[12:15], a[40:43], v[124:127]
    v_mfma_f32_16x16x32_bf16 v[120:123], a[8:11], a[40:43], v[120:123]
    v_mfma_f32_16x16x32_bf16 v[116:119], a[4:7], a[40:43], v[116:119]
    v_mfma_f32_16x16x32_bf16 v[112:115], a[0:3], a[40:43], v[112:115]
    s_waitcnt vmcnt(11) lgkmcnt(0)
    s_mov_b32 s17, 0x40000
L_p1_tag:
    v_readfirstlane_b32 s100, v6
    s_nop 0
    s_cmp_lg_u32 s100, 0
    s_cbranch_scc1 L_p1_tagok
    buffer_load_dword v6, v3, s[40:43], 0 offen sc1
    s_waitcnt vmcnt(0)
    s_sub_u32 s17, s17, 1
    s_cmp_lg_u32 s17, 0
    s_cbranch_scc1 L_p1_tag
L_p1_tagok:
    s_barrier
    s_cmp_lg_u32 s44, 4
    s_cbranch_scc1 L_p1_nopf3_0
    buffer_load_dword a248, v236, s[32:35], 0 offen
L_p1_nopf3_0:
    v_mfma_f32_16x16x32_bf16 v[32:35], a[64:67], a[44:47], v[32:35]
    ds_read_b64_tr_b16 a[20:21], v20 offset:24576
    v_mfma_f32_16x16x32_bf16 v[208:211], v[28:31], v[152:155], 0
    v_mfma_f32_16x16x32_bf16 v[36:39], a[64:67], a[48:51], v[36:39]
    ds_read_b64_tr_b16 a[22:23], v20 offset:25088
    v_mfma_f32_16x16x32_bf16 v[216:219], v[152:155], v[152:155], 0
    v_mfma_f32_16x16x32_bf16 v[128:131], a[64:67], a[60:63], v[128:131]
    s_cmp_eq_u32 s61, 2
    s_cselect_b32 s67, 10, 6
    v_mfma_f32_16x16x32_bf16 v[40:43], a[64:67], a[52:55], v[40:43]
    s_add_u32 s67, s67, s60
    s_and_b32 s67, s67, 15
    v_mfma_f32_16x16x32_bf16 v[44:47], a[64:67], a[56:59], v[44:47]
    s_lshl_b32 s48, s67, 7
    s_mul_i32 s49, s67, 393216
    v_mfma_f32_16x16x32_bf16 v[60:63], a[68:71], a[56:59], v[60:63]
    s_add_u32 m0, s52, 55296
    ds_read_b64_tr_b16 a[24:25], v21 offset:24576
    v_mfma_f32_16x16x32_bf16 v[56:59], a[68:71], a[52:55], v[56:59]
    buffer_load_dwordx4 v12, s[24:27], s49 offen offset:0 lds
    buffer_load_dwordx4 v13, s[24:27], s49 offen offset:1024 lds
    v_mfma_f32_16x16x32_bf16 v[52:55], a[68:71], a[48:51], v[52:55]
    ds_read_b64_tr_b16 a[26:27], v21 offset:25088
    ds_read_b128 a[0:3], v18 offset:18432
    v_mfma_f32_16x16x32_bf16 v[48:51], a[68:71], a[44:47], v[48:51]
    ds_read_b128 a[4:7], v18 offset:20480
    ds_read_b128 a[8:11], v18 offset:22528
    v_mfma_f32_16x16x32_bf16 v[64:67], a[72:75], a[44:47], v[64:67]
    s_add_u32 m0, s52, 59392
    ds_read_b128 a[12:15], v18 offset:24576
    v_mfma_f32_16x16x32_bf16 v[68:71], a[72:75], a[48:51], v[68:71]
    buffer_load_dwordx4 v14, s[24:27], s49 offen offset:0 lds
    ds_read_b128 a[16:19], v19 offset:18432
    v_mfma_f32_16x16x32_bf16 v[132:135], a[72:75], a[60:63], v[132:135]
    ds_read_b64_tr_b16 a[28:29], v20 offset:28672
    ds_read_b64_tr_b16 a[30:31], v20 offset:29184
    v_mfma_f32_16x16x32_bf16 v[72:75], a[72:75], a[52:55], v[72:75]
    ds_read_b64_tr_b16 a[32:33], v21 offset:28672
    ds_read_b64_tr_b16 a[34:35], v21 offset:29184
    v_mfma_f32_16x16x32_bf16 v[76:79], a[72:75], a[56:59], v[76:79]
    ds_read_b64_tr_b16 a[36:37], v20 offset:32768
    v_mfma_f32_16x16x32_bf16 v[212:215], v[28:31], v[160:163], 0
    v_mfma_f32_16x16x32_bf16 v[92:95], a[76:79], a[56:59], v[92:95]
    buffer_load_dwordx4 v15, s[24:27], s49 offen offset:1024 lds
    ds_read_b64_tr_b16 a[38:39], v20 offset:33280
    v_mfma_f32_16x16x32_bf16 v[88:91], a[76:79], a[52:55], v[88:91]
    ds_read_b64_tr_b16 a[40:41], v21 offset:32768
    v_mfma_f32_16x16x32_bf16 v[220:223], v[160:163], v[160:163], 0
    v_mfma_f32_16x16x32_bf16 v[84:87], a[76:79], a[48:51], v[84:87]
    ds_read_b64_tr_b16 a[42:43], v21 offset:33280
    v_mfma_f32_16x16x32_bf16 v[224:227], v[28:31], v[168:171], 0
    v_mfma_f32_16x16x32_bf16 v[80:83], a[76:79], a[44:47], v[80:83]
    s_add_u32 m0, s52, 63488
    v_mfma_f32_16x16x32_bf16 v[208:211], v[28:31], v[156:159], v[208:211]
    v_mfma_f32_16x16x32_bf16 v[96:99], a[44:47], a[80:83], v[96:99]
    buffer_load_dwordx4 v16, s[24:27], s49 offen offset:0 lds
    v_mfma_f32_16x16x32_bf16 v[216:219], v[156:159], v[156:159], v[216:219]
    v_mfma_f32_16x16x32_bf16 v[100:103], a[48:51], a[80:83], v[100:103]
    v_mfma_f32_16x16x32_bf16 v[212:215], v[28:31], v[164:167], v[212:215]
    v_mfma_f32_16x16x32_bf16 v[220:223], v[164:167], v[164:167], v[220:223]
    v_mfma_f32_16x16x32_bf16 v[136:139], a[60:63], a[80:83], v[136:139]
    v_mfma_f32_16x16x32_bf16 v[224:227], v[28:31], v[172:175], v[224:227]
    s_nop 0
    v_mfma_f32_16x16x32_bf16 v[104:107], a[52:55], a[80:83], v[104:107]
    s_nop 0
    s_nop 0
    v_mfma_f32_16x16x32_bf16 v[108:111], a[56:59], a[80:83], v[108:111]
    buffer_load_dwordx4 v17, s[24:27], s49 offen offset:1024 lds
    s_nop 0
    v_mfma_f32_16x16x32_bf16 v[124:127], a[56:59], a[84:87], v[124:127]
    s_nop 0
    s_nop 0
    v_mfma_f32_16x16x32_bf16 v[120:123], a[52:55], a[84:87], v[120:123]
    v_mov_b32 v140, v208
    v_mov_b32 v141, v212
    v_mfma_f32_16x16x32_bf16 v[116:119], a[48:51], a[84:87], v[116:119]
    v_mul_f32 v142, v216, v240
    v_mul_f32 v143, v220, v240
    v_mfma_f32_16x16x32_bf16 v[112:115], a[44:47], a[84:87], v[112:115]
    v_fmac_f32 v142, v217, v241
    v_fmac_f32 v143, v221, v241
    s_waitcnt lgkmcnt(0)
    v_mfma_f32_16x16x32_bf16 v[32:35], a[20:23], a[0:3], v[32:35]
    s_add_u32 m0, s51, 0
    ds_read_b64_tr_b16 a[64:65], v24 offset:24576
    v_mfma_f32_16x16x32_bf16 v[36:39], a[20:23], a[4:7], v[36:39]
    buffer_load_dwordx4 v7, s[20:23], s48 offen offset:0 lds
    ds_read_b64_tr_b16 a[66:67], v24 offset:25088
    v_mfma_f32_16x16x32_bf16 v[128:131], a[20:23], a[16:19], v[128:131]
    ds_read_b64_tr_b16 a[68:69], v25 offset:24576
    v_fmac_f32 v142, v218, v242
    v_mfma_f32_16x16x32_bf16 v[40:43], a[20:23], a[8:11], v[40:43]
    ds_read_b64_tr_b16 a[70:71], v25 offset:25088
    v_fmac_f32 v143, v222, v242
    v_mfma_f32_16x16x32_bf16 v[44:47], a[20:23], a[12:15], v[44:47]
    ds_read_b128 a[44:47], v22 offset:18432
    v_fmac_f32 v142, v219, v243
    v_mfma_f32_16x16x32_bf16 v[60:63], a[24:27], a[12:15], v[60:63]
    buffer_load_dwordx4 v8, s[20:23], s48 offen offset:1024 lds
    ds_read_b128 a[48:51], v22 offset:20480
    v_mfma_f32_16x16x32_bf16 v[56:59], a[24:27], a[8:11], v[56:59]
    ds_read_b128 a[52:55], v22 offset:22528
    v_fmac_f32 v143, v223, v243
    v_mfma_f32_16x16x32_bf16 v[52:55], a[24:27], a[4:7], v[52:55]
    ds_read_b128 a[56:59], v22 offset:24576
    v_mov_b32 v144, v224
    v_mfma_f32_16x16x32_bf16 v[48:51], a[24:27], a[0:3], v[48:51]
    ds_read_b128 a[60:63], v23 offset:18432
    v_add_f32_dpp v140, v140, v140 row_ror:1 row_mask:0xf bank_mask:0xf
    v_mfma_f32_16x16x32_bf16 v[64:67], a[28:31], a[0:3], v[64:67]
    ds_read_b64_tr_b16 a[72:73], v24 offset:28672
    v_add_f32_dpp v141, v141, v141 row_ror:1 row_mask:0xf bank_mask:0xf
    v_mfma_f32_16x16x32_bf16 v[68:71], a[28:31], a[4:7], v[68:71]
    buffer_load_dwordx4 v9, s[20:23], s48 offen offset:2048 lds
    ds_read_b64_tr_b16 a[74:75], v24 offset:29184
    v_mfma_f32_16x16x32_bf16 v[132:135], a[28:31], a[16:19], v[132:135]
    ds_read_b64_tr_b16 a[76:77], v25 offset:28672
    v_add_f32_dpp v142, v142, v142 row_ror:1 row_mask:0xf bank_mask:0xf
    v_mfma_f32_16x16x32_bf16 v[72:75], a[28:31], a[8:11], v[72:75]
    ds_read_b64_tr_b16 a[78:79], v25 offset:29184
    v_add_f32_dpp v143, v143, v143 row_ror:1 row_mask:0xf bank_mask:0xf
    v_mfma_f32_16x16x32_bf16 v[76:79], a[28:31], a[12:15], v[76:79]
    ds_read_b64_tr_b16 a[80:81], v24 offset:32768
    v_add_f32_dpp v144, v144, v144 row_ror:1 row_mask:0xf bank_mask:0xf
    v_mfma_f32_16x16x32_bf16 v[92:95], a[32:35], a[12:15], v[92:95]
    ds_read_b64_tr_b16 a[82:83], v24 offset:33280
    v_add_f32_dpp v140, v140, v140 row_ror:2 row_mask:0xf bank_mask:0xf
    v_mfma_f32_16x16x32_bf16 v[88:91], a[32:35], a[8:11], v[88:91]
    buffer_load_dwordx4 v10, s[20:23], s48 offen offset:3072 lds
    ds_read_b64_tr_b16 a[84:85], v25 offset:32768
    v_mfma_f32_16x16x32_bf16 v[84:87], a[32:35], a[4:7], v[84:87]
    ds_read_b64_tr_b16 a[86:87], v25 offset:33280
    v_add_f32_dpp v141, v141, v141 row_ror:2 row_mask:0xf bank_mask:0xf
    v_mfma_f32_16x16x32_bf16 v[80:83], a[32:35], a[0:3], v[80:83]
    v_add_f32_dpp v142, v142, v142 row_ror:2 row_mask:0xf bank_mask:0xf
    v_add_f32_dpp v143, v143, v143 row_ror:2 row_mask:0xf bank_mask:0xf
    v_mfma_f32_16x16x32_bf16 v[96:99], a[0:3], a[36:39], v[96:99]
    v_add_f32_dpp v144, v144, v144 row_ror:2 row_mask:0xf bank_mask:0xf
    v_add_f32_dpp v140, v140, v140 row_ror:4 row_mask:0xf bank_mask:0xf
    v_mfma_f32_16x16x32_bf16 v[100:103], a[4:7], a[36:39], v[100:103]
    s_add_u32 m0, s53, 16384
    v_add_f32_dpp v141, v141, v141 row_ror:4 row_mask:0xf bank_mask:0xf
    v_mfma_f32_16x16x32_bf16 v[136:139], a[16:19], a[36:39], v[136:139]
    s_mov_b64 exec, s[54:55]
    buffer_load_dwordx4 v11, s[20:23], s48 offen lds
    s_mov_b64 exec, -1
    v_mfma_f32_16x16x32_bf16 v[104:107], a[8:11], a[36:39], v[104:107]
    v_add_f32_dpp v142, v142, v142 row_ror:4 row_mask:0xf bank_mask:0xf
    v_mfma_f32_16x16x32_bf16 v[108:111], a[12:15], a[36:39], v[108:111]
    v_add_f32_dpp v143, v143, v143 row_ror:4 row_mask:0xf bank_mask:0xf
    v_add_f32_dpp v144, v144, v144 row_ror:4 row_mask:0xf bank_mask:0xf
    v_mfma_f32_16x16x32_bf16 v[124:127], a[12:15], a[40:43], v[124:127]
    v_add_f32_dpp v140, v140, v140 row_ror:8 row_mask:0xf bank_mask:0xf
    v_add_f32_dpp v141, v141, v141 row_ror:8 row_mask:0xf bank_mask:0xf
    v_mfma_f32_16x16x32_bf16 v[120:123], a[8:11], a[40:43], v[120:123]
    v_add_f32_dpp v142, v142, v142 row_ror:8 row_mask:0xf bank_mask:0xf
    v_add_f32_dpp v143, v143, v143 row_ror:8 row_mask:0xf bank_mask:0xf
    v_mfma_f32_16x16x32_bf16 v[116:119], a[4:7], a[40:43], v[116:119]
    v_add_f32_dpp v144, v144, v144 row_ror:8 row_mask:0xf bank_mask:0xf
    v_mov_b32 v145, v142
    v_mfma_f32_16x16x32_bf16 v[112:115], a[0:3], a[40:43], v[112:115]
    v_mov_b32 v146, v143
    v_permlane32_swap_b32 v142, v145
    s_waitcnt vmcnt(11) lgkmcnt(0)
    s_barrier
    s_cmp_lg_u32 s44, 5
    s_cbranch_scc1 L_p1_nopf4_0
    buffer_load_dword a248, v236, s[32:35], 0 offen
L_p1_nopf4_0:
    v_mfma_f32_16x16x32_bf16 v[32:35], a[64:67], a[44:47], v[32:35]
    ds_read_b64_tr_b16 a[20:21], v20 offset:49152
    v_permlane32_swap_b32 v143, v146
    v_mfma_f32_16x16x32_bf16 v[36:39], a[64:67], a[48:51], v[36:39]
    ds_read_b64_tr_b16 a[22:23], v20 offset:49664
    v_add_f32 v142, v142, v145
    v_mfma_f32_16x16x32_bf16 v[128:131], a[64:67], a[60:63], v[128:131]
    s_cmp_eq_u32 s61, 3
    s_cselect_b32 s67, 11, 7
    v_mfma_f32_16x16x32_bf16 v[40:43], a[64:67], a[52:55], v[40:43]
    s_add_u32 s67, s67, s60
    s_and_b32 s67, s67, 15
    v_mfma_f32_16x16x32_bf16 v[44:47], a[64:67], a[56:59], v[44:47]
    s_lshl_b32 s48, s67, 7
    s_mul_i32 s49, s67, 393216
    v_mfma_f32_16x16x32_bf16 v[60:63], a[68:71], a[56:59], v[60:63]
    s_add_u32 m0, s52, 79872
    ds_read_b64_tr_b16 a[24:25], v21 offset:49152
    v_mfma_f32_16x16x32_bf16 v[56:59], a[68:71], a[52:55], v[56:59]
    buffer_load_dwordx4 v12, s[24:27], s49 offen offset:0 lds
    buffer_load_dwordx4 v13, s[24:27], s49 offen offset:1024 lds
    v_mfma_f32_16x16x32_bf16 v[52:55], a[68:71], a[48:51], v[52:55]
    ds_read_b64_tr_b16 a[26:27], v21 offset:49664
    ds_read_b128 a[0:3], v18 offset:36864
    v_mfma_f32_16x16x32_bf16 v[48:51], a[68:71], a[44:47], v[48:51]
    ds_read_b128 a[4:7], v18 offset:38912
    ds_read_b128 a[8:11], v18 offset:40960
    v_mfma_f32_16x16x32_bf16 v[64:67], a[72:75], a[44:47], v[64:67]
    s_add_u32 m0, s52, 83968
    ds_read_b128 a[12:15], v18 offset:43008
    v_mfma_f32_16x16x32_bf16 v[68:71], a[72:75], a[48:51], v[68:71]
    buffer_load_dwordx4 v14, s[24:27], s49 offen offset:0 lds
    ds_read_b128 a[16:19], v19 offset:36864
    v_mfma_f32_16x16x32_bf16 v[132:135], a[72:75], a[60:63], v[132:135]
    ds_read_b64_tr_b16 a[28:29], v20 offset:53248
    ds_read_b64_tr_b16 a[30:31], v20 offset:53760
    v_mfma_f32_16x16x32_bf16 v[72:75], a[72:75], a[52:55], v[72:75]
    ds_read_b64_tr_b16 a[32:33], v21 offset:53248
    ds_read_b64_tr_b16 a[34:35], v21 offset:53760
    v_mfma_f32_16x16x32_bf16 v[76:79], a[72:75], a[56:59], v[76:79]
    ds_read_b64_tr_b16 a[36:37], v20 offset:57344
    v_add_f32 v143, v143, v146
    v_mfma_f32_16x16x32_bf16 v[92:95], a[76:79], a[56:59], v[92:95]
    buffer_load_dwordx4 v15, s[24:27], s49 offen offset:1024 lds
    ds_read_b64_tr_b16 a[38:39], v20 offset:57856
    v_mfma_f32_16x16x32_bf16 v[88:91], a[76:79], a[52:55], v[88:91]
    ds_read_b64_tr_b16 a[40:41], v21 offset:57344
    v_mov_b32 v145, v142
    v_mfma_f32_16x16x32_bf16 v[84:87], a[76:79], a[48:51], v[84:87]
    ds_read_b64_tr_b16 a[42:43], v21 offset:57856
    v_mov_b32 v146, v143
    v_mfma_f32_16x16x32_bf16 v[80:83], a[76:79], a[44:47], v[80:83]
    s_add_u32 m0, s52, 88064
    v_permlane16_swap_b32 v142, v145
    v_mfma_f32_16x16x32_bf16 v[96:99], a[44:47], a[80:83], v[96:99]
    buffer_load_dwordx4 v16, s[24:27], s49 offen offset:0 lds
    v_permlane16_swap_b32 v143, v146
    v_mfma_f32_16x16x32_bf16 v[100:103], a[48:51], a[80:83], v[100:103]
    v_add_f32 v142, v142, v145
    v_add_f32 v143, v143, v146
    v_mfma_f32_16x16x32_bf16 v[136:139], a[60:63], a[80:83], v[136:139]
    v_mul_f32 v26, 0x3a800000, v144
    v_cvt_pk_bf16_f32 v27, v26, v26
    v_mfma_f32_16x16x32_bf16 v[104:107], a[52:55], a[80:83], v[104:107]
    v_and_b32 v145, 0xffff0000, v27
    v_sub_f32 v26, v26, v145
    v_mfma_f32_16x16x32_bf16 v[108:111], a[56:59], a[80:83], v[108:111]
    buffer_load_dwordx4 v17, s[24:27], s49 offen offset:1024 lds
    v_cvt_pk_bf16_f32 v26, v26, v26
    v_mfma_f32_16x16x32_bf16 v[124:127], a[56:59], a[84:87], v[124:127]
    v_cmp_eq_u32 vcc, 1, v0
    s_lshl_b32 s75, s13, 4
    v_mfma_f32_16x16x32_bf16 v[120:123], a[52:55], a[84:87], v[120:123]
    s_add_u32 s75, s75, s14
    s_lshl_b32 s75, s75, 7
    v_mfma_f32_16x16x32_bf16 v[116:119], a[48:51], a[84:87], v[116:119]
    s_add_u32 s69, s75, 0x18000
    s_lshl_b32 s15, s3, 2
    v_mfma_f32_16x16x32_bf16 v[112:115], a[44:47], a[84:87], v[112:115]
    s_lshl_b32 s16, s3, 1
    v_cndmask_b32 v140, v140, v141, vcc
    v_cndmask_b32 v142, v142, v143, vcc
    v_mul_f32 v140, 0xba800000, v140
    v_mul_f32 v142, 0x3a800000, v142
    v_fma_f32 v142, -v140, v140, v142
    v_max_f32 v142, 0, v142
    v_add_f32 v142, 0x3727c5ac, v142
    v_rsq_f32 v142, v142
    v_cndmask_b32 v26, v27, v26, vcc
    v_lshl_add_u32 v1, v0, 5, s15
    v_lshl_add_u32 v141, v0, 3, s16
    s_mov_b64 exec, 3
    buffer_store_dword v140, v1, s[76:79], s69 offen sc1
    buffer_store_dword v142, v1, s[76:79], s69 offen offset:16 sc1
    buffer_store_short v26, v141, s[76:79], s69 offen offset:64 sc1
    s_mov_b64 exec, -1
    s_waitcnt lgkmcnt(0)
    v_mfma_f32_16x16x32_bf16 v[32:35], a[20:23], a[0:3], v[32:35]
    s_add_u32 m0, s51, 18432
    ds_read_b64_tr_b16 a[64:65], v24 offset:49152
    v_mfma_f32_16x16x32_bf16 v[36:39], a[20:23], a[4:7], v[36:39]
    buffer_load_dwordx4 v7, s[20:23], s48 offen offset:0 lds
    ds_read_b64_tr_b16 a[66:67], v24 offset:49664
    v_mfma_f32_16x16x32_bf16 v[128:131], a[20:23], a[16:19], v[128:131]
    ds_read_b64_tr_b16 a[68:69], v25 offset:49152
    v_mfma_f32_16x16x32_bf16 v[40:43], a[20:23], a[8:11], v[40:43]
    ds_read_b64_tr_b16 a[70:71], v25 offset:49664
    v_mfma_f32_16x16x32_bf16 v[44:47], a[20:23], a[12:15], v[44:47]
    ds_read_b128 a[44:47], v22 offset:36864
    v_mfma_f32_16x16x32_bf16 v[60:63], a[24:27], a[12:15], v[60:63]
    buffer_load_dwordx4 v8, s[20:23], s48 offen offset:1024 lds
    ds_read_b128 a[48:51], v22 offset:38912
    v_mfma_f32_16x16x32_bf16 v[56:59], a[24:27], a[8:11], v[56:59]
    ds_read_b128 a[52:55], v22 offset:40960
    v_mfma_f32_16x16x32_bf16 v[52:55], a[24:27], a[4:7], v[52:55]
    ds_read_b128 a[56:59], v22 offset:43008
    v_mfma_f32_16x16x32_bf16 v[48:51], a[24:27], a[0:3], v[48:51]
    ds_read_b128 a[60:63], v23 offset:36864
    v_mfma_f32_16x16x32_bf16 v[64:67], a[28:31], a[0:3], v[64:67]
    ds_read_b64_tr_b16 a[72:73], v24 offset:53248
    v_mfma_f32_16x16x32_bf16 v[68:71], a[28:31], a[4:7], v[68:71]
    buffer_load_dwordx4 v9, s[20:23], s48 offen offset:2048 lds
    ds_read_b64_tr_b16 a[74:75], v24 offset:53760
    v_mfma_f32_16x16x32_bf16 v[132:135], a[28:31], a[16:19], v[132:135]
    ds_read_b64_tr_b16 a[76:77], v25 offset:53248
    v_mfma_f32_16x16x32_bf16 v[72:75], a[28:31], a[8:11], v[72:75]
    ds_read_b64_tr_b16 a[78:79], v25 offset:53760
    v_mfma_f32_16x16x32_bf16 v[76:79], a[28:31], a[12:15], v[76:79]
    ds_read_b64_tr_b16 a[80:81], v24 offset:57344
    v_mfma_f32_16x16x32_bf16 v[92:95], a[32:35], a[12:15], v[92:95]
    ds_read_b64_tr_b16 a[82:83], v24 offset:57856
    v_mfma_f32_16x16x32_bf16 v[88:91], a[32:35], a[8:11], v[88:91]
    buffer_load_dwordx4 v10, s[20:23], s48 offen offset:3072 lds
    ds_read_b64_tr_b16 a[84:85], v25 offset:57344
    v_mfma_f32_16x16x32_bf16 v[84:87], a[32:35], a[4:7], v[84:87]
    ds_read_b64_tr_b16 a[86:87], v25 offset:57856
    v_mfma_f32_16x16x32_bf16 v[80:83], a[32:35], a[0:3], v[80:83]
    v_mfma_f32_16x16x32_bf16 v[96:99], a[0:3], a[36:39], v[96:99]
    v_mfma_f32_16x16x32_bf16 v[100:103], a[4:7], a[36:39], v[100:103]
    s_add_u32 m0, s53, 34816
    v_mfma_f32_16x16x32_bf16 v[136:139], a[16:19], a[36:39], v[136:139]
    s_mov_b64 exec, s[54:55]
    buffer_load_dwordx4 v11, s[20:23], s48 offen lds
    s_mov_b64 exec, -1
    v_mfma_f32_16x16x32_bf16 v[104:107], a[8:11], a[36:39], v[104:107]
    v_mfma_f32_16x16x32_bf16 v[108:111], a[12:15], a[36:39], v[108:111]
    v_mfma_f32_16x16x32_bf16 v[124:127], a[12:15], a[40:43], v[124:127]
    v_mfma_f32_16x16x32_bf16 v[120:123], a[8:11], a[40:43], v[120:123]
    v_mfma_f32_16x16x32_bf16 v[116:119], a[4:7], a[40:43], v[116:119]
    v_mfma_f32_16x16x32_bf16 v[112:115], a[0:3], a[40:43], v[112:115]
    s_waitcnt vmcnt(14) lgkmcnt(0)
    s_barrier
    s_cmp_lg_u32 s44, 6
    s_cbranch_scc1 L_p1_nopf5_0
    buffer_load_dword a248, v236, s[32:35], 0 offen
L_p1_nopf5_0:
    v_mfma_f32_16x16x32_bf16 v[32:35], a[64:67], a[44:47], v[32:35]
    ds_read_b64_tr_b16 a[20:21], v20 offset:0
    v_mfma_f32_16x16x32_bf16 v[36:39], a[64:67], a[48:51], v[36:39]
    ds_read_b64_tr_b16 a[22:23], v20 offset:512
    v_mfma_f32_16x16x32_bf16 v[128:131], a[64:67], a[60:63], v[128:131]
    s_cmp_eq_u32 s61, 0
    s_cselect_b32 s67, 12, 8
    v_mfma_f32_16x16x32_bf16 v[40:43], a[64:67], a[52:55], v[40:43]
    s_add_u32 s67, s67, s60
    s_and_b32 s67, s67, 15
    v_mfma_f32_16x16x32_bf16 v[44:47], a[64:67], a[56:59], v[44:47]
    s_lshl_b32 s48, s67, 7
    s_mul_i32 s49, s67, 393216
    v_mfma_f32_16x16x32_bf16 v[60:63], a[68:71], a[56:59], v[60:63]
    s_add_u32 m0, s52, 104448
    ds_read_b64_tr_b16 a[24:25], v21 offset:0
    v_mfma_f32_16x16x32_bf16 v[56:59], a[68:71], a[52:55], v[56:59]
    buffer_load_dwordx4 v12, s[24:27], s49 offen offset:0 lds
    buffer_load_dwordx4 v13, s[24:27], s49 offen offset:1024 lds
    v_mfma_f32_16x16x32_bf16 v[52:55], a[68:71], a[48:51], v[52:55]
    ds_read_b64_tr_b16 a[26:27], v21 offset:512
    ds_read_b128 a[0:3], v18 offset:0
    v_mfma_f32_16x16x32_bf16 v[48:51], a[68:71], a[44:47], v[48:51]
    ds_read_b128 a[4:7], v18 offset:2048
    ds_read_b128 a[8:11], v18 offset:4096
    v_mfma_f32_16x16x32_bf16 v[64:67], a[72:75], a[44:47], v[64:67]
    s_add_u32 m0, s52, 108544
    ds_read_b128 a[12:15], v18 offset:6144
    v_mfma_f32_16x16x32_bf16 v[68:71], a[72:75], a[48:51], v[68:71]
    buffer_load_dwordx4 v14, s[24:27], s49 offen offset:0 lds
    ds_read_b128 a[16:19], v19 offset:0
    v_mfma_f32_16x16x32_bf16 v[132:135], a[72:75], a[60:63], v[132:135]
    ds_read_b64_tr_b16 a[28:29], v20 offset:4096
    ds_read_b64_tr_b16 a[30:31], v20 offset:4608
    v_mfma_f32_16x16x32_bf16 v[72:75], a[72:75], a[52:55], v[72:75]
    ds_read_b64_tr_b16 a[32:33], v21 offset:4096
    ds_read_b64_tr_b16 a[34:35], v21 offset:4608
    v_mfma_f32_16x16x32_bf16 v[76:79], a[72:75], a[56:59], v[76:79]
    ds_read_b64_tr_b16 a[36:37], v20 offset:8192
    v_mfma_f32_16x16x32_bf16 v[92:95], a[76:79], a[56:59], v[92:95]
    buffer_load_dwordx4 v15, s[24:27], s49 offen offset:1024 lds
    ds_read_b64_tr_b16 a[38:39], v20 offset:8704
    v_mfma_f32_16x16x32_bf16 v[88:91], a[76:79], a[52:55], v[88:91]
    ds_read_b64_tr_b16 a[40:41], v21 offset:8192
    v_mfma_f32_16x16x32_bf16 v[84:87], a[76:79], a[48:51], v[84:87]
    ds_read_b64_tr_b16 a[42:43], v21 offset:8704
    v_mfma_f32_16x16x32_bf16 v[80:83], a[76:79], a[44:47], v[80:83]
    s_add_u32 m0, s52, 112640
    v_mfma_f32_16x16x32_bf16 v[96:99], a[44:47], a[80:83], v[96:99]
    buffer_load_dwordx4 v16, s[24:27], s49 offen offset:0 lds
    v_mfma_f32_16x16x32_bf16 v[100:103], a[48:51], a[80:83], v[100:103]
    v_mfma_f32_16x16x32_bf16 v[136:139], a[60:63], a[80:83], v[136:139]
    v_mfma_f32_16x16x32_bf16 v[104:107], a[52:55], a[80:83], v[104:107]
    v_mfma_f32_16x16x32_bf16 v[108:111], a[56:59], a[80:83], v[108:111]
    buffer_load_dwordx4 v17, s[24:27], s49 offen offset:1024 lds
    v_mfma_f32_16x16x32_bf16 v[124:127], a[56:59], a[84:87], v[124:127]
    v_mfma_f32_16x16x32_bf16 v[120:123], a[52:55], a[84:87], v[120:123]
    v_mfma_f32_16x16x32_bf16 v[116:119], a[48:51], a[84:87], v[116:119]
    v_mfma_f32_16x16x32_bf16 v[112:115], a[44:47], a[84:87], v[112:115]
    s_waitcnt lgkmcnt(0)
    v_mfma_f32_16x16x32_bf16 v[32:35], a[20:23], a[0:3], v[32:35]
    s_add_u32 m0, s51, 36864
    ds_read_b64_tr_b16 a[64:65], v24 offset:0
    v_mfma_f32_16x16x32_bf16 v[36:39], a[20:23], a[4:7], v[36:39]
    buffer_load_dwordx4 v7, s[20:23], s48 offen offset:0 lds
    ds_read_b64_tr_b16 a[66:67], v24 offset:512
    v_mfma_f32_16x16x32_bf16 v[128:131], a[20:23], a[16:19], v[128:131]
    ds_read_b64_tr_b16 a[68:69], v25 offset:0
    v_mfma_f32_16x16x32_bf16 v[40:43], a[20:23], a[8:11], v[40:43]
    ds_read_b64_tr_b16 a[70:71], v25 offset:512
    v_mfma_f32_16x16x32_bf16 v[44:47], a[20:23], a[12:15], v[44:47]
    ds_read_b128 a[44:47], v22 offset:0
    v_mfma_f32_16x16x32_bf16 v[60:63], a[24:27], a[12:15], v[60:63]
    buffer_load_dwordx4 v8, s[20:23], s48 offen offset:1024 lds
    ds_read_b128 a[48:51], v22 offset:2048
    v_mfma_f32_16x16x32_bf16 v[56:59], a[24:27], a[8:11], v[56:59]
    ds_read_b128 a[52:55], v22 offset:4096
    v_mfma_f32_16x16x32_bf16 v[52:55], a[24:27], a[4:7], v[52:55]
    ds_read_b128 a[56:59], v22 offset:6144
    v_mfma_f32_16x16x32_bf16 v[48:51], a[24:27], a[0:3], v[48:51]
    ds_read_b128 a[60:63], v23 offset:0
    v_mfma_f32_16x16x32_bf16 v[64:67], a[28:31], a[0:3], v[64:67]
    ds_read_b64_tr_b16 a[72:73], v24 offset:4096
    v_mfma_f32_16x16x32_bf16 v[68:71], a[28:31], a[4:7], v[68:71]
    buffer_load_dwordx4 v9, s[20:23], s48 offen offset:2048 lds
    ds_read_b64_tr_b16 a[74:75], v24 offset:4608
    v_mfma_f32_16x16x32_bf16 v[132:135], a[28:31], a[16:19], v[132:135]
    ds_read_b64_tr_b16 a[76:77], v25 offset:4096
    v_mfma_f32_16x16x32_bf16 v[72:75], a[28:31], a[8:11], v[72:75]
    ds_read_b64_tr_b16 a[78:79], v25 offset:4608
    v_mfma_f32_16x16x32_bf16 v[76:79], a[28:31], a[12:15], v[76:79]
    ds_read_b64_tr_b16 a[80:81], v24 offset:8192
    v_mfma_f32_16x16x32_bf16 v[92:95], a[32:35], a[12:15], v[92:95]
    ds_read_b64_tr_b16 a[82:83], v24 offset:8704
    v_mfma_f32_16x16x32_bf16 v[88:91], a[32:35], a[8:11], v[88:91]
    buffer_load_dwordx4 v10, s[20:23], s48 offen offset:3072 lds
    ds_read_b64_tr_b16 a[84:85], v25 offset:8192
    v_mfma_f32_16x16x32_bf16 v[84:87], a[32:35], a[4:7], v[84:87]
    ds_read_b64_tr_b16 a[86:87], v25 offset:8704
    v_mfma_f32_16x16x32_bf16 v[80:83], a[32:35], a[0:3], v[80:83]
    v_mfma_f32_16x16x32_bf16 v[96:99], a[0:3], a[36:39], v[96:99]
    v_mfma_f32_16x16x32_bf16 v[100:103], a[4:7], a[36:39], v[100:103]
    s_add_u32 m0, s53, 53248
    v_mfma_f32_16x16x32_bf16 v[136:139], a[16:19], a[36:39], v[136:139]
    s_mov_b64 exec, s[54:55]
    buffer_load_dwordx4 v11, s[20:23], s48 offen lds
    s_mov_b64 exec, -1
    v_mfma_f32_16x16x32_bf16 v[104:107], a[8:11], a[36:39], v[104:107]
    v_mfma_f32_16x16x32_bf16 v[108:111], a[12:15], a[36:39], v[108:111]
    v_mfma_f32_16x16x32_bf16 v[124:127], a[12:15], a[40:43], v[124:127]
    v_mfma_f32_16x16x32_bf16 v[120:123], a[8:11], a[40:43], v[120:123]
    v_mfma_f32_16x16x32_bf16 v[116:119], a[4:7], a[40:43], v[116:119]
    v_mfma_f32_16x16x32_bf16 v[112:115], a[0:3], a[40:43], v[112:115]
    s_waitcnt vmcnt(11) lgkmcnt(0)
    s_barrier
    s_cmp_lg_u32 s3, 0
    s_cbranch_scc1 L_p1_noflag
    s_mov_b64 exec, 1
    buffer_store_dword v6, v0, s[76:79], s69 offen offset:96 sc1
    s_mov_b64 exec, -1
L_p1_noflag:
    s_cmp_lg_u32 s44, 7
    s_cbranch_scc1 L_p1_nopf6_0
    buffer_load_dword a248, v236, s[32:35], 0 offen
L_p1_nopf6_0:
    v_mfma_f32_16x16x32_bf16 v[32:35], a[64:67], a[44:47], v[32:35]
    ds_read_b64_tr_b16 a[20:21], v20 offset:24576
    v_mfma_f32_16x16x32_bf16 v[36:39], a[64:67], a[48:51], v[36:39]
    ds_read_b64_tr_b16 a[22:23], v20 offset:25088
    v_mfma_f32_16x16x32_bf16 v[128:131], a[64:67], a[60:63], v[128:131]
    s_cmp_eq_u32 s61, 1
    s_cselect_b32 s67, 13, 9
    v_mfma_f32_16x16x32_bf16 v[40:43], a[64:67], a[52:55], v[40:43]
    s_add_u32 s67, s67, s60
    s_and_b32 s67, s67, 15
    v_mfma_f32_16x16x32_bf16 v[44:47], a[64:67], a[56:59], v[44:47]
    s_lshl_b32 s48, s67, 7
    s_mul_i32 s49, s67, 393216
    v_mfma_f32_16x16x32_bf16 v[60:63], a[68:71], a[56:59], v[60:63]
    s_add_u32 m0, s52, 55296
    ds_read_b64_tr_b16 a[24:25], v21 offset:24576
    v_mfma_f32_16x16x32_bf16 v[56:59], a[68:71], a[52:55], v[56:59]
    buffer_load_dwordx4 v12, s[24:27], s49 offen offset:0 lds
    buffer_load_dwordx4 v13, s[24:27], s49 offen offset:1024 lds
    v_mfma_f32_16x16x32_bf16 v[52:55], a[68:71], a[48:51], v[52:55]
    ds_read_b64_tr_b16 a[26:27], v21 offset:25088
    ds_read_b128 a[0:3], v18 offset:18432
    v_mfma_f32_16x16x32_bf16 v[48:51], a[68:71], a[44:47], v[48:51]
    ds_read_b128 a[4:7], v18 offset:20480
    ds_read_b128 a[8:11], v18 offset:22528
    v_mfma_f32_16x16x32_bf16 v[64:67], a[72:75], a[44:47], v[64:67]
    s_add_u32 m0, s52, 59392
    ds_read_b128 a[12:15], v18 offset:24576
    v_mfma_f32_16x16x32_bf16 v[68:71], a[72:75], a[48:51], v[68:71]
    buffer_load_dwordx4 v14, s[24:27], s49 offen offset:0 lds
    ds_read_b128 a[16:19], v19 offset:18432
    v_mfma_f32_16x16x32_bf16 v[132:135], a[72:75], a[60:63], v[132:135]
    ds_read_b64_tr_b16 a[28:29], v20 offset:28672
    ds_read_b64_tr_b16 a[30:31], v20 offset:29184
    v_mfma_f32_16x16x32_bf16 v[72:75], a[72:75], a[52:55], v[72:75]
    ds_read_b64_tr_b16 a[32:33], v21 offset:28672
    ds_read_b64_tr_b16 a[34:35], v21 offset:29184
    v_mfma_f32_16x16x32_bf16 v[76:79], a[72:75], a[56:59], v[76:79]
    ds_read_b64_tr_b16 a[36:37], v20 offset:32768
    v_mfma_f32_16x16x32_bf16 v[92:95], a[76:79], a[56:59], v[92:95]
    buffer_load_dwordx4 v15, s[24:27], s49 offen offset:1024 lds
    ds_read_b64_tr_b16 a[38:39], v20 offset:33280
    v_mfma_f32_16x16x32_bf16 v[88:91], a[76:79], a[52:55], v[88:91]
    ds_read_b64_tr_b16 a[40:41], v21 offset:32768
    v_mfma_f32_16x16x32_bf16 v[84:87], a[76:79], a[48:51], v[84:87]
    ds_read_b64_tr_b16 a[42:43], v21 offset:33280
    v_mfma_f32_16x16x32_bf16 v[80:83], a[76:79], a[44:47], v[80:83]
    s_add_u32 m0, s52, 63488
    v_mfma_f32_16x16x32_bf16 v[96:99], a[44:47], a[80:83], v[96:99]
    buffer_load_dwordx4 v16, s[24:27], s49 offen offset:0 lds
    v_mfma_f32_16x16x32_bf16 v[100:103], a[48:51], a[80:83], v[100:103]
    v_mfma_f32_16x16x32_bf16 v[136:139], a[60:63], a[80:83], v[136:139]
    v_mfma_f32_16x16x32_bf16 v[104:107], a[52:55], a[80:83], v[104:107]
    v_mfma_f32_16x16x32_bf16 v[108:111], a[56:59], a[80:83], v[108:111]
    buffer_load_dwordx4 v17, s[24:27], s49 offen offset:1024 lds
    v_mfma_f32_16x16x32_bf16 v[124:127], a[56:59], a[84:87], v[124:127]
    v_mfma_f32_16x16x32_bf16 v[120:123], a[52:55], a[84:87], v[120:123]
    v_mfma_f32_16x16x32_bf16 v[116:119], a[48:51], a[84:87], v[116:119]
    v_mfma_f32_16x16x32_bf16 v[112:115], a[44:47], a[84:87], v[112:115]
    s_waitcnt lgkmcnt(0)
    v_mfma_f32_16x16x32_bf16 v[32:35], a[20:23], a[0:3], v[32:35]
    s_add_u32 m0, s51, 0
    ds_read_b64_tr_b16 a[64:65], v24 offset:24576
    v_mfma_f32_16x16x32_bf16 v[36:39], a[20:23], a[4:7], v[36:39]
    buffer_load_dwordx4 v7, s[20:23], s48 offen offset:0 lds
    ds_read_b64_tr_b16 a[66:67], v24 offset:25088
    v_mfma_f32_16x16x32_bf16 v[128:131], a[20:23], a[16:19], v[128:131]
    ds_read_b64_tr_b16 a[68:69], v25 offset:24576
    v_mfma_f32_16x16x32_bf16 v[40:43], a[20:23], a[8:11], v[40:43]
    ds_read_b64_tr_b16 a[70:71], v25 offset:25088
    v_mfma_f32_16x16x32_bf16 v[44:47], a[20:23], a[12:15], v[44:47]
    ds_read_b128 a[44:47], v22 offset:18432
    v_mfma_f32_16x16x32_bf16 v[60:63], a[24:27], a[12:15], v[60:63]
    buffer_load_dwordx4 v8, s[20:23], s48 offen offset:1024 lds
    ds_read_b128 a[48:51], v22 offset:20480
    v_mfma_f32_16x16x32_bf16 v[56:59], a[24:27], a[8:11], v[56:59]
    ds_read_b128 a[52:55], v22 offset:22528
    v_mfma_f32_16x16x32_bf16 v[52:55], a[24:27], a[4:7], v[52:55]
    ds_read_b128 a[56:59], v22 offset:24576
    v_mfma_f32_16x16x32_bf16 v[48:51], a[24:27], a[0:3], v[48:51]
    ds_read_b128 a[60:63], v23 offset:18432
    v_mfma_f32_16x16x32_bf16 v[64:67], a[28:31], a[0:3], v[64:67]
    ds_read_b64_tr_b16 a[72:73], v24 offset:28672
    v_mfma_f32_16x16x32_bf16 v[68:71], a[28:31], a[4:7], v[68:71]
    buffer_load_dwordx4 v9, s[20:23], s48 offen offset:2048 lds
    ds_read_b64_tr_b16 a[74:75], v24 offset:29184
    v_mfma_f32_16x16x32_bf16 v[132:135], a[28:31], a[16:19], v[132:135]
    ds_read_b64_tr_b16 a[76:77], v25 offset:28672
    v_mfma_f32_16x16x32_bf16 v[72:75], a[28:31], a[8:11], v[72:75]
    ds_read_b64_tr_b16 a[78:79], v25 offset:29184
    v_mfma_f32_16x16x32_bf16 v[76:79], a[28:31], a[12:15], v[76:79]
    ds_read_b64_tr_b16 a[80:81], v24 offset:32768
    v_mfma_f32_16x16x32_bf16 v[92:95], a[32:35], a[12:15], v[92:95]
    ds_read_b64_tr_b16 a[82:83], v24 offset:33280
    v_mfma_f32_16x16x32_bf16 v[88:91], a[32:35], a[8:11], v[88:91]
    buffer_load_dwordx4 v10, s[20:23], s48 offen offset:3072 lds
    ds_read_b64_tr_b16 a[84:85], v25 offset:32768
    v_mfma_f32_16x16x32_bf16 v[84:87], a[32:35], a[4:7], v[84:87]
    ds_read_b64_tr_b16 a[86:87], v25 offset:33280
    v_mfma_f32_16x16x32_bf16 v[80:83], a[32:35], a[0:3], v[80:83]
    v_mfma_f32_16x16x32_bf16 v[96:99], a[0:3], a[36:39], v[96:99]
    v_mfma_f32_16x16x32_bf16 v[100:103], a[4:7], a[36:39], v[100:103]
    s_add_u32 m0, s53, 16384
    v_mfma_f32_16x16x32_bf16 v[136:139], a[16:19], a[36:39], v[136:139]
    s_mov_b64 exec, s[54:55]
    buffer_load_dwordx4 v11, s[20:23], s48 offen lds
    s_mov_b64 exec, -1
    v_mfma_f32_16x16x32_bf16 v[104:107], a[8:11], a[36:39], v[104:107]
    v_mfma_f32_16x16x32_bf16 v[108:111], a[12:15], a[36:39], v[108:111]
    v_mfma_f32_16x16x32_bf16 v[124:127], a[12:15], a[40:43], v[124:127]
    v_mfma_f32_16x16x32_bf16 v[120:123], a[8:11], a[40:43], v[120:123]
    v_mfma_f32_16x16x32_bf16 v[116:119], a[4:7], a[40:43], v[116:119]
    v_mfma_f32_16x16x32_bf16 v[112:115], a[0:3], a[40:43], v[112:115]
    s_waitcnt vmcnt(11) lgkmcnt(0)
    s_barrier
    s_cmp_lg_u32 s44, 3
    s_cbranch_scc1 L_p1_nopf7_1
    buffer_load_dword a249, v237, s[32:35], 0 offen
L_p1_nopf7_1:
    v_mfma_f32_16x16x32_bf16 v[32:35], a[64:67], a[44:47], v[32:35]
    ds_read_b64_tr_b16 a[20:21], v20 offset:49152
    v_mfma_f32_16x16x32_bf16 v[36:39], a[64:67], a[48:51], v[36:39]
    ds_read_b64_tr_b16 a[22:23], v20 offset:49664
    v_mfma_f32_16x16x32_bf16 v[128:131], a[64:67], a[60:63], v[128:131]
    s_cmp_eq_u32 s61, 2
    s_cselect_b32 s67, 14, 10
    v_mfma_f32_16x16x32_bf16 v[40:43], a[64:67], a[52:55], v[40:43]
    s_add_u32 s67, s67, s60
    s_and_b32 s67, s67, 15
    v_mfma_f32_16x16x32_bf16 v[44:47], a[64:67], a[56:59], v[44:47]
    s_lshl_b32 s48, s67, 7
    s_mul_i32 s49, s67, 393216
    v_mfma_f32_16x16x32_bf16 v[60:63], a[68:71], a[56:59], v[60:63]
    s_add_u32 m0, s52, 79872
    ds_read_b64_tr_b16 a[24:25], v21 offset:49152
    v_mfma_f32_16x16x32_bf16 v[56:59], a[68:71], a[52:55], v[56:59]
    buffer_load_dwordx4 v12, s[24:27], s49 offen offset:0 lds
    buffer_load_dwordx4 v13, s[24:27], s49 offen offset:1024 lds
    v_mfma_f32_16x16x32_bf16 v[52:55], a[68:71], a[48:51], v[52:55]
    ds_read_b64_tr_b16 a[26:27], v21 offset:49664
    ds_read_b128 a[0:3], v18 offset:36864
    v_mfma_f32_16x16x32_bf16 v[48:51], a[68:71], a[44:47], v[48:51]
    ds_read_b128 a[4:7], v18 offset:38912
    ds_read_b128 a[8:11], v18 offset:40960
    v_mfma_f32_16x16x32_bf16 v[64:67], a[72:75], a[44:47], v[64:67]
    s_add_u32 m0, s52, 83968
    ds_read_b128 a[12:15], v18 offset:43008
    v_mfma_f32_16x16x32_bf16 v[68:71], a[72:75], a[48:51], v[68:71]
    buffer_load_dwordx4 v14, s[24:27], s49 offen offset:0 lds
    ds_read_b128 a[16:19], v19 offset:36864
    v_mfma_f32_16x16x32_bf16 v[132:135], a[72:75], a[60:63], v[132:135]
    ds_read_b64_tr_b16 a[28:29], v20 offset:53248
    ds_read_b64_tr_b16 a[30:31], v20 offset:53760
    v_mfma_f32_16x16x32_bf16 v[72:75], a[72:75], a[52:55], v[72:75]
    ds_read_b64_tr_b16 a[32:33], v21 offset:53248
    ds_read_b64_tr_b16 a[34:35], v21 offset:53760
    v_mfma_f32_16x16x32_bf16 v[76:79], a[72:75], a[56:59], v[76:79]
    ds_read_b64_tr_b16 a[36:37], v20 offset:57344
    v_mfma_f32_16x16x32_bf16 v[92:95], a[76:79], a[56:59], v[92:95]
    buffer_load_dwordx4 v15, s[24:27], s49 offen offset:1024 lds
    ds_read_b64_tr_b16 a[38:39], v20 offset:57856
    v_mfma_f32_16x16x32_bf16 v[88:91], a[76:79], a[52:55], v[88:91]
    ds_read_b64_tr_b16 a[40:41], v21 offset:57344
    v_mfma_f32_16x16x32_bf16 v[84:87], a[76:79], a[48:51], v[84:87]
    ds_read_b64_tr_b16 a[42:43], v21 offset:57856
    v_mfma_f32_16x16x32_bf16 v[80:83], a[76:79], a[44:47], v[80:83]
    s_add_u32 m0, s52, 88064
    v_mfma_f32_16x16x32_bf16 v[96:99], a[44:47], a[80:83], v[96:99]
    buffer_load_dwordx4 v16, s[24:27], s49 offen offset:0 lds
    v_mfma_f32_16x16x32_bf16 v[100:103], a[48:51], a[80:83], v[100:103]
    v_mfma_f32_16x16x32_bf16 v[136:139], a[60:63], a[80:83], v[136:139]
    v_mfma_f32_16x16x32_bf16 v[104:107], a[52:55], a[80:83], v[104:107]
    v_mfma_f32_16x16x32_bf16 v[108:111], a[56:59], a[80:83], v[108:111]
    buffer_load_dwordx4 v17, s[24:27], s49 offen offset:1024 lds
    v_mfma_f32_16x16x32_bf16 v[124:127], a[56:59], a[84:87], v[124:127]
    v_mfma_f32_16x16x32_bf16 v[120:123], a[52:55], a[84:87], v[120:123]
    v_mfma_f32_16x16x32_bf16 v[116:119], a[48:51], a[84:87], v[116:119]
    v_mfma_f32_16x16x32_bf16 v[112:115], a[44:47], a[84:87], v[112:115]
    s_getpc_b64 s[72:73]
L_cp2:
    s_lshr_b32 s74, s2, 3
    s_lshl2_add_u32 s74, s74, s3
    s_lshl_b32 s74, s74, 8
    s_add_u32 s74, s74, 0
    s_min_u32 s74, s74, L_end-L_cp2
    s_add_u32 s72, s72, s74
    s_addc_u32 s73, s73, 0
    v_and_b32 v208, 1, v0
    v_lshlrev_b32 v208, 7, v208
    v_mov_b32 v209, s73
    v_add_co_u32 v208, vcc, s72, v208
    s_nop 1
    v_addc_co_u32 v209, vcc, 0, v209, vcc
    global_load_dword a251, v[208:209], off
    s_waitcnt lgkmcnt(0)
    v_mfma_f32_16x16x32_bf16 v[32:35], a[20:23], a[0:3], v[32:35]
    s_add_u32 m0, s51, 18432
    ds_read_b64_tr_b16 a[64:65], v24 offset:49152
    v_mfma_f32_16x16x32_bf16 v[36:39], a[20:23], a[4:7], v[36:39]
    buffer_load_dwordx4 v7, s[20:23], s48 offen offset:0 lds
    ds_read_b64_tr_b16 a[66:67], v24 offset:49664
    v_mfma_f32_16x16x32_bf16 v[128:131], a[20:23], a[16:19], v[128:131]
    ds_read_b64_tr_b16 a[68:69], v25 offset:49152
    v_mfma_f32_16x16x32_bf16 v[40:43], a[20:23], a[8:11], v[40:43]
    ds_read_b64_tr_b16 a[70:71], v25 offset:49664
    v_mfma_f32_16x16x32_bf16 v[44:47], a[20:23], a[12:15], v[44:47]
    ds_read_b128 a[44:47], v22 offset:36864
    v_mfma_f32_16x16x32_bf16 v[60:63], a[24:27], a[12:15], v[60:63]
    buffer_load_dwordx4 v8, s[20:23], s48 offen offset:1024 lds
    ds_read_b128 a[48:51], v22 offset:38912
    v_mfma_f32_16x16x32_bf16 v[56:59], a[24:27], a[8:11], v[56:59]
    ds_read_b128 a[52:55], v22 offset:40960
    v_mfma_f32_16x16x32_bf16 v[52:55], a[24:27], a[4:7], v[52:55]
    ds_read_b128 a[56:59], v22 offset:43008
    v_mfma_f32_16x16x32_bf16 v[48:51], a[24:27], a[0:3], v[48:51]
    ds_read_b128 a[60:63], v23 offset:36864
    v_mfma_f32_16x16x32_bf16 v[64:67], a[28:31], a[0:3], v[64:67]
    ds_read_b64_tr_b16 a[72:73], v24 offset:53248
    v_mfma_f32_16x16x32_bf16 v[68:71], a[28:31], a[4:7], v[68:71]
    buffer_load_dwordx4 v9, s[20:23], s48 offen offset:2048 lds
    ds_read_b64_tr_b16 a[74:75], v24 offset:53760
    v_mfma_f32_16x16x32_bf16 v[132:135], a[28:31], a[16:19], v[132:135]
    ds_read_b64_tr_b16 a[76:77], v25 offset:53248
    v_mfma_f32_16x16x32_bf16 v[72:75], a[28:31], a[8:11], v[72:75]
    ds_read_b64_tr_b16 a[78:79], v25 offset:53760
    v_mfma_f32_16x16x32_bf16 v[76:79], a[28:31], a[12:15], v[76:79]
    ds_read_b64_tr_b16 a[80:81], v24 offset:57344
    v_mfma_f32_16x16x32_bf16 v[92:95], a[32:35], a[12:15], v[92:95]
    ds_read_b64_tr_b16 a[82:83], v24 offset:57856
    v_mfma_f32_16x16x32_bf16 v[88:91], a[32:35], a[8:11], v[88:91]
    buffer_load_dwordx4 v10, s[20:23], s48 offen offset:3072 lds
    ds_read_b64_tr_b16 a[84:85], v25 offset:57344
    v_mfma_f32_16x16x32_bf16 v[84:87], a[32:35], a[4:7], v[84:87]
    ds_read_b64_tr_b16 a[86:87], v25 offset:57856
    v_mfma_f32_16x16x32_bf16 v[80:83], a[32:35], a[0:3], v[80:83]
    v_mfma_f32_16x16x32_bf16 v[96:99], a[0:3], a[36:39], v[96:99]
    v_mfma_f32_16x16x32_bf16 v[100:103], a[4:7], a[36:39], v[100:103]
    s_add_u32 m0, s53, 34816
    v_mfma_f32_16x16x32_bf16 v[136:139], a[16:19], a[36:39], v[136:139]
    s_mov_b64 exec, s[54:55]
    buffer_load_dwordx4 v11, s[20:23], s48 offen lds
    s_mov_b64 exec, -1
    v_mfma_f32_16x16x32_bf16 v[104:107], a[8:11], a[36:39], v[104:107]
    v_mfma_f32_16x16x32_bf16 v[108:111], a[12:15], a[36:39], v[108:111]
    v_mfma_f32_16x16x32_bf16 v[124:127], a[12:15], a[40:43], v[124:127]
    v_mfma_f32_16x16x32_bf16 v[120:123], a[8:11], a[40:43], v[120:123]
    v_mfma_f32_16x16x32_bf16 v[116:119], a[4:7], a[40:43], v[116:119]
    v_mfma_f32_16x16x32_bf16 v[112:115], a[0:3], a[40:43], v[112:115]
    s_waitcnt vmcnt(11) lgkmcnt(0)
    s_barrier
    s_cmp_lg_u32 s44, 4
    s_cbranch_scc1 L_p1_nopf8_1
    buffer_load_dword a249, v237, s[32:35], 0 offen
L_p1_nopf8_1:
    v_mfma_f32_16x16x32_bf16 v[32:35], a[64:67], a[44:47], v[32:35]
    ds_read_b64_tr_b16 a[20:21], v20 offset:0
    v_mfma_f32_16x16x32_bf16 v[36:39], a[64:67], a[48:51], v[36:39]
    ds_read_b64_tr_b16 a[22:23], v20 offset:512
    v_mfma_f32_16x16x32_bf16 v[128:131], a[64:67], a[60:63], v[128:131]
    s_cmp_eq_u32 s61, 3
    s_cselect_b32 s67, 15, 11
    v_mfma_f32_16x16x32_bf16 v[40:43], a[64:67], a[52:55], v[40:43]
    s_add_u32 s67, s67, s60
    s_and_b32 s67, s67, 15
    v_mfma_f32_16x16x32_bf16 v[44:47], a[64:67], a[56:59], v[44:47]
    s_lshl_b32 s48, s67, 7
    s_mul_i32 s49, s67, 393216
    v_mfma_f32_16x16x32_bf16 v[60:63], a[68:71], a[56:59], v[60:63]
    s_add_u32 m0, s52, 104448
    ds_read_b64_tr_b16 a[24:25], v21 offset:0
    v_mfma_f32_16x16x32_bf16 v[56:59], a[68:71], a[52:55], v[56:59]
    buffer_load_dwordx4 v12, s[24:27], s49 offen offset:0 lds
    buffer_load_dwordx4 v13, s[24:27], s49 offen offset:1024 lds
    v_mfma_f32_16x16x32_bf16 v[52:55], a[68:71], a[48:51], v[52:55]
    ds_read_b64_tr_b16 a[26:27], v21 offset:512
    ds_read_b128 a[0:3], v18 offset:0
    v_mfma_f32_16x16x32_bf16 v[48:51], a[68:71], a[44:47], v[48:51]
    ds_read_b128 a[4:7], v18 offset:2048
    ds_read_b128 a[8:11], v18 offset:4096
    v_mfma_f32_16x16x32_bf16 v[64:67], a[72:75], a[44:47], v[64:67]
    s_add_u32 m0, s52, 108544
    ds_read_b128 a[12:15], v18 offset:6144
    v_mfma_f32_16x16x32_bf16 v[68:71], a[72:75], a[48:51], v[68:71]
    buffer_load_dwordx4 v14, s[24:27], s49 offen offset:0 lds
    ds_read_b128 a[16:19], v19 offset:0
    v_mfma_f32_16x16x32_bf16 v[132:135], a[72:75], a[60:63], v[132:135]
    ds_read_b64_tr_b16 a[28:29], v20 offset:4096
    ds_read_b64_tr_b16 a[30:31], v20 offset:4608
    v_mfma_f32_16x16x32_bf16 v[72:75], a[72:75], a[52:55], v[72:75]
    ds_read_b64_tr_b16 a[32:33], v21 offset:4096
    ds_read_b64_tr_b16 a[34:35], v21 offset:4608
    v_mfma_f32_16x16x32_bf16 v[76:79], a[72:75], a[56:59], v[76:79]
    ds_read_b64_tr_b16 a[36:37], v20 offset:8192
    v_mfma_f32_16x16x32_bf16 v[92:95], a[76:79], a[56:59], v[92:95]
    buffer_load_dwordx4 v15, s[24:27], s49 offen offset:1024 lds
    ds_read_b64_tr_b16 a[38:39], v20 offset:8704
    v_mfma_f32_16x16x32_bf16 v[88:91], a[76:79], a[52:55], v[88:91]
    ds_read_b64_tr_b16 a[40:41], v21 offset:8192
    v_mfma_f32_16x16x32_bf16 v[84:87], a[76:79], a[48:51], v[84:87]
    ds_read_b64_tr_b16 a[42:43], v21 offset:8704
    v_mfma_f32_16x16x32_bf16 v[80:83], a[76:79], a[44:47], v[80:83]
    s_add_u32 m0, s52, 112640
    v_mfma_f32_16x16x32_bf16 v[96:99], a[44:47], a[80:83], v[96:99]
    buffer_load_dwordx4 v16, s[24:27], s49 offen offset:0 lds
    v_mfma_f32_16x16x32_bf16 v[100:103], a[48:51], a[80:83], v[100:103]
    v_mfma_f32_16x16x32_bf16 v[136:139], a[60:63], a[80:83], v[136:139]
    v_mfma_f32_16x16x32_bf16 v[104:107], a[52:55], a[80:83], v[104:107]
    v_mfma_f32_16x16x32_bf16 v[108:111], a[56:59], a[80:83], v[108:111]
    buffer_load_dwordx4 v17, s[24:27], s49 offen offset:1024 lds
    v_mfma_f32_16x16x32_bf16 v[124:127], a[56:59], a[84:87], v[124:127]
    v_mfma_f32_16x16x32_bf16 v[120:123], a[52:55], a[84:87], v[120:123]
    v_mfma_f32_16x16x32_bf16 v[116:119], a[48:51], a[84:87], v[116:119]
    v_mfma_f32_16x16x32_bf16 v[112:115], a[44:47], a[84:87], v[112:115]
    s_waitcnt lgkmcnt(0)
    v_mfma_f32_16x16x32_bf16 v[32:35], a[20:23], a[0:3], v[32:35]
    s_add_u32 m0, s51, 36864
    ds_read_b64_tr_b16 a[64:65], v24 offset:0
    v_mfma_f32_16x16x32_bf16 v[36:39], a[20:23], a[4:7], v[36:39]
    buffer_load_dwordx4 v7, s[20:23], s48 offen offset:0 lds
    ds_read_b64_tr_b16 a[66:67], v24 offset:512
    v_mfma_f32_16x16x32_bf16 v[128:131], a[20:23], a[16:19], v[128:131]
    ds_read_b64_tr_b16 a[68:69], v25 offset:0
    v_mfma_f32_16x16x32_bf16 v[40:43], a[20:23], a[8:11], v[40:43]
    ds_read_b64_tr_b16 a[70:71], v25 offset:512
    v_mfma_f32_16x16x32_bf16 v[44:47], a[20:23], a[12:15], v[44:47]
    ds_read_b128 a[44:47], v22 offset:0
    v_mfma_f32_16x16x32_bf16 v[60:63], a[24:27], a[12:15], v[60:63]
    buffer_load_dwordx4 v8, s[20:23], s48 offen offset:1024 lds
    ds_read_b128 a[48:51], v22 offset:2048
    v_mfma_f32_16x16x32_bf16 v[56:59], a[24:27], a[8:11], v[56:59]
    ds_read_b128 a[52:55], v22 offset:4096
    v_mfma_f32_16x16x32_bf16 v[52:55], a[24:27], a[4:7], v[52:55]
    ds_read_b128 a[56:59], v22 offset:6144
    v_mfma_f32_16x16x32_bf16 v[48:51], a[24:27], a[0:3], v[48:51]
    ds_read_b128 a[60:63], v23 offset:0
    v_mfma_f32_16x16x32_bf16 v[64:67], a[28:31], a[0:3], v[64:67]
    ds_read_b64_tr_b16 a[72:73], v24 offset:4096
    v_mfma_f32_16x16x32_bf16 v[68:71], a[28:31], a[4:7], v[68:71]
    buffer_load_dwordx4 v9, s[20:23], s48 offen offset:2048 lds
    ds_read_b64_tr_b16 a[74:75], v24 offset:4608
    v_mfma_f32_16x16x32_bf16 v[132:135], a[28:31], a[16:19], v[132:135]
    ds_read_b64_tr_b16 a[76:77], v25 offset:4096
    v_mfma_f32_16x16x32_bf16 v[72:75], a[28:31], a[8:11], v[72:75]
    ds_read_b64_tr_b16 a[78:79], v25 offset:4608
    v_mfma_f32_16x16x32_bf16 v[76:79], a[28:31], a[12:15], v[76:79]
    ds_read_b64_tr_b16 a[80:81], v24 offset:8192
    v_mfma_f32_16x16x32_bf16 v[92:95], a[32:35], a[12:15], v[92:95]
    ds_read_b64_tr_b16 a[82:83], v24 offset:8704
    v_mfma_f32_16x16x32_bf16 v[88:91], a[32:35], a[8:11], v[88:91]
    buffer_load_dwordx4 v10, s[20:23], s48 offen offset:3072 lds
    ds_read_b64_tr_b16 a[84:85], v25 offset:8192
    v_mfma_f32_16x16x32_bf16 v[84:87], a[32:35], a[4:7], v[84:87]
    ds_read_b64_tr_b16 a[86:87], v25 offset:8704
    v_mfma_f32_16x16x32_bf16 v[80:83], a[32:35], a[0:3], v[80:83]
    v_mfma_f32_16x16x32_bf16 v[96:99], a[0:3], a[36:39], v[96:99]
    v_mfma_f32_16x16x32_bf16 v[100:103], a[4:7], a[36:39], v[100:103]
    s_add_u32 m0, s53, 53248
    v_mfma_f32_16x16x32_bf16 v[136:139], a[16:19], a[36:39], v[136:139]
    s_mov_b64 exec, s[54:55]
    buffer_load_dwordx4 v11, s[20:23], s48 offen lds
    s_mov_b64 exec, -1
    v_mfma_f32_16x16x32_bf16 v[104:107], a[8:11], a[36:39], v[104:107]
    v_mfma_f32_16x16x32_bf16 v[108:111], a[12:15], a[36:39], v[108:111]
    v_mfma_f32_16x16x32_bf16 v[124:127], a[12:15], a[40:43], v[124:127]
    v_mfma_f32_16x16x32_bf16 v[120:123], a[8:11], a[40:43], v[120:123]
    v_mfma_f32_16x16x32_bf16 v[116:119], a[4:7], a[40:43], v[116:119]
    v_mfma_f32_16x16x32_bf16 v[112:115], a[0:3], a[40:43], v[112:115]
    s_waitcnt vmcnt(11) lgkmcnt(0)
    s_barrier
    s_cmp_lg_u32 s44, 5
    s_cbranch_scc1 L_p1_nopf9_1
    buffer_load_dword a249, v237, s[32:35], 0 offen
L_p1_nopf9_1:
    v_mfma_f32_16x16x32_bf16 v[32:35], a[64:67], a[44:47], v[32:35]
    ds_read_b64_tr_b16 a[20:21], v20 offset:24576
    v_mfma_f32_16x16x32_bf16 v[36:39], a[64:67], a[48:51], v[36:39]
    ds_read_b64_tr_b16 a[22:23], v20 offset:25088
    v_mfma_f32_16x16x32_bf16 v[128:131], a[64:67], a[60:63], v[128:131]
    s_cmp_eq_u32 s61, 0
    s_cselect_b32 s67, 16, 12
    v_mfma_f32_16x16x32_bf16 v[40:43], a[64:67], a[52:55], v[40:43]
    s_add_u32 s67, s67, s60
    s_and_b32 s67, s67, 15
    v_mfma_f32_16x16x32_bf16 v[44:47], a[64:67], a[56:59], v[44:47]
    s_lshl_b32 s48, s67, 7
    s_mul_i32 s49, s67, 393216
    v_mfma_f32_16x16x32_bf16 v[60:63], a[68:71], a[56:59], v[60:63]
    s_add_u32 m0, s52, 55296
    ds_read_b64_tr_b16 a[24:25], v21 offset:24576
    v_mfma_f32_16x16x32_bf16 v[56:59], a[68:71], a[52:55], v[56:59]
    buffer_load_dwordx4 v12, s[24:27], s49 offen offset:0 lds
    buffer_load_dwordx4 v13, s[24:27], s49 offen offset:1024 lds
    v_mfma_f32_16x16x32_bf16 v[52:55], a[68:71], a[48:51], v[52:55]
    ds_read_b64_tr_b16 a[26:27], v21 offset:25088
    ds_read_b128 a[0:3], v18 offset:18432
    v_mfma_f32_16x16x32_bf16 v[48:51], a[68:71], a[44:47], v[48:51]
    ds_read_b128 a[4:7], v18 offset:20480
    ds_read_b128 a[8:11], v18 offset:22528
    v_mfma_f32_16x16x32_bf16 v[64:67], a[72:75], a[44:47], v[64:67]
    s_add_u32 m0, s52, 59392
    ds_read_b128 a[12:15], v18 offset:24576
    v_mfma_f32_16x16x32_bf16 v[68:71], a[72:75], a[48:51], v[68:71]
    buffer_load_dwordx4 v14, s[24:27], s49 offen offset:0 lds
    ds_read_b128 a[16:19], v19 offset:18432
    v_mfma_f32_16x16x32_bf16 v[132:135], a[72:75], a[60:63], v[132:135]
    ds_read_b64_tr_b16 a[28:29], v20 offset:28672
    ds_read_b64_tr_b16 a[30:31], v20 offset:29184
    v_mfma_f32_16x16x32_bf16 v[72:75], a[72:75], a[52:55], v[72:75]
    ds_read_b64_tr_b16 a[32:33], v21 offset:28672
    ds_read_b64_tr_b16 a[34:35], v21 offset:29184
    v_mfma_f32_16x16x32_bf16 v[76:79], a[72:75], a[56:59], v[76:79]
    ds_read_b64_tr_b16 a[36:37], v20 offset:32768
    v_mfma_f32_16x16x32_bf16 v[92:95], a[76:79], a[56:59], v[92:95]
    buffer_load_dwordx4 v15, s[24:27], s49 offen offset:1024 lds
    ds_read_b64_tr_b16 a[38:39], v20 offset:33280
    v_mfma_f32_16x16x32_bf16 v[88:91], a[76:79], a[52:55], v[88:91]
    ds_read_b64_tr_b16 a[40:41], v21 offset:32768
    v_mfma_f32_16x16x32_bf16 v[84:87], a[76:79], a[48:51], v[84:87]
    ds_read_b64_tr_b16 a[42:43], v21 offset:33280
    v_mfma_f32_16x16x32_bf16 v[80:83], a[76:79], a[44:47], v[80:83]
    s_add_u32 m0, s52, 63488
    v_mfma_f32_16x16x32_bf16 v[96:99], a[44:47], a[80:83], v[96:99]
    buffer_load_dwordx4 v16, s[24:27], s49 offen offset:0 lds
    v_mfma_f32_16x16x32_bf16 v[100:103], a[48:51], a[80:83], v[100:103]
    v_mfma_f32_16x16x32_bf16 v[136:139], a[60:63], a[80:83], v[136:139]
    v_mfma_f32_16x16x32_bf16 v[104:107], a[52:55], a[80:83], v[104:107]
    v_mfma_f32_16x16x32_bf16 v[108:111], a[56:59], a[80:83], v[108:111]
    buffer_load_dwordx4 v17, s[24:27], s49 offen offset:1024 lds
    v_mfma_f32_16x16x32_bf16 v[124:127], a[56:59], a[84:87], v[124:127]
    v_mfma_f32_16x16x32_bf16 v[120:123], a[52:55], a[84:87], v[120:123]
    v_mfma_f32_16x16x32_bf16 v[116:119], a[48:51], a[84:87], v[116:119]
    v_mfma_f32_16x16x32_bf16 v[112:115], a[44:47], a[84:87], v[112:115]
    s_waitcnt lgkmcnt(0)
    v_mfma_f32_16x16x32_bf16 v[32:35], a[20:23], a[0:3], v[32:35]
    s_add_u32 m0, s51, 0
    ds_read_b64_tr_b16 a[64:65], v24 offset:24576
    v_mfma_f32_16x16x32_bf16 v[36:39], a[20:23], a[4:7], v[36:39]
    buffer_load_dwordx4 v7, s[20:23], s48 offen offset:0 lds
    ds_read_b64_tr_b16 a[66:67], v24 offset:25088
    v_mfma_f32_16x16x32_bf16 v[128:131], a[20:23], a[16:19], v[128:131]
    ds_read_b64_tr_b16 a[68:69], v25 offset:24576
    v_mfma_f32_16x16x32_bf16 v[40:43], a[20:23], a[8:11], v[40:43]
    ds_read_b64_tr_b16 a[70:71], v25 offset:25088
    v_mfma_f32_16x16x32_bf16 v[44:47], a[20:23], a[12:15], v[44:47]
    ds_read_b128 a[44:47], v22 offset:18432
    v_mfma_f32_16x16x32_bf16 v[60:63], a[24:27], a[12:15], v[60:63]
    buffer_load_dwordx4 v8, s[20:23], s48 offen offset:1024 lds
    ds_read_b128 a[48:51], v22 offset:20480
    v_mfma_f32_16x16x32_bf16 v[56:59], a[24:27], a[8:11], v[56:59]
    ds_read_b128 a[52:55], v22 offset:22528
    v_mfma_f32_16x16x32_bf16 v[52:55], a[24:27], a[4:7], v[52:55]
    ds_read_b128 a[56:59], v22 offset:24576
    v_mfma_f32_16x16x32_bf16 v[48:51], a[24:27], a[0:3], v[48:51]
    ds_read_b128 a[60:63], v23 offset:18432
    v_mfma_f32_16x16x32_bf16 v[64:67], a[28:31], a[0:3], v[64:67]
    ds_read_b64_tr_b16 a[72:73], v24 offset:28672
    v_mfma_f32_16x16x32_bf16 v[68:71], a[28:31], a[4:7], v[68:71]
    buffer_load_dwordx4 v9, s[20:23], s48 offen offset:2048 lds
    ds_read_b64_tr_b16 a[74:75], v24 offset:29184
    v_mfma_f32_16x16x32_bf16 v[132:135], a[28:31], a[16:19], v[132:135]
    ds_read_b64_tr_b16 a[76:77], v25 offset:28672
    v_mfma_f32_16x16x32_bf16 v[72:75], a[28:31], a[8:11], v[72:75]
    ds_read_b64_tr_b16 a[78:79], v25 offset:29184
    v_mfma_f32_16x16x32_bf16 v[76:79], a[28:31], a[12:15], v[76:79]
    ds_read_b64_tr_b16 a[80:81], v24 offset:32768
    v_mfma_f32_16x16x32_bf16 v[92:95], a[32:35], a[12:15], v[92:95]
    ds_read_b64_tr_b16 a[82:83], v24 offset:33280
    v_mfma_f32_16x16x32_bf16 v[88:91], a[32:35], a[8:11], v[88:91]
    buffer_load_dwordx4 v10, s[20:23], s48 offen offset:3072 lds
    ds_read_b64_tr_b16 a[84:85], v25 offset:32768
    v_mfma_f32_16x16x32_bf16 v[84:87], a[32:35], a[4:7], v[84:87]
    ds_read_b64_tr_b16 a[86:87], v25 offset:33280
    v_mfma_f32_16x16x32_bf16 v[80:83], a[32:35], a[0:3], v[80:83]
    v_mfma_f32_16x16x32_bf16 v[96:99], a[0:3], a[36:39], v[96:99]
    v_mfma_f32_16x16x32_bf16 v[100:103], a[4:7], a[36:39], v[100:103]
    s_add_u32 m0, s53, 16384
    v_mfma_f32_16x16x32_bf16 v[136:139], a[16:19], a[36:39], v[136:139]
    s_mov_b64 exec, s[54:55]
    buffer_load_dwordx4 v11, s[20:23], s48 offen lds
    s_mov_b64 exec, -1
    v_mfma_f32_16x16x32_bf16 v[104:107], a[8:11], a[36:39], v[104:107]
    v_mfma_f32_16x16x32_bf16 v[108:111], a[12:15], a[36:39], v[108:111]
    v_mfma_f32_16x16x32_bf16 v[124:127], a[12:15], a[40:43], v[124:127]
    v_mfma_f32_16x16x32_bf16 v[120:123], a[8:11], a[40:43], v[120:123]
    v_mfma_f32_16x16x32_bf16 v[116:119], a[4:7], a[40:43], v[116:119]
    v_mfma_f32_16x16x32_bf16 v[112:115], a[0:3], a[40:43], v[112:115]
    s_waitcnt vmcnt(11) lgkmcnt(0)
    s_barrier
    s_cmp_lg_u32 s44, 6
    s_cbranch_scc1 L_p1_nopf10_1
    buffer_load_dword a249, v237, s[32:35], 0 offen
L_p1_nopf10_1:
    v_mfma_f32_16x16x32_bf16 v[32:35], a[64:67], a[44:47], v[32:35]
    ds_read_b64_tr_b16 a[20:21], v20 offset:49152
    v_mfma_f32_16x16x32_bf16 v[36:39], a[64:67], a[48:51], v[36:39]
    ds_read_b64_tr_b16 a[22:23], v20 offset:49664
    v_mfma_f32_16x16x32_bf16 v[128:131], a[64:67], a[60:63], v[128:131]
    s_cmp_eq_u32 s61, 1
    s_cselect_b32 s67, 17, 13
    v_mfma_f32_16x16x32_bf16 v[40:43], a[64:67], a[52:55], v[40:43]
    s_add_u32 s67, s67, s60
    s_and_b32 s67, s67, 15
    v_mfma_f32_16x16x32_bf16 v[44:47], a[64:67], a[56:59], v[44:47]
    s_lshl_b32 s48, s67, 7
    s_mul_i32 s49, s67, 393216
    v_mfma_f32_16x16x32_bf16 v[60:63], a[68:71], a[56:59], v[60:63]
    s_add_u32 m0, s52, 79872
    ds_read_b64_tr_b16 a[24:25], v21 offset:49152
    v_mfma_f32_16x16x32_bf16 v[56:59], a[68:71], a[52:55], v[56:59]
    buffer_load_dwordx4 v12, s[24:27], s49 offen offset:0 lds
    buffer_load_dwordx4 v13, s[24:27], s49 offen offset:1024 lds
    v_mfma_f32_16x16x32_bf16 v[52:55], a[68:71], a[48:51], v[52:55]
    ds_read_b64_tr_b16 a[26:27], v21 offset:49664
    ds_read_b128 a[0:3], v18 offset:36864
    v_mfma_f32_16x16x32_bf16 v[48:51], a[68:71], a[44:47], v[48:51]
    ds_read_b128 a[4:7], v18 offset:38912
    ds_read_b128 a[8:11], v18 offset:40960
    v_mfma_f32_16x16x32_bf16 v[64:67], a[72:75], a[44:47], v[64:67]
    s_add_u32 m0, s52, 83968
    ds_read_b128 a[12:15], v18 offset:43008
    v_mfma_f32_16x16x32_bf16 v[68:71], a[72:75], a[48:51], v[68:71]
    buffer_load_dwordx4 v14, s[24:27], s49 offen offset:0 lds
    ds_read_b128 a[16:19], v19 offset:36864
    v_mfma_f32_16x16x32_bf16 v[132:135], a[72:75], a[60:63], v[132:135]
    ds_read_b64_tr_b16 a[28:29], v20 offset:53248
    ds_read_b64_tr_b16 a[30:31], v20 offset:53760
    v_mfma_f32_16x16x32_bf16 v[72:75], a[72:75], a[52:55], v[72:75]
    ds_read_b64_tr_b16 a[32:33], v21 offset:53248
    ds_read_b64_tr_b16 a[34:35], v21 offset:53760
    v_mfma_f32_16x16x32_bf16 v[76:79], a[72:75], a[56:59], v[76:79]
    ds_read_b64_tr_b16 a[36:37], v20 offset:57344
    v_mfma_f32_16x16x32_bf16 v[92:95], a[76:79], a[56:59], v[92:95]
    buffer_load_dwordx4 v15, s[24:27], s49 offen offset:1024 lds
    ds_read_b64_tr_b16 a[38:39], v20 offset:57856
    v_mfma_f32_16x16x32_bf16 v[88:91], a[76:79], a[52:55], v[88:91]
    ds_read_b64_tr_b16 a[40:41], v21 offset:57344
    v_mfma_f32_16x16x32_bf16 v[84:87], a[76:79], a[48:51], v[84:87]
    ds_read_b64_tr_b16 a[42:43], v21 offset:57856
    v_mfma_f32_16x16x32_bf16 v[80:83], a[76:79], a[44:47], v[80:83]
    s_add_u32 m0, s52, 88064
    v_mfma_f32_16x16x32_bf16 v[96:99], a[44:47], a[80:83], v[96:99]
    buffer_load_dwordx4 v16, s[24:27], s49 offen offset:0 lds
    v_mfma_f32_16x16x32_bf16 v[100:103], a[48:51], a[80:83], v[100:103]
    v_mfma_f32_16x16x32_bf16 v[136:139], a[60:63], a[80:83], v[136:139]
    v_mfma_f32_16x16x32_bf16 v[104:107], a[52:55], a[80:83], v[104:107]
    v_mfma_f32_16x16x32_bf16 v[108:111], a[56:59], a[80:83], v[108:111]
    buffer_load_dwordx4 v17, s[24:27], s49 offen offset:1024 lds
    v_mfma_f32_16x16x32_bf16 v[124:127], a[56:59], a[84:87], v[124:127]
    v_mfma_f32_16x16x32_bf16 v[120:123], a[52:55], a[84:87], v[120:123]
    v_mfma_f32_16x16x32_bf16 v[116:119], a[48:51], a[84:87], v[116:119]
    v_mfma_f32_16x16x32_bf16 v[112:115], a[44:47], a[84:87], v[112:115]
    s_waitcnt lgkmcnt(0)
    v_mfma_f32_16x16x32_bf16 v[32:35], a[20:23], a[0:3], v[32:35]
    s_add_u32 m0, s51, 18432
    ds_read_b64_tr_b16 a[64:65], v24 offset:49152
    v_mfma_f32_16x16x32_bf16 v[36:39], a[20:23], a[4:7], v[36:39]
    buffer_load_dwordx4 v7, s[20:23], s48 offen offset:0 lds
    ds_read_b64_tr_b16 a[66:67], v24 offset:49664
    v_mfma_f32_16x16x32_bf16 v[128:131], a[20:23], a[16:19], v[128:131]
    ds_read_b64_tr_b16 a[68:69], v25 offset:49152
    s_lshl_b32 s15, s13, 4
    v_mfma_f32_16x16x32_bf16 v[40:43], a[20:23], a[8:11], v[40:43]
    ds_read_b64_tr_b16 a[70:71], v25 offset:49664
    s_sub_u32 s15, s15, 2
    v_mfma_f32_16x16x32_bf16 v[44:47], a[20:23], a[12:15], v[44:47]
    ds_read_b128 a[44:47], v22 offset:36864
    v_add_u32 v1, s15, v0
    v_mfma_f32_16x16x32_bf16 v[60:63], a[24:27], a[12:15], v[60:63]
    buffer_load_dwordx4 v8, s[20:23], s48 offen offset:1024 lds
    ds_read_b128 a[48:51], v22 offset:38912
    v_mfma_f32_16x16x32_bf16 v[56:59], a[24:27], a[8:11], v[56:59]
    ds_read_b128 a[52:55], v22 offset:40960
    v_max_i32 v1, 0, v1
    v_mfma_f32_16x16x32_bf16 v[52:55], a[24:27], a[4:7], v[52:55]
    ds_read_b128 a[56:59], v22 offset:43008
    s_lshl1_add_u32 s46, s14, s19
    v_mfma_f32_16x16x32_bf16 v[48:51], a[24:27], a[0:3], v[48:51]
    ds_read_b128 a[60:63], v23 offset:36864
    s_lshl_b32 s46, s46, 3
    v_mfma_f32_16x16x32_bf16 v[64:67], a[28:31], a[0:3], v[64:67]
    ds_read_b64_tr_b16 a[72:73], v24 offset:53248
    v_and_b32 v3, 7, v0
    v_mfma_f32_16x16x32_bf16 v[68:71], a[28:31], a[4:7], v[68:71]
    buffer_load_dwordx4 v9, s[20:23], s48 offen offset:2048 lds
    ds_read_b64_tr_b16 a[74:75], v24 offset:53760
    v_mfma_f32_16x16x32_bf16 v[132:135], a[28:31], a[16:19], v[132:135]
    ds_read_b64_tr_b16 a[76:77], v25 offset:53248
    v_add_u32 v3, s46, v3
    v_mfma_f32_16x16x32_bf16 v[72:75], a[28:31], a[8:11], v[72:75]
    ds_read_b64_tr_b16 a[78:79], v25 offset:53760
    v_cmp_gt_u32 vcc, 18, v0
    v_mfma_f32_16x16x32_bf16 v[76:79], a[28:31], a[12:15], v[76:79]
    ds_read_b64_tr_b16 a[80:81], v24 offset:57344
    s_lshl_b32 s46, s46, 7
    v_mfma_f32_16x16x32_bf16 v[92:95], a[32:35], a[12:15], v[92:95]
    ds_read_b64_tr_b16 a[82:83], v24 offset:57856
    s_add_u32 s46, s46, 0x18000
    v_mfma_f32_16x16x32_bf16 v[88:91], a[32:35], a[8:11], v[88:91]
    buffer_load_dwordx4 v10, s[20:23], s48 offen offset:3072 lds
    ds_read_b64_tr_b16 a[84:85], v25 offset:57344
    v_mfma_f32_16x16x32_bf16 v[84:87], a[32:35], a[4:7], v[84:87]
    ds_read_b64_tr_b16 a[86:87], v25 offset:57856
    v_cndmask_b32 v1, v3, v1, vcc
    v_mfma_f32_16x16x32_bf16 v[80:83], a[32:35], a[0:3], v[80:83]
    v_lshlrev_b32 v1, 7, v1
    v_add_u32 v1, 0x18000, v1
    v_mfma_f32_16x16x32_bf16 v[96:99], a[0:3], a[36:39], v[96:99]
    v_and_b32 v3, 1, v0
    v_lshlrev_b32 v3, 3, v3
    v_mfma_f32_16x16x32_bf16 v[100:103], a[4:7], a[36:39], v[100:103]
    s_add_u32 m0, s53, 34816
    v_lshl_add_u32 v3, v5, 7, v3
    v_mfma_f32_16x16x32_bf16 v[136:139], a[16:19], a[36:39], v[136:139]
    s_mov_b64 exec, s[54:55]
    buffer_load_dwordx4 v11, s[20:23], s48 offen lds
    s_mov_b64 exec, -1
    v_mfma_f32_16x16x32_bf16 v[104:107], a[8:11], a[36:39], v[104:107]
    s_lshl_b32 s69, s13, 11
    v_mfma_f32_16x16x32_bf16 v[108:111], a[12:15], a[36:39], v[108:111]
    s_lshl_b32 s68, s18, 5
    s_add_u32 s68, s68, s69
    v_mfma_f32_16x16x32_bf16 v[124:127], a[12:15], a[40:43], v[124:127]
    s_add_u32 s68, s68, 0x18000
    s_sub_i32 s69, s69, 256
    v_mfma_f32_16x16x32_bf16 v[120:123], a[8:11], a[40:43], v[120:123]
    s_max_i32 s69, s69, 0
    s_add_u32 s69, s69, 0x18000
    v_mfma_f32_16x16x32_bf16 v[116:119], a[4:7], a[40:43], v[116:119]
    v_mfma_f32_16x16x32_bf16 v[112:115], a[0:3], a[40:43], v[112:115]
    s_waitcnt vmcnt(11) lgkmcnt(0)
    s_barrier
    s_cmp_lg_u32 s44, 7
    s_cbranch_scc1 L_p1_nopf11_1
    buffer_load_dword a249, v237, s[32:35], 0 offen
L_p1_nopf11_1:
    v_mfma_f32_16x16x32_bf16 v[32:35], a[64:67], a[44:47], v[32:35]
    ds_read_b64_tr_b16 a[20:21], v20 offset:0
    v_mfma_f32_16x16x32_bf16 v[36:39], a[64:67], a[48:51], v[36:39]
    ds_read_b64_tr_b16 a[22:23], v20 offset:512
    v_mfma_f32_16x16x32_bf16 v[128:131], a[64:67], a[60:63], v[128:131]
    s_cmp_eq_u32 s61, 2
    s_cselect_b32 s67, 18, 14
    v_mfma_f32_16x16x32_bf16 v[40:43], a[64:67], a[52:55], v[40:43]
    s_add_u32 s67, s67, s60
    s_and_b32 s67, s67, 15
    v_mfma_f32_16x16x32_bf16 v[44:47], a[64:67], a[56:59], v[44:47]
    s_lshl_b32 s48, s67, 7
    s_mul_i32 s49, s67, 393216
    v_mfma_f32_16x16x32_bf16 v[60:63], a[68:71], a[56:59], v[60:63]
    s_add_u32 m0, s52, 104448
    ds_read_b64_tr_b16 a[24:25], v21 offset:0
    v_mfma_f32_16x16x32_bf16 v[56:59], a[68:71], a[52:55], v[56:59]
    buffer_load_dwordx4 v12, s[24:27], s49 offen offset:0 lds
    buffer_load_dwordx4 v13, s[24:27], s49 offen offset:1024 lds
    v_mfma_f32_16x16x32_bf16 v[52:55], a[68:71], a[48:51], v[52:55]
    ds_read_b64_tr_b16 a[26:27], v21 offset:512
    ds_read_b128 a[0:3], v18 offset:0
    v_mfma_f32_16x16x32_bf16 v[48:51], a[68:71], a[44:47], v[48:51]
    ds_read_b128 a[4:7], v18 offset:2048
    ds_read_b128 a[8:11], v18 offset:4096
    v_mfma_f32_16x16x32_bf16 v[64:67], a[72:75], a[44:47], v[64:67]
    s_add_u32 m0, s52, 108544
    ds_read_b128 a[12:15], v18 offset:6144
    v_mfma_f32_16x16x32_bf16 v[68:71], a[72:75], a[48:51], v[68:71]
    buffer_load_dwordx4 v14, s[24:27], s49 offen offset:0 lds
    ds_read_b128 a[16:19], v19 offset:0
    v_mfma_f32_16x16x32_bf16 v[132:135], a[72:75], a[60:63], v[132:135]
    ds_read_b64_tr_b16 a[28:29], v20 offset:4096
    ds_read_b64_tr_b16 a[30:31], v20 offset:4608
    v_mfma_f32_16x16x32_bf16 v[72:75], a[72:75], a[52:55], v[72:75]
    ds_read_b64_tr_b16 a[32:33], v21 offset:4096
    ds_read_b64_tr_b16 a[34:35], v21 offset:4608
    v_mfma_f32_16x16x32_bf16 v[76:79], a[72:75], a[56:59], v[76:79]
    ds_read_b64_tr_b16 a[36:37], v20 offset:8192
    v_mfma_f32_16x16x32_bf16 v[92:95], a[76:79], a[56:59], v[92:95]
    buffer_load_dwordx4 v15, s[24:27], s49 offen offset:1024 lds
    ds_read_b64_tr_b16 a[38:39], v20 offset:8704
    v_mfma_f32_16x16x32_bf16 v[88:91], a[76:79], a[52:55], v[88:91]
    ds_read_b64_tr_b16 a[40:41], v21 offset:8192
    v_mfma_f32_16x16x32_bf16 v[84:87], a[76:79], a[48:51], v[84:87]
    ds_read_b64_tr_b16 a[42:43], v21 offset:8704
    v_mfma_f32_16x16x32_bf16 v[80:83], a[76:79], a[44:47], v[80:83]
    s_add_u32 m0, s52, 112640
    v_mfma_f32_16x16x32_bf16 v[96:99], a[44:47], a[80:83], v[96:99]
    buffer_load_dwordx4 v16, s[24:27], s49 offen offset:0 lds
    v_mfma_f32_16x16x32_bf16 v[100:103], a[48:51], a[80:83], v[100:103]
    v_mfma_f32_16x16x32_bf16 v[136:139], a[60:63], a[80:83], v[136:139]
    v_mfma_f32_16x16x32_bf16 v[104:107], a[52:55], a[80:83], v[104:107]
    v_mfma_f32_16x16x32_bf16 v[108:111], a[56:59], a[80:83], v[108:111]
    buffer_load_dwordx4 v17, s[24:27], s49 offen offset:1024 lds
    v_mfma_f32_16x16x32_bf16 v[124:127], a[56:59], a[84:87], v[124:127]
    v_mfma_f32_16x16x32_bf16 v[120:123], a[52:55], a[84:87], v[120:123]
    v_mfma_f32_16x16x32_bf16 v[116:119], a[48:51], a[84:87], v[116:119]
    v_mfma_f32_16x16x32_bf16 v[112:115], a[44:47], a[84:87], v[112:115]
    s_waitcnt lgkmcnt(0)
    v_mfma_f32_16x16x32_bf16 v[32:35], a[20:23], a[0:3], v[32:35]
    s_add_u32 m0, s51, 36864
    ds_read_b64_tr_b16 a[64:65], v24 offset:0
    v_mfma_f32_16x16x32_bf16 v[36:39], a[20:23], a[4:7], v[36:39]
    buffer_load_dwordx4 v7, s[20:23], s48 offen offset:0 lds
    ds_read_b64_tr_b16 a[66:67], v24 offset:512
    v_mfma_f32_16x16x32_bf16 v[128:131], a[20:23], a[16:19], v[128:131]
    ds_read_b64_tr_b16 a[68:69], v25 offset:0
    v_mfma_f32_16x16x32_bf16 v[40:43], a[20:23], a[8:11], v[40:43]
    ds_read_b64_tr_b16 a[70:71], v25 offset:512
    v_mfma_f32_16x16x32_bf16 v[44:47], a[20:23], a[12:15], v[44:47]
    buffer_load_dwordx4 v8, s[20:23], s48 offen offset:1024 lds
    ds_read_b128 a[44:47], v22 offset:0
    v_mfma_f32_16x16x32_bf16 v[60:63], a[24:27], a[12:15], v[60:63]
    ds_read_b128 a[48:51], v22 offset:2048
    v_mfma_f32_16x16x32_bf16 v[56:59], a[24:27], a[8:11], v[56:59]
    ds_read_b128 a[52:55], v22 offset:4096
    v_mfma_f32_16x16x32_bf16 v[52:55], a[24:27], a[4:7], v[52:55]
    ds_read_b128 a[56:59], v22 offset:6144
    v_mfma_f32_16x16x32_bf16 v[48:51], a[24:27], a[0:3], v[48:51]
    buffer_load_dwordx4 v9, s[20:23], s48 offen offset:2048 lds
    ds_read_b128 a[60:63], v23 offset:0
    v_mfma_f32_16x16x32_bf16 v[64:67], a[28:31], a[0:3], v[64:67]
    ds_read_b64_tr_b16 a[72:73], v24 offset:4096
    v_mfma_f32_16x16x32_bf16 v[68:71], a[28:31], a[4:7], v[68:71]
    ds_read_b64_tr_b16 a[74:75], v24 offset:4608
    v_mfma_f32_16x16x32_bf16 v[132:135], a[28:31], a[16:19], v[132:135]
    ds_read_b64_tr_b16 a[76:77], v25 offset:4096
    v_mfma_f32_16x16x32_bf16 v[72:75], a[28:31], a[8:11], v[72:75]
    ds_read_b64_tr_b16 a[78:79], v25 offset:4608
    v_mfma_f32_16x16x32_bf16 v[76:79], a[28:31], a[12:15], v[76:79]
    buffer_load_dwordx4 v10, s[20:23], s48 offen offset:3072 lds
    ds_read_b64_tr_b16 a[80:81], v24 offset:8192
    v_mfma_f32_16x16x32_bf16 v[92:95], a[32:35], a[12:15], v[92:95]
    ds_read_b64_tr_b16 a[82:83], v24 offset:8704
    v_mfma_f32_16x16x32_bf16 v[88:91], a[32:35], a[8:11], v[88:91]
    ds_read_b64_tr_b16 a[84:85], v25 offset:8192
    v_mfma_f32_16x16x32_bf16 v[84:87], a[32:35], a[4:7], v[84:87]
    s_add_u32 m0, s53, 53248
    ds_read_b64_tr_b16 a[86:87], v25 offset:8704
    v_mfma_f32_16x16x32_bf16 v[80:83], a[32:35], a[0:3], v[80:83]
    s_mov_b64 exec, s[54:55]
    buffer_load_dwordx4 v11, s[20:23], s48 offen lds
    s_mov_b64 exec, -1
    v_mfma_f32_16x16x32_bf16 v[96:99], a[0:3], a[36:39], v[96:99]
    v_mfma_f32_16x16x32_bf16 v[100:103], a[4:7], a[36:39], v[100:103]
    v_mfma_f32_16x16x32_bf16 v[136:139], a[16:19], a[36:39], v[136:139]
    v_mfma_f32_16x16x32_bf16 v[104:107], a[8:11], a[36:39], v[104:107]
    buffer_load_dword v6, v1, s[76:79], 0 offen offset:96 sc1
    v_mfma_f32_16x16x32_bf16 v[108:111], a[12:15], a[36:39], v[108:111]
    v_mfma_f32_16x16x32_bf16 v[124:127], a[12:15], a[40:43], v[124:127]
    v_mfma_f32_16x16x32_bf16 v[120:123], a[8:11], a[40:43], v[120:123]
    v_mfma_f32_16x16x32_bf16 v[116:119], a[4:7], a[40:43], v[116:119]
    v_mfma_f32_16x16x32_bf16 v[112:115], a[0:3], a[40:43], v[112:115]
    s_waitcnt vmcnt(12) lgkmcnt(0)
    s_barrier
    v_mfma_f32_16x16x32_bf16 v[32:35], a[64:67], a[44:47], v[32:35]
    ds_read_b64_tr_b16 a[20:21], v20 offset:24576
    v_mfma_f32_16x16x32_bf16 v[36:39], a[64:67], a[48:51], v[36:39]
    ds_read_b64_tr_b16 a[22:23], v20 offset:25088
    v_mfma_f32_16x16x32_bf16 v[128:131], a[64:67], a[60:63], v[128:131]
    s_cmp_eq_u32 s61, 3
    s_cselect_b32 s67, 19, 15
    v_mfma_f32_16x16x32_bf16 v[40:43], a[64:67], a[52:55], v[40:43]
    s_add_u32 s67, s67, s60
    s_and_b32 s67, s67, 15
    v_mfma_f32_16x16x32_bf16 v[44:47], a[64:67], a[56:59], v[44:47]
    s_lshl_b32 s48, s67, 7
    s_mul_i32 s49, s67, 393216
    v_mfma_f32_16x16x32_bf16 v[60:63], a[68:71], a[56:59], v[60:63]
    s_add_u32 m0, s52, 55296
    ds_read_b64_tr_b16 a[24:25], v21 offset:24576
    v_mfma_f32_16x16x32_bf16 v[56:59], a[68:71], a[52:55], v[56:59]
    buffer_load_dwordx4 v12, s[24:27], s49 offen offset:0 lds
    buffer_load_dwordx4 v13, s[24:27], s49 offen offset:1024 lds
    v_mfma_f32_16x16x32_bf16 v[52:55], a[68:71], a[48:51], v[52:55]
    s_add_u32 m0, s52, 59392
    ds_read_b64_tr_b16 a[26:27], v21 offset:25088
    v_mfma_f32_16x16x32_bf16 v[48:51], a[68:71], a[44:47], v[48:51]
    buffer_load_dwordx4 v14, s[24:27], s49 offen offset:0 lds
    ds_read_b128 a[0:3], v18 offset:18432
    v_mfma_f32_16x16x32_bf16 v[64:67], a[72:75], a[44:47], v[64:67]
    ds_read_b128 a[4:7], v18 offset:20480
    ds_read_b128 a[8:11], v18 offset:22528
    v_mfma_f32_16x16x32_bf16 v[68:71], a[72:75], a[48:51], v[68:71]
    ds_read_b128 a[12:15], v18 offset:24576
    ds_read_b128 a[16:19], v19 offset:18432
    v_mfma_f32_16x16x32_bf16 v[132:135], a[72:75], a[60:63], v[132:135]
    buffer_load_dwordx4 v15, s[24:27], s49 offen offset:1024 lds
    ds_read_b64_tr_b16 a[28:29], v20 offset:28672
    v_mfma_f32_16x16x32_bf16 v[72:75], a[72:75], a[52:55], v[72:75]
    ds_read_b64_tr_b16 a[30:31], v20 offset:29184
    ds_read_b64_tr_b16 a[32:33], v21 offset:28672
    v_mfma_f32_16x16x32_bf16 v[76:79], a[72:75], a[56:59], v[76:79]
    s_add_u32 m0, s52, 63488
    ds_read_b64_tr_b16 a[34:35], v21 offset:29184
    v_mfma_f32_16x16x32_bf16 v[92:95], a[76:79], a[56:59], v[92:95]
    buffer_load_dwordx4 v16, s[24:27], s49 offen offset:0 lds
    ds_read_b64_tr_b16 a[36:37], v20 offset:32768
    v_mfma_f32_16x16x32_bf16 v[88:91], a[76:79], a[52:55], v[88:91]
    ds_read_b64_tr_b16 a[38:39], v20 offset:33280
    ds_read_b64_tr_b16 a[40:41], v21 offset:32768
    v_mfma_f32_16x16x32_bf16 v[84:87], a[76:79], a[48:51], v[84:87]
    ds_read_b64_tr_b16 a[42:43], v21 offset:33280
    v_mfma_f32_16x16x32_bf16 v[80:83], a[76:79], a[44:47], v[80:83]
    buffer_load_dwordx4 v17, s[24:27], s49 offen offset:1024 lds
    v_mfma_f32_16x16x32_bf16 v[96:99], a[44:47], a[80:83], v[96:99]
    v_mfma_f32_16x16x32_bf16 v[100:103], a[48:51], a[80:83], v[100:103]
    s_add_u32 m0, s51, 147456
    v_mfma_f32_16x16x32_bf16 v[136:139], a[60:63], a[80:83], v[136:139]
    buffer_load_dwordx4 v7, s[20:23], s47 offen offset:0 lds
    v_mfma_f32_16x16x32_bf16 v[104:107], a[52:55], a[80:83], v[104:107]
    v_mfma_f32_16x16x32_bf16 v[108:111], a[56:59], a[80:83], v[108:111]
    v_mfma_f32_16x16x32_bf16 v[124:127], a[56:59], a[84:87], v[124:127]
    buffer_load_dwordx4 v8, s[20:23], s47 offen offset:1024 lds
    v_mfma_f32_16x16x32_bf16 v[120:123], a[52:55], a[84:87], v[120:123]
    v_mfma_f32_16x16x32_bf16 v[116:119], a[48:51], a[84:87], v[116:119]
    v_mfma_f32_16x16x32_bf16 v[112:115], a[44:47], a[84:87], v[112:115]
    s_waitcnt lgkmcnt(0)
    v_mfma_f32_16x16x32_bf16 v[32:35], a[20:23], a[0:3], v[32:35]
    s_add_u32 m0, s51, 0
    ds_read_b64_tr_b16 a[64:65], v24 offset:24576
    v_mfma_f32_16x16x32_bf16 v[36:39], a[20:23], a[4:7], v[36:39]
    buffer_load_dwordx4 v7, s[20:23], s48 offen offset:0 lds
    ds_read_b64_tr_b16 a[66:67], v24 offset:25088
    v_mfma_f32_16x16x32_bf16 v[128:131], a[20:23], a[16:19], v[128:131]
    ds_read_b64_tr_b16 a[68:69], v25 offset:24576
    v_mfma_f32_16x16x32_bf16 v[40:43], a[20:23], a[8:11], v[40:43]
    buffer_load_dwordx4 v8, s[20:23], s48 offen offset:1024 lds
    ds_read_b64_tr_b16 a[70:71], v25 offset:25088
    v_mfma_f32_16x16x32_bf16 v[44:47], a[20:23], a[12:15], v[44:47]
    ds_read_b128 a[44:47], v22 offset:18432
    v_mfma_f32_16x16x32_bf16 v[60:63], a[24:27], a[12:15], v[60:63]
    ds_read_b128 a[48:51], v22 offset:20480
    v_mfma_f32_16x16x32_bf16 v[56:59], a[24:27], a[8:11], v[56:59]
    ds_read_b128 a[52:55], v22 offset:22528
    v_mfma_f32_16x16x32_bf16 v[52:55], a[24:27], a[4:7], v[52:55]
    buffer_load_dwordx4 v9, s[20:23], s48 offen offset:2048 lds
    ds_read_b128 a[56:59], v22 offset:24576
    v_mfma_f32_16x16x32_bf16 v[48:51], a[24:27], a[0:3], v[48:51]
    ds_read_b128 a[60:63], v23 offset:18432
    v_mfma_f32_16x16x32_bf16 v[64:67], a[28:31], a[0:3], v[64:67]
    ds_read_b64_tr_b16 a[72:73], v24 offset:28672
    v_mfma_f32_16x16x32_bf16 v[68:71], a[28:31], a[4:7], v[68:71]
    ds_read_b64_tr_b16 a[74:75], v24 offset:29184
    v_mfma_f32_16x16x32_bf16 v[132:135], a[28:31], a[16:19], v[132:135]
    buffer_load_dwordx4 v10, s[20:23], s48 offen offset:3072 lds
    ds_read_b64_tr_b16 a[76:77], v25 offset:28672
    v_mfma_f32_16x16x32_bf16 v[72:75], a[28:31], a[8:11], v[72:75]
    ds_read_b64_tr_b16 a[78:79], v25 offset:29184
    v_mfma_f32_16x16x32_bf16 v[76:79], a[28:31], a[12:15], v[76:79]
    s_add_u32 m0, s53, 16384
    ds_read_b64_tr_b16 a[80:81], v24 offset:32768
    v_mfma_f32_16x16x32_bf16 v[92:95], a[32:35], a[12:15], v[92:95]
    s_mov_b64 exec, s[54:55]
    buffer_load_dwordx4 v11, s[20:23], s48 offen lds
    s_mov_b64 exec, -1
    v_mfma_f32_16x16x32_bf16 v[88:91], a[32:35], a[8:11], v[88:91]
    ds_read_b64_tr_b16 a[82:83], v24 offset:33280
    v_mfma_f32_16x16x32_bf16 v[84:87], a[32:35], a[4:7], v[84:87]
    ds_read_b64_tr_b16 a[84:85], v25 offset:32768
    ds_read_b64_tr_b16 a[86:87], v25 offset:33280
    v_mfma_f32_16x16x32_bf16 v[80:83], a[32:35], a[0:3], v[80:83]
    s_add_u32 m0, s51, 147456
    v_mfma_f32_16x16x32_bf16 v[96:99], a[0:3], a[36:39], v[96:99]
    buffer_load_dwordx4 v9, s[20:23], s47 offen offset:2048 lds
    v_mfma_f32_16x16x32_bf16 v[100:103], a[4:7], a[36:39], v[100:103]
    v_mfma_f32_16x16x32_bf16 v[136:139], a[16:19], a[36:39], v[136:139]
    v_mfma_f32_16x16x32_bf16 v[104:107], a[8:11], a[36:39], v[104:107]
    v_mfma_f32_16x16x32_bf16 v[108:111], a[12:15], a[36:39], v[108:111]
    buffer_load_dwordx4 v10, s[20:23], s47 offen offset:3072 lds
    v_mfma_f32_16x16x32_bf16 v[124:127], a[12:15], a[40:43], v[124:127]
    v_mfma_f32_16x16x32_bf16 v[120:123], a[8:11], a[40:43], v[120:123]
    v_mfma_f32_16x16x32_bf16 v[116:119], a[4:7], a[40:43], v[116:119]
    v_mfma_f32_16x16x32_bf16 v[112:115], a[0:3], a[40:43], v[112:115]
    s_waitcnt vmcnt(15) lgkmcnt(0)
    s_mov_b32 s17, 0x40000
L_p1_chk:
    v_cmp_ne_u32 vcc, s100, v6
    s_nop 0
    s_cmp_eq_u64 vcc, 0
    s_cbranch_scc1 L_p1_ok
    s_mov_b64 exec, vcc
    buffer_load_dword v6, v1, s[76:79], 0 offen offset:96 sc1
    s_waitcnt vmcnt(0)
    s_sub_u32 s17, s17, 1
    s_cmp_lg_u32 s17, 0
    s_cbranch_scc1 L_p1_chk
L_p1_ok:
    s_mov_b64 exec, -1
    s_barrier
    v_mfma_f32_16x16x32_bf16 v[32:35], a[64:67], a[44:47], v[32:35]
    buffer_load_dword v148, v230, s[76:79], s69 offen offset:0 sc1
    ds_read_b64_tr_b16 a[20:21], v20 offset:49152
    v_mfma_f32_16x16x32_bf16 v[36:39], a[64:67], a[48:51], v[36:39]
    ds_read_b64_tr_b16 a[22:23], v20 offset:49664
    s_and_b32 s48, s2, 2
    v_mfma_f32_16x16x32_bf16 v[128:131], a[64:67], a[60:63], v[128:131]
    buffer_load_dwordx4 v[184:187], v231, s[76:79], s69 offen offset:0 sc1
    ds_read_b64_tr_b16 a[24:25], v21 offset:49152
    v_mfma_f32_16x16x32_bf16 v[40:43], a[64:67], a[52:55], v[40:43]
    ds_read_b64_tr_b16 a[26:27], v21 offset:49664
    s_lshl_b32 s48, s48, 2
    v_mfma_f32_16x16x32_bf16 v[44:47], a[64:67], a[56:59], v[44:47]
    buffer_load_dword v149, v230, s[76:79], s69 offen offset:16 sc1
    ds_read_b128 a[0:3], v18 offset:36864
    v_mfma_f32_16x16x32_bf16 v[60:63], a[68:71], a[56:59], v[60:63]
    ds_read_b128 a[4:7], v18 offset:38912
    s_lshr_b32 s49, s2, 6
    v_mfma_f32_16x16x32_bf16 v[56:59], a[68:71], a[52:55], v[56:59]
    ds_read_b128 a[8:11], v18 offset:40960
    s_lshl1_add_u32 s48, s49, s48
    v_mfma_f32_16x16x32_bf16 v[52:55], a[68:71], a[48:51], v[52:55]
    buffer_load_dwordx4 v[188:191], v231, s[76:79], s69 offen offset:16 sc1
    ds_read_b128 a[12:15], v18 offset:43008
    v_mfma_f32_16x16x32_bf16 v[48:51], a[68:71], a[44:47], v[48:51]
    ds_read_b128 a[16:19], v19 offset:36864
    s_bfe_u32 s49, s2, 0x10002
    v_mfma_f32_16x16x32_bf16 v[64:67], a[72:75], a[44:47], v[64:67]
    buffer_load_dword v140, v228, s[76:79], s68 offen offset:0 sc1
    ds_read_b64_tr_b16 a[28:29], v20 offset:53248
    v_mfma_f32_16x16x32_bf16 v[68:71], a[72:75], a[48:51], v[68:71]
    ds_read_b64_tr_b16 a[30:31], v20 offset:53760
    s_add_u32 s48, s48, s49
    v_mfma_f32_16x16x32_bf16 v[132:135], a[72:75], a[60:63], v[132:135]
    buffer_load_dword v141, v228, s[76:79], s68 offen offset:16 sc1
    ds_read_b64_tr_b16 a[32:33], v21 offset:53248
    v_mfma_f32_16x16x32_bf16 v[72:75], a[72:75], a[52:55], v[72:75]
    ds_read_b64_tr_b16 a[34:35], v21 offset:53760
    v_lshlrev_b32 v13, 1, v5
    v_mfma_f32_16x16x32_bf16 v[76:79], a[72:75], a[56:59], v[76:79]
    ds_read_b64_tr_b16 a[36:37], v20 offset:57344
    v_and_b32 v14, 7, v0
    v_mfma_f32_16x16x32_bf16 v[92:95], a[76:79], a[56:59], v[92:95]
    buffer_load_dword v142, v228, s[76:79], s68 offen offset:512 sc1
    ds_read_b64_tr_b16 a[38:39], v20 offset:57856
    v_mfma_f32_16x16x32_bf16 v[88:91], a[76:79], a[52:55], v[88:91]
    ds_read_b64_tr_b16 a[40:41], v21 offset:57344
    v_xor_b32 v13, v13, v14
    v_mfma_f32_16x16x32_bf16 v[84:87], a[76:79], a[48:51], v[84:87]
    buffer_load_dword v143, v228, s[76:79], s68 offen offset:528 sc1
    ds_read_b64_tr_b16 a[42:43], v21 offset:57856
    v_mfma_f32_16x16x32_bf16 v[80:83], a[76:79], a[44:47], v[80:83]
    v_lshlrev_b32 v13, 4, v13
    v_lshrrev_b32 v14, 3, v0
    v_mfma_f32_16x16x32_bf16 v[96:99], a[44:47], a[80:83], v[96:99]
    buffer_load_dword v144, v228, s[76:79], s68 offen offset:1024 sc1
    v_lshl_add_u32 v13, v14, 11, v13
    v_mfma_f32_16x16x32_bf16 v[100:103], a[48:51], a[80:83], v[100:103]
    s_lshl_b32 s49, s3, 16
    v_add_u32 v13, s49, v13
    v_mfma_f32_16x16x32_bf16 v[136:139], a[60:63], a[80:83], v[136:139]
    s_lshl_b32 s49, s48, 7
    v_add_u32 v13, s49, v13
    v_mfma_f32_16x16x32_bf16 v[104:107], a[52:55], a[80:83], v[104:107]
    buffer_load_dword v145, v228, s[76:79], s68 offen offset:1040 sc1
    v_mfma_f32_16x16x32_bf16 v[108:111], a[56:59], a[80:83], v[108:111]
    v_mfma_f32_16x16x32_bf16 v[124:127], a[56:59], a[84:87], v[124:127]
    buffer_load_dword v146, v228, s[76:79], s68 offen offset:1536 sc1
    v_mfma_f32_16x16x32_bf16 v[120:123], a[52:55], a[84:87], v[120:123]
    v_mfma_f32_16x16x32_bf16 v[116:119], a[48:51], a[84:87], v[116:119]
    v_mfma_f32_16x16x32_bf16 v[112:115], a[44:47], a[84:87], v[112:115]
    s_waitcnt lgkmcnt(0)
    v_mfma_f32_16x16x32_bf16 v[32:35], a[20:23], a[0:3], v[32:35]
    buffer_load_dword v147, v228, s[76:79], s68 offen offset:1552 sc1
    ds_read_b64_tr_b16 a[64:65], v24 offset:49152
    v_mfma_f32_16x16x32_bf16 v[36:39], a[20:23], a[4:7], v[36:39]
    buffer_load_dwordx4 v[152:155], v229, s[76:79], s68 offen offset:0 sc1
    ds_read_b64_tr_b16 a[66:67], v24 offset:49664
    v_mfma_f32_16x16x32_bf16 v[128:131], a[20:23], a[16:19], v[128:131]
    ds_read_b64_tr_b16 a[68:69], v25 offset:49152
    v_mfma_f32_16x16x32_bf16 v[40:43], a[20:23], a[8:11], v[40:43]
    buffer_load_dwordx4 v[156:159], v229, s[76:79], s68 offen offset:16 sc1
    ds_read_b64_tr_b16 a[70:71], v25 offset:49664
    v_mfma_f32_16x16x32_bf16 v[44:47], a[20:23], a[12:15], v[44:47]
    ds_read_b128 a[44:47], v22 offset:36864
    v_mfma_f32_16x16x32_bf16 v[60:63], a[24:27], a[12:15], v[60:63]
    buffer_load_dwordx4 v[160:163], v229, s[76:79], s68 offen offset:512 sc1
    ds_read_b128 a[48:51], v22 offset:38912
    v_mfma_f32_16x16x32_bf16 v[56:59], a[24:27], a[8:11], v[56:59]
    buffer_load_dwordx4 v[164:167], v229, s[76:79], s68 offen offset:528 sc1
    ds_read_b128 a[52:55], v22 offset:40960
    v_mfma_f32_16x16x32_bf16 v[52:55], a[24:27], a[4:7], v[52:55]
    ds_read_b128 a[56:59], v22 offset:43008
    v_mfma_f32_16x16x32_bf16 v[48:51], a[24:27], a[0:3], v[48:51]
    buffer_load_dwordx4 v[168:171], v229, s[76:79], s68 offen offset:1024 sc1
    ds_read_b128 a[60:63], v23 offset:36864
    v_mfma_f32_16x16x32_bf16 v[64:67], a[28:31], a[0:3], v[64:67]
    ds_read_b64_tr_b16 a[72:73], v24 offset:53248
    v_mfma_f32_16x16x32_bf16 v[68:71], a[28:31], a[4:7], v[68:71]
    buffer_load_dwordx4 v[172:175], v229, s[76:79], s68 offen offset:1040 sc1
    ds_read_b64_tr_b16 a[74:75], v24 offset:53760
    v_mfma_f32_16x16x32_bf16 v[132:135], a[28:31], a[16:19], v[132:135]
    ds_read_b64_tr_b16 a[76:77], v25 offset:53248
    v_mfma_f32_16x16x32_bf16 v[72:75], a[28:31], a[8:11], v[72:75]
    buffer_load_dwordx4 v[176:179], v229, s[76:79], s68 offen offset:1536 sc1
    ds_read_b64_tr_b16 a[78:79], v25 offset:53760
    v_mfma_f32_16x16x32_bf16 v[76:79], a[28:31], a[12:15], v[76:79]
    buffer_load_dwordx4 v[180:183], v229, s[76:79], s68 offen offset:1552 sc1
    ds_read_b64_tr_b16 a[80:81], v24 offset:57344
    v_mfma_f32_16x16x32_bf16 v[92:95], a[32:35], a[12:15], v[92:95]
    ds_read_b64_tr_b16 a[82:83], v24 offset:57856
    v_mfma_f32_16x16x32_bf16 v[88:91], a[32:35], a[8:11], v[88:91]
    buffer_load_dwordx2 a[88:89], v3, s[76:79], s46 offen offset:64 sc1
    ds_read_b64_tr_b16 a[84:85], v25 offset:57344
    v_mfma_f32_16x16x32_bf16 v[84:87], a[32:35], a[4:7], v[84:87]
    ds_read_b64_tr_b16 a[86:87], v25 offset:57856
    v_mfma_f32_16x16x32_bf16 v[80:83], a[32:35], a[0:3], v[80:83]
    buffer_load_dwordx2 a[90:91], v3, s[76:79], s46 offen offset:576 sc1
    v_mfma_f32_16x16x32_bf16 v[96:99], a[0:3], a[36:39], v[96:99]
    s_mov_b32 s49, 0x140000
    s_add_u32 m0, s51, 81920
    v_mfma_f32_16x16x32_bf16 v[100:103], a[4:7], a[36:39], v[100:103]
    buffer_load_dwordx4 v13, s[36:39], s49 offen offset:0 lds
    s_add_u32 s49, s49, 15360
    v_mfma_f32_16x16x32_bf16 v[136:139], a[16:19], a[36:39], v[136:139]
    buffer_load_dwordx4 v13, s[36:39], s49 offen offset:1024 lds
    v_mfma_f32_16x16x32_bf16 v[104:107], a[8:11], a[36:39], v[104:107]
    s_add_u32 s49, s49, 15360
    v_mfma_f32_16x16x32_bf16 v[108:111], a[12:15], a[36:39], v[108:111]
    buffer_load_dwordx4 v13, s[36:39], s49 offen offset:2048 lds
    v_mfma_f32_16x16x32_bf16 v[124:127], a[12:15], a[40:43], v[124:127]
    s_add_u32 s49, s49, 15360
    v_mfma_f32_16x16x32_bf16 v[120:123], a[8:11], a[40:43], v[120:123]
    buffer_load_dwordx4 v13, s[36:39], s49 offen offset:3072 lds
    v_mfma_f32_16x16x32_bf16 v[116:119], a[4:7], a[40:43], v[116:119]
    v_mfma_f32_16x16x32_bf16 v[112:115], a[0:3], a[40:43], v[112:115]
    s_waitcnt vmcnt(28) lgkmcnt(0)
    s_barrier
    v_mfma_f32_16x16x32_bf16 v[32:35], a[64:67], a[44:47], v[32:35]
    s_mov_b32 s49, 0x180000
    s_add_u32 m0, s51, 32768
    v_mfma_f32_16x16x32_bf16 v[36:39], a[64:67], a[48:51], v[36:39]
    buffer_load_dwordx4 v13, s[36:39], s49 offen offset:0 lds
    ds_read_b64_tr_b16 a[20:21], v20 offset:0
    v_mfma_f32_16x16x32_bf16 v[128:131], a[64:67], a[60:63], v[128:131]
    ds_read_b64_tr_b16 a[22:23], v20 offset:512
    ds_read_b64_tr_b16 a[24:25], v21 offset:0
    v_mfma_f32_16x16x32_bf16 v[40:43], a[64:67], a[52:55], v[40:43]
    ds_read_b64_tr_b16 a[26:27], v21 offset:512
    v_mfma_f32_16x16x32_bf16 v[44:47], a[64:67], a[56:59], v[44:47]
    ds_read_b128 a[0:3], v18 offset:0
    v_mfma_f32_16x16x32_bf16 v[60:63], a[68:71], a[56:59], v[60:63]
    s_add_u32 s49, s49, 15360
    ds_read_b128 a[4:7], v18 offset:2048
    v_mfma_f32_16x16x32_bf16 v[56:59], a[68:71], a[52:55], v[56:59]
    buffer_load_dwordx4 v13, s[36:39], s49 offen offset:1024 lds
    ds_read_b128 a[8:11], v18 offset:4096
    v_mfma_f32_16x16x32_bf16 v[52:55], a[68:71], a[48:51], v[52:55]
    ds_read_b128 a[12:15], v18 offset:6144
    v_mfma_f32_16x16x32_bf16 v[48:51], a[68:71], a[44:47], v[48:51]
    ds_read_b128 a[16:19], v19 offset:0
    v_mfma_f32_16x16x32_bf16 v[64:67], a[72:75], a[44:47], v[64:67]
    ds_read_b64_tr_b16 a[28:29], v20 offset:4096
    v_mfma_f32_16x16x32_bf16 v[68:71], a[72:75], a[48:51], v[68:71]
    ds_read_b64_tr_b16 a[30:31], v20 offset:4608
    v_mfma_f32_16x16x32_bf16 v[132:135], a[72:75], a[60:63], v[132:135]
    ds_read_b64_tr_b16 a[32:33], v21 offset:4096
    v_mfma_f32_16x16x32_bf16 v[72:75], a[72:75], a[52:55], v[72:75]
    s_add_u32 s49, s49, 15360
    ds_read_b64_tr_b16 a[34:35], v21 offset:4608
    v_mfma_f32_16x16x32_bf16 v[76:79], a[72:75], a[56:59], v[76:79]
    buffer_load_dwordx4 v13, s[36:39], s49 offen offset:2048 lds
    ds_read_b64_tr_b16 a[36:37], v20 offset:8192
    v_mfma_f32_16x16x32_bf16 v[92:95], a[76:79], a[56:59], v[92:95]
    ds_read_b64_tr_b16 a[38:39], v20 offset:8704
    v_mfma_f32_16x16x32_bf16 v[88:91], a[76:79], a[52:55], v[88:91]
    ds_read_b64_tr_b16 a[40:41], v21 offset:8192
    v_mfma_f32_16x16x32_bf16 v[84:87], a[76:79], a[48:51], v[84:87]
    ds_read_b64_tr_b16 a[42:43], v21 offset:8704
    v_mfma_f32_16x16x32_bf16 v[80:83], a[76:79], a[44:47], v[80:83]
    v_mfma_f32_16x16x32_bf16 v[96:99], a[44:47], a[80:83], v[96:99]
    s_add_u32 s49, s49, 15360
    v_mfma_f32_16x16x32_bf16 v[100:103], a[48:51], a[80:83], v[100:103]
    buffer_load_dwordx4 v13, s[36:39], s49 offen offset:3072 lds
    v_mfma_f32_16x16x32_bf16 v[136:139], a[60:63], a[80:83], v[136:139]
    v_mfma_f32_16x16x32_bf16 v[104:107], a[52:55], a[80:83], v[104:107]
    v_mfma_f32_16x16x32_bf16 v[108:111], a[56:59], a[80:83], v[108:111]
    v_mfma_f32_16x16x32_bf16 v[124:127], a[56:59], a[84:87], v[124:127]
    v_mfma_f32_16x16x32_bf16 v[120:123], a[52:55], a[84:87], v[120:123]
    v_mfma_f32_16x16x32_bf16 v[116:119], a[48:51], a[84:87], v[116:119]
    v_mfma_f32_16x16x32_bf16 v[112:115], a[44:47], a[84:87], v[112:115]
    s_waitcnt lgkmcnt(0)
    v_mfma_f32_16x16x32_bf16 v[32:35], a[20:23], a[0:3], v[32:35]
    s_mov_b32 s49, 0x0
    s_add_u32 m0, s51, 98304
    v_mfma_f32_16x16x32_bf16 v[36:39], a[20:23], a[4:7], v[36:39]
    buffer_load_dwordx4 v13, s[36:39], s49 offen offset:0 lds
    ds_read_b64_tr_b16 a[64:65], v24 offset:0
    v_mfma_f32_16x16x32_bf16 v[128:131], a[20:23], a[16:19], v[128:131]
    ds_read_b64_tr_b16 a[66:67], v24 offset:512
    ds_read_b64_tr_b16 a[68:69], v25 offset:0
    v_mfma_f32_16x16x32_bf16 v[40:43], a[20:23], a[8:11], v[40:43]
    ds_read_b64_tr_b16 a[70:71], v25 offset:512
    s_mul_i32 s15, s3, 3072
    v_mfma_f32_16x16x32_bf16 v[44:47], a[20:23], a[12:15], v[44:47]
    ds_read_b128 a[44:47], v22 offset:0
    s_add_u32 s15, s15, 131072
    v_mfma_f32_16x16x32_bf16 v[60:63], a[24:27], a[12:15], v[60:63]
    s_add_u32 s49, s49, 15360
    ds_read_b128 a[48:51], v22 offset:2048
    v_mfma_f32_16x16x32_bf16 v[56:59], a[24:27], a[8:11], v[56:59]
    buffer_load_dwordx4 v13, s[36:39], s49 offen offset:1024 lds
    ds_read_b128 a[52:55], v22 offset:4096
    v_mfma_f32_16x16x32_bf16 v[52:55], a[24:27], a[4:7], v[52:55]
    ds_read_b128 a[56:59], v22 offset:6144
    s_xor_b32 s16, s3, 2
    v_mfma_f32_16x16x32_bf16 v[48:51], a[24:27], a[0:3], v[48:51]
    ds_read_b128 a[60:63], v23 offset:0
    s_mul_i32 s16, s16, 3072
    v_mfma_f32_16x16x32_bf16 v[64:67], a[28:31], a[0:3], v[64:67]
    ds_read_b64_tr_b16 a[72:73], v24 offset:4096
    s_add_u32 s16, s16, 131072
    v_mfma_f32_16x16x32_bf16 v[68:71], a[28:31], a[4:7], v[68:71]
    ds_read_b64_tr_b16 a[74:75], v24 offset:4608
    v_add_u32 v7, s15, v2
    v_mfma_f32_16x16x32_bf16 v[132:135], a[28:31], a[16:19], v[132:135]
    ds_read_b64_tr_b16 a[76:77], v25 offset:4096
    v_add_u32 v8, s16, v2
    v_mfma_f32_16x16x32_bf16 v[72:75], a[28:31], a[8:11], v[72:75]
    s_add_u32 s49, s49, 15360
    ds_read_b64_tr_b16 a[78:79], v25 offset:4608
    v_mfma_f32_16x16x32_bf16 v[76:79], a[28:31], a[12:15], v[76:79]
    buffer_load_dwordx4 v13, s[36:39], s49 offen offset:2048 lds
    ds_read_b64_tr_b16 a[80:81], v24 offset:8192
    v_mfma_f32_16x16x32_bf16 v[92:95], a[32:35], a[12:15], v[92:95]
    ds_read_b64_tr_b16 a[82:83], v24 offset:8704
    v_lshlrev_b32 v1, 8, v5
    v_mfma_f32_16x16x32_bf16 v[88:91], a[32:35], a[8:11], v[88:91]
    ds_read_b64_tr_b16 a[84:85], v25 offset:8192
    v_add_u32 v9, s15, v1
    v_mfma_f32_16x16x32_bf16 v[84:87], a[32:35], a[4:7], v[84:87]
    ds_read_b64_tr_b16 a[86:87], v25 offset:8704
    v_add_u32 v10, s16, v1
    v_mfma_f32_16x16x32_bf16 v[80:83], a[32:35], a[0:3], v[80:83]
    v_lshlrev_b32 v1, 4, v4
    v_add_u32 v11, s15, v1
    v_mfma_f32_16x16x32_bf16 v[96:99], a[0:3], a[36:39], v[96:99]
    s_add_u32 s49, s49, 15360
    v_add_u32 v12, s16, v1
    v_mfma_f32_16x16x32_bf16 v[100:103], a[4:7], a[36:39], v[100:103]
    buffer_load_dwordx4 v13, s[36:39], s49 offen offset:3072 lds
    s_lshl_b32 s68, s14, 1
    v_mfma_f32_16x16x32_bf16 v[136:139], a[16:19], a[36:39], v[136:139]
    s_add_u32 s68, s68, s19
    s_lshl_b32 s68, s68, 17
    v_mfma_f32_16x16x32_bf16 v[104:107], a[8:11], a[36:39], v[104:107]
    s_lshl_b32 s17, s13, 1
    s_add_u32 s17, s17, s18
    v_mfma_f32_16x16x32_bf16 v[108:111], a[12:15], a[36:39], v[108:111]
    s_lshl_b32 s17, s17, 12
    s_add_u32 s68, s68, s17
    v_mfma_f32_16x16x32_bf16 v[124:127], a[12:15], a[40:43], v[124:127]
    s_mov_b32 s66, 0x3e8293ee
    s_lshl1_add_u32 s17, s14, s19
    v_mfma_f32_16x16x32_bf16 v[120:123], a[8:11], a[40:43], v[120:123]
    s_lshl_b32 s69, s13, 5
    s_add_u32 s69, s69, s17
    v_mfma_f32_16x16x32_bf16 v[116:119], a[4:7], a[40:43], v[116:119]
    s_lshl1_add_u32 s69, s69, s18
    s_lshl_b32 s69, s69, 8
    v_mfma_f32_16x16x32_bf16 v[112:115], a[0:3], a[40:43], v[112:115]
    s_add_u32 s69, s69, 0x40000
    v_lshrrev_b32 v16, 1, v5
    s_waitcnt vmcnt(12) lgkmcnt(0)
    v_mfma_f32_16x16x32_bf16 v[32:35], a[64:67], a[44:47], v[32:35]
    s_mov_b32 s49, 0x40000
    s_add_u32 m0, s51, 114688
    v_mfma_f32_16x16x32_bf16 v[36:39], a[64:67], a[48:51], v[36:39]
    buffer_load_dwordx4 v13, s[36:39], s49 offen offset:0 lds
    v_lshlrev_b32 v16, 7, v16
    v_mfma_f32_16x16x32_bf16 v[128:131], a[64:67], a[60:63], v[128:131]
    v_lshl_add_u32 v16, v4, 3, v16
    v_and_b32 v1, 1, v5
    v_mfma_f32_16x16x32_bf16 v[40:43], a[64:67], a[52:55], v[40:43]
    v_lshl_add_u32 v16, v1, 2, v16
    v_mfma_f32_16x16x32_bf16 v[44:47], a[64:67], a[56:59], v[44:47]
    v_mfma_f32_16x16x32_bf16 v[60:63], a[68:71], a[56:59], v[60:63]
    s_add_u32 s49, s49, 15360
    v_mfma_f32_16x16x32_bf16 v[56:59], a[68:71], a[52:55], v[56:59]
    buffer_load_dwordx4 v13, s[36:39], s49 offen offset:1024 lds
    v_mfma_f32_16x16x32_bf16 v[52:55], a[68:71], a[48:51], v[52:55]
    v_mfma_f32_16x16x32_bf16 v[48:51], a[68:71], a[44:47], v[48:51]
    v_mfma_f32_16x16x32_bf16 v[64:67], a[72:75], a[44:47], v[64:67]
    v_mfma_f32_16x16x32_bf16 v[68:71], a[72:75], a[48:51], v[68:71]
    v_mfma_f32_16x16x32_bf16 v[132:135], a[72:75], a[60:63], v[132:135]
    v_mfma_f32_16x16x32_bf16 v[72:75], a[72:75], a[52:55], v[72:75]
    s_add_u32 s49, s49, 15360
    v_mfma_f32_16x16x32_bf16 v[76:79], a[72:75], a[56:59], v[76:79]
    buffer_load_dwordx4 v13, s[36:39], s49 offen offset:2048 lds
    v_mfma_f32_16x16x32_bf16 v[92:95], a[76:79], a[56:59], v[92:95]
    v_mfma_f32_16x16x32_bf16 v[88:91], a[76:79], a[52:55], v[88:91]
    v_mfma_f32_16x16x32_bf16 v[84:87], a[76:79], a[48:51], v[84:87]
    v_mfma_f32_16x16x32_bf16 v[80:83], a[76:79], a[44:47], v[80:83]
    v_mfma_f32_16x16x32_bf16 v[96:99], a[44:47], a[80:83], v[96:99]
    s_add_u32 s49, s49, 15360
    v_mfma_f32_16x16x32_bf16 v[100:103], a[48:51], a[80:83], v[100:103]
    buffer_load_dwordx4 v13, s[36:39], s49 offen offset:3072 lds
    v_mfma_f32_16x16x32_bf16 v[136:139], a[60:63], a[80:83], v[136:139]
    v_mfma_f32_16x16x32_bf16 v[104:107], a[52:55], a[80:83], v[104:107]
    v_mfma_f32_16x16x32_bf16 v[108:111], a[56:59], a[80:83], v[108:111]
    v_mfma_f32_16x16x32_bf16 v[124:127], a[56:59], a[84:87], v[124:127]
    v_mfma_f32_16x16x32_bf16 v[120:123], a[52:55], a[84:87], v[120:123]
    v_mfma_f32_16x16x32_bf16 v[116:119], a[48:51], a[84:87], v[116:119]
    v_mfma_f32_16x16x32_bf16 v[112:115], a[44:47], a[84:87], v[112:115]
    ds_write_b128 v7, v[128:131] offset:0
    ds_write_b128 v7, v[132:135] offset:1024
    ds_write_b128 v7, v[136:139] offset:2048
    s_waitcnt lgkmcnt(0)
    s_barrier
    ds_read_b128 v[216:219], v9 offset:1024
    ds_read_b128 v[220:223], v10 offset:1024
    ds_read_b128 v[228:231], v8 offset:1024
    ds_read_b128 v[208:211], v9
    ds_read_b128 v[212:215], v10
    ds_read_b32 v224, v11 offset:2048
    ds_read_b32 v226, v12 offset:2048
    ds_read_b128 v[232:235], v8 offset:2048
    s_waitcnt lgkmcnt(6)
    v_pk_fma_f32 v[64:65], v[216:217], v[140:141], v[64:65] op_sel_hi:[1,0,1]
    v_pk_fma_f32 v[66:67], v[218:219], v[140:141], v[66:67] op_sel_hi:[1,0,1]
    v_pk_mul_f32 v[64:65], v[64:65], v[140:141] op_sel:[0,1]
    v_pk_mul_f32 v[66:67], v[66:67], v[140:141] op_sel:[0,1]
    s_mov_b32 s49, 0x80000
    v_cvt_pk_bf16_f32 v240, v64, v65
    v_cvt_pk_bf16_f32 v241, v66, v67
    v_pk_fma_f32 v[80:81], v[220:221], v[140:141], v[80:81] op_sel_hi:[1,0,1]
    v_pk_fma_f32 v[82:83], v[222:223], v[140:141], v[82:83] op_sel_hi:[1,0,1]
    v_pk_mul_f32 v[80:81], v[80:81], v[140:141] op_sel:[0,1]
    s_add_u32 m0, s51, 0
    v_pk_mul_f32 v[82:83], v[82:83], v[140:141] op_sel:[0,1]
    v_cvt_pk_bf16_f32 v242, v80, v81
    v_cvt_pk_bf16_f32 v243, v82, v83
    v_pk_fma_f32 v[68:69], v[216:217], v[142:143], v[68:69] op_sel_hi:[1,0,1]
    v_pk_fma_f32 v[70:71], v[218:219], v[142:143], v[70:71] op_sel_hi:[1,0,1]
    buffer_load_dwordx4 v13, s[36:39], s49 offen offset:0 lds
    v_pk_mul_f32 v[68:69], v[68:69], v[142:143] op_sel:[0,1]
    v_pk_mul_f32 v[70:71], v[70:71], v[142:143] op_sel:[0,1]
    v_cvt_pk_bf16_f32 v244, v68, v69
    v_cvt_pk_bf16_f32 v245, v70, v71
    v_pk_fma_f32 v[84:85], v[220:221], v[142:143], v[84:85] op_sel_hi:[1,0,1]
    s_add_u32 s49, s49, 15360
    v_pk_fma_f32 v[86:87], v[222:223], v[142:143], v[86:87] op_sel_hi:[1,0,1]
    v_pk_mul_f32 v[84:85], v[84:85], v[142:143] op_sel:[0,1]
    v_pk_mul_f32 v[86:87], v[86:87], v[142:143] op_sel:[0,1]
    v_cvt_pk_bf16_f32 v246, v84, v85
    v_cvt_pk_bf16_f32 v247, v86, v87
    buffer_load_dwordx4 v13, s[36:39], s49 offen offset:1024 lds
    v_pk_fma_f32 v[72:73], v[216:217], v[144:145], v[72:73] op_sel_hi:[1,0,1]
    v_pk_fma_f32 v[74:75], v[218:219], v[144:145], v[74:75] op_sel_hi:[1,0,1]
    v_pk_mul_f32 v[72:73], v[72:73], v[144:145] op_sel:[0,1]
    v_pk_mul_f32 v[74:75], v[74:75], v[144:145] op_sel:[0,1]
    v_cvt_pk_bf16_f32 v248, v72, v73
    s_add_u32 s49, s49, 15360
    v_cvt_pk_bf16_f32 v249, v74, v75
    v_pk_fma_f32 v[88:89], v[220:221], v[144:145], v[88:89] op_sel_hi:[1,0,1]
    v_pk_fma_f32 v[90:91], v[222:223], v[144:145], v[90:91] op_sel_hi:[1,0,1]
    v_pk_mul_f32 v[88:89], v[88:89], v[144:145] op_sel:[0,1]
    v_pk_mul_f32 v[90:91], v[90:91], v[144:145] op_sel:[0,1]
    buffer_load_dwordx4 v13, s[36:39], s49 offen offset:2048 lds
    v_cvt_pk_bf16_f32 v250, v88, v89
    v_cvt_pk_bf16_f32 v251, v90, v91
    v_pk_fma_f32 v[76:77], v[216:217], v[146:147], v[76:77] op_sel_hi:[1,0,1]
    v_pk_fma_f32 v[78:79], v[218:219], v[146:147], v[78:79] op_sel_hi:[1,0,1]
    v_pk_mul_f32 v[76:77], v[76:77], v[146:147] op_sel:[0,1]
    s_add_u32 s49, s49, 15360
    v_pk_mul_f32 v[78:79], v[78:79], v[146:147] op_sel:[0,1]
    v_cvt_pk_bf16_f32 v252, v76, v77
    v_cvt_pk_bf16_f32 v253, v78, v79
    v_pk_fma_f32 v[92:93], v[220:221], v[146:147], v[92:93] op_sel_hi:[1,0,1]
    v_pk_fma_f32 v[94:95], v[222:223], v[146:147], v[94:95] op_sel_hi:[1,0,1]
    buffer_load_dwordx4 v13, s[36:39], s49 offen offset:3072 lds
    v_pk_mul_f32 v[92:93], v[92:93], v[146:147] op_sel:[0,1]
    v_pk_mul_f32 v[94:95], v[94:95], v[146:147] op_sel:[0,1]
    v_cvt_pk_bf16_f32 v254, v92, v93
    v_cvt_pk_bf16_f32 v255, v94, v95
    s_waitcnt lgkmcnt(0)
    s_mov_b32 s49, 0x100000
    v_pk_fma_f32 v[132:133], v[216:217], v[148:149], v[132:133] op_sel_hi:[1,0,1]
    v_pk_fma_f32 v[134:135], v[218:219], v[148:149], v[134:135] op_sel_hi:[1,0,1]
    v_pk_mul_f32 v[132:133], v[132:133], v[148:149] op_sel:[0,1]
    v_pk_mul_f32 v[134:135], v[134:135], v[148:149] op_sel:[0,1]
    v_cvt_pk_bf16_f32 v236, v132, v133
    s_add_u32 m0, s51, 16384
    v_cvt_pk_bf16_f32 v237, v134, v135
    v_pk_fma_f32 v[228:229], v[220:221], v[148:149], v[228:229] op_sel_hi:[1,0,1]
    v_pk_fma_f32 v[230:231], v[222:223], v[148:149], v[230:231] op_sel_hi:[1,0,1]
    v_pk_mul_f32 v[228:229], v[228:229], v[148:149] op_sel:[0,1]
    v_pk_mul_f32 v[230:231], v[230:231], v[148:149] op_sel:[0,1]
    buffer_load_dwordx4 v13, s[36:39], s49 offen offset:0 lds
    v_cvt_pk_bf16_f32 v238, v228, v229
    v_cvt_pk_bf16_f32 v239, v230, v231
    v_pk_fma_f32 v[32:33], v[208:209], v[140:141], v[32:33] op_sel_hi:[1,0,1]
    v_pk_fma_f32 v[34:35], v[210:211], v[140:141], v[34:35] op_sel_hi:[1,0,1]
    v_pk_mul_f32 v[32:33], v[32:33], v[140:141] op_sel:[0,1]
    s_add_u32 s49, s49, 15360
    v_pk_mul_f32 v[34:35], v[34:35], v[140:141] op_sel:[0,1]
    v_cvt_pk_bf16_f32 v64, v32, v33
    v_cvt_pk_bf16_f32 v65, v34, v35
    v_pk_fma_f32 v[48:49], v[212:213], v[140:141], v[48:49] op_sel_hi:[1,0,1]
    v_pk_fma_f32 v[50:51], v[214:215], v[140:141], v[50:51] op_sel_hi:[1,0,1]
    buffer_load_dwordx4 v13, s[36:39], s49 offen offset:1024 lds
    v_pk_mul_f32 v[48:49], v[48:49], v[140:141] op_sel:[0,1]
    v_pk_mul_f32 v[50:51], v[50:51], v[140:141] op_sel:[0,1]
    v_cvt_pk_bf16_f32 v66, v48, v49
    v_cvt_pk_bf16_f32 v67, v50, v51
    v_pk_fma_f32 v[36:37], v[208:209], v[142:143], v[36:37] op_sel_hi:[1,0,1]
    s_add_u32 s49, s49, 15360
    v_pk_fma_f32 v[38:39], v[210:211], v[142:143], v[38:39] op_sel_hi:[1,0,1]
    v_pk_mul_f32 v[36:37], v[36:37], v[142:143] op_sel:[0,1]
    v_pk_mul_f32 v[38:39], v[38:39], v[142:143] op_sel:[0,1]
    v_cvt_pk_bf16_f32 v68, v36, v37
    v_cvt_pk_bf16_f32 v69, v38, v39
    buffer_load_dwordx4 v13, s[36:39], s49 offen offset:2048 lds
    v_pk_fma_f32 v[52:53], v[212:213], v[142:143], v[52:53] op_sel_hi:[1,0,1]
    v_pk_fma_f32 v[54:55], v[214:215], v[142:143], v[54:55] op_sel_hi:[1,0,1]
    v_pk_mul_f32 v[52:53], v[52:53], v[142:143] op_sel:[0,1]
    v_pk_mul_f32 v[54:55], v[54:55], v[142:143] op_sel:[0,1]
    v_cvt_pk_bf16_f32 v70, v52, v53
    s_add_u32 s49, s49, 15360
    v_cvt_pk_bf16_f32 v71, v54, v55
    v_pk_fma_f32 v[40:41], v[208:209], v[144:145], v[40:41] op_sel_hi:[1,0,1]
    v_pk_fma_f32 v[42:43], v[210:211], v[144:145], v[42:43] op_sel_hi:[1,0,1]
    v_pk_mul_f32 v[40:41], v[40:41], v[144:145] op_sel:[0,1]
    v_pk_mul_f32 v[42:43], v[42:43], v[144:145] op_sel:[0,1]
    buffer_load_dwordx4 v13, s[36:39], s49 offen offset:3072 lds
    v_cvt_pk_bf16_f32 v72, v40, v41
    v_cvt_pk_bf16_f32 v73, v42, v43
    v_pk_fma_f32 v[56:57], v[212:213], v[144:145], v[56:57] op_sel_hi:[1,0,1]
    v_pk_fma_f32 v[58:59], v[214:215], v[144:145], v[58:59] op_sel_hi:[1,0,1]
    v_pk_mul_f32 v[56:57], v[56:57], v[144:145] op_sel:[0,1]
    s_mov_b32 s49, 0xc0000
    v_pk_mul_f32 v[58:59], v[58:59], v[144:145] op_sel:[0,1]
    v_cvt_pk_bf16_f32 v74, v56, v57
    v_cvt_pk_bf16_f32 v75, v58, v59
    v_pk_fma_f32 v[44:45], v[208:209], v[146:147], v[44:45] op_sel_hi:[1,0,1]
    v_pk_fma_f32 v[46:47], v[210:211], v[146:147], v[46:47] op_sel_hi:[1,0,1]
    s_add_u32 m0, s51, 65536
    v_pk_mul_f32 v[44:45], v[44:45], v[146:147] op_sel:[0,1]
    v_pk_mul_f32 v[46:47], v[46:47], v[146:147] op_sel:[0,1]
    v_cvt_pk_bf16_f32 v76, v44, v45
    v_cvt_pk_bf16_f32 v77, v46, v47
    v_pk_fma_f32 v[60:61], v[212:213], v[146:147], v[60:61] op_sel_hi:[1,0,1]
    buffer_load_dwordx4 v13, s[36:39], s49 offen offset:0 lds
    v_pk_fma_f32 v[62:63], v[214:215], v[146:147], v[62:63] op_sel_hi:[1,0,1]
    v_pk_mul_f32 v[60:61], v[60:61], v[146:147] op_sel:[0,1]
    v_pk_mul_f32 v[62:63], v[62:63], v[146:147] op_sel:[0,1]
    v_cvt_pk_bf16_f32 v78, v60, v61
    v_cvt_pk_bf16_f32 v79, v62, v63
    s_add_u32 s49, s49, 15360
    v_mfma_f32_16x16x32_bf16 v[80:83], v[240:243], v[64:67], v[192:195]
    v_mfma_f32_16x16x32_bf16 v[208:211], v[236:239], v[64:67], v[200:203]
    v_mfma_f32_16x16x32_bf16 v[84:87], v[244:247], v[68:71], v[192:195]
    v_mfma_f32_16x16x32_bf16 v[212:215], v[240:243], v[68:71], v[196:199]
    v_mfma_f32_16x16x32_bf16 v[88:91], v[248:251], v[72:75], v[192:195]
    buffer_load_dwordx4 v13, s[36:39], s49 offen offset:1024 lds
    v_mfma_f32_16x16x32_bf16 v[216:219], v[244:247], v[72:75], v[196:199]
    v_mfma_f32_16x16x32_bf16 v[92:95], v[252:255], v[76:79], v[192:195]
    v_mfma_f32_16x16x32_bf16 v[220:223], v[248:251], v[76:79], v[196:199]
    v_pk_fma_f32 v[136:137], v[184:185], v[224:225], v[136:137] op_sel_hi:[1,0,1]
    v_pk_fma_f32 v[138:139], v[186:187], v[224:225], v[138:139] op_sel_hi:[1,0,1]
    s_add_u32 s49, s49, 15360
    v_pk_mul_f32 v[136:137], v[136:137], v[188:189]
    v_pk_mul_f32 v[138:139], v[138:139], v[190:191]
    v_cvt_pk_bf16_f32 v32, v136, v137
    v_cvt_pk_bf16_f32 v33, v138, v139
    v_pk_fma_f32 v[232:233], v[184:185], v[226:227], v[232:233] op_sel_hi:[1,0,1]
    buffer_load_dwordx4 v13, s[36:39], s49 offen offset:2048 lds
    v_pk_fma_f32 v[234:235], v[186:187], v[226:227], v[234:235] op_sel_hi:[1,0,1]
    v_pk_mul_f32 v[232:233], v[232:233], v[188:189]
    v_pk_mul_f32 v[234:235], v[234:235], v[190:191]
    v_cvt_pk_bf16_f32 v44, v232, v233
    v_cvt_pk_bf16_f32 v45, v234, v235
    s_add_u32 s49, s49, 15360
    v_pk_fma_f32 v[96:97], v[152:153], v[224:225], v[96:97] op_sel_hi:[1,0,1]
    v_pk_fma_f32 v[98:99], v[154:155], v[224:225], v[98:99] op_sel_hi:[1,0,1]
    v_pk_mul_f32 v[96:97], v[96:97], v[156:157]
    v_pk_mul_f32 v[98:99], v[98:99], v[158:159]
    v_cvt_pk_bf16_f32 v34, v96, v97
    buffer_load_dwordx4 v13, s[36:39], s49 offen offset:3072 lds
    v_cvt_pk_bf16_f32 v35, v98, v99
    v_pk_fma_f32 v[100:101], v[160:161], v[224:225], v[100:101] op_sel_hi:[1,0,1]
    v_pk_fma_f32 v[102:103], v[162:163], v[224:225], v[102:103] op_sel_hi:[1,0,1]
    v_pk_mul_f32 v[100:101], v[100:101], v[164:165]
    v_pk_mul_f32 v[102:103], v[102:103], v[166:167]
    s_mov_b32 s49, 0x1c0000
    v_cvt_pk_bf16_f32 v36, v100, v101
    v_cvt_pk_bf16_f32 v37, v102, v103
    v_pk_fma_f32 v[104:105], v[168:169], v[224:225], v[104:105] op_sel_hi:[1,0,1]
    v_pk_fma_f32 v[106:107], v[170:171], v[224:225], v[106:107] op_sel_hi:[1,0,1]
    v_pk_mul_f32 v[104:105], v[104:105], v[172:173]
    s_add_u32 m0, s51, 49152
    v_pk_mul_f32 v[106:107], v[106:107], v[174:175]
    v_cvt_pk_bf16_f32 v38, v104, v105
    v_cvt_pk_bf16_f32 v39, v106, v107
    v_pk_fma_f32 v[108:109], v[176:177], v[224:225], v[108:109] op_sel_hi:[1,0,1]
    v_pk_fma_f32 v[110:111], v[178:179], v[224:225], v[110:111] op_sel_hi:[1,0,1]
    buffer_load_dwordx4 v13, s[36:39], s49 offen offset:0 lds
    v_pk_mul_f32 v[108:109], v[108:109], v[180:181]
    v_pk_mul_f32 v[110:111], v[110:111], v[182:183]
    v_cvt_pk_bf16_f32 v40, v108, v109
    v_cvt_pk_bf16_f32 v41, v110, v111
    v_pk_fma_f32 v[112:113], v[152:153], v[226:227], v[112:113] op_sel_hi:[1,0,1]
    s_add_u32 s49, s49, 15360
    v_pk_fma_f32 v[114:115], v[154:155], v[226:227], v[114:115] op_sel_hi:[1,0,1]
    v_pk_mul_f32 v[112:113], v[112:113], v[156:157]
    v_pk_mul_f32 v[114:115], v[114:115], v[158:159]
    v_cvt_pk_bf16_f32 v46, v112, v113
    v_cvt_pk_bf16_f32 v47, v114, v115
    buffer_load_dwordx4 v13, s[36:39], s49 offen offset:1024 lds
    v_pk_fma_f32 v[116:117], v[160:161], v[226:227], v[116:117] op_sel_hi:[1,0,1]
    v_pk_fma_f32 v[118:119], v[162:163], v[226:227], v[118:119] op_sel_hi:[1,0,1]
    v_pk_mul_f32 v[116:117], v[116:117], v[164:165]
    v_pk_mul_f32 v[118:119], v[118:119], v[166:167]
    v_cvt_pk_bf16_f32 v48, v116, v117
    s_add_u32 s49, s49, 15360
    v_cvt_pk_bf16_f32 v49, v118, v119
    v_pk_fma_f32 v[120:121], v[168:169], v[226:227], v[120:121] op_sel_hi:[1,0,1]
    v_pk_fma_f32 v[122:123], v[170:171], v[226:227], v[122:123] op_sel_hi:[1,0,1]
    v_pk_mul_f32 v[120:121], v[120:121], v[172:173]
    v_pk_mul_f32 v[122:123], v[122:123], v[174:175]
    buffer_load_dwordx4 v13, s[36:39], s49 offen offset:2048 lds
    v_cvt_pk_bf16_f32 v50, v120, v121
    v_cvt_pk_bf16_f32 v51, v122, v123
    v_pk_fma_f32 v[124:125], v[176:177], v[226:227], v[124:125] op_sel_hi:[1,0,1]
    v_pk_fma_f32 v[126:127], v[178:179], v[226:227], v[126:127] op_sel_hi:[1,0,1]
    v_pk_mul_f32 v[124:125], v[124:125], v[180:181]
    s_add_u32 s49, s49, 15360
    v_pk_mul_f32 v[126:127], v[126:127], v[182:183]
    v_cvt_pk_bf16_f32 v52, v124, v125
    v_cvt_pk_bf16_f32 v53, v126, v127
    v_max_f32 v80, v80, v208
    v_max_f32 v81, v81, v209
    buffer_load_dwordx4 v13, s[36:39], s49 offen offset:3072 lds
    v_max_f32 v82, v82, v210
    v_max_f32 v83, v83, v211
    v_max3_f32 v152, v80, v81, v82
    v_max_f32 v152, v152, v83
    v_max_f32 v84, v84, v212
    v_max_f32 v85, v85, v213
    v_max_f32 v86, v86, v214
    v_max_f32 v87, v87, v215
    v_max3_f32 v153, v84, v85, v86
    v_max_f32 v153, v153, v87
    v_max_f32 v88, v88, v216
    v_max_f32 v89, v89, v217
    v_max_f32 v90, v90, v218
    v_max_f32 v91, v91, v219
    v_max3_f32 v154, v88, v89, v90
    v_max_f32 v154, v154, v91
    v_max_f32 v92, v92, v220
    v_max_f32 v93, v93, v221
    v_max_f32 v94, v94, v222
    v_max_f32 v95, v95, v223
    v_max3_f32 v155, v92, v93, v94
    v_max_f32 v155, v155, v95
    v_mov_b32 v156, v152
    v_mov_b32 v157, v153
    v_mov_b32 v158, v154
    v_mov_b32 v159, v155
    v_permlane32_swap_b32 v152, v156
    v_permlane32_swap_b32 v153, v157
    v_permlane32_swap_b32 v154, v158
    v_permlane32_swap_b32 v155, v159
    v_max_f32 v152, v152, v156
    v_max_f32 v153, v153, v157
    v_max_f32 v154, v154, v158
    v_max_f32 v155, v155, v159
    v_mov_b32 v156, v152
    v_mov_b32 v157, v153
    v_mov_b32 v158, v154
    v_mov_b32 v159, v155
    v_permlane16_swap_b32 v152, v156
    v_permlane16_swap_b32 v153, v157
    v_permlane16_swap_b32 v154, v158
    v_permlane16_swap_b32 v155, v159
    v_max_f32 v152, v152, v156
    v_max_f32 v153, v153, v157
    v_max_f32 v154, v154, v158
    v_max_f32 v155, v155, v159
    v_mul_f32 v152, s66, v152
    v_mul_f32 v153, s66, v153
    v_mul_f32 v154, s66, v154
    v_mul_f32 v155, s66, v155
    v_fma_f32 v80, v80, s66, -v152
    v_fma_f32 v81, v81, s66, -v152
    v_fma_f32 v82, v82, s66, -v152
    v_fma_f32 v83, v83, s66, -v152
    v_exp_f32 v80, v80
    v_exp_f32 v81, v81
    v_exp_f32 v82, v82
    v_exp_f32 v83, v83
    v_cvt_pk_bf16_f32 v80, v80, v81
    v_cvt_pk_bf16_f32 v81, v82, v83
    v_and_b32 v160, v80, v206
    v_and_b32 v161, v81, v207
    v_and_b32 v162, v80, v204
    v_and_b32 v163, v81, v205
    v_fma_f32 v84, v84, s66, -v153
    v_fma_f32 v85, v85, s66, -v153
    v_fma_f32 v86, v86, s66, -v153
    v_fma_f32 v87, v87, s66, -v153
    v_exp_f32 v84, v84
    v_exp_f32 v85, v85
    v_exp_f32 v86, v86
    v_exp_f32 v87, v87
    v_cvt_pk_bf16_f32 v84, v84, v85
    v_cvt_pk_bf16_f32 v85, v86, v87
    v_and_b32 v164, v84, v206
    v_and_b32 v165, v85, v207
    v_and_b32 v166, v84, v204
    v_and_b32 v167, v85, v205
    v_mfma_f32_16x16x32_bf16 v[176:179], v[28:31], v[160:163], 0
    v_mfma_f32_16x16x32_bf16 v[96:99], v[32:35], v[160:163], 0
    v_mfma_f32_16x16x32_bf16 v[112:115], v[44:47], v[160:163], 0
    v_fma_f32 v88, v88, s66, -v154
    v_fma_f32 v89, v89, s66, -v154
    v_fma_f32 v90, v90, s66, -v154
    v_fma_f32 v91, v91, s66, -v154
    v_exp_f32 v88, v88
    v_exp_f32 v89, v89
    v_exp_f32 v90, v90
    v_exp_f32 v91, v91
    v_cvt_pk_bf16_f32 v88, v88, v89
    v_cvt_pk_bf16_f32 v89, v90, v91
    v_and_b32 v168, v88, v206
    v_and_b32 v169, v89, v207
    v_and_b32 v170, v88, v204
    v_and_b32 v171, v89, v205
    v_mfma_f32_16x16x32_bf16 v[180:183], v[28:31], v[164:167], 0
    v_mfma_f32_16x16x32_bf16 v[100:103], v[34:37], v[164:167], 0
    v_mfma_f32_16x16x32_bf16 v[116:119], v[46:49], v[164:167], 0
    v_fma_f32 v92, v92, s66, -v155
    v_fma_f32 v93, v93, s66, -v155
    v_fma_f32 v94, v94, s66, -v155
    v_fma_f32 v95, v95, s66, -v155
    v_exp_f32 v92, v92
    v_exp_f32 v93, v93
    v_exp_f32 v94, v94
    v_exp_f32 v95, v95
    v_cvt_pk_bf16_f32 v92, v92, v93
    v_cvt_pk_bf16_f32 v93, v94, v95
    v_and_b32 v172, v92, v206
    v_and_b32 v173, v93, v207
    v_and_b32 v174, v92, v204
    v_and_b32 v175, v93, v205
    v_mfma_f32_16x16x32_bf16 v[184:187], v[28:31], v[168:171], 0
    v_mfma_f32_16x16x32_bf16 v[104:107], v[36:39], v[168:171], 0
    v_mfma_f32_16x16x32_bf16 v[120:123], v[48:51], v[168:171], 0
    v_mfma_f32_16x16x32_bf16 v[188:191], v[28:31], v[172:175], 0
    v_mfma_f32_16x16x32_bf16 v[108:111], v[38:41], v[172:175], 0
    v_mfma_f32_16x16x32_bf16 v[124:127], v[50:53], v[172:175], 0
    s_cmp_eq_u32 s18, 0
    s_cbranch_scc0 L_p1_fin1
    v_rcp_f32 v176, v176
    s_nop 0
    v_pk_mul_f32 v[96:97], v[96:97], v[176:177] op_sel_hi:[1,0]
    v_pk_mul_f32 v[98:99], v[98:99], v[176:177] op_sel_hi:[1,0]
    v_pk_mul_f32 v[112:113], v[112:113], v[176:177] op_sel_hi:[1,0]
    v_pk_mul_f32 v[114:115], v[114:115], v[176:177] op_sel_hi:[1,0]
    v_cvt_pk_bf16_f32 v64, v96, v97
    v_cvt_pk_bf16_f32 v65, v98, v99
    v_cvt_pk_bf16_f32 v66, v112, v113
    v_cvt_pk_bf16_f32 v67, v114, v115
    buffer_store_dwordx4 v[64:67], v2, s[28:31], s68 offen offset:0 sc1
    s_nop 0
    v_mfma_f32_16x16x32_bf16 v[236:239], a[88:91], v[64:67], 0
    v_rcp_f32 v180, v180
    s_nop 0
    v_pk_mul_f32 v[100:101], v[100:101], v[180:181] op_sel_hi:[1,0]
    v_pk_mul_f32 v[102:103], v[102:103], v[180:181] op_sel_hi:[1,0]
    v_pk_mul_f32 v[116:117], v[116:117], v[180:181] op_sel_hi:[1,0]
    v_pk_mul_f32 v[118:119], v[118:119], v[180:181] op_sel_hi:[1,0]
    v_cvt_pk_bf16_f32 v68, v100, v101
    v_cvt_pk_bf16_f32 v69, v102, v103
    v_cvt_pk_bf16_f32 v70, v116, v117
    v_cvt_pk_bf16_f32 v71, v118, v119
    buffer_store_dwordx4 v[68:71], v2, s[28:31], s68 offen offset:1024 sc1
    s_nop 0
    v_mfma_f32_16x16x32_bf16 v[240:243], a[88:91], v[68:71], 0
    v_rcp_f32 v184, v184
    s_nop 0
    v_pk_mul_f32 v[104:105], v[104:105], v[184:185] op_sel_hi:[1,0]
    v_pk_mul_f32 v[106:107], v[106:107], v[184:185] op_sel_hi:[1,0]
    v_pk_mul_f32 v[120:121], v[120:121], v[184:185] op_sel_hi:[1,0]
    v_pk_mul_f32 v[122:123], v[122:123], v[184:185] op_sel_hi:[1,0]
    v_cvt_pk_bf16_f32 v72, v104, v105
    v_cvt_pk_bf16_f32 v73, v106, v107
    v_cvt_pk_bf16_f32 v74, v120, v121
    v_cvt_pk_bf16_f32 v75, v122, v123
    buffer_store_dwordx4 v[72:75], v2, s[28:31], s68 offen offset:2048 sc1
    s_nop 0
    v_mfma_f32_16x16x32_bf16 v[244:247], a[88:91], v[72:75], 0
    v_rcp_f32 v188, v188
    s_nop 0
    v_pk_mul_f32 v[108:109], v[108:109], v[188:189] op_sel_hi:[1,0]
    v_pk_mul_f32 v[110:111], v[110:111], v[188:189] op_sel_hi:[1,0]
    v_pk_mul_f32 v[124:125], v[124:125], v[188:189] op_sel_hi:[1,0]
    v_pk_mul_f32 v[126:127], v[126:127], v[188:189] op_sel_hi:[1,0]
    v_cvt_pk_bf16_f32 v76, v108, v109
    v_cvt_pk_bf16_f32 v77, v110, v111
    v_cvt_pk_bf16_f32 v78, v124, v125
    v_cvt_pk_bf16_f32 v79, v126, v127
    buffer_store_dwordx4 v[76:79], v2, s[28:31], s68 offen offset:3072 sc1
    s_nop 0
    v_mfma_f32_16x16x32_bf16 v[248:251], a[88:91], v[76:79], 0
    s_branch L_p1_fin
L_p1_fin1:
    v_rcp_f32 v176, v176
    s_nop 0
    v_pk_mul_f32 v[96:97], v[96:97], v[176:177] op_sel_hi:[1,0]
    v_pk_mul_f32 v[98:99], v[98:99], v[176:177] op_sel_hi:[1,0]
    v_pk_mul_f32 v[112:113], v[112:113], v[176:177] op_sel_hi:[1,0]
    v_pk_mul_f32 v[114:115], v[114:115], v[176:177] op_sel_hi:[1,0]
    v_cvt_pk_bf16_f32 v64, v112, v113
    v_cvt_pk_bf16_f32 v65, v114, v115
    v_cvt_pk_bf16_f32 v66, v96, v97
    v_cvt_pk_bf16_f32 v67, v98, v99
    buffer_store_dwordx4 v[64:67], v2, s[28:31], s68 offen offset:0 sc1
    s_nop 0
    v_mfma_f32_16x16x32_bf16 v[236:239], a[88:91], v[64:67], 0
    v_rcp_f32 v180, v180
    s_nop 0
    v_pk_mul_f32 v[100:101], v[100:101], v[180:181] op_sel_hi:[1,0]
    v_pk_mul_f32 v[102:103], v[102:103], v[180:181] op_sel_hi:[1,0]
    v_pk_mul_f32 v[116:117], v[116:117], v[180:181] op_sel_hi:[1,0]
    v_pk_mul_f32 v[118:119], v[118:119], v[180:181] op_sel_hi:[1,0]
    v_cvt_pk_bf16_f32 v68, v116, v117
    v_cvt_pk_bf16_f32 v69, v118, v119
    v_cvt_pk_bf16_f32 v70, v100, v101
    v_cvt_pk_bf16_f32 v71, v102, v103
    buffer_store_dwordx4 v[68:71], v2, s[28:31], s68 offen offset:1024 sc1
    s_nop 0
    v_mfma_f32_16x16x32_bf16 v[240:243], a[88:91], v[68:71], 0
    v_rcp_f32 v184, v184
    s_nop 0
    v_pk_mul_f32 v[104:105], v[104:105], v[184:185] op_sel_hi:[1,0]
    v_pk_mul_f32 v[106:107], v[106:107], v[184:185] op_sel_hi:[1,0]
    v_pk_mul_f32 v[120:121], v[120:121], v[184:185] op_sel_hi:[1,0]
    v_pk_mul_f32 v[122:123], v[122:123], v[184:185] op_sel_hi:[1,0]
    v_cvt_pk_bf16_f32 v72, v120, v121
    v_cvt_pk_bf16_f32 v73, v122, v123
    v_cvt_pk_bf16_f32 v74, v104, v105
    v_cvt_pk_bf16_f32 v75, v106, v107
    buffer_store_dwordx4 v[72:75], v2, s[28:31], s68 offen offset:2048 sc1
    s_nop 0
    v_mfma_f32_16x16x32_bf16 v[244:247], a[88:91], v[72:75], 0
    v_rcp_f32 v188, v188
    s_nop 0
    v_pk_mul_f32 v[108:109], v[108:109], v[188:189] op_sel_hi:[1,0]
    v_pk_mul_f32 v[110:111], v[110:111], v[188:189] op_sel_hi:[1,0]
    v_pk_mul_f32 v[124:125], v[124:125], v[188:189] op_sel_hi:[1,0]
    v_pk_mul_f32 v[126:127], v[126:127], v[188:189] op_sel_hi:[1,0]
    v_cvt_pk_bf16_f32 v76, v124, v125
    v_cvt_pk_bf16_f32 v77, v126, v127
    v_cvt_pk_bf16_f32 v78, v108, v109
    v_cvt_pk_bf16_f32 v79, v110, v111
    buffer_store_dwordx4 v[76:79], v2, s[28:31], s68 offen offset:3072 sc1
    s_nop 0
    v_mfma_f32_16x16x32_bf16 v[248:251], a[88:91], v[76:79], 0
L_p1_fin:
    s_lshl_b64 exec, 0xffff, 0
    v_add_f32 v1, v236, v237
    s_lshl_b64 exec, 0xffff, 16
    v_add_f32 v1, v240, v241
    s_lshl_b64 exec, 0xffff, 32
    v_add_f32 v1, v244, v245
    s_lshl_b64 exec, 0xffff, 48
    s_nop 0
    v_add_f32 v1, v248, v249
    s_mov_b64 exec, -1
    buffer_store_dword v1, v16, s[76:79], s69 offen sc1
    s_lshl_b32 s40, s3, 12
    s_and_b32 s13, s2, 1
    s_lshl_b32 s11, s13, 2
    s_bfe_u32 s14, s2, 0x20003
    s_add_u32 s11, s11, s14
    s_lshr_b32 s12, s2, 5
    s_and_b32 s14, s2, 6
    s_lshl_b32 s14, s14, 2
    s_add_u32 s12, s12, s14
    s_bfe_u32 s14, s2, 0x10002
    s_xor_b32 s54, s13, s14
    s_add_u32 s55, s11, s12
    s_and_b32 s55, s55, 3
    s_lshl_b32 s13, s54, 3
    v_and_b32 v1, 3, v0
    v_cmp_eq_u32 vcc, s55, v1
    v_add_u32 v2, s13, v0
    s_nop 0
    v_cndmask_b32 v3, 0, 0, vcc
    v_add_u32 v2, v2, v3
    v_and_b32 v2, 15, v2
    v_lshlrev_b32 v18, 18, v2
    v_mul_u32_u24 v19, 0x70000, v2
    s_and_b32 s13, s12, 1
    s_lshl_b32 s13, s13, 1
    s_and_b32 s14, s3, 1
    s_mul_i32 s14, s14, 229376
    s_lshr_b32 s15, s12, 2
    s_mul_i32 s15, s15, 896
    s_add_u32 s56, s14, s15
    s_and_b32 s57, s12, 3
    s_mul_i32 s14, s57, 96
    s_add_u32 s14, s14, s56
    s_add_u32 s14, s14, 512
    v_add_u32 v1, 0, v0
    v_mul_u32_u24 v2, 171, v1
    v_lshrrev_b32 v2, 10, v2
    v_mul_u32_u24 v3, 6, v2
    v_sub_u32 v1, v1, v3
    v_add_u32 v1, s13, v1
    v_subrev_u32 v3, 6, v1
    v_min_u32 v1, v1, v3
    v_mul_u32_u24 v2, 7168, v2
    v_lshl_add_u32 v2, v1, 4, v2
    v_add_u32 v6, s14, v2
    v_add_u32 v1, 64, v0
    v_mul_u32_u24 v2, 171, v1
    v_lshrrev_b32 v2, 10, v2
    v_mul_u32_u24 v3, 6, v2
    v_sub_u32 v1, v1, v3
    v_add_u32 v1, s13, v1
    v_subrev_u32 v3, 6, v1
    v_min_u32 v1, v1, v3
    v_mul_u32_u24 v2, 7168, v2
    v_lshl_add_u32 v2, v1, 4, v2
    v_add_u32 v7, s14, v2
    v_subrev_u32 v7, 1024, v7
    v_add_u32 v1, 128, v0
    v_mul_u32_u24 v2, 171, v1
    v_lshrrev_b32 v2, 10, v2
    v_mul_u32_u24 v3, 6, v2
    v_sub_u32 v1, v1, v3
    v_add_u32 v1, s13, v1
    v_subrev_u32 v3, 6, v1
    v_min_u32 v1, v1, v3
    v_mul_u32_u24 v2, 7168, v2
    v_lshl_add_u32 v2, v1, 4, v2
    v_add_u32 v8, s14, v2
    v_subrev_u32 v8, 2048, v8
    v_lshrrev_b32 v1, 4, v0
    v_lshlrev_b32 v2, 1, v1
    v_and_b32 v3, 7, v0
    v_xor_b32 v2, v2, v3
    v_lshlrev_b32 v252, 4, v2
    v_lshrrev_b32 v3, 3, v0
    v_mul_u32_u24 v3, 7168, v3
    v_add_u32 v9, v3, v252
    s_lshl_b32 s13, s57, 7
    s_add_u32 s13, s13, s56
    v_add_u32 v9, s13, v9
    v_add_u32 v10, 56320, v9
    v_add_u32 v11, 112640, v9
    v_add_u32 v12, 168960, v9
    s_mov_b32 s46, 0
    s_cmp_lt_u32 s3, 2
    s_cselect_b32 s16, s88, s90
    s_cselect_b32 s17, s89, s91
    s_mov_b32 s18, 0x700000
    s_mov_b32 s19, 0x00020000
    v_readlane_b32 s50, v18, s46
    v_readlane_b32 s52, v19, s46
    s_add_u32 s46, s46, 1
    v_readlane_b32 s51, v18, s46
    v_readlane_b32 s53, v19, s46
    s_add_u32 s46, s46, 1
    s_lshl_b32 s74, s3, 19
    s_add_u32 s74, s74, s75
    v_mov_b32 v2, s100
    s_waitcnt vmcnt(0)
    s_mov_b64 exec, 1
    buffer_store_dword v2, v0, s[76:79], s74 offen sc1
    s_mov_b64 exec, -1
    s_barrier
    s_add_u32 s20, s98, 0x400000
    s_addc_u32 s21, s99, 0
    s_mov_b32 s22, 0x400000
    s_mov_b32 s23, 0x00020000
    s_mov_b32 s24, s98
    s_mov_b32 s25, s99
    s_mov_b32 s26, 0x400000
    s_mov_b32 s27, 0x00020000
    s_add_u32 s28, s98, 0x1a00000
    s_addc_u32 s29, s99, 0
    s_mov_b32 s30, 0x20000
    s_mov_b32 s31, 0x00020000
    s_mov_b32 s32, s92
    s_mov_b32 s33, s93
    s_mov_b32 s34, 0x700000
    s_mov_b32 s35, 0x00020000
    s_mov_b32 s36, s94
    s_mov_b32 s37, s95
    s_mov_b32 s38, 0x400000
    s_mov_b32 s39, 0x00020000
    s_and_b32 s13, s2, 1
    s_lshl_b32 s47, s13, 3
    s_bfe_u32 s14, s2, 0x30003
    s_add_u32 s47, s47, s14
    s_and_b32 s48, s2, 2
    s_lshl_b32 s48, s48, 2
    s_lshr_b32 s14, s2, 6
    s_lshl_b32 s14, s14, 1
    s_add_u32 s48, s48, s14
    s_bfe_u32 s14, s2, 0x10002
    s_add_u32 s48, s48, s14
    s_lshr_b32 s55, s48, 1
    s_add_u32 s55, s55, s47
    s_and_b32 s55, s55, 3
    s_bfe_u32 s56, s2, 0x20001
    s_mov_b32 s49, 0x10000
    s_lshl_b32 s14, s47, 2
    s_add_u32 s14, s14, s3
    s_lshl_b32 s14, s14, 11
    v_lshl_add_u32 v212, v0, 4, s14
    v_add_u32 v213, 0x20000, v212
    v_add_u32 v214, 0x40000, v212
    v_add_u32 v215, 0x60000, v212
    v_and_b32 v1, 15, v0
    v_lshrrev_b32 v2, 1, v1
    v_lshrrev_b32 v3, 5, v0
    v_xor_b32 v2, v2, v3
    v_lshlrev_b32 v1, 7, v1
    v_lshl_add_u32 v1, v2, 4, v1
    v_bfe_u32 v2, v0, 4, 1
    v_lshl_add_u32 v1, v2, 3, v1
    s_add_u32 s13, s40, 147456
    v_add_u32 v1, s13, v1
    v_xor_b32 v2, 0, v1
    ds_read_b64 v[68:69], v2 offset:0
    ds_read_b64 v[76:77], v2 offset:2048
    v_xor_b32 v2, 32, v1
    ds_read_b64 v[70:71], v2 offset:0
    ds_read_b64 v[78:79], v2 offset:2048
    v_xor_b32 v2, 64, v1
    ds_read_b64 v[72:73], v2 offset:0
    ds_read_b64 v[80:81], v2 offset:2048
    v_xor_b32 v2, 96, v1
    ds_read_b64 v[74:75], v2 offset:0
    ds_read_b64 v[82:83], v2 offset:2048
    s_lshl_b32 s13, s11, 2
    s_add_u32 s13, s13, s3
    s_lshl_b32 s13, s13, 12
    v_lshl_add_u32 v4, v0, 4, s13
    v_add_u32 v5, 0x20000, v4
    v_lshrrev_b32 v1, 4, v0
    v_and_b32 v2, 15, v0
    v_lshrrev_b32 v3, 2, v2
    v_lshl_add_u32 v3, v1, 2, v3
    v_and_b32 v2, 3, v2
    v_lshlrev_b32 v2, 3, v2
    v_mul_u32_u24 v13, 96, v3
    v_add_u32 v13, v13, v2
    v_add_u32 v13, 0x10000, v13
    v_lshl_add_u32 v14, v3, 7, v2
    v_lshrrev_b32 v3, 1, v3
    v_and_b32 v3, 3, v3
    v_xor_b32 v2, 3, v3
    v_lshl_add_u32 v17, v2, 5, v14
    v_xor_b32 v2, 2, v3
    v_lshl_add_u32 v16, v2, 5, v14
    v_xor_b32 v2, 1, v3
    v_lshl_add_u32 v15, v2, 5, v14
    v_xor_b32 v2, 0, v3
    v_lshl_add_u32 v14, v2, 5, v14
    s_mov_b32 s62, 2
    v_add_u32 v108, 0x10000, v14
    v_add_u32 v109, 0x10000, v15
    v_add_u32 v110, 0x10000, v16
    v_add_u32 v111, 0x10000, v17
    s_mov_b32 s60, 0x20000
    s_lshl_b32 s13, s48, 18
    v_add_u32 v115, s13, v212
    v_lshrrev_b32 v1, 4, v0
    v_lshlrev_b32 v112, 12, v1
    v_and_b32 v1, 15, v0
    v_lshl_add_u32 v112, v1, 3, v112
    s_lshl_b32 s13, s47, 7
    s_add_u32 s13, s13, s3
    s_lshl_b32 s13, s13, 7
    s_add_u32 s13, s13, 0x40000
    v_add_u32 v112, s13, v112
    v_and_b32 v2, 1, v0
    v_bfe_u32 v118, v0, 2, 2
    v_lshlrev_b32 v118, 7, v118
    v_and_b32 v3, 3, v0
    v_lshl_add_u32 v118, v3, 2, v118
    s_lshl_b32 s61, s47, 1
    s_and_b32 s13, s3, 1
    s_add_u32 s61, s61, s13
    s_lshl_b32 s61, s61, 10
    s_lshr_b32 s13, s3, 1
    s_lshl_b32 s13, s13, 5
    s_add_u32 s61, s61, s13
    s_add_u32 s61, s61, 0x18000
    v_bfe_u32 v1, v0, 1, 4
    v_lshlrev_b32 v1, 7, v1
    v_lshl_add_u32 v1, v2, 19, v1
    s_lshl_b32 s13, s47, 11
    s_and_b32 s14, s3, 2
    s_lshl_b32 s14, s14, 19
    s_add_u32 s13, s13, s14
    v_add_u32 v1, s13, v1
    s_lshl_b32 s75, s47, 4
    s_add_u32 s75, s75, s48
    s_lshl_b32 s75, s75, 7
    s_add_u32 s75, s75, 0x8000
    s_getpc_b64 s[72:73]
L_cp3:
    s_lshr_b32 s74, s2, 3
    s_lshl2_add_u32 s74, s74, s3
    s_lshl_b32 s74, s74, 8
    s_add_u32 s74, s74, 4096
    s_min_u32 s74, s74, L_end-L_cp3
    s_add_u32 s72, s72, s74
    s_addc_u32 s73, s73, 0
    v_and_b32 v254, 1, v0
    v_lshlrev_b32 v254, 7, v254
    v_mov_b32 v255, s73
    v_add_co_u32 v254, vcc, s72, v254
    s_nop 1
    v_addc_co_u32 v255, vcc, 0, v255, vcc
    global_load_dword a251, v[254:255], off
    s_waitcnt lgkmcnt(0)
    v_lshlrev_b32 v28, 16, v68
    v_and_b32 v29, 0xffff0000, v68
    v_lshlrev_b32 v30, 16, v69
    v_and_b32 v31, 0xffff0000, v69
    v_lshlrev_b32 v36, 16, v70
    v_and_b32 v37, 0xffff0000, v70
    v_lshlrev_b32 v38, 16, v71
    v_and_b32 v39, 0xffff0000, v71
    v_lshlrev_b32 v44, 16, v72
    v_and_b32 v45, 0xffff0000, v72
    v_lshlrev_b32 v46, 16, v73
    v_and_b32 v47, 0xffff0000, v73
    v_lshlrev_b32 v52, 16, v74
    v_and_b32 v53, 0xffff0000, v74
    v_lshlrev_b32 v54, 16, v75
    v_and_b32 v55, 0xffff0000, v75
    v_lshlrev_b32 v32, 16, v76
    v_and_b32 v33, 0xffff0000, v76
    v_lshlrev_b32 v34, 16, v77
    v_and_b32 v35, 0xffff0000, v77
    v_lshlrev_b32 v40, 16, v78
    v_and_b32 v41, 0xffff0000, v78
    v_lshlrev_b32 v42, 16, v79
    v_and_b32 v43, 0xffff0000, v79
    v_lshlrev_b32 v48, 16, v80
    v_and_b32 v49, 0xffff0000, v80
    v_lshlrev_b32 v50, 16, v81
    v_and_b32 v51, 0xffff0000, v81
    v_lshlrev_b32 v56, 16, v82
    v_and_b32 v57, 0xffff0000, v82
    v_lshlrev_b32 v58, 16, v83
    v_and_b32 v59, 0xffff0000, v83
    ds_read_b64_tr_b16 a[128:129], v14 offset:0
    ds_read_b64_tr_b16 a[130:131], v14 offset:2048
    ds_read_b64_tr_b16 a[132:133], v14 offset:4096
    ds_read_b64_tr_b16 a[134:135], v14 offset:6144
    ds_read_b64_tr_b16 a[136:137], v15 offset:0
    ds_read_b64_tr_b16 a[138:139], v15 offset:2048
    ds_read_b64_tr_b16 a[140:141], v15 offset:4096
    ds_read_b64_tr_b16 a[142:143], v15 offset:6144
    s_lshl_b64 exec, 0xfff, 8
    s_mov_b32 s14, 0x40000
L_p2_poll:
    buffer_load_dword v2, v1, s[76:79], 0 offen sc1
    s_waitcnt vmcnt(0)
    v_cmp_ne_u32 vcc, s100, v2
    s_nop 0
    s_cmp_eq_u64 vcc, 0
    s_cbranch_scc1 L_p2_go
    s_mov_b64 exec, vcc
    s_sub_u32 s14, s14, 1
    s_cmp_lg_u32 s14, 0
    s_cbranch_scc1 L_p2_poll
L_p2_go:
    s_mov_b64 exec, -1
    s_add_u32 s58, s62, 0
    s_and_b32 s58, s58, 7
    s_lshl_b32 s58, s58, 19
    buffer_load_dwordx4 a[0:3], v212, s[24:27], s58 offen offset:0 sc1
    buffer_load_dwordx4 a[4:7], v212, s[24:27], s58 offen offset:1024 sc1
    buffer_load_dwordx4 a[8:11], v213, s[24:27], s58 offen offset:0 sc1
    buffer_load_dwordx4 a[12:15], v213, s[24:27], s58 offen offset:1024 sc1
    buffer_load_dwordx4 a[16:19], v214, s[24:27], s58 offen offset:0 sc1
    buffer_load_dwordx4 a[20:23], v214, s[24:27], s58 offen offset:1024 sc1
    buffer_load_dwordx4 a[24:27], v215, s[24:27], s58 offen offset:0 sc1
    buffer_load_dwordx4 a[28:31], v215, s[24:27], s58 offen offset:1024 sc1
    s_add_u32 s59, s62, 1
    s_and_b32 s59, s59, 7
    s_lshl_b32 s59, s59, 19
    buffer_load_dwordx4 a[32:35], v212, s[24:27], s59 offen offset:0 sc1
    buffer_load_dwordx4 a[36:39], v212, s[24:27], s59 offen offset:1024 sc1
    buffer_load_dwordx4 a[40:43], v213, s[24:27], s59 offen offset:0 sc1
    buffer_load_dwordx4 a[44:47], v213, s[24:27], s59 offen offset:1024 sc1
    buffer_load_dword v2, v1, s[76:79], 0 offen offset:0 sc1
    s_waitcnt vmcnt(9) lgkmcnt(4)
    v_mfma_f32_16x16x32_bf16 v[28:31], a[128:131], a[0:3], v[28:31]
    ds_read_b64_tr_b16 a[144:145], v16 offset:0
    buffer_load_dwordx4 a[48:51], v214, s[24:27], s59 offen offset:0 sc1
    v_mfma_f32_16x16x32_bf16 v[28:31], a[132:135], a[8:11], v[28:31]
    ds_read_b64_tr_b16 a[146:147], v16 offset:2048
    v_mfma_f32_16x16x32_bf16 v[32:35], a[132:135], a[12:15], v[32:35]
    ds_read_b64_tr_b16 a[148:149], v16 offset:4096
    buffer_load_dwordx4 a[52:55], v214, s[24:27], s59 offen offset:1024 sc1
    v_mfma_f32_16x16x32_bf16 v[32:35], a[128:131], a[4:7], v[32:35]
    ds_read_b64_tr_b16 a[150:151], v16 offset:6144
    s_waitcnt lgkmcnt(4)
    v_mfma_f32_16x16x32_bf16 v[40:43], a[136:139], a[4:7], v[40:43]
    ds_read_b64_tr_b16 a[152:153], v17 offset:0
    v_mfma_f32_16x16x32_bf16 v[40:43], a[140:143], a[12:15], v[40:43]
    ds_read_b64_tr_b16 a[154:155], v17 offset:2048
    v_mfma_f32_16x16x32_bf16 v[36:39], a[140:143], a[8:11], v[36:39]
    ds_read_b64_tr_b16 a[156:157], v17 offset:4096
    v_mfma_f32_16x16x32_bf16 v[36:39], a[136:139], a[0:3], v[36:39]
    ds_read_b64_tr_b16 a[158:159], v17 offset:6144
    s_waitcnt lgkmcnt(4)
    v_mfma_f32_16x16x32_bf16 v[44:47], a[144:147], a[0:3], v[44:47]
    ds_read_b64_tr_b16 a[128:129], v14 offset:8192
    buffer_load_dwordx4 a[56:59], v215, s[24:27], s59 offen offset:0 sc1
    v_mfma_f32_16x16x32_bf16 v[44:47], a[148:151], a[8:11], v[44:47]
    ds_read_b64_tr_b16 a[130:131], v14 offset:10240
    v_mfma_f32_16x16x32_bf16 v[48:51], a[148:151], a[12:15], v[48:51]
    ds_read_b64_tr_b16 a[132:133], v14 offset:12288
    buffer_load_dwordx4 a[60:63], v215, s[24:27], s59 offen offset:1024 sc1
    v_mfma_f32_16x16x32_bf16 v[48:51], a[144:147], a[4:7], v[48:51]
    ds_read_b64_tr_b16 a[134:135], v14 offset:14336
    s_waitcnt lgkmcnt(4)
    v_mfma_f32_16x16x32_bf16 v[56:59], a[152:155], a[4:7], v[56:59]
    ds_read_b64_tr_b16 a[136:137], v15 offset:8192
    v_mfma_f32_16x16x32_bf16 v[56:59], a[156:159], a[12:15], v[56:59]
    ds_read_b64_tr_b16 a[138:139], v15 offset:10240
    v_mfma_f32_16x16x32_bf16 v[52:55], a[156:159], a[8:11], v[52:55]
    ds_read_b64_tr_b16 a[140:141], v15 offset:12288
    v_mfma_f32_16x16x32_bf16 v[52:55], a[152:155], a[0:3], v[52:55]
    ds_read_b64_tr_b16 a[142:143], v15 offset:14336
    s_waitcnt vmcnt(9) lgkmcnt(4)
    v_mfma_f32_16x16x32_bf16 v[28:31], a[128:131], a[16:19], v[28:31]
    ds_read_b64_tr_b16 a[144:145], v16 offset:8192
    s_add_u32 s58, s62, 2
    v_mfma_f32_16x16x32_bf16 v[28:31], a[132:135], a[24:27], v[28:31]
    ds_read_b64_tr_b16 a[146:147], v16 offset:10240
    s_and_b32 s58, s58, 7
    v_mfma_f32_16x16x32_bf16 v[32:35], a[132:135], a[28:31], v[32:35]
    ds_read_b64_tr_b16 a[148:149], v16 offset:12288
    s_lshl_b32 s58, s58, 19
    v_mfma_f32_16x16x32_bf16 v[32:35], a[128:131], a[20:23], v[32:35]
    ds_read_b64_tr_b16 a[150:151], v16 offset:14336
    s_waitcnt lgkmcnt(4)
    v_mfma_f32_16x16x32_bf16 v[40:43], a[136:139], a[20:23], v[40:43]
    ds_read_b64_tr_b16 a[152:153], v17 offset:8192
    buffer_load_dwordx4 a[64:67], v212, s[24:27], s58 offen offset:0 sc1
    v_mfma_f32_16x16x32_bf16 v[40:43], a[140:143], a[28:31], v[40:43]
    ds_read_b64_tr_b16 a[154:155], v17 offset:10240
    v_mfma_f32_16x16x32_bf16 v[36:39], a[140:143], a[24:27], v[36:39]
    ds_read_b64_tr_b16 a[156:157], v17 offset:12288
    buffer_load_dwordx4 a[68:71], v212, s[24:27], s58 offen offset:1024 sc1
    v_mfma_f32_16x16x32_bf16 v[36:39], a[136:139], a[16:19], v[36:39]
    ds_read_b64_tr_b16 a[158:159], v17 offset:14336
    s_waitcnt lgkmcnt(4)
    v_mfma_f32_16x16x32_bf16 v[44:47], a[144:147], a[16:19], v[44:47]
    ds_read_b64_tr_b16 a[128:129], v108 offset:0
    buffer_load_dwordx4 a[72:75], v213, s[24:27], s58 offen offset:0 sc1
    v_mfma_f32_16x16x32_bf16 v[44:47], a[148:151], a[24:27], v[44:47]
    ds_read_b64_tr_b16 a[130:131], v108 offset:2048
    v_mfma_f32_16x16x32_bf16 v[48:51], a[148:151], a[28:31], v[48:51]
    ds_read_b64_tr_b16 a[132:133], v108 offset:4096
    buffer_load_dwordx4 a[76:79], v213, s[24:27], s58 offen offset:1024 sc1
    v_mfma_f32_16x16x32_bf16 v[48:51], a[144:147], a[20:23], v[48:51]
    ds_read_b64_tr_b16 a[134:135], v108 offset:6144
    s_waitcnt lgkmcnt(4)
    v_mfma_f32_16x16x32_bf16 v[56:59], a[152:155], a[20:23], v[56:59]
    ds_read_b64_tr_b16 a[136:137], v109 offset:0
    v_mfma_f32_16x16x32_bf16 v[56:59], a[156:159], a[28:31], v[56:59]
    ds_read_b64_tr_b16 a[138:139], v109 offset:2048
    v_mfma_f32_16x16x32_bf16 v[52:55], a[156:159], a[24:27], v[52:55]
    ds_read_b64_tr_b16 a[140:141], v109 offset:4096
    v_mfma_f32_16x16x32_bf16 v[52:55], a[152:155], a[16:19], v[52:55]
    ds_read_b64_tr_b16 a[142:143], v109 offset:6144
    s_waitcnt vmcnt(9) lgkmcnt(4)
    v_mfma_f32_16x16x32_bf16 v[28:31], a[128:131], a[32:35], v[28:31]
    ds_read_b64_tr_b16 a[144:145], v110 offset:0
    buffer_load_dwordx4 a[80:83], v214, s[24:27], s58 offen offset:0 sc1
    v_mfma_f32_16x16x32_bf16 v[28:31], a[132:135], a[40:43], v[28:31]
    ds_read_b64_tr_b16 a[146:147], v110 offset:2048
    v_mfma_f32_16x16x32_bf16 v[32:35], a[132:135], a[44:47], v[32:35]
    ds_read_b64_tr_b16 a[148:149], v110 offset:4096
    buffer_load_dwordx4 a[84:87], v214, s[24:27], s58 offen offset:1024 sc1
    v_mfma_f32_16x16x32_bf16 v[32:35], a[128:131], a[36:39], v[32:35]
    ds_read_b64_tr_b16 a[150:151], v110 offset:6144
    s_waitcnt lgkmcnt(4)
    v_mfma_f32_16x16x32_bf16 v[40:43], a[136:139], a[36:39], v[40:43]
    ds_read_b64_tr_b16 a[152:153], v111 offset:0
    v_mfma_f32_16x16x32_bf16 v[40:43], a[140:143], a[44:47], v[40:43]
    ds_read_b64_tr_b16 a[154:155], v111 offset:2048
    v_mfma_f32_16x16x32_bf16 v[36:39], a[140:143], a[40:43], v[36:39]
    ds_read_b64_tr_b16 a[156:157], v111 offset:4096
    v_mfma_f32_16x16x32_bf16 v[36:39], a[136:139], a[32:35], v[36:39]
    ds_read_b64_tr_b16 a[158:159], v111 offset:6144
    s_waitcnt lgkmcnt(4)
    v_mfma_f32_16x16x32_bf16 v[44:47], a[144:147], a[32:35], v[44:47]
    ds_read_b64_tr_b16 a[128:129], v108 offset:8192
    buffer_load_dwordx4 a[88:91], v215, s[24:27], s58 offen offset:0 sc1
    v_mfma_f32_16x16x32_bf16 v[44:47], a[148:151], a[40:43], v[44:47]
    ds_read_b64_tr_b16 a[130:131], v108 offset:10240
    v_mfma_f32_16x16x32_bf16 v[48:51], a[148:151], a[44:47], v[48:51]
    ds_read_b64_tr_b16 a[132:133], v108 offset:12288
    buffer_load_dwordx4 a[92:95], v215, s[24:27], s58 offen offset:1024 sc1
    v_mfma_f32_16x16x32_bf16 v[48:51], a[144:147], a[36:39], v[48:51]
    ds_read_b64_tr_b16 a[134:135], v108 offset:14336
    s_waitcnt lgkmcnt(4)
    v_mfma_f32_16x16x32_bf16 v[56:59], a[152:155], a[36:39], v[56:59]
    ds_read_b64_tr_b16 a[136:137], v109 offset:8192
    v_mfma_f32_16x16x32_bf16 v[56:59], a[156:159], a[44:47], v[56:59]
    ds_read_b64_tr_b16 a[138:139], v109 offset:10240
    v_mfma_f32_16x16x32_bf16 v[52:55], a[156:159], a[40:43], v[52:55]
    ds_read_b64_tr_b16 a[140:141], v109 offset:12288
    v_mfma_f32_16x16x32_bf16 v[52:55], a[152:155], a[32:35], v[52:55]
    ds_read_b64_tr_b16 a[142:143], v109 offset:14336
    s_waitcnt vmcnt(12)
    s_mov_b32 s13, 0x40000
L_p2all_chk:
    v_cmp_ne_u32 vcc, s100, v2
    s_nop 0
    s_cmp_eq_u64 vcc, 0
    s_cbranch_scc1 L_p2all_ok
    s_mov_b64 exec, vcc
    buffer_load_dword v2, v1, s[76:79], 0 offen offset:0 sc1
    s_waitcnt vmcnt(0)
    s_sub_u32 s13, s13, 1
    s_cmp_lg_u32 s13, 0
    s_cbranch_scc1 L_p2all_chk
L_p2all_ok:
    s_mov_b64 exec, -1
    s_waitcnt vmcnt(8) lgkmcnt(4)
    v_mfma_f32_16x16x32_bf16 v[28:31], a[128:131], a[48:51], v[28:31]
    ds_read_b64_tr_b16 a[144:145], v110 offset:8192
    s_add_u32 s59, s62, 3
    v_mfma_f32_16x16x32_bf16 v[28:31], a[132:135], a[56:59], v[28:31]
    ds_read_b64_tr_b16 a[146:147], v110 offset:10240
    s_and_b32 s59, s59, 7
    v_mfma_f32_16x16x32_bf16 v[32:35], a[132:135], a[60:63], v[32:35]
    ds_read_b64_tr_b16 a[148:149], v110 offset:12288
    s_lshl_b32 s59, s59, 19
    v_mfma_f32_16x16x32_bf16 v[32:35], a[128:131], a[52:55], v[32:35]
    ds_read_b64_tr_b16 a[150:151], v110 offset:14336
    s_waitcnt lgkmcnt(4)
    v_mfma_f32_16x16x32_bf16 v[40:43], a[136:139], a[52:55], v[40:43]
    ds_read_b64_tr_b16 a[152:153], v111 offset:8192
    buffer_load_dwordx4 a[96:99], v212, s[24:27], s59 offen offset:0 sc1
    v_mfma_f32_16x16x32_bf16 v[40:43], a[140:143], a[60:63], v[40:43]
    ds_read_b64_tr_b16 a[154:155], v111 offset:10240
    v_mfma_f32_16x16x32_bf16 v[36:39], a[140:143], a[56:59], v[36:39]
    ds_read_b64_tr_b16 a[156:157], v111 offset:12288
    buffer_load_dwordx4 a[100:103], v212, s[24:27], s59 offen offset:1024 sc1
    v_mfma_f32_16x16x32_bf16 v[36:39], a[136:139], a[48:51], v[36:39]
    ds_read_b64_tr_b16 a[158:159], v111 offset:14336
    s_waitcnt lgkmcnt(4)
    v_mfma_f32_16x16x32_bf16 v[44:47], a[144:147], a[48:51], v[44:47]
    ds_read_b64_tr_b16 a[128:129], v14 offset:16384
    buffer_load_dword v116, v118, s[76:79], s61 offen offset:0 sc1
    v_mfma_f32_16x16x32_bf16 v[44:47], a[148:151], a[56:59], v[44:47]
    ds_read_b64_tr_b16 a[130:131], v14 offset:18432
    v_mfma_f32_16x16x32_bf16 v[48:51], a[148:151], a[60:63], v[48:51]
    ds_read_b64_tr_b16 a[132:133], v14 offset:20480
    buffer_load_dwordx4 a[104:107], v213, s[24:27], s59 offen offset:0 sc1
    v_mfma_f32_16x16x32_bf16 v[48:51], a[144:147], a[52:55], v[48:51]
    ds_read_b64_tr_b16 a[134:135], v14 offset:22528
    s_waitcnt lgkmcnt(4)
    v_mfma_f32_16x16x32_bf16 v[56:59], a[152:155], a[52:55], v[56:59]
    ds_read_b64_tr_b16 a[136:137], v15 offset:16384
    buffer_load_dwordx4 a[108:111], v213, s[24:27], s59 offen offset:1024 sc1
    v_mfma_f32_16x16x32_bf16 v[56:59], a[156:159], a[60:63], v[56:59]
    ds_read_b64_tr_b16 a[138:139], v15 offset:18432
    v_mfma_f32_16x16x32_bf16 v[52:55], a[156:159], a[56:59], v[52:55]
    ds_read_b64_tr_b16 a[140:141], v15 offset:20480
    buffer_load_dword v117, v118, s[76:79], s61 offen offset:512 sc1
    v_mfma_f32_16x16x32_bf16 v[52:55], a[152:155], a[48:51], v[52:55]
    ds_read_b64_tr_b16 a[142:143], v15 offset:22528
    s_waitcnt vmcnt(10) lgkmcnt(4)
    v_mfma_f32_16x16x32_bf16 v[28:31], a[128:131], a[64:67], v[28:31]
    ds_read_b64_tr_b16 a[144:145], v16 offset:16384
    buffer_load_dwordx4 a[112:115], v214, s[24:27], s59 offen offset:0 sc1
    v_mfma_f32_16x16x32_bf16 v[28:31], a[132:135], a[72:75], v[28:31]
    ds_read_b64_tr_b16 a[146:147], v16 offset:18432
    v_mfma_f32_16x16x32_bf16 v[32:35], a[132:135], a[76:79], v[32:35]
    ds_read_b64_tr_b16 a[148:149], v16 offset:20480
    buffer_load_dwordx4 a[116:119], v214, s[24:27], s59 offen offset:1024 sc1
    v_mfma_f32_16x16x32_bf16 v[32:35], a[128:131], a[68:71], v[32:35]
    ds_read_b64_tr_b16 a[150:151], v16 offset:22528
    s_waitcnt lgkmcnt(4)
    v_mfma_f32_16x16x32_bf16 v[40:43], a[136:139], a[68:71], v[40:43]
    ds_read_b64_tr_b16 a[152:153], v17 offset:16384
    v_mfma_f32_16x16x32_bf16 v[40:43], a[140:143], a[76:79], v[40:43]
    ds_read_b64_tr_b16 a[154:155], v17 offset:18432
    v_mfma_f32_16x16x32_bf16 v[36:39], a[140:143], a[72:75], v[36:39]
    ds_read_b64_tr_b16 a[156:157], v17 offset:20480
    v_mfma_f32_16x16x32_bf16 v[36:39], a[136:139], a[64:67], v[36:39]
    ds_read_b64_tr_b16 a[158:159], v17 offset:22528
    s_waitcnt lgkmcnt(4)
    v_mfma_f32_16x16x32_bf16 v[44:47], a[144:147], a[64:67], v[44:47]
    ds_read_b64_tr_b16 a[128:129], v14 offset:24576
    buffer_load_dwordx4 a[120:123], v215, s[24:27], s59 offen offset:0 sc1
    v_mfma_f32_16x16x32_bf16 v[44:47], a[148:151], a[72:75], v[44:47]
    ds_read_b64_tr_b16 a[130:131], v14 offset:26624
    v_mfma_f32_16x16x32_bf16 v[48:51], a[148:151], a[76:79], v[48:51]
    ds_read_b64_tr_b16 a[132:133], v14 offset:28672
    buffer_load_dwordx4 a[124:127], v215, s[24:27], s59 offen offset:1024 sc1
    v_mfma_f32_16x16x32_bf16 v[48:51], a[144:147], a[68:71], v[48:51]
    ds_read_b64_tr_b16 a[134:135], v14 offset:30720
    s_waitcnt lgkmcnt(4)
    v_mfma_f32_16x16x32_bf16 v[56:59], a[152:155], a[68:71], v[56:59]
    ds_read_b64_tr_b16 a[136:137], v15 offset:24576
    buffer_load_dwordx2 v[92:93], v112, s[76:79], 0 offen offset:0 sc1
    v_mfma_f32_16x16x32_bf16 v[56:59], a[156:159], a[76:79], v[56:59]
    ds_read_b64_tr_b16 a[138:139], v15 offset:26624
    v_mfma_f32_16x16x32_bf16 v[52:55], a[156:159], a[72:75], v[52:55]
    ds_read_b64_tr_b16 a[140:141], v15 offset:28672
    v_mfma_f32_16x16x32_bf16 v[52:55], a[152:155], a[64:67], v[52:55]
    ds_read_b64_tr_b16 a[142:143], v15 offset:30720
    s_waitcnt vmcnt(11) lgkmcnt(4)
    v_mfma_f32_16x16x32_bf16 v[28:31], a[128:131], a[80:83], v[28:31]
    ds_read_b64_tr_b16 a[144:145], v16 offset:24576
    s_add_u32 s58, s62, 4
    v_mfma_f32_16x16x32_bf16 v[28:31], a[132:135], a[88:91], v[28:31]
    ds_read_b64_tr_b16 a[146:147], v16 offset:26624
    s_and_b32 s58, s58, 7
    v_mfma_f32_16x16x32_bf16 v[32:35], a[132:135], a[92:95], v[32:35]
    ds_read_b64_tr_b16 a[148:149], v16 offset:28672
    s_lshl_b32 s58, s58, 19
    v_mfma_f32_16x16x32_bf16 v[32:35], a[128:131], a[84:87], v[32:35]
    ds_read_b64_tr_b16 a[150:151], v16 offset:30720
    s_waitcnt lgkmcnt(4)
    v_mfma_f32_16x16x32_bf16 v[40:43], a[136:139], a[84:87], v[40:43]
    ds_read_b64_tr_b16 a[152:153], v17 offset:24576
    buffer_load_dwordx4 a[0:3], v212, s[24:27], s58 offen offset:0 sc1
    v_mfma_f32_16x16x32_bf16 v[40:43], a[140:143], a[92:95], v[40:43]
    ds_read_b64_tr_b16 a[154:155], v17 offset:26624
    v_mfma_f32_16x16x32_bf16 v[36:39], a[140:143], a[88:91], v[36:39]
    ds_read_b64_tr_b16 a[156:157], v17 offset:28672
    buffer_load_dwordx4 a[4:7], v212, s[24:27], s58 offen offset:1024 sc1
    v_mfma_f32_16x16x32_bf16 v[36:39], a[136:139], a[80:83], v[36:39]
    ds_read_b64_tr_b16 a[158:159], v17 offset:30720
    s_waitcnt lgkmcnt(4)
    v_mfma_f32_16x16x32_bf16 v[44:47], a[144:147], a[80:83], v[44:47]
    ds_read_b64_tr_b16 a[128:129], v108 offset:16384
    buffer_load_dwordx2 v[94:95], v112, s[76:79], 0 offen offset:512 sc1
    v_mfma_f32_16x16x32_bf16 v[44:47], a[148:151], a[88:91], v[44:47]
    ds_read_b64_tr_b16 a[130:131], v108 offset:18432
    v_mfma_f32_16x16x32_bf16 v[48:51], a[148:151], a[92:95], v[48:51]
    ds_read_b64_tr_b16 a[132:133], v108 offset:20480
    buffer_load_dwordx4 a[8:11], v213, s[24:27], s58 offen offset:0 sc1
    v_mfma_f32_16x16x32_bf16 v[48:51], a[144:147], a[84:87], v[48:51]
    ds_read_b64_tr_b16 a[134:135], v108 offset:22528
    s_waitcnt lgkmcnt(4)
    v_mfma_f32_16x16x32_bf16 v[56:59], a[152:155], a[84:87], v[56:59]
    ds_read_b64_tr_b16 a[136:137], v109 offset:16384
    buffer_load_dwordx4 a[12:15], v213, s[24:27], s58 offen offset:1024 sc1
    v_mfma_f32_16x16x32_bf16 v[56:59], a[156:159], a[92:95], v[56:59]
    ds_read_b64_tr_b16 a[138:139], v109 offset:18432
    v_mfma_f32_16x16x32_bf16 v[52:55], a[156:159], a[88:91], v[52:55]
    ds_read_b64_tr_b16 a[140:141], v109 offset:20480
    buffer_load_dwordx2 v[96:97], v112, s[76:79], 0 offen offset:1024 sc1
    v_mfma_f32_16x16x32_bf16 v[52:55], a[152:155], a[80:83], v[52:55]
    ds_read_b64_tr_b16 a[142:143], v109 offset:22528
    s_waitcnt vmcnt(12) lgkmcnt(4)
    v_mfma_f32_16x16x32_bf16 v[28:31], a[128:131], a[96:99], v[28:31]
    ds_read_b64_tr_b16 a[144:145], v110 offset:16384
    buffer_load_dwordx4 a[16:19], v214, s[24:27], s58 offen offset:0 sc1
    v_mfma_f32_16x16x32_bf16 v[28:31], a[132:135], a[104:107], v[28:31]
    ds_read_b64_tr_b16 a[146:147], v110 offset:18432
    v_mfma_f32_16x16x32_bf16 v[32:35], a[132:135], a[108:111], v[32:35]
    ds_read_b64_tr_b16 a[148:149], v110 offset:20480
    buffer_load_dwordx4 a[20:23], v214, s[24:27], s58 offen offset:1024 sc1
    v_mfma_f32_16x16x32_bf16 v[32:35], a[128:131], a[100:103], v[32:35]
    ds_read_b64_tr_b16 a[150:151], v110 offset:22528
    s_waitcnt lgkmcnt(4)
    v_mfma_f32_16x16x32_bf16 v[40:43], a[136:139], a[100:103], v[40:43]
    ds_read_b64_tr_b16 a[152:153], v111 offset:16384
    v_mfma_f32_16x16x32_bf16 v[40:43], a[140:143], a[108:111], v[40:43]
    ds_read_b64_tr_b16 a[154:155], v111 offset:18432
    v_mfma_f32_16x16x32_bf16 v[36:39], a[140:143], a[104:107], v[36:39]
    ds_read_b64_tr_b16 a[156:157], v111 offset:20480
    v_mfma_f32_16x16x32_bf16 v[36:39], a[136:139], a[96:99], v[36:39]
    ds_read_b64_tr_b16 a[158:159], v111 offset:22528
    s_waitcnt lgkmcnt(4)
    v_mfma_f32_16x16x32_bf16 v[44:47], a[144:147], a[96:99], v[44:47]
    ds_read_b64_tr_b16 a[128:129], v108 offset:24576
    buffer_load_dwordx4 a[24:27], v215, s[24:27], s58 offen offset:0 sc1
    v_mfma_f32_16x16x32_bf16 v[44:47], a[148:151], a[104:107], v[44:47]
    ds_read_b64_tr_b16 a[130:131], v108 offset:26624
    v_mfma_f32_16x16x32_bf16 v[48:51], a[148:151], a[108:111], v[48:51]
    ds_read_b64_tr_b16 a[132:133], v108 offset:28672
    buffer_load_dwordx4 a[28:31], v215, s[24:27], s58 offen offset:1024 sc1
    v_mfma_f32_16x16x32_bf16 v[48:51], a[144:147], a[100:103], v[48:51]
    ds_read_b64_tr_b16 a[134:135], v108 offset:30720
    s_waitcnt lgkmcnt(4)
    v_mfma_f32_16x16x32_bf16 v[56:59], a[152:155], a[100:103], v[56:59]
    ds_read_b64_tr_b16 a[136:137], v109 offset:24576
    buffer_load_dwordx2 v[98:99], v112, s[76:79], 0 offen offset:1536 sc1
    v_mfma_f32_16x16x32_bf16 v[56:59], a[156:159], a[108:111], v[56:59]
    ds_read_b64_tr_b16 a[138:139], v109 offset:26624
    v_mfma_f32_16x16x32_bf16 v[52:55], a[156:159], a[104:107], v[52:55]
    ds_read_b64_tr_b16 a[140:141], v109 offset:28672
    v_mfma_f32_16x16x32_bf16 v[52:55], a[152:155], a[96:99], v[52:55]
    ds_read_b64_tr_b16 a[142:143], v109 offset:30720
    s_waitcnt vmcnt(12) lgkmcnt(4)
    v_mfma_f32_16x16x32_bf16 v[28:31], a[128:131], a[112:115], v[28:31]
    ds_read_b64_tr_b16 a[144:145], v110 offset:24576
    s_add_u32 s59, s62, 5
    v_mfma_f32_16x16x32_bf16 v[28:31], a[132:135], a[120:123], v[28:31]
    ds_read_b64_tr_b16 a[146:147], v110 offset:26624
    s_and_b32 s59, s59, 7
    v_mfma_f32_16x16x32_bf16 v[32:35], a[132:135], a[124:127], v[32:35]
    ds_read_b64_tr_b16 a[148:149], v110 offset:28672
    s_lshl_b32 s59, s59, 19
    v_mfma_f32_16x16x32_bf16 v[32:35], a[128:131], a[116:119], v[32:35]
    ds_read_b64_tr_b16 a[150:151], v110 offset:30720
    s_waitcnt lgkmcnt(4)
    v_mfma_f32_16x16x32_bf16 v[40:43], a[136:139], a[116:119], v[40:43]
    ds_read_b64_tr_b16 a[152:153], v111 offset:24576
    buffer_load_dwordx4 a[32:35], v212, s[24:27], s59 offen offset:0 sc1
    v_mfma_f32_16x16x32_bf16 v[40:43], a[140:143], a[124:127], v[40:43]
    ds_read_b64_tr_b16 a[154:155], v111 offset:26624
    v_mfma_f32_16x16x32_bf16 v[36:39], a[140:143], a[120:123], v[36:39]
    ds_read_b64_tr_b16 a[156:157], v111 offset:28672
    buffer_load_dwordx4 a[36:39], v212, s[24:27], s59 offen offset:1024 sc1
    v_mfma_f32_16x16x32_bf16 v[36:39], a[136:139], a[112:115], v[36:39]
    ds_read_b64_tr_b16 a[158:159], v111 offset:30720
    s_waitcnt lgkmcnt(4)
    v_mfma_f32_16x16x32_bf16 v[44:47], a[144:147], a[112:115], v[44:47]
    ds_read_b64_tr_b16 a[128:129], v14 offset:32768
    buffer_load_dwordx2 v[100:101], v112, s[76:79], 0 offen offset:2048 sc1
    v_mfma_f32_16x16x32_bf16 v[44:47], a[148:151], a[120:123], v[44:47]
    ds_read_b64_tr_b16 a[130:131], v14 offset:34816
    v_mfma_f32_16x16x32_bf16 v[48:51], a[148:151], a[124:127], v[48:51]
    ds_read_b64_tr_b16 a[132:133], v14 offset:36864
    buffer_load_dwordx4 a[40:43], v213, s[24:27], s59 offen offset:0 sc1
    v_mfma_f32_16x16x32_bf16 v[48:51], a[144:147], a[116:119], v[48:51]
    ds_read_b64_tr_b16 a[134:135], v14 offset:38912
    s_waitcnt lgkmcnt(4)
    v_mfma_f32_16x16x32_bf16 v[56:59], a[152:155], a[116:119], v[56:59]
    ds_read_b64_tr_b16 a[136:137], v15 offset:32768
    buffer_load_dwordx4 a[44:47], v213, s[24:27], s59 offen offset:1024 sc1
    v_mfma_f32_16x16x32_bf16 v[56:59], a[156:159], a[124:127], v[56:59]
    ds_read_b64_tr_b16 a[138:139], v15 offset:34816
    v_mfma_f32_16x16x32_bf16 v[52:55], a[156:159], a[120:123], v[52:55]
    ds_read_b64_tr_b16 a[140:141], v15 offset:36864
    buffer_load_dwordx2 v[102:103], v112, s[76:79], 0 offen offset:2560 sc1
    v_mfma_f32_16x16x32_bf16 v[52:55], a[152:155], a[112:115], v[52:55]
    ds_read_b64_tr_b16 a[142:143], v15 offset:38912
    s_waitcnt vmcnt(12) lgkmcnt(4)
    v_mfma_f32_16x16x32_bf16 v[28:31], a[128:131], a[0:3], v[28:31]
    ds_read_b64_tr_b16 a[144:145], v16 offset:32768
    buffer_load_dwordx4 a[48:51], v214, s[24:27], s59 offen offset:0 sc1
    v_mfma_f32_16x16x32_bf16 v[28:31], a[132:135], a[8:11], v[28:31]
    ds_read_b64_tr_b16 a[146:147], v16 offset:34816
    v_mfma_f32_16x16x32_bf16 v[32:35], a[132:135], a[12:15], v[32:35]
    ds_read_b64_tr_b16 a[148:149], v16 offset:36864
    buffer_load_dwordx4 a[52:55], v214, s[24:27], s59 offen offset:1024 sc1
    v_mfma_f32_16x16x32_bf16 v[32:35], a[128:131], a[4:7], v[32:35]
    ds_read_b64_tr_b16 a[150:151], v16 offset:38912
    s_waitcnt lgkmcnt(4)
    v_mfma_f32_16x16x32_bf16 v[40:43], a[136:139], a[4:7], v[40:43]
    ds_read_b64_tr_b16 a[152:153], v17 offset:32768
    v_mfma_f32_16x16x32_bf16 v[40:43], a[140:143], a[12:15], v[40:43]
    ds_read_b64_tr_b16 a[154:155], v17 offset:34816
    v_mfma_f32_16x16x32_bf16 v[36:39], a[140:143], a[8:11], v[36:39]
    ds_read_b64_tr_b16 a[156:157], v17 offset:36864
    v_mfma_f32_16x16x32_bf16 v[36:39], a[136:139], a[0:3], v[36:39]
    ds_read_b64_tr_b16 a[158:159], v17 offset:38912
    s_waitcnt lgkmcnt(4)
    v_mfma_f32_16x16x32_bf16 v[44:47], a[144:147], a[0:3], v[44:47]
    ds_read_b64_tr_b16 a[128:129], v14 offset:40960
    buffer_load_dwordx4 a[56:59], v215, s[24:27], s59 offen offset:0 sc1
    v_mfma_f32_16x16x32_bf16 v[44:47], a[148:151], a[8:11], v[44:47]
    ds_read_b64_tr_b16 a[130:131], v14 offset:43008
    v_mfma_f32_16x16x32_bf16 v[48:51], a[148:151], a[12:15], v[48:51]
    ds_read_b64_tr_b16 a[132:133], v14 offset:45056
    buffer_load_dwordx4 a[60:63], v215, s[24:27], s59 offen offset:1024 sc1
    v_mfma_f32_16x16x32_bf16 v[48:51], a[144:147], a[4:7], v[48:51]
    ds_read_b64_tr_b16 a[134:135], v14 offset:47104
    s_waitcnt lgkmcnt(4)
    v_mfma_f32_16x16x32_bf16 v[56:59], a[152:155], a[4:7], v[56:59]
    ds_read_b64_tr_b16 a[136:137], v15 offset:40960
    buffer_load_dwordx2 v[104:105], v112, s[76:79], 0 offen offset:3072 sc1
    v_mfma_f32_16x16x32_bf16 v[56:59], a[156:159], a[12:15], v[56:59]
    ds_read_b64_tr_b16 a[138:139], v15 offset:43008
    v_mfma_f32_16x16x32_bf16 v[52:55], a[156:159], a[8:11], v[52:55]
    ds_read_b64_tr_b16 a[140:141], v15 offset:45056
    v_mfma_f32_16x16x32_bf16 v[52:55], a[152:155], a[0:3], v[52:55]
    ds_read_b64_tr_b16 a[142:143], v15 offset:47104
    s_waitcnt vmcnt(12) lgkmcnt(4)
    v_mfma_f32_16x16x32_bf16 v[28:31], a[128:131], a[16:19], v[28:31]
    ds_read_b64_tr_b16 a[144:145], v16 offset:40960
    s_add_u32 s58, s62, 6
    v_mfma_f32_16x16x32_bf16 v[28:31], a[132:135], a[24:27], v[28:31]
    ds_read_b64_tr_b16 a[146:147], v16 offset:43008
    s_and_b32 s58, s58, 7
    v_mfma_f32_16x16x32_bf16 v[32:35], a[132:135], a[28:31], v[32:35]
    ds_read_b64_tr_b16 a[148:149], v16 offset:45056
    s_lshl_b32 s58, s58, 19
    v_mfma_f32_16x16x32_bf16 v[32:35], a[128:131], a[20:23], v[32:35]
    ds_read_b64_tr_b16 a[150:151], v16 offset:47104
    s_waitcnt lgkmcnt(4)
    v_mfma_f32_16x16x32_bf16 v[40:43], a[136:139], a[20:23], v[40:43]
    ds_read_b64_tr_b16 a[152:153], v17 offset:40960
    buffer_load_dwordx4 a[64:67], v212, s[24:27], s58 offen offset:0 sc1
    v_mfma_f32_16x16x32_bf16 v[40:43], a[140:143], a[28:31], v[40:43]
    ds_read_b64_tr_b16 a[154:155], v17 offset:43008
    v_mfma_f32_16x16x32_bf16 v[36:39], a[140:143], a[24:27], v[36:39]
    ds_read_b64_tr_b16 a[156:157], v17 offset:45056
    buffer_load_dwordx4 a[68:71], v212, s[24:27], s58 offen offset:1024 sc1
    v_mfma_f32_16x16x32_bf16 v[36:39], a[136:139], a[16:19], v[36:39]
    ds_read_b64_tr_b16 a[158:159], v17 offset:47104
    s_waitcnt lgkmcnt(4)
    v_mfma_f32_16x16x32_bf16 v[44:47], a[144:147], a[16:19], v[44:47]
    ds_read_b64_tr_b16 a[128:129], v14 offset:49152
    buffer_load_dwordx2 v[106:107], v112, s[76:79], 0 offen offset:3584 sc1
    v_mfma_f32_16x16x32_bf16 v[44:47], a[148:151], a[24:27], v[44:47]
    ds_read_b64_tr_b16 a[130:131], v14 offset:51200
    v_mfma_f32_16x16x32_bf16 v[48:51], a[148:151], a[28:31], v[48:51]
    ds_read_b64_tr_b16 a[132:133], v14 offset:53248
    buffer_load_dwordx4 a[72:75], v213, s[24:27], s58 offen offset:0 sc1
    v_mfma_f32_16x16x32_bf16 v[48:51], a[144:147], a[20:23], v[48:51]
    ds_read_b64_tr_b16 a[134:135], v14 offset:55296
    s_waitcnt lgkmcnt(4)
    v_mfma_f32_16x16x32_bf16 v[56:59], a[152:155], a[20:23], v[56:59]
    ds_read_b64_tr_b16 a[136:137], v15 offset:49152
    buffer_load_dwordx4 a[76:79], v213, s[24:27], s58 offen offset:1024 sc1
    v_mfma_f32_16x16x32_bf16 v[56:59], a[156:159], a[28:31], v[56:59]
    ds_read_b64_tr_b16 a[138:139], v15 offset:51200
    v_mfma_f32_16x16x32_bf16 v[52:55], a[156:159], a[24:27], v[52:55]
    ds_read_b64_tr_b16 a[140:141], v15 offset:53248
    v_mfma_f32_16x16x32_bf16 v[52:55], a[152:155], a[16:19], v[52:55]
    ds_read_b64_tr_b16 a[142:143], v15 offset:55296
    s_waitcnt vmcnt(11) lgkmcnt(4)
    v_mfma_f32_16x16x32_bf16 v[28:31], a[128:131], a[32:35], v[28:31]
    ds_read_b64_tr_b16 a[144:145], v16 offset:49152
    buffer_load_dwordx4 a[80:83], v214, s[24:27], s58 offen offset:0 sc1
    v_mfma_f32_16x16x32_bf16 v[28:31], a[132:135], a[40:43], v[28:31]
    ds_read_b64_tr_b16 a[146:147], v16 offset:51200
    v_mfma_f32_16x16x32_bf16 v[32:35], a[132:135], a[44:47], v[32:35]
    ds_read_b64_tr_b16 a[148:149], v16 offset:53248
    buffer_load_dwordx4 a[84:87], v214, s[24:27], s58 offen offset:1024 sc1
    v_mfma_f32_16x16x32_bf16 v[32:35], a[128:131], a[36:39], v[32:35]
    ds_read_b64_tr_b16 a[150:151], v16 offset:55296
    s_waitcnt lgkmcnt(4)
    v_mfma_f32_16x16x32_bf16 v[40:43], a[136:139], a[36:39], v[40:43]
    ds_read_b64_tr_b16 a[152:153], v17 offset:49152
    v_mfma_f32_16x16x32_bf16 v[40:43], a[140:143], a[44:47], v[40:43]
    ds_read_b64_tr_b16 a[154:155], v17 offset:51200
    v_mfma_f32_16x16x32_bf16 v[36:39], a[140:143], a[40:43], v[36:39]
    ds_read_b64_tr_b16 a[156:157], v17 offset:53248
    v_mfma_f32_16x16x32_bf16 v[36:39], a[136:139], a[32:35], v[36:39]
    ds_read_b64_tr_b16 a[158:159], v17 offset:55296
    s_waitcnt lgkmcnt(4)
    v_mfma_f32_16x16x32_bf16 v[44:47], a[144:147], a[32:35], v[44:47]
    ds_read_b64_tr_b16 a[128:129], v14 offset:57344
    buffer_load_dwordx4 a[88:91], v215, s[24:27], s58 offen offset:0 sc1
    v_mfma_f32_16x16x32_bf16 v[44:47], a[148:151], a[40:43], v[44:47]
    ds_read_b64_tr_b16 a[130:131], v14 offset:59392
    v_mfma_f32_16x16x32_bf16 v[48:51], a[148:151], a[44:47], v[48:51]
    ds_read_b64_tr_b16 a[132:133], v14 offset:61440
    buffer_load_dwordx4 a[92:95], v215, s[24:27], s58 offen offset:1024 sc1
    v_mfma_f32_16x16x32_bf16 v[48:51], a[144:147], a[36:39], v[48:51]
    ds_read_b64_tr_b16 a[134:135], v14 offset:63488
    s_waitcnt lgkmcnt(4)
    v_mfma_f32_16x16x32_bf16 v[56:59], a[152:155], a[36:39], v[56:59]
    ds_read_b64_tr_b16 a[136:137], v15 offset:57344
    v_mfma_f32_16x16x32_bf16 v[56:59], a[156:159], a[44:47], v[56:59]
    ds_read_b64_tr_b16 a[138:139], v15 offset:59392
    v_mfma_f32_16x16x32_bf16 v[52:55], a[156:159], a[40:43], v[52:55]
    ds_read_b64_tr_b16 a[140:141], v15 offset:61440
    v_mfma_f32_16x16x32_bf16 v[52:55], a[152:155], a[32:35], v[52:55]
    ds_read_b64_tr_b16 a[142:143], v15 offset:63488
    s_waitcnt vmcnt(10) lgkmcnt(4)
    v_mfma_f32_16x16x32_bf16 v[28:31], a[128:131], a[48:51], v[28:31]
    ds_read_b64_tr_b16 a[144:145], v16 offset:57344
    s_add_u32 s59, s62, 7
    v_mfma_f32_16x16x32_bf16 v[28:31], a[132:135], a[56:59], v[28:31]
    ds_read_b64_tr_b16 a[146:147], v16 offset:59392
    s_and_b32 s59, s59, 7
    v_mfma_f32_16x16x32_bf16 v[32:35], a[132:135], a[60:63], v[32:35]
    ds_read_b64_tr_b16 a[148:149], v16 offset:61440
    s_lshl_b32 s59, s59, 19
    v_mfma_f32_16x16x32_bf16 v[32:35], a[128:131], a[52:55], v[32:35]
    ds_read_b64_tr_b16 a[150:151], v16 offset:63488
    s_waitcnt lgkmcnt(4)
    v_mfma_f32_16x16x32_bf16 v[40:43], a[136:139], a[52:55], v[40:43]
    ds_read_b64_tr_b16 a[152:153], v17 offset:57344
    buffer_load_dwordx4 a[96:99], v212, s[24:27], s59 offen offset:0 sc1
    v_mfma_f32_16x16x32_bf16 v[40:43], a[140:143], a[60:63], v[40:43]
    ds_read_b64_tr_b16 a[154:155], v17 offset:59392
    v_mfma_f32_16x16x32_bf16 v[36:39], a[140:143], a[56:59], v[36:39]
    ds_read_b64_tr_b16 a[156:157], v17 offset:61440
    buffer_load_dwordx4 a[100:103], v212, s[24:27], s59 offen offset:1024 sc1
    v_mfma_f32_16x16x32_bf16 v[36:39], a[136:139], a[48:51], v[36:39]
    ds_read_b64_tr_b16 a[158:159], v17 offset:63488
    s_waitcnt lgkmcnt(4)
    v_mfma_f32_16x16x32_bf16 v[44:47], a[144:147], a[48:51], v[44:47]
    ds_read_b64_tr_b16 a[128:129], v108 offset:32768
    buffer_load_dwordx4 a[104:107], v213, s[24:27], s59 offen offset:0 sc1
    v_mfma_f32_16x16x32_bf16 v[44:47], a[148:151], a[56:59], v[44:47]
    ds_read_b64_tr_b16 a[130:131], v108 offset:34816
    v_mfma_f32_16x16x32_bf16 v[48:51], a[148:151], a[60:63], v[48:51]
    ds_read_b64_tr_b16 a[132:133], v108 offset:36864
    buffer_load_dwordx4 a[108:111], v213, s[24:27], s59 offen offset:1024 sc1
    v_mfma_f32_16x16x32_bf16 v[48:51], a[144:147], a[52:55], v[48:51]
    ds_read_b64_tr_b16 a[134:135], v108 offset:38912
    s_waitcnt lgkmcnt(4)
    v_mfma_f32_16x16x32_bf16 v[56:59], a[152:155], a[52:55], v[56:59]
    ds_read_b64_tr_b16 a[136:137], v109 offset:32768
    v_mfma_f32_16x16x32_bf16 v[56:59], a[156:159], a[60:63], v[56:59]
    ds_read_b64_tr_b16 a[138:139], v109 offset:34816
    v_mfma_f32_16x16x32_bf16 v[52:55], a[156:159], a[56:59], v[52:55]
    ds_read_b64_tr_b16 a[140:141], v109 offset:36864
    v_mfma_f32_16x16x32_bf16 v[52:55], a[152:155], a[48:51], v[52:55]
    ds_read_b64_tr_b16 a[142:143], v109 offset:38912
    s_waitcnt vmcnt(8) lgkmcnt(4)
    v_mfma_f32_16x16x32_bf16 v[28:31], a[128:131], a[64:67], v[28:31]
    ds_read_b64_tr_b16 a[144:145], v110 offset:32768
    buffer_load_dwordx4 a[112:115], v214, s[24:27], s59 offen offset:0 sc1
    v_mfma_f32_16x16x32_bf16 v[28:31], a[132:135], a[72:75], v[28:31]
    ds_read_b64_tr_b16 a[146:147], v110 offset:34816
    v_mfma_f32_16x16x32_bf16 v[32:35], a[132:135], a[76:79], v[32:35]
    ds_read_b64_tr_b16 a[148:149], v110 offset:36864
    buffer_load_dwordx4 a[116:119], v214, s[24:27], s59 offen offset:1024 sc1
    v_mfma_f32_16x16x32_bf16 v[32:35], a[128:131], a[68:71], v[32:35]
    ds_read_b64_tr_b16 a[150:151], v110 offset:38912
    s_waitcnt lgkmcnt(4)
    v_mfma_f32_16x16x32_bf16 v[40:43], a[136:139], a[68:71], v[40:43]
    ds_read_b64_tr_b16 a[152:153], v111 offset:32768
    v_mfma_f32_16x16x32_bf16 v[40:43], a[140:143], a[76:79], v[40:43]
    ds_read_b64_tr_b16 a[154:155], v111 offset:34816
    v_mfma_f32_16x16x32_bf16 v[36:39], a[140:143], a[72:75], v[36:39]
    ds_read_b64_tr_b16 a[156:157], v111 offset:36864
    v_mfma_f32_16x16x32_bf16 v[36:39], a[136:139], a[64:67], v[36:39]
    ds_read_b64_tr_b16 a[158:159], v111 offset:38912
    s_waitcnt lgkmcnt(4)
    v_mfma_f32_16x16x32_bf16 v[44:47], a[144:147], a[64:67], v[44:47]
    ds_read_b64_tr_b16 a[128:129], v108 offset:40960
    buffer_load_dwordx4 a[120:123], v215, s[24:27], s59 offen offset:0 sc1
    v_mfma_f32_16x16x32_bf16 v[44:47], a[148:151], a[72:75], v[44:47]
    ds_read_b64_tr_b16 a[130:131], v108 offset:43008
    v_mfma_f32_16x16x32_bf16 v[48:51], a[148:151], a[76:79], v[48:51]
    ds_read_b64_tr_b16 a[132:133], v108 offset:45056
    buffer_load_dwordx4 a[124:127], v215, s[24:27], s59 offen offset:1024 sc1
    v_mfma_f32_16x16x32_bf16 v[48:51], a[144:147], a[68:71], v[48:51]
    ds_read_b64_tr_b16 a[134:135], v108 offset:47104
    s_waitcnt lgkmcnt(4)
    v_mfma_f32_16x16x32_bf16 v[56:59], a[152:155], a[68:71], v[56:59]
    ds_read_b64_tr_b16 a[136:137], v109 offset:40960
    v_mfma_f32_16x16x32_bf16 v[56:59], a[156:159], a[76:79], v[56:59]
    ds_read_b64_tr_b16 a[138:139], v109 offset:43008
    v_mfma_f32_16x16x32_bf16 v[52:55], a[156:159], a[72:75], v[52:55]
    ds_read_b64_tr_b16 a[140:141], v109 offset:45056
    v_mfma_f32_16x16x32_bf16 v[52:55], a[152:155], a[64:67], v[52:55]
    ds_read_b64_tr_b16 a[142:143], v109 offset:47104
    s_waitcnt vmcnt(8) lgkmcnt(4)
    v_mfma_f32_16x16x32_bf16 v[28:31], a[128:131], a[80:83], v[28:31]
    ds_read_b64_tr_b16 a[144:145], v110 offset:40960
    v_mfma_f32_16x16x32_bf16 v[28:31], a[132:135], a[88:91], v[28:31]
    ds_read_b64_tr_b16 a[146:147], v110 offset:43008
    v_mfma_f32_16x16x32_bf16 v[32:35], a[132:135], a[92:95], v[32:35]
    ds_read_b64_tr_b16 a[148:149], v110 offset:45056
    v_mfma_f32_16x16x32_bf16 v[32:35], a[128:131], a[84:87], v[32:35]
    ds_read_b64_tr_b16 a[150:151], v110 offset:47104
    s_waitcnt lgkmcnt(4)
    v_mfma_f32_16x16x32_bf16 v[40:43], a[136:139], a[84:87], v[40:43]
    ds_read_b64_tr_b16 a[152:153], v111 offset:40960
    v_mfma_f32_16x16x32_bf16 v[40:43], a[140:143], a[92:95], v[40:43]
    ds_read_b64_tr_b16 a[154:155], v111 offset:43008
    v_mfma_f32_16x16x32_bf16 v[36:39], a[140:143], a[88:91], v[36:39]
    ds_read_b64_tr_b16 a[156:157], v111 offset:45056
    v_mfma_f32_16x16x32_bf16 v[36:39], a[136:139], a[80:83], v[36:39]
    ds_read_b64_tr_b16 a[158:159], v111 offset:47104
    s_waitcnt lgkmcnt(4)
    v_mfma_f32_16x16x32_bf16 v[44:47], a[144:147], a[80:83], v[44:47]
    ds_read_b64_tr_b16 a[128:129], v108 offset:49152
    v_mfma_f32_16x16x32_bf16 v[44:47], a[148:151], a[88:91], v[44:47]
    ds_read_b64_tr_b16 a[130:131], v108 offset:51200
    v_mfma_f32_16x16x32_bf16 v[48:51], a[148:151], a[92:95], v[48:51]
    ds_read_b64_tr_b16 a[132:133], v108 offset:53248
    v_mfma_f32_16x16x32_bf16 v[48:51], a[144:147], a[84:87], v[48:51]
    ds_read_b64_tr_b16 a[134:135], v108 offset:55296
    s_waitcnt lgkmcnt(4)
    v_mfma_f32_16x16x32_bf16 v[56:59], a[152:155], a[84:87], v[56:59]
    ds_read_b64_tr_b16 a[136:137], v109 offset:49152
    v_mfma_f32_16x16x32_bf16 v[56:59], a[156:159], a[92:95], v[56:59]
    ds_read_b64_tr_b16 a[138:139], v109 offset:51200
    v_mfma_f32_16x16x32_bf16 v[52:55], a[156:159], a[88:91], v[52:55]
    ds_read_b64_tr_b16 a[140:141], v109 offset:53248
    v_mfma_f32_16x16x32_bf16 v[52:55], a[152:155], a[80:83], v[52:55]
    ds_read_b64_tr_b16 a[142:143], v109 offset:55296
    s_waitcnt vmcnt(4) lgkmcnt(4)
    v_mfma_f32_16x16x32_bf16 v[28:31], a[128:131], a[96:99], v[28:31]
    ds_read_b64_tr_b16 a[144:145], v110 offset:49152
    v_mfma_f32_16x16x32_bf16 v[28:31], a[132:135], a[104:107], v[28:31]
    ds_read_b64_tr_b16 a[146:147], v110 offset:51200
    v_mfma_f32_16x16x32_bf16 v[32:35], a[132:135], a[108:111], v[32:35]
    ds_read_b64_tr_b16 a[148:149], v110 offset:53248
    v_mfma_f32_16x16x32_bf16 v[32:35], a[128:131], a[100:103], v[32:35]
    ds_read_b64_tr_b16 a[150:151], v110 offset:55296
    s_waitcnt lgkmcnt(4)
    v_mfma_f32_16x16x32_bf16 v[40:43], a[136:139], a[100:103], v[40:43]
    ds_read_b64_tr_b16 a[152:153], v111 offset:49152
    v_mfma_f32_16x16x32_bf16 v[40:43], a[140:143], a[108:111], v[40:43]
    ds_read_b64_tr_b16 a[154:155], v111 offset:51200
    v_mfma_f32_16x16x32_bf16 v[36:39], a[140:143], a[104:107], v[36:39]
    ds_read_b64_tr_b16 a[156:157], v111 offset:53248
    v_mfma_f32_16x16x32_bf16 v[36:39], a[136:139], a[96:99], v[36:39]
    ds_read_b64_tr_b16 a[158:159], v111 offset:55296
    s_waitcnt lgkmcnt(4)
    v_mfma_f32_16x16x32_bf16 v[44:47], a[144:147], a[96:99], v[44:47]
    ds_read_b64_tr_b16 a[128:129], v108 offset:57344
    v_mfma_f32_16x16x32_bf16 v[44:47], a[148:151], a[104:107], v[44:47]
    ds_read_b64_tr_b16 a[130:131], v108 offset:59392
    v_mfma_f32_16x16x32_bf16 v[48:51], a[148:151], a[108:111], v[48:51]
    ds_read_b64_tr_b16 a[132:133], v108 offset:61440
    v_mfma_f32_16x16x32_bf16 v[48:51], a[144:147], a[100:103], v[48:51]
    ds_read_b64_tr_b16 a[134:135], v108 offset:63488
    s_waitcnt lgkmcnt(4)
    v_mfma_f32_16x16x32_bf16 v[56:59], a[152:155], a[100:103], v[56:59]
    ds_read_b64_tr_b16 a[136:137], v109 offset:57344
    v_mfma_f32_16x16x32_bf16 v[56:59], a[156:159], a[108:111], v[56:59]
    ds_read_b64_tr_b16 a[138:139], v109 offset:59392
    v_mfma_f32_16x16x32_bf16 v[52:55], a[156:159], a[104:107], v[52:55]
    ds_read_b64_tr_b16 a[140:141], v109 offset:61440
    v_mfma_f32_16x16x32_bf16 v[52:55], a[152:155], a[96:99], v[52:55]
    ds_read_b64_tr_b16 a[142:143], v109 offset:63488
    s_waitcnt vmcnt(0) lgkmcnt(4)
    v_mfma_f32_16x16x32_bf16 v[28:31], a[128:131], a[112:115], v[28:31]
    ds_read_b64_tr_b16 a[144:145], v110 offset:57344
    v_mfma_f32_16x16x32_bf16 v[28:31], a[132:135], a[120:123], v[28:31]
    ds_read_b64_tr_b16 a[146:147], v110 offset:59392
    v_mfma_f32_16x16x32_bf16 v[32:35], a[132:135], a[124:127], v[32:35]
    ds_read_b64_tr_b16 a[148:149], v110 offset:61440
    v_mfma_f32_16x16x32_bf16 v[32:35], a[128:131], a[116:119], v[32:35]
    ds_read_b64_tr_b16 a[150:151], v110 offset:63488
    s_waitcnt lgkmcnt(4)
    v_mfma_f32_16x16x32_bf16 v[40:43], a[136:139], a[116:119], v[40:43]
    ds_read_b64_tr_b16 a[152:153], v111 offset:57344
    v_mfma_f32_16x16x32_bf16 v[40:43], a[140:143], a[124:127], v[40:43]
    ds_read_b64_tr_b16 a[154:155], v111 offset:59392
    v_mfma_f32_16x16x32_bf16 v[36:39], a[140:143], a[120:123], v[36:39]
    ds_read_b64_tr_b16 a[156:157], v111 offset:61440
    v_mfma_f32_16x16x32_bf16 v[36:39], a[136:139], a[112:115], v[36:39]
    ds_read_b64_tr_b16 a[158:159], v111 offset:63488
    s_waitcnt lgkmcnt(4)
    v_mfma_f32_16x16x32_bf16 v[44:47], a[144:147], a[112:115], v[44:47]
    v_mfma_f32_16x16x32_bf16 v[44:47], a[148:151], a[120:123], v[44:47]
    v_mfma_f32_16x16x32_bf16 v[48:51], a[148:151], a[124:127], v[48:51]
    v_mfma_f32_16x16x32_bf16 v[48:51], a[144:147], a[116:119], v[48:51]
    s_waitcnt lgkmcnt(0)
    v_mfma_f32_16x16x32_bf16 v[56:59], a[152:155], a[116:119], v[56:59]
    v_mfma_f32_16x16x32_bf16 v[56:59], a[156:159], a[124:127], v[56:59]
    v_mfma_f32_16x16x32_bf16 v[52:55], a[156:159], a[120:123], v[52:55]
    v_mfma_f32_16x16x32_bf16 v[52:55], a[152:155], a[112:115], v[52:55]
    s_waitcnt vmcnt(14)
    v_pk_add_f32 v[92:93], v[92:93], v[100:101]
    v_pk_add_f32 v[94:95], v[94:95], v[102:103]
    v_pk_add_f32 v[96:97], v[96:97], v[104:105]
    v_pk_add_f32 v[98:99], v[98:99], v[106:107]
    v_pk_add_f32 v[92:93], v[92:93], v[96:97]
    v_pk_add_f32 v[94:95], v[94:95], v[98:99]
    v_pk_add_f32 v[92:93], v[92:93], v[94:95]
    v_mov_b32 v94, v92
    v_mov_b32 v95, v93
    s_nop 0
    v_permlane32_swap_b32 v92, v94
    v_permlane32_swap_b32 v93, v95
    v_add_f32 v92, v92, v94
    v_add_f32 v93, v93, v95
    v_mov_b32 v94, v92
    v_mov_b32 v95, v93
    s_nop 0
    v_permlane16_swap_b32 v92, v94
    v_permlane16_swap_b32 v93, v95
    v_add_f32 v92, v92, v94
    v_add_f32 v93, v93, v95
    v_sub_f32 v84, v116, v92
    v_mov_b32 v86, 0
    v_mov_b32 v87, 0
    v_sub_f32 v85, v117, v93
    v_mov_b32 v88, 0
    v_mov_b32 v89, 0
    v_cvt_pk_bf16_f32 v68, v28, v29
    v_pk_add_f32 v[28:29], v[28:29], v[84:85] op_sel:[0,0] op_sel_hi:[1,0]
    v_cvt_pk_bf16_f32 v92, v28, v29
    v_cvt_pk_bf16_f32 v69, v30, v31
    v_pk_add_f32 v[30:31], v[30:31], v[84:85] op_sel:[0,0] op_sel_hi:[1,0]
    v_cvt_pk_bf16_f32 v93, v30, v31
    v_cvt_pk_bf16_f32 v70, v36, v37
    v_pk_add_f32 v[36:37], v[36:37], v[84:85] op_sel:[0,0] op_sel_hi:[1,0]
    v_cvt_pk_bf16_f32 v94, v36, v37
    v_cvt_pk_bf16_f32 v71, v38, v39
    v_pk_add_f32 v[38:39], v[38:39], v[84:85] op_sel:[0,0] op_sel_hi:[1,0]
    v_cvt_pk_bf16_f32 v95, v38, v39
    buffer_store_dwordx4 v[92:95], v115, s[20:23], 0 offen offset:0 sc1
    v_cvt_pk_bf16_f32 v72, v44, v45
    v_pk_add_f32 v[44:45], v[44:45], v[84:85] op_sel:[0,0] op_sel_hi:[1,0]
    v_cvt_pk_bf16_f32 v96, v44, v45
    v_cvt_pk_bf16_f32 v73, v46, v47
    v_pk_add_f32 v[46:47], v[46:47], v[84:85] op_sel:[0,0] op_sel_hi:[1,0]
    v_cvt_pk_bf16_f32 v97, v46, v47
    v_cvt_pk_bf16_f32 v74, v52, v53
    v_pk_add_f32 v[52:53], v[52:53], v[84:85] op_sel:[0,0] op_sel_hi:[1,0]
    v_cvt_pk_bf16_f32 v98, v52, v53
    v_cvt_pk_bf16_f32 v75, v54, v55
    v_pk_add_f32 v[54:55], v[54:55], v[84:85] op_sel:[0,0] op_sel_hi:[1,0]
    v_cvt_pk_bf16_f32 v99, v54, v55
    buffer_store_dwordx4 v[96:99], v115, s[20:23], s60 offen offset:0 sc1
    v_cvt_pk_bf16_f32 v76, v32, v33
    v_pk_add_f32 v[32:33], v[32:33], v[84:85] op_sel:[0,1] op_sel_hi:[1,1]
    v_cvt_pk_bf16_f32 v100, v32, v33
    v_cvt_pk_bf16_f32 v77, v34, v35
    v_pk_add_f32 v[34:35], v[34:35], v[84:85] op_sel:[0,1] op_sel_hi:[1,1]
    v_cvt_pk_bf16_f32 v101, v34, v35
    v_cvt_pk_bf16_f32 v78, v40, v41
    v_pk_add_f32 v[40:41], v[40:41], v[84:85] op_sel:[0,1] op_sel_hi:[1,1]
    v_cvt_pk_bf16_f32 v102, v40, v41
    v_cvt_pk_bf16_f32 v79, v42, v43
    v_pk_add_f32 v[42:43], v[42:43], v[84:85] op_sel:[0,1] op_sel_hi:[1,1]
    v_cvt_pk_bf16_f32 v103, v42, v43
    buffer_store_dwordx4 v[100:103], v115, s[20:23], 0 offen offset:1024 sc1
    v_cvt_pk_bf16_f32 v80, v48, v49
    v_pk_add_f32 v[48:49], v[48:49], v[84:85] op_sel:[0,1] op_sel_hi:[1,1]
    v_cvt_pk_bf16_f32 v104, v48, v49
    v_cvt_pk_bf16_f32 v81, v50, v51
    v_pk_add_f32 v[50:51], v[50:51], v[84:85] op_sel:[0,1] op_sel_hi:[1,1]
    v_cvt_pk_bf16_f32 v105, v50, v51
    v_cvt_pk_bf16_f32 v82, v56, v57
    v_pk_add_f32 v[56:57], v[56:57], v[84:85] op_sel:[0,1] op_sel_hi:[1,1]
    v_cvt_pk_bf16_f32 v106, v56, v57
    v_cvt_pk_bf16_f32 v83, v58, v59
    v_pk_add_f32 v[58:59], v[58:59], v[84:85] op_sel:[0,1] op_sel_hi:[1,1]
    v_cvt_pk_bf16_f32 v107, v58, v59
    buffer_store_dwordx4 v[104:107], v115, s[20:23], s60 offen offset:1024 sc1
    v_pk_fma_f32 v[86:87], v[28:29], v[28:29], v[86:87]
    v_pk_fma_f32 v[88:89], v[32:33], v[32:33], v[88:89]
    v_pk_fma_f32 v[86:87], v[30:31], v[30:31], v[86:87]
    v_pk_fma_f32 v[88:89], v[34:35], v[34:35], v[88:89]
    v_pk_fma_f32 v[86:87], v[36:37], v[36:37], v[86:87]
    v_pk_fma_f32 v[88:89], v[40:41], v[40:41], v[88:89]
    v_pk_fma_f32 v[86:87], v[38:39], v[38:39], v[86:87]
    v_pk_fma_f32 v[88:89], v[42:43], v[42:43], v[88:89]
    v_pk_fma_f32 v[86:87], v[44:45], v[44:45], v[86:87]
    v_pk_fma_f32 v[88:89], v[48:49], v[48:49], v[88:89]
    v_pk_fma_f32 v[86:87], v[46:47], v[46:47], v[86:87]
    v_pk_fma_f32 v[88:89], v[50:51], v[50:51], v[88:89]
    v_pk_fma_f32 v[86:87], v[52:53], v[52:53], v[86:87]
    v_pk_fma_f32 v[88:89], v[56:57], v[56:57], v[88:89]
    v_pk_fma_f32 v[86:87], v[54:55], v[54:55], v[86:87]
    v_pk_fma_f32 v[88:89], v[58:59], v[58:59], v[88:89]
    v_add_f32 v86, v86, v87
    v_add_f32 v88, v88, v89
    v_mov_b32 v87, v86
    v_mov_b32 v89, v88
    s_nop 0
    v_permlane32_swap_b32 v86, v87
    v_permlane32_swap_b32 v88, v89
    v_add_f32 v86, v86, v87
    v_add_f32 v88, v88, v89
    v_mov_b32 v87, v86
    v_mov_b32 v89, v88
    s_nop 0
    v_permlane16_swap_b32 v86, v87
    v_permlane16_swap_b32 v88, v89
    v_add_f32 v86, v86, v87
    v_add_f32 v88, v88, v89
    v_mov_b32 v87, v88
    s_lshl_b32 s13, s47, 4
    s_add_u32 s13, s13, s48
    s_lshl2_add_u32 s13, s13, s3
    s_lshl_b32 s13, s13, 7
    v_lshlrev_b32 v1, 3, v0
    s_mov_b64 exec, 0xffff
    buffer_store_dwordx2 v[86:87], v1, s[28:31], s13 offen sc1
    s_mov_b64 exec, -1
    v_accvgpr_write_b32 a232, v68
    v_accvgpr_write_b32 a233, v69
    v_accvgpr_write_b32 a234, v70
    v_accvgpr_write_b32 a235, v71
    v_accvgpr_write_b32 a236, v72
    v_accvgpr_write_b32 a237, v73
    v_accvgpr_write_b32 a238, v74
    v_accvgpr_write_b32 a239, v75
    v_accvgpr_write_b32 a240, v76
    v_accvgpr_write_b32 a241, v77
    v_accvgpr_write_b32 a242, v78
    v_accvgpr_write_b32 a243, v79
    v_accvgpr_write_b32 a244, v80
    v_accvgpr_write_b32 a245, v81
    v_accvgpr_write_b32 a246, v82
    v_accvgpr_write_b32 a247, v83
    s_add_u32 s24, s98, 0xc00000
    s_addc_u32 s25, s99, 0
    s_mov_b32 s26, 0xe00000
    s_mov_b32 s27, 0x00020000
    v_bfe_u32 v1, v0, 1, 4
    v_lshlrev_b32 v1, 7, v1
    v_and_b32 v2, 1, v0
    v_lshl_add_u32 v1, v2, 19, v1
    s_lshl_b32 s13, s11, 12
    s_add_u32 s13, s13, 0x8000
    s_and_b32 s14, s3, 2
    s_lshl_b32 s14, s14, 10
    s_add_u32 s13, s13, s14
    s_and_b32 s14, s3, 1
    s_lshl_b32 s14, s14, 20
    s_add_u32 s13, s13, s14
    v_add_u32 v1, s13, v1
    s_lshl_b32 s74, s3, 19
    s_add_u32 s74, s74, s75
    v_mov_b32 v2, s100
    s_waitcnt vmcnt(0)
    s_mov_b64 exec, 1
    buffer_store_dword v2, v0, s[76:79], s74 offen sc1
    s_mov_b64 exec, -1
    s_barrier
    s_add_u32 m0, s40, 65536
    s_nop 0
    buffer_load_dwordx4 v6, s[16:19], s52 offen offset:0 lds
    buffer_load_dwordx4 v7, s[16:19], s52 offen offset:1024 lds
    s_lshr_b32 s13, s12, 2
    s_mul_i32 s13, s13, 6
    buffer_load_dwordx4 v8, s[16:19], s52 offen offset:2048 lds
    s_mul_i32 s14, s57, 3
    s_add_u32 s14, s14, 1
    s_lshr_b32 s14, s14, 1
    s_add_u32 s13, s13, s14
    s_add_u32 s13, s13, 64
    s_add_u32 m0, s40, 0
    s_lshl_b32 s42, s13, 17
    s_add_u32 s14, s42, 0x20000
    s_sub_u32 s15, s42, 0x1fe00
    s_bitcmp1_b32 s12, 0
    s_cselect_b32 s43, s15, s14
    s_lshl_b32 s44, s12, 18
    s_add_u32 s45, s44, 0x20000
    s_mov_b32 s49, 0x10000
    v_subrev_u32 v128, 16, v0
    v_and_b32 v124, 3, v128
    buffer_load_dwordx4 v9, s[16:19], s52 offen offset:0 lds
    v_cmp_eq_u32 vcc, s55, v124
    s_mul_i32 s13, s56, 2
    s_mul_i32 s14, s56, 3
    s_lshr_b32 s14, s14, 1
    v_cndmask_b32 v125, 0, 0, vcc
    buffer_load_dwordx4 v10, s[16:19], s52 offen offset:1024 lds
    v_add3_u32 v125, v125, v128, s13
    v_and_b32 v125, 7, v125
    v_xor_b32 v124, s55, v128
    v_and_b32 v124, 1, v124
    v_cmp_eq_u32 vcc, 0, v124
    buffer_load_dwordx4 v11, s[16:19], s52 offen offset:2048 lds
    s_and_b32 s15, s48, 1
    s_sub_u32 s14, s14, 8
    v_cndmask_b32 v126, 0, 2, vcc
    v_add3_u32 v126, v126, v128, s14
    v_subrev_u32 v124, 6, v126
    buffer_load_dwordx4 v12, s[16:19], s52 offen offset:3072 lds
    v_min_u32 v126, v126, v124
    v_lshl_add_u32 v125, v125, 1, s15
    v_lshl_add_u32 v126, v126, 1, s15
    v_lshl_add_u32 v127, v125, 2, s3
    v_lshrrev_b32 v124, 3, v127
    s_add_u32 m0, s40, 81920
    v_mul_u32_u24 v124, 6, v124
    v_add_u32 v127, v127, v124
    v_lshl_add_u32 v128, v126, 2, s3
    v_mul_u32_u24 v124, 43, v128
    v_lshrrev_b32 v124, 8, v124
    buffer_load_dwordx4 v6, s[16:19], s53 offen offset:0 lds
    v_lshl_add_u32 v128, v124, 3, v128
    v_add_u32 v128, 8, v128
    v_add_u32 v126, 16, v126
    v_cmp_gt_u32 vcc, 24, v0
    s_nop 1
    v_cndmask_b32 v125, v126, v125, vcc
    buffer_load_dwordx4 v7, s[16:19], s53 offen offset:1024 lds
    v_cndmask_b32 v127, v128, v127, vcc
    v_lshlrev_b32 v125, 19, v125
    v_lshlrev_b32 v127, 16, v127
    v_cmp_gt_u32 vcc, 16, v0
    s_nop 1
    v_cndmask_b32 v18, v125, v18, vcc
    buffer_load_dwordx4 v8, s[16:19], s53 offen offset:2048 lds
    v_cndmask_b32 v19, v127, v19, vcc
    s_mul_i32 s14, s56, 896
    s_lshr_b32 s15, s2, 3
    s_mul_i32 s15, s15, 28
    s_add_u32 s14, s14, s15
    s_add_u32 m0, s40, 16384
    s_mul_i32 s15, s3, 7
    s_add_u32 s14, s14, s15
    s_lshl_b32 s14, s14, 11
    s_lshl_b32 s15, s54, 10
    s_add_u32 s14, s14, s15
    buffer_load_dwordx4 v9, s[16:19], s53 offen offset:0 lds
    v_lshrrev_b32 v254, 3, v0
    v_min_u32 v254, 6, v254
    v_lshlrev_b32 v255, 11, v254
    v_and_b32 v254, 7, v0
    v_lshl_add_u32 v255, v254, 7, v255
    buffer_load_dwordx4 v10, s[16:19], s53 offen offset:1024 lds
    v_add_u32 v253, s14, v255
    s_lshr_b32 s57, s2, 3
    s_mul_i32 s57, s57, 7
    s_lshr_b32 s57, s57, 5
    s_add_u32 s57, s57, 1
    buffer_load_dwordx4 v11, s[16:19], s53 offen offset:2048 lds
    buffer_load_dwordx4 v12, s[16:19], s53 offen offset:3072 lds
    s_lshl_b32 s14, s54, 4
    s_lshl_b64 exec, 63, s14
    s_mov_b32 s13, 0x40000
L_p3_poll:
    buffer_load_dword v2, v1, s[76:79], 0 offen sc1
    s_waitcnt vmcnt(0)
    v_cmp_ne_u32 vcc, s100, v2
    s_nop 0
    s_cmp_eq_u64 vcc, 0
    s_cbranch_scc1 L_p3_go
    s_mov_b64 exec, vcc
    s_sub_u32 s13, s13, 1
    s_cmp_lg_u32 s13, 0
    s_cbranch_scc1 L_p3_poll
L_p3_go:
    s_mov_b64 exec, -1
    s_lshl_b32 s75, s11, 5
    s_add_u32 s75, s75, s12
    s_lshl_b32 s75, s75, 7
    s_add_u32 s75, s75, 0x10000
    s_lshl_b32 s13, s3, 19
    s_add_u32 s75, s75, s13
    buffer_load_dwordx4 a[0:3], v4, s[20:23], s50 offen offset:0 sc1
    buffer_load_dwordx4 a[4:7], v4, s[20:23], s50 offen offset:1024 sc1
    buffer_load_dwordx4 a[8:11], v4, s[20:23], s50 offen offset:2048 sc1
    buffer_load_dwordx4 a[12:15], v4, s[20:23], s50 offen offset:3072 sc1
    buffer_load_dwordx4 a[16:19], v5, s[20:23], s50 offen offset:0 sc1
    buffer_load_dwordx4 a[20:23], v5, s[20:23], s50 offen offset:1024 sc1
    buffer_load_dwordx4 a[24:27], v5, s[20:23], s50 offen offset:2048 sc1
    buffer_load_dwordx4 a[28:31], v5, s[20:23], s50 offen offset:3072 sc1
    buffer_load_dwordx4 a[32:35], v4, s[20:23], s51 offen offset:0 sc1
    buffer_load_dwordx4 a[36:39], v4, s[20:23], s51 offen offset:1024 sc1
    buffer_load_dwordx4 a[40:43], v4, s[20:23], s51 offen offset:2048 sc1
    buffer_load_dwordx4 a[44:47], v4, s[20:23], s51 offen offset:3072 sc1
    buffer_load_dwordx4 a[48:51], v5, s[20:23], s51 offen offset:0 sc1
    buffer_load_dwordx4 a[52:55], v5, s[20:23], s51 offen offset:1024 sc1
    buffer_load_dwordx4 a[56:59], v5, s[20:23], s51 offen offset:2048 sc1
    buffer_load_dwordx4 a[60:63], v5, s[20:23], s51 offen offset:3072 sc1
    v_readlane_b32 s50, v18, s46
    v_readlane_b32 s52, v19, s46
    s_add_u32 s46, s46, 1
    s_add_u32 m0, s40, 98304
    s_nop 2
    buffer_load_dwordx4 v6, s[16:19], s52 offen offset:0 lds
    v_readlane_b32 s51, v18, s46
    buffer_load_dwordx4 a[64:67], v4, s[20:23], s50 offen offset:0 sc1
    v_readlane_b32 s53, v19, s46
    s_waitcnt vmcnt(10)
    s_barrier
    ds_read_b64_tr_b16 a[128:129], v13 offset:0
    ds_read_b64_tr_b16 a[130:131], v13 offset:1536
    ds_read_b64_tr_b16 a[132:133], v13 offset:4096
    ds_read_b64_tr_b16 a[134:135], v13 offset:5632
    ds_read_b64_tr_b16 a[144:145], v13 offset:8192
    ds_read_b64_tr_b16 a[146:147], v13 offset:9728
    ds_read_b64_tr_b16 a[148:149], v13 offset:12288
    ds_read_b64_tr_b16 a[150:151], v13 offset:13824
    s_waitcnt lgkmcnt(4)
    v_mfma_f32_16x16x32_bf16 v[28:31], a[128:131], a[0:3], 0
    ds_read_b64_tr_b16 a[160:161], v13 offset:32
    buffer_load_dword v254, v1, s[76:79], 0 offen offset:0 sc1
    v_mfma_f32_16x16x32_bf16 v[28:31], a[132:135], a[16:19], v[28:31]
    ds_read_b64_tr_b16 a[162:163], v13 offset:1568
    v_mfma_f32_16x16x32_bf16 v[32:35], a[132:135], a[20:23], 0
    ds_read_b64_tr_b16 a[164:165], v13 offset:4128
    v_mfma_f32_16x16x32_bf16 v[32:35], a[128:131], a[4:7], v[32:35]
    ds_read_b64_tr_b16 a[166:167], v13 offset:5664
    buffer_load_dwordx4 v7, s[16:19], s52 offen offset:1024 lds
    v_mfma_f32_16x16x32_bf16 v[36:39], a[128:131], a[8:11], 0
    s_add_u32 s46, s46, 1
    v_mfma_f32_16x16x32_bf16 v[36:39], a[132:135], a[24:27], v[36:39]
    v_mfma_f32_16x16x32_bf16 v[40:43], a[132:135], a[28:31], 0
    v_mfma_f32_16x16x32_bf16 v[40:43], a[128:131], a[12:15], v[40:43]
    s_waitcnt lgkmcnt(4)
    v_mfma_f32_16x16x32_bf16 v[56:59], a[144:147], a[12:15], 0
    ds_read_b64_tr_b16 a[176:177], v13 offset:8224
    v_mfma_f32_16x16x32_bf16 v[56:59], a[148:151], a[28:31], v[56:59]
    ds_read_b64_tr_b16 a[178:179], v13 offset:9760
    v_mfma_f32_16x16x32_bf16 v[52:55], a[148:151], a[24:27], 0
    ds_read_b64_tr_b16 a[180:181], v13 offset:12320
    v_mfma_f32_16x16x32_bf16 v[52:55], a[144:147], a[8:11], v[52:55]
    ds_read_b64_tr_b16 a[182:183], v13 offset:13856
    buffer_load_dwordx4 a[68:71], v4, s[20:23], s50 offen offset:1024 sc1
    v_mfma_f32_16x16x32_bf16 v[48:51], a[144:147], a[4:7], 0
    v_mfma_f32_16x16x32_bf16 v[48:51], a[148:151], a[20:23], v[48:51]
    v_mfma_f32_16x16x32_bf16 v[44:47], a[148:151], a[16:19], 0
    buffer_load_dwordx4 v8, s[16:19], s52 offen offset:2048 lds
    v_mfma_f32_16x16x32_bf16 v[44:47], a[144:147], a[0:3], v[44:47]
    s_waitcnt lgkmcnt(4)
    v_mfma_f32_16x16x32_bf16 v[60:63], a[160:163], a[0:3], 0
    ds_read_b64_tr_b16 a[128:129], v13 offset:64
    v_mfma_f32_16x16x32_bf16 v[60:63], a[164:167], a[16:19], v[60:63]
    ds_read_b64_tr_b16 a[130:131], v13 offset:1600
    v_mfma_f32_16x16x32_bf16 v[64:67], a[164:167], a[20:23], 0
    ds_read_b64_tr_b16 a[132:133], v13 offset:4160
    v_mfma_f32_16x16x32_bf16 v[64:67], a[160:163], a[4:7], v[64:67]
    ds_read_b64_tr_b16 a[134:135], v13 offset:5696
    v_mfma_f32_16x16x32_bf16 v[68:71], a[160:163], a[8:11], 0
    v_mfma_f32_16x16x32_bf16 v[68:71], a[164:167], a[24:27], v[68:71]
    buffer_load_dwordx4 a[72:75], v4, s[20:23], s50 offen offset:2048 sc1
    v_mfma_f32_16x16x32_bf16 v[72:75], a[164:167], a[28:31], 0
    v_mfma_f32_16x16x32_bf16 v[72:75], a[160:163], a[12:15], v[72:75]
    s_waitcnt lgkmcnt(4)
    v_mfma_f32_16x16x32_bf16 v[88:91], a[176:179], a[12:15], 0
    ds_read_b64_tr_b16 a[144:145], v13 offset:8256
    v_mfma_f32_16x16x32_bf16 v[88:91], a[180:183], a[28:31], v[88:91]
    ds_read_b64_tr_b16 a[146:147], v13 offset:9792
    v_mfma_f32_16x16x32_bf16 v[84:87], a[180:183], a[24:27], 0
    ds_read_b64_tr_b16 a[148:149], v13 offset:12352
    v_mfma_f32_16x16x32_bf16 v[84:87], a[176:179], a[8:11], v[84:87]
    ds_read_b64_tr_b16 a[150:151], v13 offset:13888
    v_mfma_f32_16x16x32_bf16 v[80:83], a[176:179], a[4:7], 0
    s_add_u32 m0, s40, 32768
    v_mfma_f32_16x16x32_bf16 v[80:83], a[180:183], a[20:23], v[80:83]
    buffer_load_dwordx4 v9, s[16:19], s52 offen offset:0 lds
    v_mfma_f32_16x16x32_bf16 v[76:79], a[180:183], a[16:19], 0
    v_mfma_f32_16x16x32_bf16 v[76:79], a[176:179], a[0:3], v[76:79]
    s_waitcnt lgkmcnt(4)
    v_mfma_f32_16x16x32_bf16 v[92:95], a[128:131], a[0:3], 0
    ds_read_b64_tr_b16 a[160:161], v14 offset:0
    v_mfma_f32_16x16x32_bf16 v[92:95], a[132:135], a[16:19], v[92:95]
    ds_read_b64_tr_b16 a[162:163], v14 offset:2048
    v_mfma_f32_16x16x32_bf16 v[96:99], a[132:135], a[20:23], 0
    ds_read_b64_tr_b16 a[164:165], v14 offset:4096
    v_mfma_f32_16x16x32_bf16 v[96:99], a[128:131], a[4:7], v[96:99]
    ds_read_b64_tr_b16 a[166:167], v14 offset:6144
    v_mfma_f32_16x16x32_bf16 v[100:103], a[128:131], a[8:11], 0
    buffer_load_dwordx4 a[76:79], v4, s[20:23], s50 offen offset:3072 sc1
    v_mfma_f32_16x16x32_bf16 v[100:103], a[132:135], a[24:27], v[100:103]
    v_mfma_f32_16x16x32_bf16 v[104:107], a[132:135], a[28:31], 0
    v_mfma_f32_16x16x32_bf16 v[104:107], a[128:131], a[12:15], v[104:107]
    s_waitcnt lgkmcnt(4)
    v_mfma_f32_16x16x32_bf16 v[120:123], a[144:147], a[12:15], 0
    ds_read_b64_tr_b16 a[176:177], v14 offset:8192
    v_mfma_f32_16x16x32_bf16 v[120:123], a[148:151], a[28:31], v[120:123]
    ds_read_b64_tr_b16 a[178:179], v14 offset:10240
    v_mfma_f32_16x16x32_bf16 v[116:119], a[148:151], a[24:27], 0
    ds_read_b64_tr_b16 a[180:181], v14 offset:12288
    v_mfma_f32_16x16x32_bf16 v[116:119], a[144:147], a[8:11], v[116:119]
    ds_read_b64_tr_b16 a[182:183], v14 offset:14336
    v_mfma_f32_16x16x32_bf16 v[112:115], a[144:147], a[4:7], 0
    buffer_load_dwordx4 v10, s[16:19], s52 offen offset:1024 lds
    v_mfma_f32_16x16x32_bf16 v[112:115], a[148:151], a[20:23], v[112:115]
    v_mfma_f32_16x16x32_bf16 v[108:111], a[148:151], a[16:19], 0
    v_mfma_f32_16x16x32_bf16 v[108:111], a[144:147], a[0:3], v[108:111]
    s_waitcnt lgkmcnt(4)
    v_mfma_f32_16x16x32_bf16 v[124:127], a[160:163], a[0:3], 0
    ds_read_b64_tr_b16 a[128:129], v15 offset:0
    v_mfma_f32_16x16x32_bf16 v[124:127], a[164:167], a[16:19], v[124:127]
    ds_read_b64_tr_b16 a[130:131], v15 offset:2048
    v_mfma_f32_16x16x32_bf16 v[128:131], a[164:167], a[20:23], 0
    ds_read_b64_tr_b16 a[132:133], v15 offset:4096
    v_mfma_f32_16x16x32_bf16 v[128:131], a[160:163], a[4:7], v[128:131]
    ds_read_b64_tr_b16 a[134:135], v15 offset:6144
    v_mfma_f32_16x16x32_bf16 v[132:135], a[160:163], a[8:11], 0
    buffer_load_dwordx4 a[80:83], v5, s[20:23], s50 offen offset:0 sc1
    v_mfma_f32_16x16x32_bf16 v[132:135], a[164:167], a[24:27], v[132:135]
    v_mfma_f32_16x16x32_bf16 v[136:139], a[164:167], a[28:31], 0
    v_mfma_f32_16x16x32_bf16 v[136:139], a[160:163], a[12:15], v[136:139]
    s_waitcnt lgkmcnt(4)
    v_mfma_f32_16x16x32_bf16 v[152:155], a[176:179], a[12:15], 0
    ds_read_b64_tr_b16 a[144:145], v15 offset:8192
    v_mfma_f32_16x16x32_bf16 v[152:155], a[180:183], a[28:31], v[152:155]
    ds_read_b64_tr_b16 a[146:147], v15 offset:10240
    v_mfma_f32_16x16x32_bf16 v[148:151], a[180:183], a[24:27], 0
    ds_read_b64_tr_b16 a[148:149], v15 offset:12288
    v_mfma_f32_16x16x32_bf16 v[148:151], a[176:179], a[8:11], v[148:151]
    ds_read_b64_tr_b16 a[150:151], v15 offset:14336
    v_mfma_f32_16x16x32_bf16 v[144:147], a[176:179], a[4:7], 0
    buffer_load_dwordx4 v11, s[16:19], s52 offen offset:2048 lds
    v_mfma_f32_16x16x32_bf16 v[144:147], a[180:183], a[20:23], v[144:147]
    v_mfma_f32_16x16x32_bf16 v[140:143], a[180:183], a[16:19], 0
    v_mfma_f32_16x16x32_bf16 v[140:143], a[176:179], a[0:3], v[140:143]
    s_waitcnt lgkmcnt(4)
    v_mfma_f32_16x16x32_bf16 v[156:159], a[128:131], a[0:3], 0
    ds_read_b64_tr_b16 a[160:161], v16 offset:0
    v_mfma_f32_16x16x32_bf16 v[156:159], a[132:135], a[16:19], v[156:159]
    ds_read_b64_tr_b16 a[162:163], v16 offset:2048
    v_mfma_f32_16x16x32_bf16 v[160:163], a[132:135], a[20:23], 0
    ds_read_b64_tr_b16 a[164:165], v16 offset:4096
    v_mfma_f32_16x16x32_bf16 v[160:163], a[128:131], a[4:7], v[160:163]
    ds_read_b64_tr_b16 a[166:167], v16 offset:6144
    v_mfma_f32_16x16x32_bf16 v[164:167], a[128:131], a[8:11], 0
    buffer_load_dwordx4 a[84:87], v5, s[20:23], s50 offen offset:1024 sc1
    v_mfma_f32_16x16x32_bf16 v[164:167], a[132:135], a[24:27], v[164:167]
    v_mfma_f32_16x16x32_bf16 v[168:171], a[132:135], a[28:31], 0
    v_mfma_f32_16x16x32_bf16 v[168:171], a[128:131], a[12:15], v[168:171]
    s_waitcnt lgkmcnt(4)
    v_mfma_f32_16x16x32_bf16 v[184:187], a[144:147], a[12:15], 0
    ds_read_b64_tr_b16 a[176:177], v16 offset:8192
    v_mfma_f32_16x16x32_bf16 v[184:187], a[148:151], a[28:31], v[184:187]
    ds_read_b64_tr_b16 a[178:179], v16 offset:10240
    v_mfma_f32_16x16x32_bf16 v[180:183], a[148:151], a[24:27], 0
    ds_read_b64_tr_b16 a[180:181], v16 offset:12288
    v_mfma_f32_16x16x32_bf16 v[180:183], a[144:147], a[8:11], v[180:183]
    ds_read_b64_tr_b16 a[182:183], v16 offset:14336
    v_mfma_f32_16x16x32_bf16 v[176:179], a[144:147], a[4:7], 0
    buffer_load_dwordx4 v12, s[16:19], s52 offen offset:3072 lds
    v_mfma_f32_16x16x32_bf16 v[176:179], a[148:151], a[20:23], v[176:179]
    v_mfma_f32_16x16x32_bf16 v[172:175], a[148:151], a[16:19], 0
    v_mfma_f32_16x16x32_bf16 v[172:175], a[144:147], a[0:3], v[172:175]
    s_waitcnt lgkmcnt(4)
    v_mfma_f32_16x16x32_bf16 v[188:191], a[160:163], a[0:3], 0
    ds_read_b64_tr_b16 a[128:129], v17 offset:0
    v_mfma_f32_16x16x32_bf16 v[188:191], a[164:167], a[16:19], v[188:191]
    ds_read_b64_tr_b16 a[130:131], v17 offset:2048
    v_mfma_f32_16x16x32_bf16 v[192:195], a[164:167], a[20:23], 0
    ds_read_b64_tr_b16 a[132:133], v17 offset:4096
    v_mfma_f32_16x16x32_bf16 v[192:195], a[160:163], a[4:7], v[192:195]
    ds_read_b64_tr_b16 a[134:135], v17 offset:6144
    v_mfma_f32_16x16x32_bf16 v[196:199], a[160:163], a[8:11], 0
    buffer_load_dwordx4 a[88:91], v5, s[20:23], s50 offen offset:2048 sc1
    v_mfma_f32_16x16x32_bf16 v[196:199], a[164:167], a[24:27], v[196:199]
    v_mfma_f32_16x16x32_bf16 v[200:203], a[164:167], a[28:31], 0
    v_mfma_f32_16x16x32_bf16 v[200:203], a[160:163], a[12:15], v[200:203]
    s_waitcnt lgkmcnt(4)
    v_mfma_f32_16x16x32_bf16 v[216:219], a[176:179], a[12:15], 0
    ds_read_b64_tr_b16 a[144:145], v17 offset:8192
    v_mfma_f32_16x16x32_bf16 v[216:219], a[180:183], a[28:31], v[216:219]
    ds_read_b64_tr_b16 a[146:147], v17 offset:10240
    v_mfma_f32_16x16x32_bf16 v[212:215], a[180:183], a[24:27], 0
    ds_read_b64_tr_b16 a[148:149], v17 offset:12288
    v_mfma_f32_16x16x32_bf16 v[212:215], a[176:179], a[8:11], v[212:215]
    ds_read_b64_tr_b16 a[150:151], v17 offset:14336
    buffer_load_dwordx4 a[92:95], v5, s[20:23], s50 offen offset:3072 sc1
    v_mfma_f32_16x16x32_bf16 v[208:211], a[176:179], a[4:7], 0
    v_mfma_f32_16x16x32_bf16 v[208:211], a[180:183], a[20:23], v[208:211]
    v_mfma_f32_16x16x32_bf16 v[204:207], a[180:183], a[16:19], 0
    v_mfma_f32_16x16x32_bf16 v[204:207], a[176:179], a[0:3], v[204:207]
    s_waitcnt lgkmcnt(4)
    v_mfma_f32_16x16x32_bf16 v[220:223], a[128:131], a[0:3], 0
    s_waitcnt vmcnt(13)
    s_mov_b32 s13, 0x40000
L_p3all_chk:
    v_cmp_ne_u32 vcc, s100, v254
    s_nop 0
    s_cmp_eq_u64 vcc, 0
    s_cbranch_scc1 L_p3all_ok
    s_mov_b64 exec, vcc
    buffer_load_dword v254, v1, s[76:79], 0 offen offset:0 sc1
    s_waitcnt vmcnt(0)
    s_sub_u32 s13, s13, 1
    s_cmp_lg_u32 s13, 0
    s_cbranch_scc1 L_p3all_chk
L_p3all_ok:
    s_mov_b64 exec, -1
    s_barrier
    ds_read_b64_tr_b16 a[160:161], v13 offset:16384
    v_mfma_f32_16x16x32_bf16 v[220:223], a[132:135], a[16:19], v[220:223]
    ds_read_b64_tr_b16 a[162:163], v13 offset:17920
    s_add_u32 m0, s40, 114688
    v_mfma_f32_16x16x32_bf16 v[224:227], a[132:135], a[20:23], 0
    ds_read_b64_tr_b16 a[164:165], v13 offset:20480
    v_mfma_f32_16x16x32_bf16 v[224:227], a[128:131], a[4:7], v[224:227]
    ds_read_b64_tr_b16 a[166:167], v13 offset:22016
    v_mfma_f32_16x16x32_bf16 v[228:231], a[128:131], a[8:11], 0
    buffer_load_dwordx4 v6, s[16:19], s53 offen offset:0 lds
    v_mfma_f32_16x16x32_bf16 v[228:231], a[132:135], a[24:27], v[228:231]
    v_readlane_b32 s50, v18, s46
    v_mfma_f32_16x16x32_bf16 v[232:235], a[132:135], a[28:31], 0
    v_mfma_f32_16x16x32_bf16 v[232:235], a[128:131], a[12:15], v[232:235]
    s_waitcnt lgkmcnt(4)
    v_mfma_f32_16x16x32_bf16 v[248:251], a[144:147], a[12:15], 0
    ds_read_b64_tr_b16 a[176:177], v13 offset:24576
    v_mfma_f32_16x16x32_bf16 v[248:251], a[148:151], a[28:31], v[248:251]
    ds_read_b64_tr_b16 a[178:179], v13 offset:26112
    v_mfma_f32_16x16x32_bf16 v[244:247], a[148:151], a[24:27], 0
    ds_read_b64_tr_b16 a[180:181], v13 offset:28672
    v_mfma_f32_16x16x32_bf16 v[244:247], a[144:147], a[8:11], v[244:247]
    ds_read_b64_tr_b16 a[182:183], v13 offset:30208
    v_mfma_f32_16x16x32_bf16 v[240:243], a[144:147], a[4:7], 0
    buffer_load_dwordx4 a[96:99], v4, s[20:23], s51 offen offset:0 sc1
    v_mfma_f32_16x16x32_bf16 v[240:243], a[148:151], a[20:23], v[240:243]
    v_readlane_b32 s52, v19, s46
    v_mfma_f32_16x16x32_bf16 v[236:239], a[148:151], a[16:19], 0
    v_mfma_f32_16x16x32_bf16 v[236:239], a[144:147], a[0:3], v[236:239]
    s_waitcnt lgkmcnt(4)
    v_mfma_f32_16x16x32_bf16 v[28:31], a[160:163], a[32:35], v[28:31]
    ds_read_b64_tr_b16 a[128:129], v13 offset:16416
    v_lshrrev_b32 v2, 4, v0
    v_mfma_f32_16x16x32_bf16 v[28:31], a[164:167], a[48:51], v[28:31]
    ds_read_b64_tr_b16 a[130:131], v13 offset:17952
    v_lshlrev_b32 v2, 11, v2
    v_mfma_f32_16x16x32_bf16 v[32:35], a[164:167], a[52:55], v[32:35]
    ds_read_b64_tr_b16 a[132:133], v13 offset:20512
    v_and_b32 v3, 15, v0
    v_mfma_f32_16x16x32_bf16 v[32:35], a[160:163], a[36:39], v[32:35]
    ds_read_b64_tr_b16 a[134:135], v13 offset:22048
    buffer_load_dwordx4 v7, s[16:19], s53 offen offset:1024 lds
    v_mfma_f32_16x16x32_bf16 v[36:39], a[160:163], a[40:43], v[36:39]
    s_add_u32 s46, s46, 1
    v_mfma_f32_16x16x32_bf16 v[36:39], a[164:167], a[56:59], v[36:39]
    v_lshl_add_u32 v2, v3, 3, v2
    s_lshr_b32 s14, s3, 1
    v_mfma_f32_16x16x32_bf16 v[40:43], a[164:167], a[60:63], v[40:43]
    s_lshl1_add_u32 s14, s11, s14
    s_lshl_b32 s14, s14, 13
    v_mfma_f32_16x16x32_bf16 v[40:43], a[160:163], a[44:47], v[40:43]
    s_and_b32 s15, s3, 1
    s_waitcnt lgkmcnt(4)
    v_mfma_f32_16x16x32_bf16 v[56:59], a[176:179], a[44:47], v[56:59]
    ds_read_b64_tr_b16 a[144:145], v13 offset:24608
    s_lshl_b32 s15, s15, 8
    v_mfma_f32_16x16x32_bf16 v[56:59], a[180:183], a[60:63], v[56:59]
    ds_read_b64_tr_b16 a[146:147], v13 offset:26144
    s_add_u32 s14, s14, s15
    v_mfma_f32_16x16x32_bf16 v[52:55], a[180:183], a[56:59], v[52:55]
    ds_read_b64_tr_b16 a[148:149], v13 offset:28704
    buffer_load_dwordx2 a[192:193], v2, s[28:31], s14 offen offset:0 sc1
    v_mfma_f32_16x16x32_bf16 v[52:55], a[176:179], a[40:43], v[52:55]
    ds_read_b64_tr_b16 a[150:151], v13 offset:30240
    buffer_load_dwordx4 a[100:103], v4, s[20:23], s51 offen offset:1024 sc1
    v_mfma_f32_16x16x32_bf16 v[48:51], a[176:179], a[36:39], v[48:51]
    buffer_load_dwordx2 a[194:195], v2, s[28:31], s14 offen offset:512 sc1
    v_mfma_f32_16x16x32_bf16 v[48:51], a[180:183], a[52:55], v[48:51]
    buffer_load_dwordx2 a[196:197], v2, s[28:31], s14 offen offset:1024 sc1
    buffer_load_dwordx2 a[198:199], v2, s[28:31], s14 offen offset:1536 sc1
    v_mfma_f32_16x16x32_bf16 v[44:47], a[180:183], a[48:51], v[44:47]
    buffer_load_dwordx4 v8, s[16:19], s53 offen offset:2048 lds
    v_mfma_f32_16x16x32_bf16 v[44:47], a[176:179], a[32:35], v[44:47]
    buffer_load_dwordx2 a[200:201], v2, s[28:31], s14 offen offset:128 sc1
    s_waitcnt lgkmcnt(4)
    v_mfma_f32_16x16x32_bf16 v[60:63], a[128:131], a[32:35], v[60:63]
    ds_read_b64_tr_b16 a[160:161], v13 offset:16448
    buffer_load_dwordx2 a[202:203], v2, s[28:31], s14 offen offset:640 sc1
    v_mfma_f32_16x16x32_bf16 v[60:63], a[132:135], a[48:51], v[60:63]
    ds_read_b64_tr_b16 a[162:163], v13 offset:17984
    buffer_load_dwordx2 a[204:205], v2, s[28:31], s14 offen offset:1152 sc1
    v_mfma_f32_16x16x32_bf16 v[64:67], a[132:135], a[52:55], v[64:67]
    ds_read_b64_tr_b16 a[164:165], v13 offset:20544
    buffer_load_dwordx2 a[206:207], v2, s[28:31], s14 offen offset:1664 sc1
    v_mfma_f32_16x16x32_bf16 v[64:67], a[128:131], a[36:39], v[64:67]
    ds_read_b64_tr_b16 a[166:167], v13 offset:22080
    v_mfma_f32_16x16x32_bf16 v[68:71], a[128:131], a[40:43], v[68:71]
    v_mfma_f32_16x16x32_bf16 v[68:71], a[132:135], a[56:59], v[68:71]
    buffer_load_dwordx4 a[104:107], v4, s[20:23], s51 offen offset:2048 sc1
    v_mfma_f32_16x16x32_bf16 v[72:75], a[132:135], a[60:63], v[72:75]
    v_mfma_f32_16x16x32_bf16 v[72:75], a[128:131], a[44:47], v[72:75]
    s_waitcnt lgkmcnt(4)
    v_mfma_f32_16x16x32_bf16 v[88:91], a[144:147], a[44:47], v[88:91]
    ds_read_b64_tr_b16 a[176:177], v13 offset:24640
    v_mfma_f32_16x16x32_bf16 v[88:91], a[148:151], a[60:63], v[88:91]
    ds_read_b64_tr_b16 a[178:179], v13 offset:26176
    v_mfma_f32_16x16x32_bf16 v[84:87], a[148:151], a[56:59], v[84:87]
    ds_read_b64_tr_b16 a[180:181], v13 offset:28736
    v_mfma_f32_16x16x32_bf16 v[84:87], a[144:147], a[40:43], v[84:87]
    ds_read_b64_tr_b16 a[182:183], v13 offset:30272
    v_mfma_f32_16x16x32_bf16 v[80:83], a[144:147], a[36:39], v[80:83]
    s_add_u32 m0, s40, 49152
    v_mfma_f32_16x16x32_bf16 v[80:83], a[148:151], a[52:55], v[80:83]
    buffer_load_dwordx4 v9, s[16:19], s53 offen offset:0 lds
    v_mfma_f32_16x16x32_bf16 v[76:79], a[148:151], a[48:51], v[76:79]
    v_mfma_f32_16x16x32_bf16 v[76:79], a[144:147], a[32:35], v[76:79]
    s_waitcnt lgkmcnt(4)
    v_mfma_f32_16x16x32_bf16 v[92:95], a[160:163], a[32:35], v[92:95]
    ds_read_b64_tr_b16 a[128:129], v14 offset:16384
    v_mfma_f32_16x16x32_bf16 v[92:95], a[164:167], a[48:51], v[92:95]
    ds_read_b64_tr_b16 a[130:131], v14 offset:18432
    v_mfma_f32_16x16x32_bf16 v[96:99], a[164:167], a[52:55], v[96:99]
    ds_read_b64_tr_b16 a[132:133], v14 offset:20480
    v_mfma_f32_16x16x32_bf16 v[96:99], a[160:163], a[36:39], v[96:99]
    ds_read_b64_tr_b16 a[134:135], v14 offset:22528
    v_mfma_f32_16x16x32_bf16 v[100:103], a[160:163], a[40:43], v[100:103]
    buffer_load_dwordx4 a[108:111], v4, s[20:23], s51 offen offset:3072 sc1
    v_mfma_f32_16x16x32_bf16 v[100:103], a[164:167], a[56:59], v[100:103]
    v_mfma_f32_16x16x32_bf16 v[104:107], a[164:167], a[60:63], v[104:107]
    v_mfma_f32_16x16x32_bf16 v[104:107], a[160:163], a[44:47], v[104:107]
    s_waitcnt lgkmcnt(4)
    v_mfma_f32_16x16x32_bf16 v[120:123], a[176:179], a[44:47], v[120:123]
    ds_read_b64_tr_b16 a[144:145], v14 offset:24576
    v_mfma_f32_16x16x32_bf16 v[120:123], a[180:183], a[60:63], v[120:123]
    ds_read_b64_tr_b16 a[146:147], v14 offset:26624
    v_mfma_f32_16x16x32_bf16 v[116:119], a[180:183], a[56:59], v[116:119]
    ds_read_b64_tr_b16 a[148:149], v14 offset:28672
    v_mfma_f32_16x16x32_bf16 v[116:119], a[176:179], a[40:43], v[116:119]
    ds_read_b64_tr_b16 a[150:151], v14 offset:30720
    v_mfma_f32_16x16x32_bf16 v[112:115], a[176:179], a[36:39], v[112:115]
    buffer_load_dwordx4 v10, s[16:19], s53 offen offset:1024 lds
    v_mfma_f32_16x16x32_bf16 v[112:115], a[180:183], a[52:55], v[112:115]
    v_mfma_f32_16x16x32_bf16 v[108:111], a[180:183], a[48:51], v[108:111]
    v_mfma_f32_16x16x32_bf16 v[108:111], a[176:179], a[32:35], v[108:111]
    s_waitcnt lgkmcnt(4)
    v_mfma_f32_16x16x32_bf16 v[124:127], a[128:131], a[32:35], v[124:127]
    ds_read_b64_tr_b16 a[160:161], v15 offset:16384
    v_mfma_f32_16x16x32_bf16 v[124:127], a[132:135], a[48:51], v[124:127]
    ds_read_b64_tr_b16 a[162:163], v15 offset:18432
    v_mfma_f32_16x16x32_bf16 v[128:131], a[132:135], a[52:55], v[128:131]
    ds_read_b64_tr_b16 a[164:165], v15 offset:20480
    v_mfma_f32_16x16x32_bf16 v[128:131], a[128:131], a[36:39], v[128:131]
    ds_read_b64_tr_b16 a[166:167], v15 offset:22528
    v_mfma_f32_16x16x32_bf16 v[132:135], a[128:131], a[40:43], v[132:135]
    buffer_load_dwordx4 a[112:115], v5, s[20:23], s51 offen offset:0 sc1
    v_mfma_f32_16x16x32_bf16 v[132:135], a[132:135], a[56:59], v[132:135]
    v_mfma_f32_16x16x32_bf16 v[136:139], a[132:135], a[60:63], v[136:139]
    v_mfma_f32_16x16x32_bf16 v[136:139], a[128:131], a[44:47], v[136:139]
    s_waitcnt lgkmcnt(4)
    v_mfma_f32_16x16x32_bf16 v[152:155], a[144:147], a[44:47], v[152:155]
    ds_read_b64_tr_b16 a[176:177], v15 offset:24576
    v_mfma_f32_16x16x32_bf16 v[152:155], a[148:151], a[60:63], v[152:155]
    ds_read_b64_tr_b16 a[178:179], v15 offset:26624
    v_mfma_f32_16x16x32_bf16 v[148:151], a[148:151], a[56:59], v[148:151]
    ds_read_b64_tr_b16 a[180:181], v15 offset:28672
    v_mfma_f32_16x16x32_bf16 v[148:151], a[144:147], a[40:43], v[148:151]
    ds_read_b64_tr_b16 a[182:183], v15 offset:30720
    v_mfma_f32_16x16x32_bf16 v[144:147], a[144:147], a[36:39], v[144:147]
    buffer_load_dwordx4 v11, s[16:19], s53 offen offset:2048 lds
    v_mfma_f32_16x16x32_bf16 v[144:147], a[148:151], a[52:55], v[144:147]
    v_mfma_f32_16x16x32_bf16 v[140:143], a[148:151], a[48:51], v[140:143]
    v_mfma_f32_16x16x32_bf16 v[140:143], a[144:147], a[32:35], v[140:143]
    s_waitcnt lgkmcnt(4)
    v_mfma_f32_16x16x32_bf16 v[156:159], a[160:163], a[32:35], v[156:159]
    ds_read_b64_tr_b16 a[128:129], v16 offset:16384
    v_mfma_f32_16x16x32_bf16 v[156:159], a[164:167], a[48:51], v[156:159]
    ds_read_b64_tr_b16 a[130:131], v16 offset:18432
    v_mfma_f32_16x16x32_bf16 v[160:163], a[164:167], a[52:55], v[160:163]
    ds_read_b64_tr_b16 a[132:133], v16 offset:20480
    v_mfma_f32_16x16x32_bf16 v[160:163], a[160:163], a[36:39], v[160:163]
    ds_read_b64_tr_b16 a[134:135], v16 offset:22528
    v_mfma_f32_16x16x32_bf16 v[164:167], a[160:163], a[40:43], v[164:167]
    buffer_load_dwordx4 a[116:119], v5, s[20:23], s51 offen offset:1024 sc1
    v_mfma_f32_16x16x32_bf16 v[164:167], a[164:167], a[56:59], v[164:167]
    v_mfma_f32_16x16x32_bf16 v[168:171], a[164:167], a[60:63], v[168:171]
    v_mfma_f32_16x16x32_bf16 v[168:171], a[160:163], a[44:47], v[168:171]
    s_waitcnt lgkmcnt(4)
    v_mfma_f32_16x16x32_bf16 v[184:187], a[176:179], a[44:47], v[184:187]
    ds_read_b64_tr_b16 a[144:145], v16 offset:24576
    v_mfma_f32_16x16x32_bf16 v[184:187], a[180:183], a[60:63], v[184:187]
    ds_read_b64_tr_b16 a[146:147], v16 offset:26624
    v_mfma_f32_16x16x32_bf16 v[180:183], a[180:183], a[56:59], v[180:183]
    ds_read_b64_tr_b16 a[148:149], v16 offset:28672
    v_mfma_f32_16x16x32_bf16 v[180:183], a[176:179], a[40:43], v[180:183]
    ds_read_b64_tr_b16 a[150:151], v16 offset:30720
    v_mfma_f32_16x16x32_bf16 v[176:179], a[176:179], a[36:39], v[176:179]
    buffer_load_dwordx4 v12, s[16:19], s53 offen offset:3072 lds
    v_mfma_f32_16x16x32_bf16 v[176:179], a[180:183], a[52:55], v[176:179]
    v_mfma_f32_16x16x32_bf16 v[172:175], a[180:183], a[48:51], v[172:175]
    v_mfma_f32_16x16x32_bf16 v[172:175], a[176:179], a[32:35], v[172:175]
    s_waitcnt lgkmcnt(4)
    v_mfma_f32_16x16x32_bf16 v[188:191], a[128:131], a[32:35], v[188:191]
    ds_read_b64_tr_b16 a[160:161], v17 offset:16384
    v_mfma_f32_16x16x32_bf16 v[188:191], a[132:135], a[48:51], v[188:191]
    ds_read_b64_tr_b16 a[162:163], v17 offset:18432
    v_mfma_f32_16x16x32_bf16 v[192:195], a[132:135], a[52:55], v[192:195]
    ds_read_b64_tr_b16 a[164:165], v17 offset:20480
    v_mfma_f32_16x16x32_bf16 v[192:195], a[128:131], a[36:39], v[192:195]
    ds_read_b64_tr_b16 a[166:167], v17 offset:22528
    v_mfma_f32_16x16x32_bf16 v[196:199], a[128:131], a[40:43], v[196:199]
    buffer_load_dwordx4 a[120:123], v5, s[20:23], s51 offen offset:2048 sc1
    v_mfma_f32_16x16x32_bf16 v[196:199], a[132:135], a[56:59], v[196:199]
    v_mfma_f32_16x16x32_bf16 v[200:203], a[132:135], a[60:63], v[200:203]
    v_mfma_f32_16x16x32_bf16 v[200:203], a[128:131], a[44:47], v[200:203]
    s_waitcnt lgkmcnt(4)
    v_mfma_f32_16x16x32_bf16 v[216:219], a[144:147], a[44:47], v[216:219]
    ds_read_b64_tr_b16 a[176:177], v17 offset:24576
    v_mfma_f32_16x16x32_bf16 v[216:219], a[148:151], a[60:63], v[216:219]
    ds_read_b64_tr_b16 a[178:179], v17 offset:26624
    v_mfma_f32_16x16x32_bf16 v[212:215], a[148:151], a[56:59], v[212:215]
    ds_read_b64_tr_b16 a[180:181], v17 offset:28672
    v_mfma_f32_16x16x32_bf16 v[212:215], a[144:147], a[40:43], v[212:215]
    ds_read_b64_tr_b16 a[182:183], v17 offset:30720
    buffer_load_dwordx4 a[124:127], v5, s[20:23], s51 offen offset:3072 sc1
    v_mfma_f32_16x16x32_bf16 v[208:211], a[144:147], a[36:39], v[208:211]
    v_mfma_f32_16x16x32_bf16 v[208:211], a[148:151], a[52:55], v[208:211]
    v_mfma_f32_16x16x32_bf16 v[204:207], a[148:151], a[48:51], v[204:207]
    v_mfma_f32_16x16x32_bf16 v[204:207], a[144:147], a[32:35], v[204:207]
    s_waitcnt lgkmcnt(4)
    v_mfma_f32_16x16x32_bf16 v[220:223], a[160:163], a[32:35], v[220:223]
    s_waitcnt vmcnt(23)
    s_barrier
    ds_read_b64_tr_b16 a[128:129], v13 offset:32768
    v_mfma_f32_16x16x32_bf16 v[220:223], a[164:167], a[48:51], v[220:223]
    ds_read_b64_tr_b16 a[130:131], v13 offset:34304
    s_add_u32 m0, s40, 65536
    v_mfma_f32_16x16x32_bf16 v[224:227], a[164:167], a[52:55], v[224:227]
    ds_read_b64_tr_b16 a[132:133], v13 offset:36864
    v_mfma_f32_16x16x32_bf16 v[224:227], a[160:163], a[36:39], v[224:227]
    ds_read_b64_tr_b16 a[134:135], v13 offset:38400
    v_mfma_f32_16x16x32_bf16 v[228:231], a[160:163], a[40:43], v[228:231]
    buffer_load_dwordx4 v6, s[16:19], s52 offen offset:0 lds
    v_mfma_f32_16x16x32_bf16 v[228:231], a[164:167], a[56:59], v[228:231]
    v_readlane_b32 s51, v18, s46
    v_mfma_f32_16x16x32_bf16 v[232:235], a[164:167], a[60:63], v[232:235]
    v_mfma_f32_16x16x32_bf16 v[232:235], a[160:163], a[44:47], v[232:235]
    s_waitcnt lgkmcnt(4)
    v_mfma_f32_16x16x32_bf16 v[248:251], a[176:179], a[44:47], v[248:251]
    ds_read_b64_tr_b16 a[144:145], v13 offset:40960
    v_mfma_f32_16x16x32_bf16 v[248:251], a[180:183], a[60:63], v[248:251]
    ds_read_b64_tr_b16 a[146:147], v13 offset:42496
    v_mfma_f32_16x16x32_bf16 v[244:247], a[180:183], a[56:59], v[244:247]
    ds_read_b64_tr_b16 a[148:149], v13 offset:45056
    v_mfma_f32_16x16x32_bf16 v[244:247], a[176:179], a[40:43], v[244:247]
    ds_read_b64_tr_b16 a[150:151], v13 offset:46592
    v_mfma_f32_16x16x32_bf16 v[240:243], a[176:179], a[36:39], v[240:243]
    buffer_load_dwordx4 a[0:3], v4, s[20:23], s50 offen offset:0 sc1
    v_mfma_f32_16x16x32_bf16 v[240:243], a[180:183], a[52:55], v[240:243]
    v_readlane_b32 s53, v19, s46
    v_mfma_f32_16x16x32_bf16 v[236:239], a[180:183], a[48:51], v[236:239]
    v_mfma_f32_16x16x32_bf16 v[236:239], a[176:179], a[32:35], v[236:239]
    s_waitcnt lgkmcnt(4)
    v_mfma_f32_16x16x32_bf16 v[28:31], a[128:131], a[64:67], v[28:31]
    ds_read_b64_tr_b16 a[160:161], v13 offset:32800
    v_mfma_f32_16x16x32_bf16 v[28:31], a[132:135], a[80:83], v[28:31]
    ds_read_b64_tr_b16 a[162:163], v13 offset:34336
    v_mfma_f32_16x16x32_bf16 v[32:35], a[132:135], a[84:87], v[32:35]
    ds_read_b64_tr_b16 a[164:165], v13 offset:36896
    v_mfma_f32_16x16x32_bf16 v[32:35], a[128:131], a[68:71], v[32:35]
    ds_read_b64_tr_b16 a[166:167], v13 offset:38432
    buffer_load_dwordx4 v7, s[16:19], s52 offen offset:1024 lds
    v_mfma_f32_16x16x32_bf16 v[36:39], a[128:131], a[72:75], v[36:39]
    s_add_u32 s46, s46, 1
    v_mfma_f32_16x16x32_bf16 v[36:39], a[132:135], a[88:91], v[36:39]
    v_mfma_f32_16x16x32_bf16 v[40:43], a[132:135], a[92:95], v[40:43]
    v_mfma_f32_16x16x32_bf16 v[40:43], a[128:131], a[76:79], v[40:43]
    s_waitcnt lgkmcnt(4)
    v_mfma_f32_16x16x32_bf16 v[56:59], a[144:147], a[76:79], v[56:59]
    ds_read_b64_tr_b16 a[176:177], v13 offset:40992
    v_mfma_f32_16x16x32_bf16 v[56:59], a[148:151], a[92:95], v[56:59]
    ds_read_b64_tr_b16 a[178:179], v13 offset:42528
    v_mfma_f32_16x16x32_bf16 v[52:55], a[148:151], a[88:91], v[52:55]
    ds_read_b64_tr_b16 a[180:181], v13 offset:45088
    v_mfma_f32_16x16x32_bf16 v[52:55], a[144:147], a[72:75], v[52:55]
    ds_read_b64_tr_b16 a[182:183], v13 offset:46624
    buffer_load_dwordx4 a[4:7], v4, s[20:23], s50 offen offset:1024 sc1
    v_mfma_f32_16x16x32_bf16 v[48:51], a[144:147], a[68:71], v[48:51]
    v_mfma_f32_16x16x32_bf16 v[48:51], a[148:151], a[84:87], v[48:51]
    v_mfma_f32_16x16x32_bf16 v[44:47], a[148:151], a[80:83], v[44:47]
    buffer_load_dwordx4 v8, s[16:19], s52 offen offset:2048 lds
    v_mfma_f32_16x16x32_bf16 v[44:47], a[144:147], a[64:67], v[44:47]
    s_waitcnt lgkmcnt(4)
    v_mfma_f32_16x16x32_bf16 v[60:63], a[160:163], a[64:67], v[60:63]
    ds_read_b64_tr_b16 a[128:129], v13 offset:32832
    v_mfma_f32_16x16x32_bf16 v[60:63], a[164:167], a[80:83], v[60:63]
    ds_read_b64_tr_b16 a[130:131], v13 offset:34368
    v_mfma_f32_16x16x32_bf16 v[64:67], a[164:167], a[84:87], v[64:67]
    ds_read_b64_tr_b16 a[132:133], v13 offset:36928
    v_mfma_f32_16x16x32_bf16 v[64:67], a[160:163], a[68:71], v[64:67]
    ds_read_b64_tr_b16 a[134:135], v13 offset:38464
    v_mfma_f32_16x16x32_bf16 v[68:71], a[160:163], a[72:75], v[68:71]
    v_mfma_f32_16x16x32_bf16 v[68:71], a[164:167], a[88:91], v[68:71]
    buffer_load_dwordx4 a[8:11], v4, s[20:23], s50 offen offset:2048 sc1
    v_mfma_f32_16x16x32_bf16 v[72:75], a[164:167], a[92:95], v[72:75]
    v_mfma_f32_16x16x32_bf16 v[72:75], a[160:163], a[76:79], v[72:75]
    s_waitcnt lgkmcnt(4)
    v_mfma_f32_16x16x32_bf16 v[88:91], a[176:179], a[76:79], v[88:91]
    ds_read_b64_tr_b16 a[144:145], v13 offset:41024
    v_mfma_f32_16x16x32_bf16 v[88:91], a[180:183], a[92:95], v[88:91]
    ds_read_b64_tr_b16 a[146:147], v13 offset:42560
    v_mfma_f32_16x16x32_bf16 v[84:87], a[180:183], a[88:91], v[84:87]
    ds_read_b64_tr_b16 a[148:149], v13 offset:45120
    v_mfma_f32_16x16x32_bf16 v[84:87], a[176:179], a[72:75], v[84:87]
    ds_read_b64_tr_b16 a[150:151], v13 offset:46656
    v_mfma_f32_16x16x32_bf16 v[80:83], a[176:179], a[68:71], v[80:83]
    s_add_u32 m0, s40, 0
    v_mfma_f32_16x16x32_bf16 v[80:83], a[180:183], a[84:87], v[80:83]
    buffer_load_dwordx4 v9, s[16:19], s52 offen offset:0 lds
    v_mfma_f32_16x16x32_bf16 v[76:79], a[180:183], a[80:83], v[76:79]
    v_mfma_f32_16x16x32_bf16 v[76:79], a[176:179], a[64:67], v[76:79]
    s_waitcnt lgkmcnt(4)
    v_mfma_f32_16x16x32_bf16 v[92:95], a[128:131], a[64:67], v[92:95]
    ds_read_b64_tr_b16 a[160:161], v14 offset:32768
    v_mfma_f32_16x16x32_bf16 v[92:95], a[132:135], a[80:83], v[92:95]
    ds_read_b64_tr_b16 a[162:163], v14 offset:34816
    v_mfma_f32_16x16x32_bf16 v[96:99], a[132:135], a[84:87], v[96:99]
    ds_read_b64_tr_b16 a[164:165], v14 offset:36864
    v_mfma_f32_16x16x32_bf16 v[96:99], a[128:131], a[68:71], v[96:99]
    ds_read_b64_tr_b16 a[166:167], v14 offset:38912
    v_mfma_f32_16x16x32_bf16 v[100:103], a[128:131], a[72:75], v[100:103]
    buffer_load_dwordx4 a[12:15], v4, s[20:23], s50 offen offset:3072 sc1
    v_mfma_f32_16x16x32_bf16 v[100:103], a[132:135], a[88:91], v[100:103]
    v_mfma_f32_16x16x32_bf16 v[104:107], a[132:135], a[92:95], v[104:107]
    v_mfma_f32_16x16x32_bf16 v[104:107], a[128:131], a[76:79], v[104:107]
    s_waitcnt lgkmcnt(4)
    v_mfma_f32_16x16x32_bf16 v[120:123], a[144:147], a[76:79], v[120:123]
    ds_read_b64_tr_b16 a[176:177], v14 offset:40960
    v_mfma_f32_16x16x32_bf16 v[120:123], a[148:151], a[92:95], v[120:123]
    ds_read_b64_tr_b16 a[178:179], v14 offset:43008
    v_mfma_f32_16x16x32_bf16 v[116:119], a[148:151], a[88:91], v[116:119]
    ds_read_b64_tr_b16 a[180:181], v14 offset:45056
    v_mfma_f32_16x16x32_bf16 v[116:119], a[144:147], a[72:75], v[116:119]
    ds_read_b64_tr_b16 a[182:183], v14 offset:47104
    v_mfma_f32_16x16x32_bf16 v[112:115], a[144:147], a[68:71], v[112:115]
    buffer_load_dwordx4 v10, s[16:19], s52 offen offset:1024 lds
    v_mfma_f32_16x16x32_bf16 v[112:115], a[148:151], a[84:87], v[112:115]
    v_mfma_f32_16x16x32_bf16 v[108:111], a[148:151], a[80:83], v[108:111]
    v_mfma_f32_16x16x32_bf16 v[108:111], a[144:147], a[64:67], v[108:111]
    s_waitcnt lgkmcnt(4)
    v_mfma_f32_16x16x32_bf16 v[124:127], a[160:163], a[64:67], v[124:127]
    ds_read_b64_tr_b16 a[128:129], v15 offset:32768
    v_mfma_f32_16x16x32_bf16 v[124:127], a[164:167], a[80:83], v[124:127]
    ds_read_b64_tr_b16 a[130:131], v15 offset:34816
    v_mfma_f32_16x16x32_bf16 v[128:131], a[164:167], a[84:87], v[128:131]
    ds_read_b64_tr_b16 a[132:133], v15 offset:36864
    v_mfma_f32_16x16x32_bf16 v[128:131], a[160:163], a[68:71], v[128:131]
    ds_read_b64_tr_b16 a[134:135], v15 offset:38912
    v_mfma_f32_16x16x32_bf16 v[132:135], a[160:163], a[72:75], v[132:135]
    buffer_load_dwordx4 a[16:19], v5, s[20:23], s50 offen offset:0 sc1
    v_mfma_f32_16x16x32_bf16 v[132:135], a[164:167], a[88:91], v[132:135]
    v_mfma_f32_16x16x32_bf16 v[136:139], a[164:167], a[92:95], v[136:139]
    v_mfma_f32_16x16x32_bf16 v[136:139], a[160:163], a[76:79], v[136:139]
    s_waitcnt lgkmcnt(4)
    v_mfma_f32_16x16x32_bf16 v[152:155], a[176:179], a[76:79], v[152:155]
    ds_read_b64_tr_b16 a[144:145], v15 offset:40960
    v_mfma_f32_16x16x32_bf16 v[152:155], a[180:183], a[92:95], v[152:155]
    ds_read_b64_tr_b16 a[146:147], v15 offset:43008
    v_mfma_f32_16x16x32_bf16 v[148:151], a[180:183], a[88:91], v[148:151]
    ds_read_b64_tr_b16 a[148:149], v15 offset:45056
    v_mfma_f32_16x16x32_bf16 v[148:151], a[176:179], a[72:75], v[148:151]
    ds_read_b64_tr_b16 a[150:151], v15 offset:47104
    v_mfma_f32_16x16x32_bf16 v[144:147], a[176:179], a[68:71], v[144:147]
    buffer_load_dwordx4 v11, s[16:19], s52 offen offset:2048 lds
    v_mfma_f32_16x16x32_bf16 v[144:147], a[180:183], a[84:87], v[144:147]
    v_mfma_f32_16x16x32_bf16 v[140:143], a[180:183], a[80:83], v[140:143]
    v_mfma_f32_16x16x32_bf16 v[140:143], a[176:179], a[64:67], v[140:143]
    s_waitcnt lgkmcnt(4)
    v_mfma_f32_16x16x32_bf16 v[156:159], a[128:131], a[64:67], v[156:159]
    ds_read_b64_tr_b16 a[160:161], v16 offset:32768
    v_mfma_f32_16x16x32_bf16 v[156:159], a[132:135], a[80:83], v[156:159]
    ds_read_b64_tr_b16 a[162:163], v16 offset:34816
    v_mfma_f32_16x16x32_bf16 v[160:163], a[132:135], a[84:87], v[160:163]
    ds_read_b64_tr_b16 a[164:165], v16 offset:36864
    v_mfma_f32_16x16x32_bf16 v[160:163], a[128:131], a[68:71], v[160:163]
    ds_read_b64_tr_b16 a[166:167], v16 offset:38912
    v_mfma_f32_16x16x32_bf16 v[164:167], a[128:131], a[72:75], v[164:167]
    buffer_load_dwordx4 a[20:23], v5, s[20:23], s50 offen offset:1024 sc1
    v_mfma_f32_16x16x32_bf16 v[164:167], a[132:135], a[88:91], v[164:167]
    v_mfma_f32_16x16x32_bf16 v[168:171], a[132:135], a[92:95], v[168:171]
    v_mfma_f32_16x16x32_bf16 v[168:171], a[128:131], a[76:79], v[168:171]
    s_waitcnt lgkmcnt(4)
    v_mfma_f32_16x16x32_bf16 v[184:187], a[144:147], a[76:79], v[184:187]
    ds_read_b64_tr_b16 a[176:177], v16 offset:40960
    v_mfma_f32_16x16x32_bf16 v[184:187], a[148:151], a[92:95], v[184:187]
    ds_read_b64_tr_b16 a[178:179], v16 offset:43008
    v_mfma_f32_16x16x32_bf16 v[180:183], a[148:151], a[88:91], v[180:183]
    ds_read_b64_tr_b16 a[180:181], v16 offset:45056
    v_mfma_f32_16x16x32_bf16 v[180:183], a[144:147], a[72:75], v[180:183]
    ds_read_b64_tr_b16 a[182:183], v16 offset:47104
    v_mfma_f32_16x16x32_bf16 v[176:179], a[144:147], a[68:71], v[176:179]
    buffer_load_dwordx4 v12, s[16:19], s52 offen offset:3072 lds
    v_mfma_f32_16x16x32_bf16 v[176:179], a[148:151], a[84:87], v[176:179]
    v_mfma_f32_16x16x32_bf16 v[172:175], a[148:151], a[80:83], v[172:175]
    v_mfma_f32_16x16x32_bf16 v[172:175], a[144:147], a[64:67], v[172:175]
    s_waitcnt lgkmcnt(4)
    v_mfma_f32_16x16x32_bf16 v[188:191], a[160:163], a[64:67], v[188:191]
    ds_read_b64_tr_b16 a[128:129], v17 offset:32768
    v_mfma_f32_16x16x32_bf16 v[188:191], a[164:167], a[80:83], v[188:191]
    ds_read_b64_tr_b16 a[130:131], v17 offset:34816
    v_mfma_f32_16x16x32_bf16 v[192:195], a[164:167], a[84:87], v[192:195]
    ds_read_b64_tr_b16 a[132:133], v17 offset:36864
    v_mfma_f32_16x16x32_bf16 v[192:195], a[160:163], a[68:71], v[192:195]
    ds_read_b64_tr_b16 a[134:135], v17 offset:38912
    v_mfma_f32_16x16x32_bf16 v[196:199], a[160:163], a[72:75], v[196:199]
    buffer_load_dwordx4 a[24:27], v5, s[20:23], s50 offen offset:2048 sc1
    v_mfma_f32_16x16x32_bf16 v[196:199], a[164:167], a[88:91], v[196:199]
    v_mfma_f32_16x16x32_bf16 v[200:203], a[164:167], a[92:95], v[200:203]
    v_mfma_f32_16x16x32_bf16 v[200:203], a[160:163], a[76:79], v[200:203]
    s_waitcnt lgkmcnt(4)
    v_mfma_f32_16x16x32_bf16 v[216:219], a[176:179], a[76:79], v[216:219]
    ds_read_b64_tr_b16 a[144:145], v17 offset:40960
    v_mfma_f32_16x16x32_bf16 v[216:219], a[180:183], a[92:95], v[216:219]
    ds_read_b64_tr_b16 a[146:147], v17 offset:43008
    v_mfma_f32_16x16x32_bf16 v[212:215], a[180:183], a[88:91], v[212:215]
    ds_read_b64_tr_b16 a[148:149], v17 offset:45056
    v_mfma_f32_16x16x32_bf16 v[212:215], a[176:179], a[72:75], v[212:215]
    ds_read_b64_tr_b16 a[150:151], v17 offset:47104
    buffer_load_dwordx4 a[28:31], v5, s[20:23], s50 offen offset:3072 sc1
    v_mfma_f32_16x16x32_bf16 v[208:211], a[176:179], a[68:71], v[208:211]
    v_mfma_f32_16x16x32_bf16 v[208:211], a[180:183], a[84:87], v[208:211]
    v_mfma_f32_16x16x32_bf16 v[204:207], a[180:183], a[80:83], v[204:207]
    v_mfma_f32_16x16x32_bf16 v[204:207], a[176:179], a[64:67], v[204:207]
    s_waitcnt lgkmcnt(4)
    v_mfma_f32_16x16x32_bf16 v[220:223], a[128:131], a[64:67], v[220:223]
    s_waitcnt vmcnt(15)
    s_barrier
    ds_read_b64_tr_b16 a[160:161], v13 offset:49152
    v_mfma_f32_16x16x32_bf16 v[220:223], a[132:135], a[80:83], v[220:223]
    ds_read_b64_tr_b16 a[162:163], v13 offset:50688
    s_add_u32 m0, s40, 81920
    v_mfma_f32_16x16x32_bf16 v[224:227], a[132:135], a[84:87], v[224:227]
    ds_read_b64_tr_b16 a[164:165], v13 offset:53248
    v_mfma_f32_16x16x32_bf16 v[224:227], a[128:131], a[68:71], v[224:227]
    ds_read_b64_tr_b16 a[166:167], v13 offset:54784
    v_mfma_f32_16x16x32_bf16 v[228:231], a[128:131], a[72:75], v[228:231]
    buffer_load_dwordx4 v6, s[16:19], s53 offen offset:0 lds
    v_mfma_f32_16x16x32_bf16 v[228:231], a[132:135], a[88:91], v[228:231]
    v_readlane_b32 s50, v18, s46
    v_mfma_f32_16x16x32_bf16 v[232:235], a[132:135], a[92:95], v[232:235]
    v_mfma_f32_16x16x32_bf16 v[232:235], a[128:131], a[76:79], v[232:235]
    s_waitcnt lgkmcnt(4)
    v_mfma_f32_16x16x32_bf16 v[248:251], a[144:147], a[76:79], v[248:251]
    ds_read_b64_tr_b16 a[176:177], v13 offset:57344
    v_mfma_f32_16x16x32_bf16 v[248:251], a[148:151], a[92:95], v[248:251]
    ds_read_b64_tr_b16 a[178:179], v13 offset:58880
    v_mfma_f32_16x16x32_bf16 v[244:247], a[148:151], a[88:91], v[244:247]
    ds_read_b64_tr_b16 a[180:181], v13 offset:61440
    v_mfma_f32_16x16x32_bf16 v[244:247], a[144:147], a[72:75], v[244:247]
    ds_read_b64_tr_b16 a[182:183], v13 offset:62976
    v_mfma_f32_16x16x32_bf16 v[240:243], a[144:147], a[68:71], v[240:243]
    buffer_load_dwordx4 a[32:35], v4, s[20:23], s51 offen offset:0 sc1
    v_mfma_f32_16x16x32_bf16 v[240:243], a[148:151], a[84:87], v[240:243]
    v_readlane_b32 s52, v19, s46
    v_mfma_f32_16x16x32_bf16 v[236:239], a[148:151], a[80:83], v[236:239]
    v_mfma_f32_16x16x32_bf16 v[236:239], a[144:147], a[64:67], v[236:239]
    s_mov_b32 s41, 2
L_pf_loop:
    s_waitcnt lgkmcnt(4)
    v_mfma_f32_16x16x32_bf16 v[28:31], a[160:163], a[96:99], v[28:31]
    ds_read_b64_tr_b16 a[128:129], v13 offset:49184
    v_mfma_f32_16x16x32_bf16 v[28:31], a[164:167], a[112:115], v[28:31]
    ds_read_b64_tr_b16 a[130:131], v13 offset:50720
    v_mfma_f32_16x16x32_bf16 v[32:35], a[164:167], a[116:119], v[32:35]
    ds_read_b64_tr_b16 a[132:133], v13 offset:53280
    v_mfma_f32_16x16x32_bf16 v[32:35], a[160:163], a[100:103], v[32:35]
    ds_read_b64_tr_b16 a[134:135], v13 offset:54816
    buffer_load_dwordx4 v7, s[16:19], s53 offen offset:1024 lds
    v_mfma_f32_16x16x32_bf16 v[36:39], a[160:163], a[104:107], v[36:39]
    s_add_u32 s46, s46, 1
    v_mfma_f32_16x16x32_bf16 v[36:39], a[164:167], a[120:123], v[36:39]
    v_mfma_f32_16x16x32_bf16 v[40:43], a[164:167], a[124:127], v[40:43]
    v_mfma_f32_16x16x32_bf16 v[40:43], a[160:163], a[108:111], v[40:43]
    s_waitcnt lgkmcnt(4)
    v_mfma_f32_16x16x32_bf16 v[56:59], a[176:179], a[108:111], v[56:59]
    ds_read_b64_tr_b16 a[144:145], v13 offset:57376
    v_mfma_f32_16x16x32_bf16 v[56:59], a[180:183], a[124:127], v[56:59]
    ds_read_b64_tr_b16 a[146:147], v13 offset:58912
    v_mfma_f32_16x16x32_bf16 v[52:55], a[180:183], a[120:123], v[52:55]
    ds_read_b64_tr_b16 a[148:149], v13 offset:61472
    v_mfma_f32_16x16x32_bf16 v[52:55], a[176:179], a[104:107], v[52:55]
    ds_read_b64_tr_b16 a[150:151], v13 offset:63008
    buffer_load_dwordx4 a[36:39], v4, s[20:23], s51 offen offset:1024 sc1
    v_mfma_f32_16x16x32_bf16 v[48:51], a[176:179], a[100:103], v[48:51]
    v_mfma_f32_16x16x32_bf16 v[48:51], a[180:183], a[116:119], v[48:51]
    v_mfma_f32_16x16x32_bf16 v[44:47], a[180:183], a[112:115], v[44:47]
    buffer_load_dwordx4 v8, s[16:19], s53 offen offset:2048 lds
    v_mfma_f32_16x16x32_bf16 v[44:47], a[176:179], a[96:99], v[44:47]
    s_waitcnt lgkmcnt(4)
    v_mfma_f32_16x16x32_bf16 v[60:63], a[128:131], a[96:99], v[60:63]
    ds_read_b64_tr_b16 a[160:161], v13 offset:49216
    v_mfma_f32_16x16x32_bf16 v[60:63], a[132:135], a[112:115], v[60:63]
    ds_read_b64_tr_b16 a[162:163], v13 offset:50752
    v_mfma_f32_16x16x32_bf16 v[64:67], a[132:135], a[116:119], v[64:67]
    ds_read_b64_tr_b16 a[164:165], v13 offset:53312
    v_mfma_f32_16x16x32_bf16 v[64:67], a[128:131], a[100:103], v[64:67]
    ds_read_b64_tr_b16 a[166:167], v13 offset:54848
    v_mfma_f32_16x16x32_bf16 v[68:71], a[128:131], a[104:107], v[68:71]
    v_mfma_f32_16x16x32_bf16 v[68:71], a[132:135], a[120:123], v[68:71]
    buffer_load_dwordx4 a[40:43], v4, s[20:23], s51 offen offset:2048 sc1
    v_mfma_f32_16x16x32_bf16 v[72:75], a[132:135], a[124:127], v[72:75]
    v_mfma_f32_16x16x32_bf16 v[72:75], a[128:131], a[108:111], v[72:75]
    s_waitcnt lgkmcnt(4)
    v_mfma_f32_16x16x32_bf16 v[88:91], a[144:147], a[108:111], v[88:91]
    ds_read_b64_tr_b16 a[176:177], v13 offset:57408
    v_mfma_f32_16x16x32_bf16 v[88:91], a[148:151], a[124:127], v[88:91]
    ds_read_b64_tr_b16 a[178:179], v13 offset:58944
    v_mfma_f32_16x16x32_bf16 v[84:87], a[148:151], a[120:123], v[84:87]
    ds_read_b64_tr_b16 a[180:181], v13 offset:61504
    v_mfma_f32_16x16x32_bf16 v[84:87], a[144:147], a[104:107], v[84:87]
    ds_read_b64_tr_b16 a[182:183], v13 offset:63040
    v_mfma_f32_16x16x32_bf16 v[80:83], a[144:147], a[100:103], v[80:83]
    s_add_u32 m0, s40, 16384
    v_mfma_f32_16x16x32_bf16 v[80:83], a[148:151], a[116:119], v[80:83]
    buffer_load_dwordx4 v9, s[16:19], s53 offen offset:0 lds
    v_mfma_f32_16x16x32_bf16 v[76:79], a[148:151], a[112:115], v[76:79]
    v_mfma_f32_16x16x32_bf16 v[76:79], a[144:147], a[96:99], v[76:79]
    s_waitcnt lgkmcnt(4)
    v_mfma_f32_16x16x32_bf16 v[92:95], a[160:163], a[96:99], v[92:95]
    ds_read_b64_tr_b16 a[128:129], v14 offset:49152
    v_mfma_f32_16x16x32_bf16 v[92:95], a[164:167], a[112:115], v[92:95]
    ds_read_b64_tr_b16 a[130:131], v14 offset:51200
    v_mfma_f32_16x16x32_bf16 v[96:99], a[164:167], a[116:119], v[96:99]
    ds_read_b64_tr_b16 a[132:133], v14 offset:53248
    v_mfma_f32_16x16x32_bf16 v[96:99], a[160:163], a[100:103], v[96:99]
    ds_read_b64_tr_b16 a[134:135], v14 offset:55296
    v_mfma_f32_16x16x32_bf16 v[100:103], a[160:163], a[104:107], v[100:103]
    buffer_load_dwordx4 a[44:47], v4, s[20:23], s51 offen offset:3072 sc1
    v_mfma_f32_16x16x32_bf16 v[100:103], a[164:167], a[120:123], v[100:103]
    v_mfma_f32_16x16x32_bf16 v[104:107], a[164:167], a[124:127], v[104:107]
    v_mfma_f32_16x16x32_bf16 v[104:107], a[160:163], a[108:111], v[104:107]
    s_waitcnt lgkmcnt(4)
    v_mfma_f32_16x16x32_bf16 v[120:123], a[176:179], a[108:111], v[120:123]
    ds_read_b64_tr_b16 a[144:145], v14 offset:57344
    v_mfma_f32_16x16x32_bf16 v[120:123], a[180:183], a[124:127], v[120:123]
    ds_read_b64_tr_b16 a[146:147], v14 offset:59392
    v_mfma_f32_16x16x32_bf16 v[116:119], a[180:183], a[120:123], v[116:119]
    ds_read_b64_tr_b16 a[148:149], v14 offset:61440
    v_mfma_f32_16x16x32_bf16 v[116:119], a[176:179], a[104:107], v[116:119]
    ds_read_b64_tr_b16 a[150:151], v14 offset:63488
    v_mfma_f32_16x16x32_bf16 v[112:115], a[176:179], a[100:103], v[112:115]
    buffer_load_dwordx4 v10, s[16:19], s53 offen offset:1024 lds
    v_mfma_f32_16x16x32_bf16 v[112:115], a[180:183], a[116:119], v[112:115]
    v_mfma_f32_16x16x32_bf16 v[108:111], a[180:183], a[112:115], v[108:111]
    v_mfma_f32_16x16x32_bf16 v[108:111], a[176:179], a[96:99], v[108:111]
    s_waitcnt lgkmcnt(4)
    v_mfma_f32_16x16x32_bf16 v[124:127], a[128:131], a[96:99], v[124:127]
    ds_read_b64_tr_b16 a[160:161], v15 offset:49152
    v_mfma_f32_16x16x32_bf16 v[124:127], a[132:135], a[112:115], v[124:127]
    ds_read_b64_tr_b16 a[162:163], v15 offset:51200
    v_mfma_f32_16x16x32_bf16 v[128:131], a[132:135], a[116:119], v[128:131]
    ds_read_b64_tr_b16 a[164:165], v15 offset:53248
    v_mfma_f32_16x16x32_bf16 v[128:131], a[128:131], a[100:103], v[128:131]
    ds_read_b64_tr_b16 a[166:167], v15 offset:55296
    v_mfma_f32_16x16x32_bf16 v[132:135], a[128:131], a[104:107], v[132:135]
    buffer_load_dwordx4 a[48:51], v5, s[20:23], s51 offen offset:0 sc1
    v_mfma_f32_16x16x32_bf16 v[132:135], a[132:135], a[120:123], v[132:135]
    v_mfma_f32_16x16x32_bf16 v[136:139], a[132:135], a[124:127], v[136:139]
    v_mfma_f32_16x16x32_bf16 v[136:139], a[128:131], a[108:111], v[136:139]
    s_waitcnt lgkmcnt(4)
    v_mfma_f32_16x16x32_bf16 v[152:155], a[144:147], a[108:111], v[152:155]
    ds_read_b64_tr_b16 a[176:177], v15 offset:57344
    v_mfma_f32_16x16x32_bf16 v[152:155], a[148:151], a[124:127], v[152:155]
    ds_read_b64_tr_b16 a[178:179], v15 offset:59392
    v_mfma_f32_16x16x32_bf16 v[148:151], a[148:151], a[120:123], v[148:151]
    ds_read_b64_tr_b16 a[180:181], v15 offset:61440
    v_mfma_f32_16x16x32_bf16 v[148:151], a[144:147], a[104:107], v[148:151]
    ds_read_b64_tr_b16 a[182:183], v15 offset:63488
    v_mfma_f32_16x16x32_bf16 v[144:147], a[144:147], a[100:103], v[144:147]
    buffer_load_dwordx4 v11, s[16:19], s53 offen offset:2048 lds
    v_mfma_f32_16x16x32_bf16 v[144:147], a[148:151], a[116:119], v[144:147]
    v_mfma_f32_16x16x32_bf16 v[140:143], a[148:151], a[112:115], v[140:143]
    v_mfma_f32_16x16x32_bf16 v[140:143], a[144:147], a[96:99], v[140:143]
    s_waitcnt lgkmcnt(4)
    v_mfma_f32_16x16x32_bf16 v[156:159], a[160:163], a[96:99], v[156:159]
    ds_read_b64_tr_b16 a[128:129], v16 offset:49152
    v_mfma_f32_16x16x32_bf16 v[156:159], a[164:167], a[112:115], v[156:159]
    ds_read_b64_tr_b16 a[130:131], v16 offset:51200
    v_mfma_f32_16x16x32_bf16 v[160:163], a[164:167], a[116:119], v[160:163]
    ds_read_b64_tr_b16 a[132:133], v16 offset:53248
    v_mfma_f32_16x16x32_bf16 v[160:163], a[160:163], a[100:103], v[160:163]
    ds_read_b64_tr_b16 a[134:135], v16 offset:55296
    v_mfma_f32_16x16x32_bf16 v[164:167], a[160:163], a[104:107], v[164:167]
    buffer_load_dwordx4 a[52:55], v5, s[20:23], s51 offen offset:1024 sc1
    v_mfma_f32_16x16x32_bf16 v[164:167], a[164:167], a[120:123], v[164:167]
    v_mfma_f32_16x16x32_bf16 v[168:171], a[164:167], a[124:127], v[168:171]
    v_mfma_f32_16x16x32_bf16 v[168:171], a[160:163], a[108:111], v[168:171]
    s_waitcnt lgkmcnt(4)
    v_mfma_f32_16x16x32_bf16 v[184:187], a[176:179], a[108:111], v[184:187]
    ds_read_b64_tr_b16 a[144:145], v16 offset:57344
    v_mfma_f32_16x16x32_bf16 v[184:187], a[180:183], a[124:127], v[184:187]
    ds_read_b64_tr_b16 a[146:147], v16 offset:59392
    v_mfma_f32_16x16x32_bf16 v[180:183], a[180:183], a[120:123], v[180:183]
    ds_read_b64_tr_b16 a[148:149], v16 offset:61440
    v_mfma_f32_16x16x32_bf16 v[180:183], a[176:179], a[104:107], v[180:183]
    ds_read_b64_tr_b16 a[150:151], v16 offset:63488
    v_mfma_f32_16x16x32_bf16 v[176:179], a[176:179], a[100:103], v[176:179]
    buffer_load_dwordx4 v12, s[16:19], s53 offen offset:3072 lds
    v_mfma_f32_16x16x32_bf16 v[176:179], a[180:183], a[116:119], v[176:179]
    v_mfma_f32_16x16x32_bf16 v[172:175], a[180:183], a[112:115], v[172:175]
    v_mfma_f32_16x16x32_bf16 v[172:175], a[176:179], a[96:99], v[172:175]
    s_waitcnt lgkmcnt(4)
    v_mfma_f32_16x16x32_bf16 v[188:191], a[128:131], a[96:99], v[188:191]
    ds_read_b64_tr_b16 a[160:161], v17 offset:49152
    v_mfma_f32_16x16x32_bf16 v[188:191], a[132:135], a[112:115], v[188:191]
    ds_read_b64_tr_b16 a[162:163], v17 offset:51200
    v_mfma_f32_16x16x32_bf16 v[192:195], a[132:135], a[116:119], v[192:195]
    ds_read_b64_tr_b16 a[164:165], v17 offset:53248
    v_mfma_f32_16x16x32_bf16 v[192:195], a[128:131], a[100:103], v[192:195]
    ds_read_b64_tr_b16 a[166:167], v17 offset:55296
    v_mfma_f32_16x16x32_bf16 v[196:199], a[128:131], a[104:107], v[196:199]
    buffer_load_dwordx4 a[56:59], v5, s[20:23], s51 offen offset:2048 sc1
    v_mfma_f32_16x16x32_bf16 v[196:199], a[132:135], a[120:123], v[196:199]
    v_mfma_f32_16x16x32_bf16 v[200:203], a[132:135], a[124:127], v[200:203]
    v_mfma_f32_16x16x32_bf16 v[200:203], a[128:131], a[108:111], v[200:203]
    s_waitcnt lgkmcnt(4)
    v_mfma_f32_16x16x32_bf16 v[216:219], a[144:147], a[108:111], v[216:219]
    ds_read_b64_tr_b16 a[176:177], v17 offset:57344
    v_mfma_f32_16x16x32_bf16 v[216:219], a[148:151], a[124:127], v[216:219]
    ds_read_b64_tr_b16 a[178:179], v17 offset:59392
    v_mfma_f32_16x16x32_bf16 v[212:215], a[148:151], a[120:123], v[212:215]
    ds_read_b64_tr_b16 a[180:181], v17 offset:61440
    v_mfma_f32_16x16x32_bf16 v[212:215], a[144:147], a[104:107], v[212:215]
    ds_read_b64_tr_b16 a[182:183], v17 offset:63488
    buffer_load_dwordx4 a[60:63], v5, s[20:23], s51 offen offset:3072 sc1
    v_mfma_f32_16x16x32_bf16 v[208:211], a[144:147], a[100:103], v[208:211]
    v_mfma_f32_16x16x32_bf16 v[208:211], a[148:151], a[116:119], v[208:211]
    v_mfma_f32_16x16x32_bf16 v[204:207], a[148:151], a[112:115], v[204:207]
    v_mfma_f32_16x16x32_bf16 v[204:207], a[144:147], a[96:99], v[204:207]
    s_waitcnt lgkmcnt(4)
    v_mfma_f32_16x16x32_bf16 v[220:223], a[160:163], a[96:99], v[220:223]
    s_waitcnt vmcnt(15)
    s_sub_u32 s57, s57, 1
    s_cmp_lg_u32 s57, 0
    s_cbranch_scc1 L_pfd0
    buffer_load_dword a249, v253, s[32:35], 0 offen
L_pfd0:
    s_barrier
    ds_read_b64_tr_b16 a[128:129], v13 offset:0
    v_mfma_f32_16x16x32_bf16 v[220:223], a[164:167], a[112:115], v[220:223]
    ds_read_b64_tr_b16 a[130:131], v13 offset:1536
    s_add_u32 m0, s40, 98304
    v_mfma_f32_16x16x32_bf16 v[224:227], a[164:167], a[116:119], v[224:227]
    ds_read_b64_tr_b16 a[132:133], v13 offset:4096
    v_mfma_f32_16x16x32_bf16 v[224:227], a[160:163], a[100:103], v[224:227]
    ds_read_b64_tr_b16 a[134:135], v13 offset:5632
    v_mfma_f32_16x16x32_bf16 v[228:231], a[160:163], a[104:107], v[228:231]
    buffer_load_dwordx4 v6, s[16:19], s52 offen offset:0 lds
    v_mfma_f32_16x16x32_bf16 v[228:231], a[164:167], a[120:123], v[228:231]
    v_readlane_b32 s51, v18, s46
    v_mfma_f32_16x16x32_bf16 v[232:235], a[164:167], a[124:127], v[232:235]
    v_mfma_f32_16x16x32_bf16 v[232:235], a[160:163], a[108:111], v[232:235]
    s_waitcnt lgkmcnt(4)
    v_mfma_f32_16x16x32_bf16 v[248:251], a[176:179], a[108:111], v[248:251]
    ds_read_b64_tr_b16 a[144:145], v13 offset:8192
    v_mfma_f32_16x16x32_bf16 v[248:251], a[180:183], a[124:127], v[248:251]
    ds_read_b64_tr_b16 a[146:147], v13 offset:9728
    v_mfma_f32_16x16x32_bf16 v[244:247], a[180:183], a[120:123], v[244:247]
    ds_read_b64_tr_b16 a[148:149], v13 offset:12288
    v_mfma_f32_16x16x32_bf16 v[244:247], a[176:179], a[104:107], v[244:247]
    ds_read_b64_tr_b16 a[150:151], v13 offset:13824
    v_mfma_f32_16x16x32_bf16 v[240:243], a[176:179], a[100:103], v[240:243]
    buffer_load_dwordx4 a[64:67], v4, s[20:23], s50 offen offset:0 sc1
    v_mfma_f32_16x16x32_bf16 v[240:243], a[180:183], a[116:119], v[240:243]
    v_readlane_b32 s53, v19, s46
    v_mfma_f32_16x16x32_bf16 v[236:239], a[180:183], a[112:115], v[236:239]
    v_mfma_f32_16x16x32_bf16 v[236:239], a[176:179], a[96:99], v[236:239]
    s_waitcnt lgkmcnt(4)
    v_mfma_f32_16x16x32_bf16 v[28:31], a[128:131], a[0:3], v[28:31]
    ds_read_b64_tr_b16 a[160:161], v13 offset:32
    v_mfma_f32_16x16x32_bf16 v[28:31], a[132:135], a[16:19], v[28:31]
    ds_read_b64_tr_b16 a[162:163], v13 offset:1568
    v_mfma_f32_16x16x32_bf16 v[32:35], a[132:135], a[20:23], v[32:35]
    ds_read_b64_tr_b16 a[164:165], v13 offset:4128
    v_mfma_f32_16x16x32_bf16 v[32:35], a[128:131], a[4:7], v[32:35]
    ds_read_b64_tr_b16 a[166:167], v13 offset:5664
    buffer_load_dwordx4 v7, s[16:19], s52 offen offset:1024 lds
    v_mfma_f32_16x16x32_bf16 v[36:39], a[128:131], a[8:11], v[36:39]
    s_add_u32 s46, s46, 1
    v_mfma_f32_16x16x32_bf16 v[36:39], a[132:135], a[24:27], v[36:39]
    v_mfma_f32_16x16x32_bf16 v[40:43], a[132:135], a[28:31], v[40:43]
    v_mfma_f32_16x16x32_bf16 v[40:43], a[128:131], a[12:15], v[40:43]
    s_waitcnt lgkmcnt(4)
    v_mfma_f32_16x16x32_bf16 v[56:59], a[144:147], a[12:15], v[56:59]
    ds_read_b64_tr_b16 a[176:177], v13 offset:8224
    v_mfma_f32_16x16x32_bf16 v[56:59], a[148:151], a[28:31], v[56:59]
    ds_read_b64_tr_b16 a[178:179], v13 offset:9760
    v_mfma_f32_16x16x32_bf16 v[52:55], a[148:151], a[24:27], v[52:55]
    ds_read_b64_tr_b16 a[180:181], v13 offset:12320
    v_mfma_f32_16x16x32_bf16 v[52:55], a[144:147], a[8:11], v[52:55]
    ds_read_b64_tr_b16 a[182:183], v13 offset:13856
    buffer_load_dwordx4 a[68:71], v4, s[20:23], s50 offen offset:1024 sc1
    v_mfma_f32_16x16x32_bf16 v[48:51], a[144:147], a[4:7], v[48:51]
    v_mfma_f32_16x16x32_bf16 v[48:51], a[148:151], a[20:23], v[48:51]
    v_mfma_f32_16x16x32_bf16 v[44:47], a[148:151], a[16:19], v[44:47]
    buffer_load_dwordx4 v8, s[16:19], s52 offen offset:2048 lds
    v_mfma_f32_16x16x32_bf16 v[44:47], a[144:147], a[0:3], v[44:47]
    s_waitcnt lgkmcnt(4)
    v_mfma_f32_16x16x32_bf16 v[60:63], a[160:163], a[0:3], v[60:63]
    ds_read_b64_tr_b16 a[128:129], v13 offset:64
    v_mfma_f32_16x16x32_bf16 v[60:63], a[164:167], a[16:19], v[60:63]
    ds_read_b64_tr_b16 a[130:131], v13 offset:1600
    v_mfma_f32_16x16x32_bf16 v[64:67], a[164:167], a[20:23], v[64:67]
    ds_read_b64_tr_b16 a[132:133], v13 offset:4160
    v_mfma_f32_16x16x32_bf16 v[64:67], a[160:163], a[4:7], v[64:67]
    ds_read_b64_tr_b16 a[134:135], v13 offset:5696
    v_mfma_f32_16x16x32_bf16 v[68:71], a[160:163], a[8:11], v[68:71]
    v_mfma_f32_16x16x32_bf16 v[68:71], a[164:167], a[24:27], v[68:71]
    buffer_load_dwordx4 a[72:75], v4, s[20:23], s50 offen offset:2048 sc1
    v_mfma_f32_16x16x32_bf16 v[72:75], a[164:167], a[28:31], v[72:75]
    v_mfma_f32_16x16x32_bf16 v[72:75], a[160:163], a[12:15], v[72:75]
    s_waitcnt lgkmcnt(4)
    v_mfma_f32_16x16x32_bf16 v[88:91], a[176:179], a[12:15], v[88:91]
    ds_read_b64_tr_b16 a[144:145], v13 offset:8256
    v_mfma_f32_16x16x32_bf16 v[88:91], a[180:183], a[28:31], v[88:91]
    ds_read_b64_tr_b16 a[146:147], v13 offset:9792
    v_mfma_f32_16x16x32_bf16 v[84:87], a[180:183], a[24:27], v[84:87]
    ds_read_b64_tr_b16 a[148:149], v13 offset:12352
    v_mfma_f32_16x16x32_bf16 v[84:87], a[176:179], a[8:11], v[84:87]
    ds_read_b64_tr_b16 a[150:151], v13 offset:13888
    v_mfma_f32_16x16x32_bf16 v[80:83], a[176:179], a[4:7], v[80:83]
    s_add_u32 m0, s40, 32768
    v_mfma_f32_16x16x32_bf16 v[80:83], a[180:183], a[20:23], v[80:83]
    buffer_load_dwordx4 v9, s[16:19], s52 offen offset:0 lds
    v_mfma_f32_16x16x32_bf16 v[76:79], a[180:183], a[16:19], v[76:79]
    v_mfma_f32_16x16x32_bf16 v[76:79], a[176:179], a[0:3], v[76:79]
    s_waitcnt lgkmcnt(4)
    v_mfma_f32_16x16x32_bf16 v[92:95], a[128:131], a[0:3], v[92:95]
    ds_read_b64_tr_b16 a[160:161], v14 offset:0
    v_mfma_f32_16x16x32_bf16 v[92:95], a[132:135], a[16:19], v[92:95]
    ds_read_b64_tr_b16 a[162:163], v14 offset:2048
    v_mfma_f32_16x16x32_bf16 v[96:99], a[132:135], a[20:23], v[96:99]
    ds_read_b64_tr_b16 a[164:165], v14 offset:4096
    v_mfma_f32_16x16x32_bf16 v[96:99], a[128:131], a[4:7], v[96:99]
    ds_read_b64_tr_b16 a[166:167], v14 offset:6144
    v_mfma_f32_16x16x32_bf16 v[100:103], a[128:131], a[8:11], v[100:103]
    buffer_load_dwordx4 a[76:79], v4, s[20:23], s50 offen offset:3072 sc1
    v_mfma_f32_16x16x32_bf16 v[100:103], a[132:135], a[24:27], v[100:103]
    v_mfma_f32_16x16x32_bf16 v[104:107], a[132:135], a[28:31], v[104:107]
    v_mfma_f32_16x16x32_bf16 v[104:107], a[128:131], a[12:15], v[104:107]
    s_waitcnt lgkmcnt(4)
    v_mfma_f32_16x16x32_bf16 v[120:123], a[144:147], a[12:15], v[120:123]
    ds_read_b64_tr_b16 a[176:177], v14 offset:8192
    v_mfma_f32_16x16x32_bf16 v[120:123], a[148:151], a[28:31], v[120:123]
    ds_read_b64_tr_b16 a[178:179], v14 offset:10240
    v_mfma_f32_16x16x32_bf16 v[116:119], a[148:151], a[24:27], v[116:119]
    ds_read_b64_tr_b16 a[180:181], v14 offset:12288
    v_mfma_f32_16x16x32_bf16 v[116:119], a[144:147], a[8:11], v[116:119]
    ds_read_b64_tr_b16 a[182:183], v14 offset:14336
    v_mfma_f32_16x16x32_bf16 v[112:115], a[144:147], a[4:7], v[112:115]
    buffer_load_dwordx4 v10, s[16:19], s52 offen offset:1024 lds
    v_mfma_f32_16x16x32_bf16 v[112:115], a[148:151], a[20:23], v[112:115]
    v_mfma_f32_16x16x32_bf16 v[108:111], a[148:151], a[16:19], v[108:111]
    v_mfma_f32_16x16x32_bf16 v[108:111], a[144:147], a[0:3], v[108:111]
    s_waitcnt lgkmcnt(4)
    v_mfma_f32_16x16x32_bf16 v[124:127], a[160:163], a[0:3], v[124:127]
    ds_read_b64_tr_b16 a[128:129], v15 offset:0
    v_mfma_f32_16x16x32_bf16 v[124:127], a[164:167], a[16:19], v[124:127]
    ds_read_b64_tr_b16 a[130:131], v15 offset:2048
    v_mfma_f32_16x16x32_bf16 v[128:131], a[164:167], a[20:23], v[128:131]
    ds_read_b64_tr_b16 a[132:133], v15 offset:4096
    v_mfma_f32_16x16x32_bf16 v[128:131], a[160:163], a[4:7], v[128:131]
    ds_read_b64_tr_b16 a[134:135], v15 offset:6144
    v_mfma_f32_16x16x32_bf16 v[132:135], a[160:163], a[8:11], v[132:135]
    buffer_load_dwordx4 a[80:83], v5, s[20:23], s50 offen offset:0 sc1
    v_mfma_f32_16x16x32_bf16 v[132:135], a[164:167], a[24:27], v[132:135]
    v_mfma_f32_16x16x32_bf16 v[136:139], a[164:167], a[28:31], v[136:139]
    v_mfma_f32_16x16x32_bf16 v[136:139], a[160:163], a[12:15], v[136:139]
    s_waitcnt lgkmcnt(4)
    v_mfma_f32_16x16x32_bf16 v[152:155], a[176:179], a[12:15], v[152:155]
    ds_read_b64_tr_b16 a[144:145], v15 offset:8192
    v_mfma_f32_16x16x32_bf16 v[152:155], a[180:183], a[28:31], v[152:155]
    ds_read_b64_tr_b16 a[146:147], v15 offset:10240
    v_mfma_f32_16x16x32_bf16 v[148:151], a[180:183], a[24:27], v[148:151]
    ds_read_b64_tr_b16 a[148:149], v15 offset:12288
    v_mfma_f32_16x16x32_bf16 v[148:151], a[176:179], a[8:11], v[148:151]
    ds_read_b64_tr_b16 a[150:151], v15 offset:14336
    v_mfma_f32_16x16x32_bf16 v[144:147], a[176:179], a[4:7], v[144:147]
    buffer_load_dwordx4 v11, s[16:19], s52 offen offset:2048 lds
    v_mfma_f32_16x16x32_bf16 v[144:147], a[180:183], a[20:23], v[144:147]
    v_mfma_f32_16x16x32_bf16 v[140:143], a[180:183], a[16:19], v[140:143]
    v_mfma_f32_16x16x32_bf16 v[140:143], a[176:179], a[0:3], v[140:143]
    s_waitcnt lgkmcnt(4)
    v_mfma_f32_16x16x32_bf16 v[156:159], a[128:131], a[0:3], v[156:159]
    ds_read_b64_tr_b16 a[160:161], v16 offset:0
    v_mfma_f32_16x16x32_bf16 v[156:159], a[132:135], a[16:19], v[156:159]
    ds_read_b64_tr_b16 a[162:163], v16 offset:2048
    v_mfma_f32_16x16x32_bf16 v[160:163], a[132:135], a[20:23], v[160:163]
    ds_read_b64_tr_b16 a[164:165], v16 offset:4096
    v_mfma_f32_16x16x32_bf16 v[160:163], a[128:131], a[4:7], v[160:163]
    ds_read_b64_tr_b16 a[166:167], v16 offset:6144
    v_mfma_f32_16x16x32_bf16 v[164:167], a[128:131], a[8:11], v[164:167]
    buffer_load_dwordx4 a[84:87], v5, s[20:23], s50 offen offset:1024 sc1
    v_mfma_f32_16x16x32_bf16 v[164:167], a[132:135], a[24:27], v[164:167]
    v_mfma_f32_16x16x32_bf16 v[168:171], a[132:135], a[28:31], v[168:171]
    v_mfma_f32_16x16x32_bf16 v[168:171], a[128:131], a[12:15], v[168:171]
    s_waitcnt lgkmcnt(4)
    v_mfma_f32_16x16x32_bf16 v[184:187], a[144:147], a[12:15], v[184:187]
    ds_read_b64_tr_b16 a[176:177], v16 offset:8192
    v_mfma_f32_16x16x32_bf16 v[184:187], a[148:151], a[28:31], v[184:187]
    ds_read_b64_tr_b16 a[178:179], v16 offset:10240
    v_mfma_f32_16x16x32_bf16 v[180:183], a[148:151], a[24:27], v[180:183]
    ds_read_b64_tr_b16 a[180:181], v16 offset:12288
    v_mfma_f32_16x16x32_bf16 v[180:183], a[144:147], a[8:11], v[180:183]
    ds_read_b64_tr_b16 a[182:183], v16 offset:14336
    v_mfma_f32_16x16x32_bf16 v[176:179], a[144:147], a[4:7], v[176:179]
    buffer_load_dwordx4 v12, s[16:19], s52 offen offset:3072 lds
    v_mfma_f32_16x16x32_bf16 v[176:179], a[148:151], a[20:23], v[176:179]
    v_mfma_f32_16x16x32_bf16 v[172:175], a[148:151], a[16:19], v[172:175]
    v_mfma_f32_16x16x32_bf16 v[172:175], a[144:147], a[0:3], v[172:175]
    s_waitcnt lgkmcnt(4)
    v_mfma_f32_16x16x32_bf16 v[188:191], a[160:163], a[0:3], v[188:191]
    ds_read_b64_tr_b16 a[128:129], v17 offset:0
    v_mfma_f32_16x16x32_bf16 v[188:191], a[164:167], a[16:19], v[188:191]
    ds_read_b64_tr_b16 a[130:131], v17 offset:2048
    v_mfma_f32_16x16x32_bf16 v[192:195], a[164:167], a[20:23], v[192:195]
    ds_read_b64_tr_b16 a[132:133], v17 offset:4096
    v_mfma_f32_16x16x32_bf16 v[192:195], a[160:163], a[4:7], v[192:195]
    ds_read_b64_tr_b16 a[134:135], v17 offset:6144
    v_mfma_f32_16x16x32_bf16 v[196:199], a[160:163], a[8:11], v[196:199]
    buffer_load_dwordx4 a[88:91], v5, s[20:23], s50 offen offset:2048 sc1
    v_mfma_f32_16x16x32_bf16 v[196:199], a[164:167], a[24:27], v[196:199]
    v_mfma_f32_16x16x32_bf16 v[200:203], a[164:167], a[28:31], v[200:203]
    v_mfma_f32_16x16x32_bf16 v[200:203], a[160:163], a[12:15], v[200:203]
    s_waitcnt lgkmcnt(4)
    v_mfma_f32_16x16x32_bf16 v[216:219], a[176:179], a[12:15], v[216:219]
    ds_read_b64_tr_b16 a[144:145], v17 offset:8192
    v_mfma_f32_16x16x32_bf16 v[216:219], a[180:183], a[28:31], v[216:219]
    ds_read_b64_tr_b16 a[146:147], v17 offset:10240
    v_mfma_f32_16x16x32_bf16 v[212:215], a[180:183], a[24:27], v[212:215]
    ds_read_b64_tr_b16 a[148:149], v17 offset:12288
    v_mfma_f32_16x16x32_bf16 v[212:215], a[176:179], a[8:11], v[212:215]
    ds_read_b64_tr_b16 a[150:151], v17 offset:14336
    buffer_load_dwordx4 a[92:95], v5, s[20:23], s50 offen offset:3072 sc1
    v_mfma_f32_16x16x32_bf16 v[208:211], a[176:179], a[4:7], v[208:211]
    v_mfma_f32_16x16x32_bf16 v[208:211], a[180:183], a[20:23], v[208:211]
    v_mfma_f32_16x16x32_bf16 v[204:207], a[180:183], a[16:19], v[204:207]
    v_mfma_f32_16x16x32_bf16 v[204:207], a[176:179], a[0:3], v[204:207]
    s_waitcnt lgkmcnt(4)
    v_mfma_f32_16x16x32_bf16 v[220:223], a[128:131], a[0:3], v[220:223]
    s_waitcnt vmcnt(15)
    s_sub_u32 s57, s57, 1
    s_cmp_lg_u32 s57, 0
    s_cbranch_scc1 L_pfd1
    buffer_load_dword a249, v253, s[32:35], 0 offen
L_pfd1:
    s_barrier
    ds_read_b64_tr_b16 a[160:161], v13 offset:16384
    v_mfma_f32_16x16x32_bf16 v[220:223], a[132:135], a[16:19], v[220:223]
    ds_read_b64_tr_b16 a[162:163], v13 offset:17920
    s_add_u32 m0, s40, 114688
    v_mfma_f32_16x16x32_bf16 v[224:227], a[132:135], a[20:23], v[224:227]
    ds_read_b64_tr_b16 a[164:165], v13 offset:20480
    v_mfma_f32_16x16x32_bf16 v[224:227], a[128:131], a[4:7], v[224:227]
    ds_read_b64_tr_b16 a[166:167], v13 offset:22016
    v_mfma_f32_16x16x32_bf16 v[228:231], a[128:131], a[8:11], v[228:231]
    buffer_load_dwordx4 v6, s[16:19], s53 offen offset:0 lds
    v_mfma_f32_16x16x32_bf16 v[228:231], a[132:135], a[24:27], v[228:231]
    v_readlane_b32 s50, v18, s46
    v_mfma_f32_16x16x32_bf16 v[232:235], a[132:135], a[28:31], v[232:235]
    v_mfma_f32_16x16x32_bf16 v[232:235], a[128:131], a[12:15], v[232:235]
    s_waitcnt lgkmcnt(4)
    v_mfma_f32_16x16x32_bf16 v[248:251], a[144:147], a[12:15], v[248:251]
    ds_read_b64_tr_b16 a[176:177], v13 offset:24576
    v_mfma_f32_16x16x32_bf16 v[248:251], a[148:151], a[28:31], v[248:251]
    ds_read_b64_tr_b16 a[178:179], v13 offset:26112
    v_mfma_f32_16x16x32_bf16 v[244:247], a[148:151], a[24:27], v[244:247]
    ds_read_b64_tr_b16 a[180:181], v13 offset:28672
    v_mfma_f32_16x16x32_bf16 v[244:247], a[144:147], a[8:11], v[244:247]
    ds_read_b64_tr_b16 a[182:183], v13 offset:30208
    v_mfma_f32_16x16x32_bf16 v[240:243], a[144:147], a[4:7], v[240:243]
    buffer_load_dwordx4 a[96:99], v4, s[20:23], s51 offen offset:0 sc1
    v_mfma_f32_16x16x32_bf16 v[240:243], a[148:151], a[20:23], v[240:243]
    v_readlane_b32 s52, v19, s46
    v_mfma_f32_16x16x32_bf16 v[236:239], a[148:151], a[16:19], v[236:239]
    v_mfma_f32_16x16x32_bf16 v[236:239], a[144:147], a[0:3], v[236:239]
    s_waitcnt lgkmcnt(4)
    v_mfma_f32_16x16x32_bf16 v[28:31], a[160:163], a[32:35], v[28:31]
    ds_read_b64_tr_b16 a[128:129], v13 offset:16416
    v_mfma_f32_16x16x32_bf16 v[28:31], a[164:167], a[48:51], v[28:31]
    ds_read_b64_tr_b16 a[130:131], v13 offset:17952
    v_mfma_f32_16x16x32_bf16 v[32:35], a[164:167], a[52:55], v[32:35]
    ds_read_b64_tr_b16 a[132:133], v13 offset:20512
    v_mfma_f32_16x16x32_bf16 v[32:35], a[160:163], a[36:39], v[32:35]
    ds_read_b64_tr_b16 a[134:135], v13 offset:22048
    buffer_load_dwordx4 v7, s[16:19], s53 offen offset:1024 lds
    v_mfma_f32_16x16x32_bf16 v[36:39], a[160:163], a[40:43], v[36:39]
    s_add_u32 s46, s46, 1
    v_mfma_f32_16x16x32_bf16 v[36:39], a[164:167], a[56:59], v[36:39]
    v_mfma_f32_16x16x32_bf16 v[40:43], a[164:167], a[60:63], v[40:43]
    v_mfma_f32_16x16x32_bf16 v[40:43], a[160:163], a[44:47], v[40:43]
    s_waitcnt lgkmcnt(4)
    v_mfma_f32_16x16x32_bf16 v[56:59], a[176:179], a[44:47], v[56:59]
    ds_read_b64_tr_b16 a[144:145], v13 offset:24608
    v_mfma_f32_16x16x32_bf16 v[56:59], a[180:183], a[60:63], v[56:59]
    ds_read_b64_tr_b16 a[146:147], v13 offset:26144
    v_mfma_f32_16x16x32_bf16 v[52:55], a[180:183], a[56:59], v[52:55]
    ds_read_b64_tr_b16 a[148:149], v13 offset:28704
    v_mfma_f32_16x16x32_bf16 v[52:55], a[176:179], a[40:43], v[52:55]
    ds_read_b64_tr_b16 a[150:151], v13 offset:30240
    buffer_load_dwordx4 a[100:103], v4, s[20:23], s51 offen offset:1024 sc1
    v_mfma_f32_16x16x32_bf16 v[48:51], a[176:179], a[36:39], v[48:51]
    v_mfma_f32_16x16x32_bf16 v[48:51], a[180:183], a[52:55], v[48:51]
    v_mfma_f32_16x16x32_bf16 v[44:47], a[180:183], a[48:51], v[44:47]
    buffer_load_dwordx4 v8, s[16:19], s53 offen offset:2048 lds
    v_mfma_f32_16x16x32_bf16 v[44:47], a[176:179], a[32:35], v[44:47]
    s_waitcnt lgkmcnt(4)
    v_mfma_f32_16x16x32_bf16 v[60:63], a[128:131], a[32:35], v[60:63]
    ds_read_b64_tr_b16 a[160:161], v13 offset:16448
    v_mfma_f32_16x16x32_bf16 v[60:63], a[132:135], a[48:51], v[60:63]
    ds_read_b64_tr_b16 a[162:163], v13 offset:17984
    v_mfma_f32_16x16x32_bf16 v[64:67], a[132:135], a[52:55], v[64:67]
    ds_read_b64_tr_b16 a[164:165], v13 offset:20544
    v_mfma_f32_16x16x32_bf16 v[64:67], a[128:131], a[36:39], v[64:67]
    ds_read_b64_tr_b16 a[166:167], v13 offset:22080
    v_mfma_f32_16x16x32_bf16 v[68:71], a[128:131], a[40:43], v[68:71]
    v_mfma_f32_16x16x32_bf16 v[68:71], a[132:135], a[56:59], v[68:71]
    buffer_load_dwordx4 a[104:107], v4, s[20:23], s51 offen offset:2048 sc1
    v_mfma_f32_16x16x32_bf16 v[72:75], a[132:135], a[60:63], v[72:75]
    v_mfma_f32_16x16x32_bf16 v[72:75], a[128:131], a[44:47], v[72:75]
    s_waitcnt lgkmcnt(4)
    v_mfma_f32_16x16x32_bf16 v[88:91], a[144:147], a[44:47], v[88:91]
    ds_read_b64_tr_b16 a[176:177], v13 offset:24640
    v_mfma_f32_16x16x32_bf16 v[88:91], a[148:151], a[60:63], v[88:91]
    ds_read_b64_tr_b16 a[178:179], v13 offset:26176
    v_mfma_f32_16x16x32_bf16 v[84:87], a[148:151], a[56:59], v[84:87]
    ds_read_b64_tr_b16 a[180:181], v13 offset:28736
    v_mfma_f32_16x16x32_bf16 v[84:87], a[144:147], a[40:43], v[84:87]
    ds_read_b64_tr_b16 a[182:183], v13 offset:30272
    v_mfma_f32_16x16x32_bf16 v[80:83], a[144:147], a[36:39], v[80:83]
    s_add_u32 m0, s40, 49152
    v_mfma_f32_16x16x32_bf16 v[80:83], a[148:151], a[52:55], v[80:83]
    buffer_load_dwordx4 v9, s[16:19], s53 offen offset:0 lds
    v_mfma_f32_16x16x32_bf16 v[76:79], a[148:151], a[48:51], v[76:79]
    v_mfma_f32_16x16x32_bf16 v[76:79], a[144:147], a[32:35], v[76:79]
    s_waitcnt lgkmcnt(4)
    v_mfma_f32_16x16x32_bf16 v[92:95], a[160:163], a[32:35], v[92:95]
    ds_read_b64_tr_b16 a[128:129], v14 offset:16384
    v_mfma_f32_16x16x32_bf16 v[92:95], a[164:167], a[48:51], v[92:95]
    ds_read_b64_tr_b16 a[130:131], v14 offset:18432
    v_mfma_f32_16x16x32_bf16 v[96:99], a[164:167], a[52:55], v[96:99]
    ds_read_b64_tr_b16 a[132:133], v14 offset:20480
    v_mfma_f32_16x16x32_bf16 v[96:99], a[160:163], a[36:39], v[96:99]
    ds_read_b64_tr_b16 a[134:135], v14 offset:22528
    v_mfma_f32_16x16x32_bf16 v[100:103], a[160:163], a[40:43], v[100:103]
    buffer_load_dwordx4 a[108:111], v4, s[20:23], s51 offen offset:3072 sc1
    v_mfma_f32_16x16x32_bf16 v[100:103], a[164:167], a[56:59], v[100:103]
    v_mfma_f32_16x16x32_bf16 v[104:107], a[164:167], a[60:63], v[104:107]
    v_mfma_f32_16x16x32_bf16 v[104:107], a[160:163], a[44:47], v[104:107]
    s_waitcnt lgkmcnt(4)
    v_mfma_f32_16x16x32_bf16 v[120:123], a[176:179], a[44:47], v[120:123]
    ds_read_b64_tr_b16 a[144:145], v14 offset:24576
    v_mfma_f32_16x16x32_bf16 v[120:123], a[180:183], a[60:63], v[120:123]
    ds_read_b64_tr_b16 a[146:147], v14 offset:26624
    v_mfma_f32_16x16x32_bf16 v[116:119], a[180:183], a[56:59], v[116:119]
    ds_read_b64_tr_b16 a[148:149], v14 offset:28672
    v_mfma_f32_16x16x32_bf16 v[116:119], a[176:179], a[40:43], v[116:119]
    ds_read_b64_tr_b16 a[150:151], v14 offset:30720
    v_mfma_f32_16x16x32_bf16 v[112:115], a[176:179], a[36:39], v[112:115]
    buffer_load_dwordx4 v10, s[16:19], s53 offen offset:1024 lds
    v_mfma_f32_16x16x32_bf16 v[112:115], a[180:183], a[52:55], v[112:115]
    v_mfma_f32_16x16x32_bf16 v[108:111], a[180:183], a[48:51], v[108:111]
    v_mfma_f32_16x16x32_bf16 v[108:111], a[176:179], a[32:35], v[108:111]
    s_waitcnt lgkmcnt(4)
    v_mfma_f32_16x16x32_bf16 v[124:127], a[128:131], a[32:35], v[124:127]
    ds_read_b64_tr_b16 a[160:161], v15 offset:16384
    v_mfma_f32_16x16x32_bf16 v[124:127], a[132:135], a[48:51], v[124:127]
    ds_read_b64_tr_b16 a[162:163], v15 offset:18432
    v_mfma_f32_16x16x32_bf16 v[128:131], a[132:135], a[52:55], v[128:131]
    ds_read_b64_tr_b16 a[164:165], v15 offset:20480
    v_mfma_f32_16x16x32_bf16 v[128:131], a[128:131], a[36:39], v[128:131]
    ds_read_b64_tr_b16 a[166:167], v15 offset:22528
    v_mfma_f32_16x16x32_bf16 v[132:135], a[128:131], a[40:43], v[132:135]
    buffer_load_dwordx4 a[112:115], v5, s[20:23], s51 offen offset:0 sc1
    v_mfma_f32_16x16x32_bf16 v[132:135], a[132:135], a[56:59], v[132:135]
    v_mfma_f32_16x16x32_bf16 v[136:139], a[132:135], a[60:63], v[136:139]
    v_mfma_f32_16x16x32_bf16 v[136:139], a[128:131], a[44:47], v[136:139]
    s_waitcnt lgkmcnt(4)
    v_mfma_f32_16x16x32_bf16 v[152:155], a[144:147], a[44:47], v[152:155]
    ds_read_b64_tr_b16 a[176:177], v15 offset:24576
    v_mfma_f32_16x16x32_bf16 v[152:155], a[148:151], a[60:63], v[152:155]
    ds_read_b64_tr_b16 a[178:179], v15 offset:26624
    v_mfma_f32_16x16x32_bf16 v[148:151], a[148:151], a[56:59], v[148:151]
    ds_read_b64_tr_b16 a[180:181], v15 offset:28672
    v_mfma_f32_16x16x32_bf16 v[148:151], a[144:147], a[40:43], v[148:151]
    ds_read_b64_tr_b16 a[182:183], v15 offset:30720
    v_mfma_f32_16x16x32_bf16 v[144:147], a[144:147], a[36:39], v[144:147]
    buffer_load_dwordx4 v11, s[16:19], s53 offen offset:2048 lds
    v_mfma_f32_16x16x32_bf16 v[144:147], a[148:151], a[52:55], v[144:147]
    v_mfma_f32_16x16x32_bf16 v[140:143], a[148:151], a[48:51], v[140:143]
    v_mfma_f32_16x16x32_bf16 v[140:143], a[144:147], a[32:35], v[140:143]
    s_waitcnt lgkmcnt(4)
    v_mfma_f32_16x16x32_bf16 v[156:159], a[160:163], a[32:35], v[156:159]
    ds_read_b64_tr_b16 a[128:129], v16 offset:16384
    v_mfma_f32_16x16x32_bf16 v[156:159], a[164:167], a[48:51], v[156:159]
    ds_read_b64_tr_b16 a[130:131], v16 offset:18432
    v_mfma_f32_16x16x32_bf16 v[160:163], a[164:167], a[52:55], v[160:163]
    ds_read_b64_tr_b16 a[132:133], v16 offset:20480
    v_mfma_f32_16x16x32_bf16 v[160:163], a[160:163], a[36:39], v[160:163]
    ds_read_b64_tr_b16 a[134:135], v16 offset:22528
    v_mfma_f32_16x16x32_bf16 v[164:167], a[160:163], a[40:43], v[164:167]
    buffer_load_dwordx4 a[116:119], v5, s[20:23], s51 offen offset:1024 sc1
    v_mfma_f32_16x16x32_bf16 v[164:167], a[164:167], a[56:59], v[164:167]
    v_mfma_f32_16x16x32_bf16 v[168:171], a[164:167], a[60:63], v[168:171]
    v_mfma_f32_16x16x32_bf16 v[168:171], a[160:163], a[44:47], v[168:171]
    s_waitcnt lgkmcnt(4)
    v_mfma_f32_16x16x32_bf16 v[184:187], a[176:179], a[44:47], v[184:187]
    ds_read_b64_tr_b16 a[144:145], v16 offset:24576
    v_mfma_f32_16x16x32_bf16 v[184:187], a[180:183], a[60:63], v[184:187]
    ds_read_b64_tr_b16 a[146:147], v16 offset:26624
    v_mfma_f32_16x16x32_bf16 v[180:183], a[180:183], a[56:59], v[180:183]
    ds_read_b64_tr_b16 a[148:149], v16 offset:28672
    v_mfma_f32_16x16x32_bf16 v[180:183], a[176:179], a[40:43], v[180:183]
    ds_read_b64_tr_b16 a[150:151], v16 offset:30720
    v_mfma_f32_16x16x32_bf16 v[176:179], a[176:179], a[36:39], v[176:179]
    buffer_load_dwordx4 v12, s[16:19], s53 offen offset:3072 lds
    v_mfma_f32_16x16x32_bf16 v[176:179], a[180:183], a[52:55], v[176:179]
    v_mfma_f32_16x16x32_bf16 v[172:175], a[180:183], a[48:51], v[172:175]
    v_mfma_f32_16x16x32_bf16 v[172:175], a[176:179], a[32:35], v[172:175]
    s_waitcnt lgkmcnt(4)
    v_mfma_f32_16x16x32_bf16 v[188:191], a[128:131], a[32:35], v[188:191]
    ds_read_b64_tr_b16 a[160:161], v17 offset:16384
    v_mfma_f32_16x16x32_bf16 v[188:191], a[132:135], a[48:51], v[188:191]
    ds_read_b64_tr_b16 a[162:163], v17 offset:18432
    v_mfma_f32_16x16x32_bf16 v[192:195], a[132:135], a[52:55], v[192:195]
    ds_read_b64_tr_b16 a[164:165], v17 offset:20480
    v_mfma_f32_16x16x32_bf16 v[192:195], a[128:131], a[36:39], v[192:195]
    ds_read_b64_tr_b16 a[166:167], v17 offset:22528
    v_mfma_f32_16x16x32_bf16 v[196:199], a[128:131], a[40:43], v[196:199]
    buffer_load_dwordx4 a[120:123], v5, s[20:23], s51 offen offset:2048 sc1
    v_mfma_f32_16x16x32_bf16 v[196:199], a[132:135], a[56:59], v[196:199]
    v_mfma_f32_16x16x32_bf16 v[200:203], a[132:135], a[60:63], v[200:203]
    v_mfma_f32_16x16x32_bf16 v[200:203], a[128:131], a[44:47], v[200:203]
    s_waitcnt lgkmcnt(4)
    v_mfma_f32_16x16x32_bf16 v[216:219], a[144:147], a[44:47], v[216:219]
    ds_read_b64_tr_b16 a[176:177], v17 offset:24576
    v_mfma_f32_16x16x32_bf16 v[216:219], a[148:151], a[60:63], v[216:219]
    ds_read_b64_tr_b16 a[178:179], v17 offset:26624
    v_mfma_f32_16x16x32_bf16 v[212:215], a[148:151], a[56:59], v[212:215]
    ds_read_b64_tr_b16 a[180:181], v17 offset:28672
    v_mfma_f32_16x16x32_bf16 v[212:215], a[144:147], a[40:43], v[212:215]
    ds_read_b64_tr_b16 a[182:183], v17 offset:30720
    buffer_load_dwordx4 a[124:127], v5, s[20:23], s51 offen offset:3072 sc1
    v_mfma_f32_16x16x32_bf16 v[208:211], a[144:147], a[36:39], v[208:211]
    v_mfma_f32_16x16x32_bf16 v[208:211], a[148:151], a[52:55], v[208:211]
    v_mfma_f32_16x16x32_bf16 v[204:207], a[148:151], a[48:51], v[204:207]
    v_mfma_f32_16x16x32_bf16 v[204:207], a[144:147], a[32:35], v[204:207]
    s_waitcnt lgkmcnt(4)
    v_mfma_f32_16x16x32_bf16 v[220:223], a[160:163], a[32:35], v[220:223]
    s_waitcnt vmcnt(15)
    s_sub_u32 s57, s57, 1
    s_cmp_lg_u32 s57, 0
    s_cbranch_scc1 L_pfd2
    buffer_load_dword a249, v253, s[32:35], 0 offen
L_pfd2:
    s_barrier
    ds_read_b64_tr_b16 a[128:129], v13 offset:32768
    v_mfma_f32_16x16x32_bf16 v[220:223], a[164:167], a[48:51], v[220:223]
    ds_read_b64_tr_b16 a[130:131], v13 offset:34304
    s_add_u32 m0, s40, 65536
    v_mfma_f32_16x16x32_bf16 v[224:227], a[164:167], a[52:55], v[224:227]
    ds_read_b64_tr_b16 a[132:133], v13 offset:36864
    v_mfma_f32_16x16x32_bf16 v[224:227], a[160:163], a[36:39], v[224:227]
    ds_read_b64_tr_b16 a[134:135], v13 offset:38400
    v_mfma_f32_16x16x32_bf16 v[228:231], a[160:163], a[40:43], v[228:231]
    buffer_load_dwordx4 v6, s[16:19], s52 offen offset:0 lds
    v_mfma_f32_16x16x32_bf16 v[228:231], a[164:167], a[56:59], v[228:231]
    v_readlane_b32 s51, v18, s46
    v_mfma_f32_16x16x32_bf16 v[232:235], a[164:167], a[60:63], v[232:235]
    v_mfma_f32_16x16x32_bf16 v[232:235], a[160:163], a[44:47], v[232:235]
    s_waitcnt lgkmcnt(4)
    v_mfma_f32_16x16x32_bf16 v[248:251], a[176:179], a[44:47], v[248:251]
    ds_read_b64_tr_b16 a[144:145], v13 offset:40960
    v_mfma_f32_16x16x32_bf16 v[248:251], a[180:183], a[60:63], v[248:251]
    ds_read_b64_tr_b16 a[146:147], v13 offset:42496
    v_mfma_f32_16x16x32_bf16 v[244:247], a[180:183], a[56:59], v[244:247]
    ds_read_b64_tr_b16 a[148:149], v13 offset:45056
    v_mfma_f32_16x16x32_bf16 v[244:247], a[176:179], a[40:43], v[244:247]
    ds_read_b64_tr_b16 a[150:151], v13 offset:46592
    v_mfma_f32_16x16x32_bf16 v[240:243], a[176:179], a[36:39], v[240:243]
    buffer_load_dwordx4 a[0:3], v4, s[20:23], s50 offen offset:0 sc1
    v_mfma_f32_16x16x32_bf16 v[240:243], a[180:183], a[52:55], v[240:243]
    v_readlane_b32 s53, v19, s46
    v_mfma_f32_16x16x32_bf16 v[236:239], a[180:183], a[48:51], v[236:239]
    v_mfma_f32_16x16x32_bf16 v[236:239], a[176:179], a[32:35], v[236:239]
    s_waitcnt lgkmcnt(4)
    v_mfma_f32_16x16x32_bf16 v[28:31], a[128:131], a[64:67], v[28:31]
    ds_read_b64_tr_b16 a[160:161], v13 offset:32800
    v_mfma_f32_16x16x32_bf16 v[28:31], a[132:135], a[80:83], v[28:31]
    ds_read_b64_tr_b16 a[162:163], v13 offset:34336
    v_mfma_f32_16x16x32_bf16 v[32:35], a[132:135], a[84:87], v[32:35]
    ds_read_b64_tr_b16 a[164:165], v13 offset:36896
    v_mfma_f32_16x16x32_bf16 v[32:35], a[128:131], a[68:71], v[32:35]
    ds_read_b64_tr_b16 a[166:167], v13 offset:38432
    buffer_load_dwordx4 v7, s[16:19], s52 offen offset:1024 lds
    v_mfma_f32_16x16x32_bf16 v[36:39], a[128:131], a[72:75], v[36:39]
    s_add_u32 s46, s46, 1
    v_mfma_f32_16x16x32_bf16 v[36:39], a[132:135], a[88:91], v[36:39]
    v_mfma_f32_16x16x32_bf16 v[40:43], a[132:135], a[92:95], v[40:43]
    v_mfma_f32_16x16x32_bf16 v[40:43], a[128:131], a[76:79], v[40:43]
    s_waitcnt lgkmcnt(4)
    v_mfma_f32_16x16x32_bf16 v[56:59], a[144:147], a[76:79], v[56:59]
    ds_read_b64_tr_b16 a[176:177], v13 offset:40992
    v_mfma_f32_16x16x32_bf16 v[56:59], a[148:151], a[92:95], v[56:59]
    ds_read_b64_tr_b16 a[178:179], v13 offset:42528
    v_mfma_f32_16x16x32_bf16 v[52:55], a[148:151], a[88:91], v[52:55]
    ds_read_b64_tr_b16 a[180:181], v13 offset:45088
    v_mfma_f32_16x16x32_bf16 v[52:55], a[144:147], a[72:75], v[52:55]
    ds_read_b64_tr_b16 a[182:183], v13 offset:46624
    buffer_load_dwordx4 a[4:7], v4, s[20:23], s50 offen offset:1024 sc1
    v_mfma_f32_16x16x32_bf16 v[48:51], a[144:147], a[68:71], v[48:51]
    v_mfma_f32_16x16x32_bf16 v[48:51], a[148:151], a[84:87], v[48:51]
    v_mfma_f32_16x16x32_bf16 v[44:47], a[148:151], a[80:83], v[44:47]
    buffer_load_dwordx4 v8, s[16:19], s52 offen offset:2048 lds
    v_mfma_f32_16x16x32_bf16 v[44:47], a[144:147], a[64:67], v[44:47]
    s_waitcnt lgkmcnt(4)
    v_mfma_f32_16x16x32_bf16 v[60:63], a[160:163], a[64:67], v[60:63]
    ds_read_b64_tr_b16 a[128:129], v13 offset:32832
    v_mfma_f32_16x16x32_bf16 v[60:63], a[164:167], a[80:83], v[60:63]
    ds_read_b64_tr_b16 a[130:131], v13 offset:34368
    v_mfma_f32_16x16x32_bf16 v[64:67], a[164:167], a[84:87], v[64:67]
    ds_read_b64_tr_b16 a[132:133], v13 offset:36928
    v_mfma_f32_16x16x32_bf16 v[64:67], a[160:163], a[68:71], v[64:67]
    ds_read_b64_tr_b16 a[134:135], v13 offset:38464
    v_mfma_f32_16x16x32_bf16 v[68:71], a[160:163], a[72:75], v[68:71]
    v_mfma_f32_16x16x32_bf16 v[68:71], a[164:167], a[88:91], v[68:71]
    buffer_load_dwordx4 a[8:11], v4, s[20:23], s50 offen offset:2048 sc1
    v_mfma_f32_16x16x32_bf16 v[72:75], a[164:167], a[92:95], v[72:75]
    v_mfma_f32_16x16x32_bf16 v[72:75], a[160:163], a[76:79], v[72:75]
    s_waitcnt lgkmcnt(4)
    v_mfma_f32_16x16x32_bf16 v[88:91], a[176:179], a[76:79], v[88:91]
    ds_read_b64_tr_b16 a[144:145], v13 offset:41024
    v_mfma_f32_16x16x32_bf16 v[88:91], a[180:183], a[92:95], v[88:91]
    ds_read_b64_tr_b16 a[146:147], v13 offset:42560
    v_mfma_f32_16x16x32_bf16 v[84:87], a[180:183], a[88:91], v[84:87]
    ds_read_b64_tr_b16 a[148:149], v13 offset:45120
    v_mfma_f32_16x16x32_bf16 v[84:87], a[176:179], a[72:75], v[84:87]
    ds_read_b64_tr_b16 a[150:151], v13 offset:46656
    v_mfma_f32_16x16x32_bf16 v[80:83], a[176:179], a[68:71], v[80:83]
    s_add_u32 m0, s40, 0
    v_mfma_f32_16x16x32_bf16 v[80:83], a[180:183], a[84:87], v[80:83]
    buffer_load_dwordx4 v9, s[16:19], s52 offen offset:0 lds
    v_mfma_f32_16x16x32_bf16 v[76:79], a[180:183], a[80:83], v[76:79]
    v_mfma_f32_16x16x32_bf16 v[76:79], a[176:179], a[64:67], v[76:79]
    s_waitcnt lgkmcnt(4)
    v_mfma_f32_16x16x32_bf16 v[92:95], a[128:131], a[64:67], v[92:95]
    ds_read_b64_tr_b16 a[160:161], v14 offset:32768
    v_mfma_f32_16x16x32_bf16 v[92:95], a[132:135], a[80:83], v[92:95]
    ds_read_b64_tr_b16 a[162:163], v14 offset:34816
    v_mfma_f32_16x16x32_bf16 v[96:99], a[132:135], a[84:87], v[96:99]
    ds_read_b64_tr_b16 a[164:165], v14 offset:36864
    v_mfma_f32_16x16x32_bf16 v[96:99], a[128:131], a[68:71], v[96:99]
    ds_read_b64_tr_b16 a[166:167], v14 offset:38912
    v_mfma_f32_16x16x32_bf16 v[100:103], a[128:131], a[72:75], v[100:103]
    buffer_load_dwordx4 a[12:15], v4, s[20:23], s50 offen offset:3072 sc1
    v_mfma_f32_16x16x32_bf16 v[100:103], a[132:135], a[88:91], v[100:103]
    v_mfma_f32_16x16x32_bf16 v[104:107], a[132:135], a[92:95], v[104:107]
    v_mfma_f32_16x16x32_bf16 v[104:107], a[128:131], a[76:79], v[104:107]
    s_waitcnt lgkmcnt(4)
    v_mfma_f32_16x16x32_bf16 v[120:123], a[144:147], a[76:79], v[120:123]
    ds_read_b64_tr_b16 a[176:177], v14 offset:40960
    v_mfma_f32_16x16x32_bf16 v[120:123], a[148:151], a[92:95], v[120:123]
    ds_read_b64_tr_b16 a[178:179], v14 offset:43008
    v_mfma_f32_16x16x32_bf16 v[116:119], a[148:151], a[88:91], v[116:119]
    ds_read_b64_tr_b16 a[180:181], v14 offset:45056
    v_mfma_f32_16x16x32_bf16 v[116:119], a[144:147], a[72:75], v[116:119]
    ds_read_b64_tr_b16 a[182:183], v14 offset:47104
    v_mfma_f32_16x16x32_bf16 v[112:115], a[144:147], a[68:71], v[112:115]
    buffer_load_dwordx4 v10, s[16:19], s52 offen offset:1024 lds
    v_mfma_f32_16x16x32_bf16 v[112:115], a[148:151], a[84:87], v[112:115]
    v_mfma_f32_16x16x32_bf16 v[108:111], a[148:151], a[80:83], v[108:111]
    v_mfma_f32_16x16x32_bf16 v[108:111], a[144:147], a[64:67], v[108:111]
    s_waitcnt lgkmcnt(4)
    v_mfma_f32_16x16x32_bf16 v[124:127], a[160:163], a[64:67], v[124:127]
    ds_read_b64_tr_b16 a[128:129], v15 offset:32768
    v_mfma_f32_16x16x32_bf16 v[124:127], a[164:167], a[80:83], v[124:127]
    ds_read_b64_tr_b16 a[130:131], v15 offset:34816
    v_mfma_f32_16x16x32_bf16 v[128:131], a[164:167], a[84:87], v[128:131]
    ds_read_b64_tr_b16 a[132:133], v15 offset:36864
    v_mfma_f32_16x16x32_bf16 v[128:131], a[160:163], a[68:71], v[128:131]
    ds_read_b64_tr_b16 a[134:135], v15 offset:38912
    v_mfma_f32_16x16x32_bf16 v[132:135], a[160:163], a[72:75], v[132:135]
    buffer_load_dwordx4 a[16:19], v5, s[20:23], s50 offen offset:0 sc1
    v_mfma_f32_16x16x32_bf16 v[132:135], a[164:167], a[88:91], v[132:135]
    v_mfma_f32_16x16x32_bf16 v[136:139], a[164:167], a[92:95], v[136:139]
    v_mfma_f32_16x16x32_bf16 v[136:139], a[160:163], a[76:79], v[136:139]
    s_waitcnt lgkmcnt(4)
    v_mfma_f32_16x16x32_bf16 v[152:155], a[176:179], a[76:79], v[152:155]
    ds_read_b64_tr_b16 a[144:145], v15 offset:40960
    v_mfma_f32_16x16x32_bf16 v[152:155], a[180:183], a[92:95], v[152:155]
    ds_read_b64_tr_b16 a[146:147], v15 offset:43008
    v_mfma_f32_16x16x32_bf16 v[148:151], a[180:183], a[88:91], v[148:151]
    ds_read_b64_tr_b16 a[148:149], v15 offset:45056
    v_mfma_f32_16x16x32_bf16 v[148:151], a[176:179], a[72:75], v[148:151]
    ds_read_b64_tr_b16 a[150:151], v15 offset:47104
    v_mfma_f32_16x16x32_bf16 v[144:147], a[176:179], a[68:71], v[144:147]
    buffer_load_dwordx4 v11, s[16:19], s52 offen offset:2048 lds
    v_mfma_f32_16x16x32_bf16 v[144:147], a[180:183], a[84:87], v[144:147]
    v_mfma_f32_16x16x32_bf16 v[140:143], a[180:183], a[80:83], v[140:143]
    v_mfma_f32_16x16x32_bf16 v[140:143], a[176:179], a[64:67], v[140:143]
    s_waitcnt lgkmcnt(4)
    v_mfma_f32_16x16x32_bf16 v[156:159], a[128:131], a[64:67], v[156:159]
    ds_read_b64_tr_b16 a[160:161], v16 offset:32768
    v_mfma_f32_16x16x32_bf16 v[156:159], a[132:135], a[80:83], v[156:159]
    ds_read_b64_tr_b16 a[162:163], v16 offset:34816
    v_mfma_f32_16x16x32_bf16 v[160:163], a[132:135], a[84:87], v[160:163]
    ds_read_b64_tr_b16 a[164:165], v16 offset:36864
    v_mfma_f32_16x16x32_bf16 v[160:163], a[128:131], a[68:71], v[160:163]
    ds_read_b64_tr_b16 a[166:167], v16 offset:38912
    v_mfma_f32_16x16x32_bf16 v[164:167], a[128:131], a[72:75], v[164:167]
    buffer_load_dwordx4 a[20:23], v5, s[20:23], s50 offen offset:1024 sc1
    v_mfma_f32_16x16x32_bf16 v[164:167], a[132:135], a[88:91], v[164:167]
    v_mfma_f32_16x16x32_bf16 v[168:171], a[132:135], a[92:95], v[168:171]
    v_mfma_f32_16x16x32_bf16 v[168:171], a[128:131], a[76:79], v[168:171]
    s_waitcnt lgkmcnt(4)
    v_mfma_f32_16x16x32_bf16 v[184:187], a[144:147], a[76:79], v[184:187]
    ds_read_b64_tr_b16 a[176:177], v16 offset:40960
    v_mfma_f32_16x16x32_bf16 v[184:187], a[148:151], a[92:95], v[184:187]
    ds_read_b64_tr_b16 a[178:179], v16 offset:43008
    v_mfma_f32_16x16x32_bf16 v[180:183], a[148:151], a[88:91], v[180:183]
    ds_read_b64_tr_b16 a[180:181], v16 offset:45056
    v_mfma_f32_16x16x32_bf16 v[180:183], a[144:147], a[72:75], v[180:183]
    ds_read_b64_tr_b16 a[182:183], v16 offset:47104
    v_mfma_f32_16x16x32_bf16 v[176:179], a[144:147], a[68:71], v[176:179]
    buffer_load_dwordx4 v12, s[16:19], s52 offen offset:3072 lds
    v_mfma_f32_16x16x32_bf16 v[176:179], a[148:151], a[84:87], v[176:179]
    v_mfma_f32_16x16x32_bf16 v[172:175], a[148:151], a[80:83], v[172:175]
    v_mfma_f32_16x16x32_bf16 v[172:175], a[144:147], a[64:67], v[172:175]
    s_waitcnt lgkmcnt(4)
    v_mfma_f32_16x16x32_bf16 v[188:191], a[160:163], a[64:67], v[188:191]
    ds_read_b64_tr_b16 a[128:129], v17 offset:32768
    v_mfma_f32_16x16x32_bf16 v[188:191], a[164:167], a[80:83], v[188:191]
    ds_read_b64_tr_b16 a[130:131], v17 offset:34816
    v_mfma_f32_16x16x32_bf16 v[192:195], a[164:167], a[84:87], v[192:195]
    ds_read_b64_tr_b16 a[132:133], v17 offset:36864
    v_mfma_f32_16x16x32_bf16 v[192:195], a[160:163], a[68:71], v[192:195]
    ds_read_b64_tr_b16 a[134:135], v17 offset:38912
    v_mfma_f32_16x16x32_bf16 v[196:199], a[160:163], a[72:75], v[196:199]
    buffer_load_dwordx4 a[24:27], v5, s[20:23], s50 offen offset:2048 sc1
    v_mfma_f32_16x16x32_bf16 v[196:199], a[164:167], a[88:91], v[196:199]
    v_mfma_f32_16x16x32_bf16 v[200:203], a[164:167], a[92:95], v[200:203]
    v_mfma_f32_16x16x32_bf16 v[200:203], a[160:163], a[76:79], v[200:203]
    s_waitcnt lgkmcnt(4)
    v_mfma_f32_16x16x32_bf16 v[216:219], a[176:179], a[76:79], v[216:219]
    ds_read_b64_tr_b16 a[144:145], v17 offset:40960
    v_mfma_f32_16x16x32_bf16 v[216:219], a[180:183], a[92:95], v[216:219]
    ds_read_b64_tr_b16 a[146:147], v17 offset:43008
    v_mfma_f32_16x16x32_bf16 v[212:215], a[180:183], a[88:91], v[212:215]
    ds_read_b64_tr_b16 a[148:149], v17 offset:45056
    v_mfma_f32_16x16x32_bf16 v[212:215], a[176:179], a[72:75], v[212:215]
    ds_read_b64_tr_b16 a[150:151], v17 offset:47104
    buffer_load_dwordx4 a[28:31], v5, s[20:23], s50 offen offset:3072 sc1
    v_mfma_f32_16x16x32_bf16 v[208:211], a[176:179], a[68:71], v[208:211]
    v_mfma_f32_16x16x32_bf16 v[208:211], a[180:183], a[84:87], v[208:211]
    v_mfma_f32_16x16x32_bf16 v[204:207], a[180:183], a[80:83], v[204:207]
    v_mfma_f32_16x16x32_bf16 v[204:207], a[176:179], a[64:67], v[204:207]
    s_waitcnt lgkmcnt(4)
    v_mfma_f32_16x16x32_bf16 v[220:223], a[128:131], a[64:67], v[220:223]
    s_waitcnt vmcnt(15)
    s_sub_u32 s57, s57, 1
    s_cmp_lg_u32 s57, 0
    s_cbranch_scc1 L_pfd3
    buffer_load_dword a249, v253, s[32:35], 0 offen
L_pfd3:
    s_barrier
    ds_read_b64_tr_b16 a[160:161], v13 offset:49152
    v_mfma_f32_16x16x32_bf16 v[220:223], a[132:135], a[80:83], v[220:223]
    ds_read_b64_tr_b16 a[162:163], v13 offset:50688
    s_add_u32 m0, s40, 81920
    v_mfma_f32_16x16x32_bf16 v[224:227], a[132:135], a[84:87], v[224:227]
    ds_read_b64_tr_b16 a[164:165], v13 offset:53248
    v_mfma_f32_16x16x32_bf16 v[224:227], a[128:131], a[68:71], v[224:227]
    ds_read_b64_tr_b16 a[166:167], v13 offset:54784
    v_mfma_f32_16x16x32_bf16 v[228:231], a[128:131], a[72:75], v[228:231]
    buffer_load_dwordx4 v6, s[16:19], s53 offen offset:0 lds
    v_mfma_f32_16x16x32_bf16 v[228:231], a[132:135], a[88:91], v[228:231]
    v_readlane_b32 s50, v18, s46
    v_mfma_f32_16x16x32_bf16 v[232:235], a[132:135], a[92:95], v[232:235]
    v_mfma_f32_16x16x32_bf16 v[232:235], a[128:131], a[76:79], v[232:235]
    s_waitcnt lgkmcnt(4)
    v_mfma_f32_16x16x32_bf16 v[248:251], a[144:147], a[76:79], v[248:251]
    ds_read_b64_tr_b16 a[176:177], v13 offset:57344
    v_mfma_f32_16x16x32_bf16 v[248:251], a[148:151], a[92:95], v[248:251]
    ds_read_b64_tr_b16 a[178:179], v13 offset:58880
    v_mfma_f32_16x16x32_bf16 v[244:247], a[148:151], a[88:91], v[244:247]
    ds_read_b64_tr_b16 a[180:181], v13 offset:61440
    v_mfma_f32_16x16x32_bf16 v[244:247], a[144:147], a[72:75], v[244:247]
    ds_read_b64_tr_b16 a[182:183], v13 offset:62976
    v_mfma_f32_16x16x32_bf16 v[240:243], a[144:147], a[68:71], v[240:243]
    buffer_load_dwordx4 a[32:35], v4, s[20:23], s51 offen offset:0 sc1
    v_mfma_f32_16x16x32_bf16 v[240:243], a[148:151], a[84:87], v[240:243]
    v_readlane_b32 s52, v19, s46
    v_mfma_f32_16x16x32_bf16 v[236:239], a[148:151], a[80:83], v[236:239]
    v_mfma_f32_16x16x32_bf16 v[236:239], a[144:147], a[64:67], v[236:239]
    s_sub_u32 s41, s41, 1
    s_cmp_lg_u32 s41, 0
    s_cbranch_scc1 L_pf_loop
    s_getpc_b64 s[72:73]
L_cp4:
    s_lshr_b32 s74, s2, 3
    s_lshl2_add_u32 s74, s74, s3
    s_lshl_b32 s74, s74, 7
    s_add_u32 s74, s74, 4096
    s_min_u32 s74, s74, L_end-L_cp4
    s_add_u32 s72, s72, s74
    s_addc_u32 s73, s73, 0
    v_and_b32 v254, 0, v0
    v_lshlrev_b32 v254, 7, v254
    v_mov_b32 v255, s73
    v_add_co_u32 v254, vcc, s72, v254
    s_nop 1
    v_addc_co_u32 v255, vcc, 0, v255, vcc
    global_load_dword a251, v[254:255], off
    s_waitcnt lgkmcnt(4)
    v_mfma_f32_16x16x32_bf16 v[28:31], a[160:163], a[96:99], v[28:31]
    ds_read_b64_tr_b16 a[128:129], v13 offset:49184
    v_accvgpr_read_b32 v20, a192
    v_mfma_f32_16x16x32_bf16 v[28:31], a[164:167], a[112:115], v[28:31]
    ds_read_b64_tr_b16 a[130:131], v13 offset:50720
    v_accvgpr_read_b32 v21, a194
    v_mfma_f32_16x16x32_bf16 v[32:35], a[164:167], a[116:119], v[32:35]
    ds_read_b64_tr_b16 a[132:133], v13 offset:53280
    v_accvgpr_read_b32 v2, a196
    v_mfma_f32_16x16x32_bf16 v[32:35], a[160:163], a[100:103], v[32:35]
    ds_read_b64_tr_b16 a[134:135], v13 offset:54816
    buffer_load_dwordx4 v7, s[16:19], s53 offen offset:1024 lds
    v_mfma_f32_16x16x32_bf16 v[36:39], a[160:163], a[104:107], v[36:39]
    s_add_u32 s46, s46, 1
    v_mfma_f32_16x16x32_bf16 v[36:39], a[164:167], a[120:123], v[36:39]
    v_accvgpr_read_b32 v3, a198
    v_add_f32 v20, v20, v21
    v_mfma_f32_16x16x32_bf16 v[40:43], a[164:167], a[124:127], v[40:43]
    v_add_f32 v2, v2, v3
    v_add_f32 v20, v20, v2
    v_mfma_f32_16x16x32_bf16 v[40:43], a[160:163], a[108:111], v[40:43]
    v_accvgpr_read_b32 v22, a193
    s_waitcnt lgkmcnt(4)
    v_mfma_f32_16x16x32_bf16 v[56:59], a[176:179], a[108:111], v[56:59]
    ds_read_b64_tr_b16 a[144:145], v13 offset:57376
    v_accvgpr_read_b32 v23, a195
    v_mfma_f32_16x16x32_bf16 v[56:59], a[180:183], a[124:127], v[56:59]
    ds_read_b64_tr_b16 a[146:147], v13 offset:58912
    v_accvgpr_read_b32 v2, a197
    v_mfma_f32_16x16x32_bf16 v[52:55], a[180:183], a[120:123], v[52:55]
    ds_read_b64_tr_b16 a[148:149], v13 offset:61472
    v_accvgpr_read_b32 v3, a199
    v_mfma_f32_16x16x32_bf16 v[52:55], a[176:179], a[104:107], v[52:55]
    ds_read_b64_tr_b16 a[150:151], v13 offset:63008
    buffer_load_dwordx4 a[36:39], v4, s[20:23], s51 offen offset:1024 sc1
    v_mfma_f32_16x16x32_bf16 v[48:51], a[176:179], a[100:103], v[48:51]
    v_add_f32 v22, v22, v23
    v_mfma_f32_16x16x32_bf16 v[48:51], a[180:183], a[116:119], v[48:51]
    v_add_f32 v2, v2, v3
    v_add_f32 v22, v22, v2
    v_mfma_f32_16x16x32_bf16 v[44:47], a[180:183], a[112:115], v[44:47]
    buffer_load_dwordx4 v8, s[16:19], s53 offen offset:2048 lds
    v_mfma_f32_16x16x32_bf16 v[44:47], a[176:179], a[96:99], v[44:47]
    v_accvgpr_read_b32 v24, a200
    s_waitcnt lgkmcnt(4)
    v_mfma_f32_16x16x32_bf16 v[60:63], a[128:131], a[96:99], v[60:63]
    ds_read_b64_tr_b16 a[160:161], v13 offset:49216
    v_accvgpr_read_b32 v25, a202
    v_mfma_f32_16x16x32_bf16 v[60:63], a[132:135], a[112:115], v[60:63]
    ds_read_b64_tr_b16 a[162:163], v13 offset:50752
    v_accvgpr_read_b32 v2, a204
    v_mfma_f32_16x16x32_bf16 v[64:67], a[132:135], a[116:119], v[64:67]
    ds_read_b64_tr_b16 a[164:165], v13 offset:53312
    v_accvgpr_read_b32 v3, a206
    v_mfma_f32_16x16x32_bf16 v[64:67], a[128:131], a[100:103], v[64:67]
    ds_read_b64_tr_b16 a[166:167], v13 offset:54848
    v_add_f32 v24, v24, v25
    v_mfma_f32_16x16x32_bf16 v[68:71], a[128:131], a[104:107], v[68:71]
    v_add_f32 v2, v2, v3
    v_add_f32 v24, v24, v2
    v_mfma_f32_16x16x32_bf16 v[68:71], a[132:135], a[120:123], v[68:71]
    buffer_load_dwordx4 a[40:43], v4, s[20:23], s51 offen offset:2048 sc1
    v_mfma_f32_16x16x32_bf16 v[72:75], a[132:135], a[124:127], v[72:75]
    v_accvgpr_read_b32 v26, a201
    v_accvgpr_read_b32 v27, a203
    v_mfma_f32_16x16x32_bf16 v[72:75], a[128:131], a[108:111], v[72:75]
    v_accvgpr_read_b32 v2, a205
    s_waitcnt lgkmcnt(4)
    v_mfma_f32_16x16x32_bf16 v[88:91], a[144:147], a[108:111], v[88:91]
    ds_read_b64_tr_b16 a[176:177], v13 offset:57408
    v_accvgpr_read_b32 v3, a207
    v_mfma_f32_16x16x32_bf16 v[88:91], a[148:151], a[124:127], v[88:91]
    ds_read_b64_tr_b16 a[178:179], v13 offset:58944
    v_add_f32 v26, v26, v27
    v_mfma_f32_16x16x32_bf16 v[84:87], a[148:151], a[120:123], v[84:87]
    ds_read_b64_tr_b16 a[180:181], v13 offset:61504
    v_add_f32 v2, v2, v3
    v_mfma_f32_16x16x32_bf16 v[84:87], a[144:147], a[104:107], v[84:87]
    ds_read_b64_tr_b16 a[182:183], v13 offset:63040
    v_add_f32 v26, v26, v2
    v_mfma_f32_16x16x32_bf16 v[80:83], a[144:147], a[100:103], v[80:83]
    s_add_u32 m0, s40, 16384
    v_mov_b32 v21, v20
    v_mfma_f32_16x16x32_bf16 v[80:83], a[148:151], a[116:119], v[80:83]
    buffer_load_dwordx4 v9, s[16:19], s53 offen offset:0 lds
    v_mfma_f32_16x16x32_bf16 v[76:79], a[148:151], a[112:115], v[76:79]
    v_mov_b32 v23, v22
    v_mov_b32 v25, v24
    v_mfma_f32_16x16x32_bf16 v[76:79], a[144:147], a[96:99], v[76:79]
    v_mov_b32 v27, v26
    s_waitcnt lgkmcnt(4)
    v_mfma_f32_16x16x32_bf16 v[92:95], a[160:163], a[96:99], v[92:95]
    ds_read_b64_tr_b16 a[128:129], v14 offset:49152
    v_permlane32_swap_b32 v20, v21
    v_mfma_f32_16x16x32_bf16 v[92:95], a[164:167], a[112:115], v[92:95]
    ds_read_b64_tr_b16 a[130:131], v14 offset:51200
    v_permlane32_swap_b32 v22, v23
    v_mfma_f32_16x16x32_bf16 v[96:99], a[164:167], a[116:119], v[96:99]
    ds_read_b64_tr_b16 a[132:133], v14 offset:53248
    v_permlane32_swap_b32 v24, v25
    v_mfma_f32_16x16x32_bf16 v[96:99], a[160:163], a[100:103], v[96:99]
    ds_read_b64_tr_b16 a[134:135], v14 offset:55296
    v_permlane32_swap_b32 v26, v27
    v_mfma_f32_16x16x32_bf16 v[100:103], a[160:163], a[104:107], v[100:103]
    buffer_load_dwordx4 a[44:47], v4, s[20:23], s51 offen offset:3072 sc1
    v_mfma_f32_16x16x32_bf16 v[100:103], a[164:167], a[120:123], v[100:103]
    v_add_f32 v20, v20, v21
    v_add_f32 v22, v22, v23
    v_mfma_f32_16x16x32_bf16 v[104:107], a[164:167], a[124:127], v[104:107]
    v_add_f32 v24, v24, v25
    v_add_f32 v26, v26, v27
    v_mfma_f32_16x16x32_bf16 v[104:107], a[160:163], a[108:111], v[104:107]
    v_mov_b32 v21, v20
    s_waitcnt lgkmcnt(4)
    v_mfma_f32_16x16x32_bf16 v[120:123], a[176:179], a[108:111], v[120:123]
    ds_read_b64_tr_b16 a[144:145], v14 offset:57344
    v_mov_b32 v23, v22
    v_mfma_f32_16x16x32_bf16 v[120:123], a[180:183], a[124:127], v[120:123]
    ds_read_b64_tr_b16 a[146:147], v14 offset:59392
    v_mov_b32 v25, v24
    v_mfma_f32_16x16x32_bf16 v[116:119], a[180:183], a[120:123], v[116:119]
    ds_read_b64_tr_b16 a[148:149], v14 offset:61440
    v_mov_b32 v27, v26
    v_mfma_f32_16x16x32_bf16 v[116:119], a[176:179], a[104:107], v[116:119]
    ds_read_b64_tr_b16 a[150:151], v14 offset:63488
    v_permlane16_swap_b32 v20, v21
    v_mfma_f32_16x16x32_bf16 v[112:115], a[176:179], a[100:103], v[112:115]
    buffer_load_dwordx4 v10, s[16:19], s53 offen offset:1024 lds
    v_mfma_f32_16x16x32_bf16 v[112:115], a[180:183], a[116:119], v[112:115]
    v_permlane16_swap_b32 v22, v23
    v_permlane16_swap_b32 v24, v25
    v_mfma_f32_16x16x32_bf16 v[108:111], a[180:183], a[112:115], v[108:111]
    v_permlane16_swap_b32 v26, v27
    v_add_f32 v20, v20, v21
    v_mfma_f32_16x16x32_bf16 v[108:111], a[176:179], a[96:99], v[108:111]
    v_add_f32 v22, v22, v23
    s_waitcnt lgkmcnt(4)
    v_mfma_f32_16x16x32_bf16 v[124:127], a[128:131], a[96:99], v[124:127]
    ds_read_b64_tr_b16 a[160:161], v15 offset:49152
    v_add_f32 v24, v24, v25
    v_mfma_f32_16x16x32_bf16 v[124:127], a[132:135], a[112:115], v[124:127]
    ds_read_b64_tr_b16 a[162:163], v15 offset:51200
    v_add_f32 v26, v26, v27
    v_mfma_f32_16x16x32_bf16 v[128:131], a[132:135], a[116:119], v[128:131]
    ds_read_b64_tr_b16 a[164:165], v15 offset:53248
    v_mul_f32 v20, 0x3a800000, v20
    v_mfma_f32_16x16x32_bf16 v[128:131], a[128:131], a[100:103], v[128:131]
    ds_read_b64_tr_b16 a[166:167], v15 offset:55296
    v_mul_f32 v22, 0x3a800000, v22
    v_mfma_f32_16x16x32_bf16 v[132:135], a[128:131], a[104:107], v[132:135]
    buffer_load_dwordx4 a[48:51], v5, s[20:23], s51 offen offset:0 sc1
    v_mfma_f32_16x16x32_bf16 v[132:135], a[132:135], a[120:123], v[132:135]
    v_mul_f32 v24, 0x3a800000, v24
    v_mul_f32 v26, 0x3a800000, v26
    v_mfma_f32_16x16x32_bf16 v[136:139], a[132:135], a[124:127], v[136:139]
    v_add_f32 v20, 0x3727c5ac, v20
    v_add_f32 v22, 0x3727c5ac, v22
    v_mfma_f32_16x16x32_bf16 v[136:139], a[128:131], a[108:111], v[136:139]
    v_add_f32 v24, 0x3727c5ac, v24
    s_waitcnt lgkmcnt(4)
    v_mfma_f32_16x16x32_bf16 v[152:155], a[144:147], a[108:111], v[152:155]
    ds_read_b64_tr_b16 a[176:177], v15 offset:57344
    v_add_f32 v26, 0x3727c5ac, v26
    v_mfma_f32_16x16x32_bf16 v[152:155], a[148:151], a[124:127], v[152:155]
    ds_read_b64_tr_b16 a[178:179], v15 offset:59392
    v_sqrt_f32 v21, v20
    v_mfma_f32_16x16x32_bf16 v[148:151], a[148:151], a[120:123], v[148:151]
    ds_read_b64_tr_b16 a[180:181], v15 offset:61440
    v_mfma_f32_16x16x32_bf16 v[148:151], a[144:147], a[104:107], v[148:151]
    ds_read_b64_tr_b16 a[182:183], v15 offset:63488
    v_rsq_f32 v20, v20
    v_mfma_f32_16x16x32_bf16 v[144:147], a[144:147], a[100:103], v[144:147]
    v_sqrt_f32 v23, v22
    v_mfma_f32_16x16x32_bf16 v[144:147], a[148:151], a[116:119], v[144:147]
    v_rsq_f32 v22, v22
    v_mfma_f32_16x16x32_bf16 v[140:143], a[148:151], a[112:115], v[140:143]
    buffer_load_dwordx4 v11, s[16:19], s53 offen offset:2048 lds
    v_mfma_f32_16x16x32_bf16 v[140:143], a[144:147], a[96:99], v[140:143]
    s_waitcnt lgkmcnt(4)
    v_mfma_f32_16x16x32_bf16 v[156:159], a[160:163], a[96:99], v[156:159]
    ds_read_b64_tr_b16 a[128:129], v16 offset:49152
    v_sqrt_f32 v25, v24
    v_mfma_f32_16x16x32_bf16 v[156:159], a[164:167], a[112:115], v[156:159]
    ds_read_b64_tr_b16 a[130:131], v16 offset:51200
    v_mfma_f32_16x16x32_bf16 v[160:163], a[164:167], a[116:119], v[160:163]
    ds_read_b64_tr_b16 a[132:133], v16 offset:53248
    v_rsq_f32 v24, v24
    v_mfma_f32_16x16x32_bf16 v[160:163], a[160:163], a[100:103], v[160:163]
    ds_read_b64_tr_b16 a[134:135], v16 offset:55296
    v_mfma_f32_16x16x32_bf16 v[164:167], a[160:163], a[104:107], v[164:167]
    buffer_load_dwordx4 a[52:55], v5, s[20:23], s51 offen offset:1024 sc1
    v_mfma_f32_16x16x32_bf16 v[164:167], a[164:167], a[120:123], v[164:167]
    v_sqrt_f32 v27, v26
    v_mfma_f32_16x16x32_bf16 v[168:171], a[164:167], a[124:127], v[168:171]
    v_rsq_f32 v26, v26
    v_mfma_f32_16x16x32_bf16 v[168:171], a[160:163], a[108:111], v[168:171]
    v_mul_f32 v20, 0xbfb8aa3b, v20
    s_waitcnt lgkmcnt(4)
    v_mfma_f32_16x16x32_bf16 v[184:187], a[176:179], a[108:111], v[184:187]
    ds_read_b64_tr_b16 a[144:145], v16 offset:57344
    v_mul_f32 v22, 0xbfb8aa3b, v22
    v_mfma_f32_16x16x32_bf16 v[184:187], a[180:183], a[124:127], v[184:187]
    ds_read_b64_tr_b16 a[146:147], v16 offset:59392
    v_mul_f32 v24, 0xbfb8aa3b, v24
    v_mfma_f32_16x16x32_bf16 v[180:183], a[180:183], a[120:123], v[180:183]
    ds_read_b64_tr_b16 a[148:149], v16 offset:61440
    v_mul_f32 v26, 0xbfb8aa3b, v26
    v_mfma_f32_16x16x32_bf16 v[180:183], a[176:179], a[104:107], v[180:183]
    ds_read_b64_tr_b16 a[150:151], v16 offset:63488
    v_mfma_f32_16x16x32_bf16 v[176:179], a[176:179], a[100:103], v[176:179]
    buffer_load_dwordx4 v12, s[16:19], s53 offen offset:3072 lds
    v_mfma_f32_16x16x32_bf16 v[176:179], a[180:183], a[116:119], v[176:179]
    v_mfma_f32_16x16x32_bf16 v[172:175], a[180:183], a[112:115], v[172:175]
    v_mfma_f32_16x16x32_bf16 v[172:175], a[176:179], a[96:99], v[172:175]
    s_waitcnt lgkmcnt(4)
    v_mfma_f32_16x16x32_bf16 v[188:191], a[128:131], a[96:99], v[188:191]
    ds_read_b64_tr_b16 a[160:161], v17 offset:49152
    v_mfma_f32_16x16x32_bf16 v[188:191], a[132:135], a[112:115], v[188:191]
    ds_read_b64_tr_b16 a[162:163], v17 offset:51200
    v_mfma_f32_16x16x32_bf16 v[192:195], a[132:135], a[116:119], v[192:195]
    ds_read_b64_tr_b16 a[164:165], v17 offset:53248
    v_mfma_f32_16x16x32_bf16 v[192:195], a[128:131], a[100:103], v[192:195]
    ds_read_b64_tr_b16 a[166:167], v17 offset:55296
    v_mfma_f32_16x16x32_bf16 v[196:199], a[128:131], a[104:107], v[196:199]
    buffer_load_dwordx4 a[56:59], v5, s[20:23], s51 offen offset:2048 sc1
    v_mfma_f32_16x16x32_bf16 v[196:199], a[132:135], a[120:123], v[196:199]
    v_mfma_f32_16x16x32_bf16 v[200:203], a[132:135], a[124:127], v[200:203]
    v_mfma_f32_16x16x32_bf16 v[200:203], a[128:131], a[108:111], v[200:203]
    s_waitcnt lgkmcnt(4)
    v_mfma_f32_16x16x32_bf16 v[216:219], a[144:147], a[108:111], v[216:219]
    ds_read_b64_tr_b16 a[176:177], v17 offset:57344
    v_mfma_f32_16x16x32_bf16 v[216:219], a[148:151], a[124:127], v[216:219]
    ds_read_b64_tr_b16 a[178:179], v17 offset:59392
    v_mfma_f32_16x16x32_bf16 v[212:215], a[148:151], a[120:123], v[212:215]
    ds_read_b64_tr_b16 a[180:181], v17 offset:61440
    v_mfma_f32_16x16x32_bf16 v[212:215], a[144:147], a[104:107], v[212:215]
    ds_read_b64_tr_b16 a[182:183], v17 offset:63488
    buffer_load_dwordx4 a[60:63], v5, s[20:23], s51 offen offset:3072 sc1
    v_mfma_f32_16x16x32_bf16 v[208:211], a[144:147], a[100:103], v[208:211]
    v_mfma_f32_16x16x32_bf16 v[208:211], a[148:151], a[116:119], v[208:211]
    v_mfma_f32_16x16x32_bf16 v[204:207], a[148:151], a[112:115], v[204:207]
    v_mfma_f32_16x16x32_bf16 v[204:207], a[144:147], a[96:99], v[204:207]
    s_waitcnt lgkmcnt(4)
    v_mfma_f32_16x16x32_bf16 v[220:223], a[160:163], a[96:99], v[220:223]
    s_waitcnt vmcnt(16)
    s_barrier
    ds_read_b64_tr_b16 a[128:129], v14 offset:0
    v_mfma_f32_16x16x32_bf16 v[220:223], a[164:167], a[112:115], v[220:223]
    ds_read_b64_tr_b16 a[130:131], v14 offset:2048
    s_add_u32 m0, s40, 98304
    v_mfma_f32_16x16x32_bf16 v[224:227], a[164:167], a[116:119], v[224:227]
    ds_read_b64_tr_b16 a[132:133], v14 offset:4096
    v_mfma_f32_16x16x32_bf16 v[224:227], a[160:163], a[100:103], v[224:227]
    ds_read_b64_tr_b16 a[134:135], v14 offset:6144
    v_mfma_f32_16x16x32_bf16 v[228:231], a[160:163], a[104:107], v[228:231]
    buffer_load_dwordx4 v6, s[16:19], s52 offen offset:0 lds
    v_mfma_f32_16x16x32_bf16 v[228:231], a[164:167], a[120:123], v[228:231]
    v_readlane_b32 s51, v18, s46
    v_mfma_f32_16x16x32_bf16 v[232:235], a[164:167], a[124:127], v[232:235]
    buffer_load_dwordx4 a[64:67], v4, s[20:23], s50 offen offset:0 sc1
    v_mfma_f32_16x16x32_bf16 v[232:235], a[160:163], a[108:111], v[232:235]
    v_readlane_b32 s53, v19, s46
    s_waitcnt lgkmcnt(4)
    v_mfma_f32_16x16x32_bf16 v[248:251], a[176:179], a[108:111], v[248:251]
    ds_read_b64_tr_b16 a[144:145], v14 offset:8192
    v_mfma_f32_16x16x32_bf16 v[248:251], a[180:183], a[124:127], v[248:251]
    ds_read_b64_tr_b16 a[146:147], v14 offset:10240
    v_mfma_f32_16x16x32_bf16 v[244:247], a[180:183], a[120:123], v[244:247]
    ds_read_b64_tr_b16 a[148:149], v14 offset:12288
    v_mfma_f32_16x16x32_bf16 v[244:247], a[176:179], a[104:107], v[244:247]
    ds_read_b64_tr_b16 a[150:151], v14 offset:14336
    v_mfma_f32_16x16x32_bf16 v[240:243], a[176:179], a[100:103], v[240:243]
    buffer_load_dwordx4 v7, s[16:19], s52 offen offset:1024 lds
    v_mfma_f32_16x16x32_bf16 v[240:243], a[180:183], a[116:119], v[240:243]
    s_add_u32 s46, s46, 1
    v_mfma_f32_16x16x32_bf16 v[236:239], a[180:183], a[112:115], v[236:239]
    buffer_load_dwordx4 a[68:71], v4, s[20:23], s50 offen offset:1024 sc1
    v_mfma_f32_16x16x32_bf16 v[236:239], a[176:179], a[96:99], v[236:239]
    s_waitcnt lgkmcnt(4)
    v_mfma_f32_16x16x32_bf16 v[124:127], a[128:131], a[0:3], v[124:127]
    ds_read_b64_tr_b16 a[160:161], v15 offset:0
    v_mfma_f32_16x16x32_bf16 v[124:127], a[132:135], a[16:19], v[124:127]
    ds_read_b64_tr_b16 a[162:163], v15 offset:2048
    v_mfma_f32_16x16x32_bf16 v[128:131], a[132:135], a[20:23], v[128:131]
    ds_read_b64_tr_b16 a[164:165], v15 offset:4096
    v_mfma_f32_16x16x32_bf16 v[128:131], a[128:131], a[4:7], v[128:131]
    ds_read_b64_tr_b16 a[166:167], v15 offset:6144
    v_mfma_f32_16x16x32_bf16 v[132:135], a[128:131], a[8:11], v[132:135]
    buffer_load_dwordx4 v8, s[16:19], s52 offen offset:2048 lds
    v_mfma_f32_16x16x32_bf16 v[132:135], a[132:135], a[24:27], v[132:135]
    buffer_load_dwordx4 a[72:75], v4, s[20:23], s50 offen offset:2048 sc1
    v_mfma_f32_16x16x32_bf16 v[136:139], a[132:135], a[28:31], v[136:139]
    v_mfma_f32_16x16x32_bf16 v[136:139], a[128:131], a[12:15], v[136:139]
    s_waitcnt lgkmcnt(4)
    v_mfma_f32_16x16x32_bf16 v[152:155], a[144:147], a[12:15], v[152:155]
    ds_read_b64_tr_b16 a[176:177], v15 offset:8192
    s_add_u32 m0, s40, 32768
    v_mfma_f32_16x16x32_bf16 v[152:155], a[148:151], a[28:31], v[152:155]
    ds_read_b64_tr_b16 a[178:179], v15 offset:10240
    v_mfma_f32_16x16x32_bf16 v[148:151], a[148:151], a[24:27], v[148:151]
    ds_read_b64_tr_b16 a[180:181], v15 offset:12288
    v_mfma_f32_16x16x32_bf16 v[148:151], a[144:147], a[8:11], v[148:151]
    ds_read_b64_tr_b16 a[182:183], v15 offset:14336
    v_mfma_f32_16x16x32_bf16 v[144:147], a[144:147], a[4:7], v[144:147]
    buffer_load_dwordx4 v9, s[16:19], s52 offen offset:0 lds
    v_mfma_f32_16x16x32_bf16 v[144:147], a[148:151], a[20:23], v[144:147]
    buffer_load_dwordx4 a[76:79], v4, s[20:23], s50 offen offset:3072 sc1
    v_mfma_f32_16x16x32_bf16 v[140:143], a[148:151], a[16:19], v[140:143]
    v_mfma_f32_16x16x32_bf16 v[140:143], a[144:147], a[0:3], v[140:143]
    s_waitcnt lgkmcnt(4)
    v_mfma_f32_16x16x32_bf16 v[156:159], a[160:163], a[0:3], v[156:159]
    ds_read_b64_tr_b16 a[128:129], v16 offset:0
    v_mfma_f32_16x16x32_bf16 v[156:159], a[164:167], a[16:19], v[156:159]
    ds_read_b64_tr_b16 a[130:131], v16 offset:2048
    v_mfma_f32_16x16x32_bf16 v[160:163], a[164:167], a[20:23], v[160:163]
    ds_read_b64_tr_b16 a[132:133], v16 offset:4096
    v_mfma_f32_16x16x32_bf16 v[160:163], a[160:163], a[4:7], v[160:163]
    ds_read_b64_tr_b16 a[134:135], v16 offset:6144
    v_mfma_f32_16x16x32_bf16 v[164:167], a[160:163], a[8:11], v[164:167]
    buffer_load_dwordx4 v10, s[16:19], s52 offen offset:1024 lds
    v_mfma_f32_16x16x32_bf16 v[164:167], a[164:167], a[24:27], v[164:167]
    v_mfma_f32_16x16x32_bf16 v[168:171], a[164:167], a[28:31], v[168:171]
    buffer_load_dwordx4 a[80:83], v5, s[20:23], s50 offen offset:0 sc1
    v_mfma_f32_16x16x32_bf16 v[168:171], a[160:163], a[12:15], v[168:171]
    s_waitcnt lgkmcnt(4)
    v_mfma_f32_16x16x32_bf16 v[184:187], a[176:179], a[12:15], v[184:187]
    ds_read_b64_tr_b16 a[144:145], v16 offset:8192
    v_mfma_f32_16x16x32_bf16 v[184:187], a[180:183], a[28:31], v[184:187]
    ds_read_b64_tr_b16 a[146:147], v16 offset:10240
    v_mfma_f32_16x16x32_bf16 v[180:183], a[180:183], a[24:27], v[180:183]
    ds_read_b64_tr_b16 a[148:149], v16 offset:12288
    v_mfma_f32_16x16x32_bf16 v[180:183], a[176:179], a[8:11], v[180:183]
    ds_read_b64_tr_b16 a[150:151], v16 offset:14336
    v_mfma_f32_16x16x32_bf16 v[176:179], a[176:179], a[4:7], v[176:179]
    buffer_load_dwordx4 v11, s[16:19], s52 offen offset:2048 lds
    v_mfma_f32_16x16x32_bf16 v[176:179], a[180:183], a[20:23], v[176:179]
    v_mfma_f32_16x16x32_bf16 v[172:175], a[180:183], a[16:19], v[172:175]
    buffer_load_dwordx4 a[84:87], v5, s[20:23], s50 offen offset:1024 sc1
    v_mfma_f32_16x16x32_bf16 v[172:175], a[176:179], a[0:3], v[172:175]
    s_waitcnt lgkmcnt(4)
    v_mfma_f32_16x16x32_bf16 v[188:191], a[128:131], a[0:3], v[188:191]
    ds_read_b64_tr_b16 a[160:161], v17 offset:0
    v_mfma_f32_16x16x32_bf16 v[188:191], a[132:135], a[16:19], v[188:191]
    ds_read_b64_tr_b16 a[162:163], v17 offset:2048
    v_mfma_f32_16x16x32_bf16 v[192:195], a[132:135], a[20:23], v[192:195]
    ds_read_b64_tr_b16 a[164:165], v17 offset:4096
    v_mfma_f32_16x16x32_bf16 v[192:195], a[128:131], a[4:7], v[192:195]
    ds_read_b64_tr_b16 a[166:167], v17 offset:6144
    v_mfma_f32_16x16x32_bf16 v[196:199], a[128:131], a[8:11], v[196:199]
    buffer_load_dwordx4 v12, s[16:19], s52 offen offset:3072 lds
    v_mfma_f32_16x16x32_bf16 v[196:199], a[132:135], a[24:27], v[196:199]
    v_mfma_f32_16x16x32_bf16 v[200:203], a[132:135], a[28:31], v[200:203]
    buffer_load_dwordx4 a[88:91], v5, s[20:23], s50 offen offset:2048 sc1
    v_mfma_f32_16x16x32_bf16 v[200:203], a[128:131], a[12:15], v[200:203]
    s_waitcnt lgkmcnt(4)
    v_mfma_f32_16x16x32_bf16 v[216:219], a[144:147], a[12:15], v[216:219]
    ds_read_b64_tr_b16 a[176:177], v17 offset:8192
    v_mfma_f32_16x16x32_bf16 v[216:219], a[148:151], a[28:31], v[216:219]
    ds_read_b64_tr_b16 a[178:179], v17 offset:10240
    v_mfma_f32_16x16x32_bf16 v[212:215], a[148:151], a[24:27], v[212:215]
    ds_read_b64_tr_b16 a[180:181], v17 offset:12288
    v_mfma_f32_16x16x32_bf16 v[212:215], a[144:147], a[8:11], v[212:215]
    ds_read_b64_tr_b16 a[182:183], v17 offset:14336
    v_mfma_f32_16x16x32_bf16 v[208:211], a[144:147], a[4:7], v[208:211]
    buffer_load_dwordx4 a[92:95], v5, s[20:23], s50 offen offset:3072 sc1
    v_mfma_f32_16x16x32_bf16 v[208:211], a[148:151], a[20:23], v[208:211]
    v_mfma_f32_16x16x32_bf16 v[204:207], a[148:151], a[16:19], v[204:207]
    v_mfma_f32_16x16x32_bf16 v[204:207], a[144:147], a[0:3], v[204:207]
    s_waitcnt lgkmcnt(4)
    v_mfma_f32_16x16x32_bf16 v[220:223], a[160:163], a[0:3], v[220:223]
    s_waitcnt vmcnt(15)
    s_barrier
    ds_read_b64_tr_b16 a[128:129], v14 offset:16384
    v_mfma_f32_16x16x32_bf16 v[220:223], a[164:167], a[16:19], v[220:223]
    ds_read_b64_tr_b16 a[130:131], v14 offset:18432
    s_add_u32 m0, s40, 114688
    v_mfma_f32_16x16x32_bf16 v[224:227], a[164:167], a[20:23], v[224:227]
    ds_read_b64_tr_b16 a[132:133], v14 offset:20480
    v_mfma_f32_16x16x32_bf16 v[224:227], a[160:163], a[4:7], v[224:227]
    ds_read_b64_tr_b16 a[134:135], v14 offset:22528
    v_mfma_f32_16x16x32_bf16 v[228:231], a[160:163], a[8:11], v[228:231]
    buffer_load_dwordx4 v6, s[16:19], s53 offen offset:0 lds
    v_mfma_f32_16x16x32_bf16 v[228:231], a[164:167], a[24:27], v[228:231]
    v_readlane_b32 s50, v18, s46
    v_mfma_f32_16x16x32_bf16 v[232:235], a[164:167], a[28:31], v[232:235]
    buffer_load_dwordx4 a[96:99], v4, s[20:23], s51 offen offset:0 sc1
    v_mfma_f32_16x16x32_bf16 v[232:235], a[160:163], a[12:15], v[232:235]
    v_readlane_b32 s52, v19, s46
    s_waitcnt lgkmcnt(4)
    v_mfma_f32_16x16x32_bf16 v[248:251], a[176:179], a[12:15], v[248:251]
    ds_read_b64_tr_b16 a[144:145], v14 offset:24576
    v_mfma_f32_16x16x32_bf16 v[248:251], a[180:183], a[28:31], v[248:251]
    ds_read_b64_tr_b16 a[146:147], v14 offset:26624
    v_mfma_f32_16x16x32_bf16 v[244:247], a[180:183], a[24:27], v[244:247]
    ds_read_b64_tr_b16 a[148:149], v14 offset:28672
    v_mfma_f32_16x16x32_bf16 v[244:247], a[176:179], a[8:11], v[244:247]
    ds_read_b64_tr_b16 a[150:151], v14 offset:30720
    v_mfma_f32_16x16x32_bf16 v[240:243], a[176:179], a[4:7], v[240:243]
    buffer_load_dwordx4 v7, s[16:19], s53 offen offset:1024 lds
    v_mfma_f32_16x16x32_bf16 v[240:243], a[180:183], a[20:23], v[240:243]
    s_add_u32 s46, s46, 1
    v_mfma_f32_16x16x32_bf16 v[236:239], a[180:183], a[16:19], v[236:239]
    buffer_load_dwordx4 a[100:103], v4, s[20:23], s51 offen offset:1024 sc1
    v_mfma_f32_16x16x32_bf16 v[236:239], a[176:179], a[0:3], v[236:239]
    s_waitcnt lgkmcnt(4)
    v_mfma_f32_16x16x32_bf16 v[124:127], a[128:131], a[32:35], v[124:127]
    ds_read_b64_tr_b16 a[160:161], v15 offset:16384
    v_mfma_f32_16x16x32_bf16 v[124:127], a[132:135], a[48:51], v[124:127]
    ds_read_b64_tr_b16 a[162:163], v15 offset:18432
    v_mfma_f32_16x16x32_bf16 v[128:131], a[132:135], a[52:55], v[128:131]
    ds_read_b64_tr_b16 a[164:165], v15 offset:20480
    v_mfma_f32_16x16x32_bf16 v[128:131], a[128:131], a[36:39], v[128:131]
    ds_read_b64_tr_b16 a[166:167], v15 offset:22528
    v_mfma_f32_16x16x32_bf16 v[132:135], a[128:131], a[40:43], v[132:135]
    buffer_load_dwordx4 v8, s[16:19], s53 offen offset:2048 lds
    v_mfma_f32_16x16x32_bf16 v[132:135], a[132:135], a[56:59], v[132:135]
    buffer_load_dwordx4 a[104:107], v4, s[20:23], s51 offen offset:2048 sc1
    v_mfma_f32_16x16x32_bf16 v[136:139], a[132:135], a[60:63], v[136:139]
    v_mfma_f32_16x16x32_bf16 v[136:139], a[128:131], a[44:47], v[136:139]
    s_waitcnt lgkmcnt(4)
    v_mfma_f32_16x16x32_bf16 v[152:155], a[144:147], a[44:47], v[152:155]
    ds_read_b64_tr_b16 a[176:177], v15 offset:24576
    s_add_u32 m0, s40, 49152
    v_mfma_f32_16x16x32_bf16 v[152:155], a[148:151], a[60:63], v[152:155]
    ds_read_b64_tr_b16 a[178:179], v15 offset:26624
    v_mfma_f32_16x16x32_bf16 v[148:151], a[148:151], a[56:59], v[148:151]
    ds_read_b64_tr_b16 a[180:181], v15 offset:28672
    v_mfma_f32_16x16x32_bf16 v[148:151], a[144:147], a[40:43], v[148:151]
    ds_read_b64_tr_b16 a[182:183], v15 offset:30720
    v_mfma_f32_16x16x32_bf16 v[144:147], a[144:147], a[36:39], v[144:147]
    buffer_load_dwordx4 v9, s[16:19], s53 offen offset:0 lds
    v_mfma_f32_16x16x32_bf16 v[144:147], a[148:151], a[52:55], v[144:147]
    buffer_load_dwordx4 a[108:111], v4, s[20:23], s51 offen offset:3072 sc1
    v_mfma_f32_16x16x32_bf16 v[140:143], a[148:151], a[48:51], v[140:143]
    v_mfma_f32_16x16x32_bf16 v[140:143], a[144:147], a[32:35], v[140:143]
    s_waitcnt lgkmcnt(4)
    v_mfma_f32_16x16x32_bf16 v[156:159], a[160:163], a[32:35], v[156:159]
    ds_read_b64_tr_b16 a[128:129], v16 offset:16384
    v_mfma_f32_16x16x32_bf16 v[156:159], a[164:167], a[48:51], v[156:159]
    ds_read_b64_tr_b16 a[130:131], v16 offset:18432
    v_mfma_f32_16x16x32_bf16 v[160:163], a[164:167], a[52:55], v[160:163]
    ds_read_b64_tr_b16 a[132:133], v16 offset:20480
    v_mfma_f32_16x16x32_bf16 v[160:163], a[160:163], a[36:39], v[160:163]
    ds_read_b64_tr_b16 a[134:135], v16 offset:22528
    v_mfma_f32_16x16x32_bf16 v[164:167], a[160:163], a[40:43], v[164:167]
    buffer_load_dwordx4 v10, s[16:19], s53 offen offset:1024 lds
    v_mfma_f32_16x16x32_bf16 v[164:167], a[164:167], a[56:59], v[164:167]
    v_mfma_f32_16x16x32_bf16 v[168:171], a[164:167], a[60:63], v[168:171]
    buffer_load_dwordx4 a[112:115], v5, s[20:23], s51 offen offset:0 sc1
    v_mfma_f32_16x16x32_bf16 v[168:171], a[160:163], a[44:47], v[168:171]
    s_waitcnt lgkmcnt(4)
    v_mfma_f32_16x16x32_bf16 v[184:187], a[176:179], a[44:47], v[184:187]
    ds_read_b64_tr_b16 a[144:145], v16 offset:24576
    v_mfma_f32_16x16x32_bf16 v[184:187], a[180:183], a[60:63], v[184:187]
    ds_read_b64_tr_b16 a[146:147], v16 offset:26624
    v_mfma_f32_16x16x32_bf16 v[180:183], a[180:183], a[56:59], v[180:183]
    ds_read_b64_tr_b16 a[148:149], v16 offset:28672
    v_mfma_f32_16x16x32_bf16 v[180:183], a[176:179], a[40:43], v[180:183]
    ds_read_b64_tr_b16 a[150:151], v16 offset:30720
    v_mfma_f32_16x16x32_bf16 v[176:179], a[176:179], a[36:39], v[176:179]
    buffer_load_dwordx4 v11, s[16:19], s53 offen offset:2048 lds
    v_mfma_f32_16x16x32_bf16 v[176:179], a[180:183], a[52:55], v[176:179]
    v_mfma_f32_16x16x32_bf16 v[172:175], a[180:183], a[48:51], v[172:175]
    buffer_load_dwordx4 a[116:119], v5, s[20:23], s51 offen offset:1024 sc1
    v_mfma_f32_16x16x32_bf16 v[172:175], a[176:179], a[32:35], v[172:175]
    s_waitcnt lgkmcnt(4)
    v_mfma_f32_16x16x32_bf16 v[188:191], a[128:131], a[32:35], v[188:191]
    ds_read_b64_tr_b16 a[160:161], v17 offset:16384
    v_mfma_f32_16x16x32_bf16 v[188:191], a[132:135], a[48:51], v[188:191]
    ds_read_b64_tr_b16 a[162:163], v17 offset:18432
    v_mfma_f32_16x16x32_bf16 v[192:195], a[132:135], a[52:55], v[192:195]
    ds_read_b64_tr_b16 a[164:165], v17 offset:20480
    v_mfma_f32_16x16x32_bf16 v[192:195], a[128:131], a[36:39], v[192:195]
    ds_read_b64_tr_b16 a[166:167], v17 offset:22528
    v_mfma_f32_16x16x32_bf16 v[196:199], a[128:131], a[40:43], v[196:199]
    buffer_load_dwordx4 v12, s[16:19], s53 offen offset:3072 lds
    v_mfma_f32_16x16x32_bf16 v[196:199], a[132:135], a[56:59], v[196:199]
    v_mfma_f32_16x16x32_bf16 v[200:203], a[132:135], a[60:63], v[200:203]
    buffer_load_dwordx4 a[120:123], v5, s[20:23], s51 offen offset:2048 sc1
    v_mfma_f32_16x16x32_bf16 v[200:203], a[128:131], a[44:47], v[200:203]
    s_waitcnt lgkmcnt(4)
    v_mfma_f32_16x16x32_bf16 v[216:219], a[144:147], a[44:47], v[216:219]
    ds_read_b64_tr_b16 a[176:177], v17 offset:24576
    v_mfma_f32_16x16x32_bf16 v[216:219], a[148:151], a[60:63], v[216:219]
    ds_read_b64_tr_b16 a[178:179], v17 offset:26624
    v_mfma_f32_16x16x32_bf16 v[212:215], a[148:151], a[56:59], v[212:215]
    ds_read_b64_tr_b16 a[180:181], v17 offset:28672
    v_mfma_f32_16x16x32_bf16 v[212:215], a[144:147], a[40:43], v[212:215]
    ds_read_b64_tr_b16 a[182:183], v17 offset:30720
    v_mfma_f32_16x16x32_bf16 v[208:211], a[144:147], a[36:39], v[208:211]
    buffer_load_dwordx4 a[124:127], v5, s[20:23], s51 offen offset:3072 sc1
    v_mfma_f32_16x16x32_bf16 v[208:211], a[148:151], a[52:55], v[208:211]
    v_mfma_f32_16x16x32_bf16 v[204:207], a[148:151], a[48:51], v[204:207]
    v_mfma_f32_16x16x32_bf16 v[204:207], a[144:147], a[32:35], v[204:207]
    s_waitcnt lgkmcnt(4)
    v_mfma_f32_16x16x32_bf16 v[220:223], a[160:163], a[32:35], v[220:223]
    s_waitcnt vmcnt(15)
    s_barrier
    ds_read_b64_tr_b16 a[128:129], v14 offset:32768
    v_mfma_f32_16x16x32_bf16 v[220:223], a[164:167], a[48:51], v[220:223]
    ds_read_b64_tr_b16 a[130:131], v14 offset:34816
    v_mfma_f32_16x16x32_bf16 v[224:227], a[164:167], a[52:55], v[224:227]
    ds_read_b64_tr_b16 a[132:133], v14 offset:36864
    v_mfma_f32_16x16x32_bf16 v[224:227], a[160:163], a[36:39], v[224:227]
    ds_read_b64_tr_b16 a[134:135], v14 offset:38912
    v_mfma_f32_16x16x32_bf16 v[228:231], a[160:163], a[40:43], v[228:231]
    v_mfma_f32_16x16x32_bf16 v[228:231], a[164:167], a[56:59], v[228:231]
    v_mfma_f32_16x16x32_bf16 v[232:235], a[164:167], a[60:63], v[232:235]
    v_mfma_f32_16x16x32_bf16 v[232:235], a[160:163], a[44:47], v[232:235]
    s_waitcnt lgkmcnt(4)
    v_mfma_f32_16x16x32_bf16 v[248:251], a[176:179], a[44:47], v[248:251]
    ds_read_b64_tr_b16 a[144:145], v14 offset:40960
    v_mfma_f32_16x16x32_bf16 v[248:251], a[180:183], a[60:63], v[248:251]
    ds_read_b64_tr_b16 a[146:147], v14 offset:43008
    v_mfma_f32_16x16x32_bf16 v[244:247], a[180:183], a[56:59], v[244:247]
    ds_read_b64_tr_b16 a[148:149], v14 offset:45056
    v_mfma_f32_16x16x32_bf16 v[244:247], a[176:179], a[40:43], v[244:247]
    ds_read_b64_tr_b16 a[150:151], v14 offset:47104
    v_mfma_f32_16x16x32_bf16 v[240:243], a[176:179], a[36:39], v[240:243]
    v_mfma_f32_16x16x32_bf16 v[240:243], a[180:183], a[52:55], v[240:243]
    v_mfma_f32_16x16x32_bf16 v[236:239], a[180:183], a[48:51], v[236:239]
    v_mfma_f32_16x16x32_bf16 v[236:239], a[176:179], a[32:35], v[236:239]
    s_waitcnt lgkmcnt(4)
    v_mfma_f32_16x16x32_bf16 v[124:127], a[128:131], a[64:67], v[124:127]
    ds_read_b64_tr_b16 a[160:161], v15 offset:32768
    v_mfma_f32_16x16x32_bf16 v[124:127], a[132:135], a[80:83], v[124:127]
    ds_read_b64_tr_b16 a[162:163], v15 offset:34816
    v_mfma_f32_16x16x32_bf16 v[128:131], a[132:135], a[84:87], v[128:131]
    ds_read_b64_tr_b16 a[164:165], v15 offset:36864
    v_mfma_f32_16x16x32_bf16 v[128:131], a[128:131], a[68:71], v[128:131]
    ds_read_b64_tr_b16 a[166:167], v15 offset:38912
    v_mfma_f32_16x16x32_bf16 v[132:135], a[128:131], a[72:75], v[132:135]
    v_mfma_f32_16x16x32_bf16 v[132:135], a[132:135], a[88:91], v[132:135]
    v_mfma_f32_16x16x32_bf16 v[136:139], a[132:135], a[92:95], v[136:139]
    v_mfma_f32_16x16x32_bf16 v[136:139], a[128:131], a[76:79], v[136:139]
    s_waitcnt lgkmcnt(4)
    v_mfma_f32_16x16x32_bf16 v[152:155], a[144:147], a[76:79], v[152:155]
    ds_read_b64_tr_b16 a[176:177], v15 offset:40960
    v_mfma_f32_16x16x32_bf16 v[152:155], a[148:151], a[92:95], v[152:155]
    ds_read_b64_tr_b16 a[178:179], v15 offset:43008
    v_mfma_f32_16x16x32_bf16 v[148:151], a[148:151], a[88:91], v[148:151]
    ds_read_b64_tr_b16 a[180:181], v15 offset:45056
    v_mfma_f32_16x16x32_bf16 v[148:151], a[144:147], a[72:75], v[148:151]
    ds_read_b64_tr_b16 a[182:183], v15 offset:47104
    v_mfma_f32_16x16x32_bf16 v[144:147], a[144:147], a[68:71], v[144:147]
    v_mfma_f32_16x16x32_bf16 v[144:147], a[148:151], a[84:87], v[144:147]
    v_mfma_f32_16x16x32_bf16 v[140:143], a[148:151], a[80:83], v[140:143]
    v_mfma_f32_16x16x32_bf16 v[140:143], a[144:147], a[64:67], v[140:143]
    s_waitcnt lgkmcnt(4)
    v_mfma_f32_16x16x32_bf16 v[156:159], a[160:163], a[64:67], v[156:159]
    ds_read_b64_tr_b16 a[128:129], v16 offset:32768
    v_mfma_f32_16x16x32_bf16 v[156:159], a[164:167], a[80:83], v[156:159]
    ds_read_b64_tr_b16 a[130:131], v16 offset:34816
    v_mfma_f32_16x16x32_bf16 v[160:163], a[164:167], a[84:87], v[160:163]
    ds_read_b64_tr_b16 a[132:133], v16 offset:36864
    v_mfma_f32_16x16x32_bf16 v[160:163], a[160:163], a[68:71], v[160:163]
    ds_read_b64_tr_b16 a[134:135], v16 offset:38912
    v_mfma_f32_16x16x32_bf16 v[164:167], a[160:163], a[72:75], v[164:167]
    v_mfma_f32_16x16x32_bf16 v[164:167], a[164:167], a[88:91], v[164:167]
    v_mfma_f32_16x16x32_bf16 v[168:171], a[164:167], a[92:95], v[168:171]
    v_mfma_f32_16x16x32_bf16 v[168:171], a[160:163], a[76:79], v[168:171]
    s_waitcnt lgkmcnt(4)
    v_mfma_f32_16x16x32_bf16 v[184:187], a[176:179], a[76:79], v[184:187]
    ds_read_b64_tr_b16 a[144:145], v16 offset:40960
    v_mfma_f32_16x16x32_bf16 v[184:187], a[180:183], a[92:95], v[184:187]
    ds_read_b64_tr_b16 a[146:147], v16 offset:43008
    v_mfma_f32_16x16x32_bf16 v[180:183], a[180:183], a[88:91], v[180:183]
    ds_read_b64_tr_b16 a[148:149], v16 offset:45056
    v_mfma_f32_16x16x32_bf16 v[180:183], a[176:179], a[72:75], v[180:183]
    ds_read_b64_tr_b16 a[150:151], v16 offset:47104
    v_mfma_f32_16x16x32_bf16 v[176:179], a[176:179], a[68:71], v[176:179]
    v_mfma_f32_16x16x32_bf16 v[176:179], a[180:183], a[84:87], v[176:179]
    v_mfma_f32_16x16x32_bf16 v[172:175], a[180:183], a[80:83], v[172:175]
    v_mfma_f32_16x16x32_bf16 v[172:175], a[176:179], a[64:67], v[172:175]
    s_waitcnt lgkmcnt(4)
    v_mfma_f32_16x16x32_bf16 v[188:191], a[128:131], a[64:67], v[188:191]
    ds_read_b64_tr_b16 a[160:161], v17 offset:32768
    v_mfma_f32_16x16x32_bf16 v[188:191], a[132:135], a[80:83], v[188:191]
    ds_read_b64_tr_b16 a[162:163], v17 offset:34816
    v_mfma_f32_16x16x32_bf16 v[192:195], a[132:135], a[84:87], v[192:195]
    ds_read_b64_tr_b16 a[164:165], v17 offset:36864
    v_mfma_f32_16x16x32_bf16 v[192:195], a[128:131], a[68:71], v[192:195]
    ds_read_b64_tr_b16 a[166:167], v17 offset:38912
    v_mfma_f32_16x16x32_bf16 v[196:199], a[128:131], a[72:75], v[196:199]
    v_mfma_f32_16x16x32_bf16 v[196:199], a[132:135], a[88:91], v[196:199]
    v_mfma_f32_16x16x32_bf16 v[200:203], a[132:135], a[92:95], v[200:203]
    v_mfma_f32_16x16x32_bf16 v[200:203], a[128:131], a[76:79], v[200:203]
    s_waitcnt lgkmcnt(4)
    v_mfma_f32_16x16x32_bf16 v[216:219], a[144:147], a[76:79], v[216:219]
    ds_read_b64_tr_b16 a[176:177], v17 offset:40960
    v_mfma_f32_16x16x32_bf16 v[216:219], a[148:151], a[92:95], v[216:219]
    ds_read_b64_tr_b16 a[178:179], v17 offset:43008
    v_mfma_f32_16x16x32_bf16 v[212:215], a[148:151], a[88:91], v[212:215]
    ds_read_b64_tr_b16 a[180:181], v17 offset:45056
    v_mfma_f32_16x16x32_bf16 v[212:215], a[144:147], a[72:75], v[212:215]
    ds_read_b64_tr_b16 a[182:183], v17 offset:47104
    v_mfma_f32_16x16x32_bf16 v[208:211], a[144:147], a[68:71], v[208:211]
    v_mfma_f32_16x16x32_bf16 v[208:211], a[148:151], a[84:87], v[208:211]
    v_mfma_f32_16x16x32_bf16 v[204:207], a[148:151], a[80:83], v[204:207]
    v_mfma_f32_16x16x32_bf16 v[204:207], a[144:147], a[64:67], v[204:207]
    s_waitcnt lgkmcnt(4)
    v_mfma_f32_16x16x32_bf16 v[220:223], a[160:163], a[64:67], v[220:223]
    s_waitcnt vmcnt(0)
    s_barrier
    ds_read_b64_tr_b16 a[128:129], v14 offset:49152
    v_mfma_f32_16x16x32_bf16 v[220:223], a[164:167], a[80:83], v[220:223]
    ds_read_b64_tr_b16 a[130:131], v14 offset:51200
    v_mfma_f32_16x16x32_bf16 v[224:227], a[164:167], a[84:87], v[224:227]
    ds_read_b64_tr_b16 a[132:133], v14 offset:53248
    v_mfma_f32_16x16x32_bf16 v[224:227], a[160:163], a[68:71], v[224:227]
    ds_read_b64_tr_b16 a[134:135], v14 offset:55296
    v_mfma_f32_16x16x32_bf16 v[228:231], a[160:163], a[72:75], v[228:231]
    v_mfma_f32_16x16x32_bf16 v[228:231], a[164:167], a[88:91], v[228:231]
    v_mfma_f32_16x16x32_bf16 v[232:235], a[164:167], a[92:95], v[232:235]
    v_mfma_f32_16x16x32_bf16 v[232:235], a[160:163], a[76:79], v[232:235]
    s_waitcnt lgkmcnt(4)
    v_mfma_f32_16x16x32_bf16 v[248:251], a[176:179], a[76:79], v[248:251]
    ds_read_b64_tr_b16 a[144:145], v14 offset:57344
    v_mfma_f32_16x16x32_bf16 v[248:251], a[180:183], a[92:95], v[248:251]
    ds_read_b64_tr_b16 a[146:147], v14 offset:59392
    v_mfma_f32_16x16x32_bf16 v[244:247], a[180:183], a[88:91], v[244:247]
    ds_read_b64_tr_b16 a[148:149], v14 offset:61440
    v_mfma_f32_16x16x32_bf16 v[244:247], a[176:179], a[72:75], v[244:247]
    ds_read_b64_tr_b16 a[150:151], v14 offset:63488
    v_mfma_f32_16x16x32_bf16 v[240:243], a[176:179], a[68:71], v[240:243]
    v_mfma_f32_16x16x32_bf16 v[240:243], a[180:183], a[84:87], v[240:243]
    v_mfma_f32_16x16x32_bf16 v[236:239], a[180:183], a[80:83], v[236:239]
    v_mfma_f32_16x16x32_bf16 v[236:239], a[176:179], a[64:67], v[236:239]
    s_getpc_b64 s[72:73]
L_cp5:
    s_lshr_b32 s74, s2, 3
    s_lshl2_add_u32 s74, s74, s3
    s_lshl_b32 s74, s74, 7
    s_add_u32 s74, s74, 4096
    s_min_u32 s74, s74, L_end-L_cp5
    s_add_u32 s72, s72, s74
    s_addc_u32 s73, s73, 0
    v_and_b32 v254, 0, v0
    v_lshlrev_b32 v254, 7, v254
    v_mov_b32 v255, s73
    v_add_co_u32 v254, vcc, s72, v254
    s_nop 1
    v_addc_co_u32 v255, vcc, 0, v255, vcc
    global_load_dword a251, v[254:255], off
    s_waitcnt lgkmcnt(4)
    v_mfma_f32_16x16x32_bf16 v[124:127], a[128:131], a[96:99], v[124:127]
    ds_read_b64_tr_b16 a[160:161], v15 offset:49152
    v_mfma_f32_16x16x32_bf16 v[124:127], a[132:135], a[112:115], v[124:127]
    ds_read_b64_tr_b16 a[162:163], v15 offset:51200
    v_mfma_f32_16x16x32_bf16 v[128:131], a[132:135], a[116:119], v[128:131]
    ds_read_b64_tr_b16 a[164:165], v15 offset:53248
    v_mfma_f32_16x16x32_bf16 v[128:131], a[128:131], a[100:103], v[128:131]
    ds_read_b64_tr_b16 a[166:167], v15 offset:55296
    v_mfma_f32_16x16x32_bf16 v[132:135], a[128:131], a[104:107], v[132:135]
    v_mfma_f32_16x16x32_bf16 v[132:135], a[132:135], a[120:123], v[132:135]
    v_mfma_f32_16x16x32_bf16 v[136:139], a[132:135], a[124:127], v[136:139]
    v_mfma_f32_16x16x32_bf16 v[136:139], a[128:131], a[108:111], v[136:139]
    s_waitcnt lgkmcnt(4)
    v_mfma_f32_16x16x32_bf16 v[152:155], a[144:147], a[108:111], v[152:155]
    ds_read_b64_tr_b16 a[176:177], v15 offset:57344
    v_mfma_f32_16x16x32_bf16 v[152:155], a[148:151], a[124:127], v[152:155]
    ds_read_b64_tr_b16 a[178:179], v15 offset:59392
    v_mfma_f32_16x16x32_bf16 v[148:151], a[148:151], a[120:123], v[148:151]
    ds_read_b64_tr_b16 a[180:181], v15 offset:61440
    v_mfma_f32_16x16x32_bf16 v[148:151], a[144:147], a[104:107], v[148:151]
    ds_read_b64_tr_b16 a[182:183], v15 offset:63488
    v_mfma_f32_16x16x32_bf16 v[144:147], a[144:147], a[100:103], v[144:147]
    v_mfma_f32_16x16x32_bf16 v[144:147], a[148:151], a[116:119], v[144:147]
    v_mfma_f32_16x16x32_bf16 v[140:143], a[148:151], a[112:115], v[140:143]
    v_mfma_f32_16x16x32_bf16 v[140:143], a[144:147], a[96:99], v[140:143]
    s_waitcnt lgkmcnt(4)
    v_mfma_f32_16x16x32_bf16 v[156:159], a[160:163], a[96:99], v[156:159]
    ds_read_b64_tr_b16 a[128:129], v16 offset:49152
    v_mfma_f32_16x16x32_bf16 v[156:159], a[164:167], a[112:115], v[156:159]
    ds_read_b64_tr_b16 a[130:131], v16 offset:51200
    v_mfma_f32_16x16x32_bf16 v[160:163], a[164:167], a[116:119], v[160:163]
    ds_read_b64_tr_b16 a[132:133], v16 offset:53248
    v_mfma_f32_16x16x32_bf16 v[160:163], a[160:163], a[100:103], v[160:163]
    ds_read_b64_tr_b16 a[134:135], v16 offset:55296
    v_mfma_f32_16x16x32_bf16 v[164:167], a[160:163], a[104:107], v[164:167]
    v_mfma_f32_16x16x32_bf16 v[164:167], a[164:167], a[120:123], v[164:167]
    v_mfma_f32_16x16x32_bf16 v[168:171], a[164:167], a[124:127], v[168:171]
    v_mfma_f32_16x16x32_bf16 v[168:171], a[160:163], a[108:111], v[168:171]
    s_waitcnt lgkmcnt(4)
    v_mfma_f32_16x16x32_bf16 v[184:187], a[176:179], a[108:111], v[184:187]
    ds_read_b64_tr_b16 a[144:145], v16 offset:57344
    v_mfma_f32_16x16x32_bf16 v[184:187], a[180:183], a[124:127], v[184:187]
    ds_read_b64_tr_b16 a[146:147], v16 offset:59392
    v_mfma_f32_16x16x32_bf16 v[180:183], a[180:183], a[120:123], v[180:183]
    ds_read_b64_tr_b16 a[148:149], v16 offset:61440
    v_mfma_f32_16x16x32_bf16 v[180:183], a[176:179], a[104:107], v[180:183]
    ds_read_b64_tr_b16 a[150:151], v16 offset:63488
    v_mfma_f32_16x16x32_bf16 v[176:179], a[176:179], a[100:103], v[176:179]
    v_mfma_f32_16x16x32_bf16 v[176:179], a[180:183], a[116:119], v[176:179]
    v_mfma_f32_16x16x32_bf16 v[172:175], a[180:183], a[112:115], v[172:175]
    v_mfma_f32_16x16x32_bf16 v[172:175], a[176:179], a[96:99], v[172:175]
    s_waitcnt lgkmcnt(4)
    v_mfma_f32_16x16x32_bf16 v[188:191], a[128:131], a[96:99], v[188:191]
    ds_read_b64_tr_b16 a[160:161], v17 offset:49152
    v_mfma_f32_16x16x32_bf16 v[188:191], a[132:135], a[112:115], v[188:191]
    ds_read_b64_tr_b16 a[162:163], v17 offset:51200
    v_mfma_f32_16x16x32_bf16 v[192:195], a[132:135], a[116:119], v[192:195]
    ds_read_b64_tr_b16 a[164:165], v17 offset:53248
    v_mfma_f32_16x16x32_bf16 v[192:195], a[128:131], a[100:103], v[192:195]
    ds_read_b64_tr_b16 a[166:167], v17 offset:55296
    v_mfma_f32_16x16x32_bf16 v[196:199], a[128:131], a[104:107], v[196:199]
    v_mfma_f32_16x16x32_bf16 v[196:199], a[132:135], a[120:123], v[196:199]
    v_mfma_f32_16x16x32_bf16 v[200:203], a[132:135], a[124:127], v[200:203]
    v_mfma_f32_16x16x32_bf16 v[200:203], a[128:131], a[108:111], v[200:203]
    s_waitcnt lgkmcnt(4)
    v_mfma_f32_16x16x32_bf16 v[216:219], a[144:147], a[108:111], v[216:219]
    ds_read_b64_tr_b16 a[176:177], v17 offset:57344
    v_mfma_f32_16x16x32_bf16 v[216:219], a[148:151], a[124:127], v[216:219]
    ds_read_b64_tr_b16 a[178:179], v17 offset:59392
    v_mfma_f32_16x16x32_bf16 v[212:215], a[148:151], a[120:123], v[212:215]
    ds_read_b64_tr_b16 a[180:181], v17 offset:61440
    v_mfma_f32_16x16x32_bf16 v[212:215], a[144:147], a[104:107], v[212:215]
    ds_read_b64_tr_b16 a[182:183], v17 offset:63488
    v_mfma_f32_16x16x32_bf16 v[208:211], a[144:147], a[100:103], v[208:211]
    v_mfma_f32_16x16x32_bf16 v[208:211], a[148:151], a[116:119], v[208:211]
    v_mfma_f32_16x16x32_bf16 v[204:207], a[148:151], a[112:115], v[204:207]
    v_mfma_f32_16x16x32_bf16 v[204:207], a[144:147], a[96:99], v[204:207]
    s_waitcnt lgkmcnt(4)
    v_mfma_f32_16x16x32_bf16 v[220:223], a[160:163], a[96:99], v[220:223]
    s_waitcnt vmcnt(63)
    s_barrier
    ds_read_b64_tr_b16 a[128:129], v13 offset:0
    v_mfma_f32_16x16x32_bf16 v[220:223], a[164:167], a[112:115], v[220:223]
    ds_read_b64_tr_b16 a[130:131], v13 offset:1536
    v_mfma_f32_16x16x32_bf16 v[224:227], a[164:167], a[116:119], v[224:227]
    ds_read_b64_tr_b16 a[132:133], v13 offset:4096
    v_mfma_f32_16x16x32_bf16 v[224:227], a[160:163], a[100:103], v[224:227]
    ds_read_b64_tr_b16 a[134:135], v13 offset:5632
    v_mfma_f32_16x16x32_bf16 v[228:231], a[160:163], a[104:107], v[228:231]
    v_mfma_f32_16x16x32_bf16 v[228:231], a[164:167], a[120:123], v[228:231]
    v_mfma_f32_16x16x32_bf16 v[232:235], a[164:167], a[124:127], v[232:235]
    v_mfma_f32_16x16x32_bf16 v[232:235], a[160:163], a[108:111], v[232:235]
    s_waitcnt lgkmcnt(4)
    v_mfma_f32_16x16x32_bf16 v[248:251], a[176:179], a[108:111], v[248:251]
    ds_read_b64_tr_b16 a[144:145], v13 offset:8192
    v_mfma_f32_16x16x32_bf16 v[248:251], a[180:183], a[124:127], v[248:251]
    ds_read_b64_tr_b16 a[146:147], v13 offset:9728
    v_mfma_f32_16x16x32_bf16 v[244:247], a[180:183], a[120:123], v[244:247]
    ds_read_b64_tr_b16 a[148:149], v13 offset:12288
    v_mfma_f32_16x16x32_bf16 v[244:247], a[176:179], a[104:107], v[244:247]
    ds_read_b64_tr_b16 a[150:151], v13 offset:13824
    v_mfma_f32_16x16x32_bf16 v[240:243], a[176:179], a[100:103], v[240:243]
    v_mfma_f32_16x16x32_bf16 v[240:243], a[180:183], a[116:119], v[240:243]
    v_mfma_f32_16x16x32_bf16 v[236:239], a[180:183], a[112:115], v[236:239]
    v_mfma_f32_16x16x32_bf16 v[236:239], a[176:179], a[96:99], v[236:239]
    v_pk_mul_f32 v[124:125], v[124:125], v[20:21] op_sel_hi:[1,0]
    v_pk_mul_f32 v[126:127], v[126:127], v[20:21] op_sel_hi:[1,0]
    v_pk_mul_f32 v[156:157], v[156:157], v[20:21] op_sel_hi:[1,0]
    v_pk_mul_f32 v[158:159], v[158:159], v[20:21] op_sel_hi:[1,0]
    v_exp_f32 v124, v124
    v_exp_f32 v125, v125
    v_exp_f32 v126, v126
    v_exp_f32 v127, v127
    v_exp_f32 v156, v156
    v_exp_f32 v157, v157
    v_exp_f32 v158, v158
    v_exp_f32 v159, v159
    v_pk_fma_f32 v[124:125], v[124:125], v[20:21], v[20:21] op_sel:[0,1,1] op_sel_hi:[1,1,1]
    v_pk_fma_f32 v[126:127], v[126:127], v[20:21], v[20:21] op_sel:[0,1,1] op_sel_hi:[1,1,1]
    v_pk_fma_f32 v[156:157], v[156:157], v[20:21], v[20:21] op_sel:[0,1,1] op_sel_hi:[1,1,1]
    v_pk_fma_f32 v[158:159], v[158:159], v[20:21], v[20:21] op_sel:[0,1,1] op_sel_hi:[1,1,1]
    v_rcp_f32 v124, v124
    v_rcp_f32 v125, v125
    v_rcp_f32 v126, v126
    v_rcp_f32 v127, v127
    v_rcp_f32 v156, v156
    v_rcp_f32 v157, v157
    v_rcp_f32 v158, v158
    v_rcp_f32 v159, v159
    v_pk_mul_f32 v[140:141], v[140:141], v[124:125]
    v_pk_mul_f32 v[142:143], v[142:143], v[126:127]
    v_pk_mul_f32 v[172:173], v[172:173], v[156:157]
    v_pk_mul_f32 v[174:175], v[174:175], v[158:159]
    v_cvt_pk_bf16_f32 v124, v140, v141
    v_cvt_pk_bf16_f32 v125, v142, v143
    v_cvt_pk_bf16_f32 v126, v172, v173
    v_cvt_pk_bf16_f32 v127, v174, v175
    buffer_store_dwordx4 v[124:127], v4, s[24:27], s44 offen offset:0 sc1
    v_pk_mul_f32 v[128:129], v[128:129], v[22:23] op_sel_hi:[1,0]
    v_pk_mul_f32 v[130:131], v[130:131], v[22:23] op_sel_hi:[1,0]
    v_pk_mul_f32 v[160:161], v[160:161], v[22:23] op_sel_hi:[1,0]
    v_pk_mul_f32 v[162:163], v[162:163], v[22:23] op_sel_hi:[1,0]
    v_exp_f32 v128, v128
    v_exp_f32 v129, v129
    v_exp_f32 v130, v130
    v_exp_f32 v131, v131
    v_exp_f32 v160, v160
    v_exp_f32 v161, v161
    v_exp_f32 v162, v162
    v_exp_f32 v163, v163
    v_pk_fma_f32 v[128:129], v[128:129], v[22:23], v[22:23] op_sel:[0,1,1] op_sel_hi:[1,1,1]
    v_pk_fma_f32 v[130:131], v[130:131], v[22:23], v[22:23] op_sel:[0,1,1] op_sel_hi:[1,1,1]
    v_pk_fma_f32 v[160:161], v[160:161], v[22:23], v[22:23] op_sel:[0,1,1] op_sel_hi:[1,1,1]
    v_pk_fma_f32 v[162:163], v[162:163], v[22:23], v[22:23] op_sel:[0,1,1] op_sel_hi:[1,1,1]
    v_rcp_f32 v128, v128
    v_rcp_f32 v129, v129
    v_rcp_f32 v130, v130
    v_rcp_f32 v131, v131
    v_rcp_f32 v160, v160
    v_rcp_f32 v161, v161
    v_rcp_f32 v162, v162
    v_rcp_f32 v163, v163
    v_pk_mul_f32 v[144:145], v[144:145], v[128:129]
    v_pk_mul_f32 v[146:147], v[146:147], v[130:131]
    v_pk_mul_f32 v[176:177], v[176:177], v[160:161]
    v_pk_mul_f32 v[178:179], v[178:179], v[162:163]
    v_cvt_pk_bf16_f32 v128, v144, v145
    v_cvt_pk_bf16_f32 v129, v146, v147
    v_cvt_pk_bf16_f32 v130, v176, v177
    v_cvt_pk_bf16_f32 v131, v178, v179
    buffer_store_dwordx4 v[128:131], v4, s[24:27], s44 offen offset:1024 sc1
    v_pk_mul_f32 v[132:133], v[132:133], v[24:25] op_sel_hi:[1,0]
    v_pk_mul_f32 v[134:135], v[134:135], v[24:25] op_sel_hi:[1,0]
    v_pk_mul_f32 v[164:165], v[164:165], v[24:25] op_sel_hi:[1,0]
    v_pk_mul_f32 v[166:167], v[166:167], v[24:25] op_sel_hi:[1,0]
    v_exp_f32 v132, v132
    v_exp_f32 v133, v133
    v_exp_f32 v134, v134
    v_exp_f32 v135, v135
    v_exp_f32 v164, v164
    v_exp_f32 v165, v165
    v_exp_f32 v166, v166
    v_exp_f32 v167, v167
    v_pk_fma_f32 v[132:133], v[132:133], v[24:25], v[24:25] op_sel:[0,1,1] op_sel_hi:[1,1,1]
    v_pk_fma_f32 v[134:135], v[134:135], v[24:25], v[24:25] op_sel:[0,1,1] op_sel_hi:[1,1,1]
    v_pk_fma_f32 v[164:165], v[164:165], v[24:25], v[24:25] op_sel:[0,1,1] op_sel_hi:[1,1,1]
    v_pk_fma_f32 v[166:167], v[166:167], v[24:25], v[24:25] op_sel:[0,1,1] op_sel_hi:[1,1,1]
    v_rcp_f32 v132, v132
    v_rcp_f32 v133, v133
    v_rcp_f32 v134, v134
    v_rcp_f32 v135, v135
    v_rcp_f32 v164, v164
    v_rcp_f32 v165, v165
    v_rcp_f32 v166, v166
    v_rcp_f32 v167, v167
    v_pk_mul_f32 v[148:149], v[148:149], v[132:133]
    v_pk_mul_f32 v[150:151], v[150:151], v[134:135]
    v_pk_mul_f32 v[180:181], v[180:181], v[164:165]
    v_pk_mul_f32 v[182:183], v[182:183], v[166:167]
    v_cvt_pk_bf16_f32 v132, v148, v149
    v_cvt_pk_bf16_f32 v133, v150, v151
    v_cvt_pk_bf16_f32 v134, v180, v181
    v_cvt_pk_bf16_f32 v135, v182, v183
    buffer_store_dwordx4 v[132:135], v4, s[24:27], s44 offen offset:2048 sc1
    v_pk_mul_f32 v[136:137], v[136:137], v[26:27] op_sel_hi:[1,0]
    v_pk_mul_f32 v[138:139], v[138:139], v[26:27] op_sel_hi:[1,0]
    v_pk_mul_f32 v[168:169], v[168:169], v[26:27] op_sel_hi:[1,0]
    v_pk_mul_f32 v[170:171], v[170:171], v[26:27] op_sel_hi:[1,0]
    v_exp_f32 v136, v136
    v_exp_f32 v137, v137
    v_exp_f32 v138, v138
    v_exp_f32 v139, v139
    v_exp_f32 v168, v168
    v_exp_f32 v169, v169
    v_exp_f32 v170, v170
    v_exp_f32 v171, v171
    v_pk_fma_f32 v[136:137], v[136:137], v[26:27], v[26:27] op_sel:[0,1,1] op_sel_hi:[1,1,1]
    v_pk_fma_f32 v[138:139], v[138:139], v[26:27], v[26:27] op_sel:[0,1,1] op_sel_hi:[1,1,1]
    v_pk_fma_f32 v[168:169], v[168:169], v[26:27], v[26:27] op_sel:[0,1,1] op_sel_hi:[1,1,1]
    v_pk_fma_f32 v[170:171], v[170:171], v[26:27], v[26:27] op_sel:[0,1,1] op_sel_hi:[1,1,1]
    v_rcp_f32 v136, v136
    v_rcp_f32 v137, v137
    v_rcp_f32 v138, v138
    v_rcp_f32 v139, v139
    v_rcp_f32 v168, v168
    v_rcp_f32 v169, v169
    v_rcp_f32 v170, v170
    v_rcp_f32 v171, v171
    v_pk_mul_f32 v[152:153], v[152:153], v[136:137]
    v_pk_mul_f32 v[154:155], v[154:155], v[138:139]
    v_pk_mul_f32 v[184:185], v[184:185], v[168:169]
    v_pk_mul_f32 v[186:187], v[186:187], v[170:171]
    v_cvt_pk_bf16_f32 v136, v152, v153
    v_cvt_pk_bf16_f32 v137, v154, v155
    v_cvt_pk_bf16_f32 v138, v184, v185
    v_cvt_pk_bf16_f32 v139, v186, v187
    buffer_store_dwordx4 v[136:139], v4, s[24:27], s44 offen offset:3072 sc1
    v_pk_mul_f32 v[188:189], v[188:189], v[20:21] op_sel_hi:[1,0]
    v_pk_mul_f32 v[190:191], v[190:191], v[20:21] op_sel_hi:[1,0]
    v_pk_mul_f32 v[220:221], v[220:221], v[20:21] op_sel_hi:[1,0]
    v_pk_mul_f32 v[222:223], v[222:223], v[20:21] op_sel_hi:[1,0]
    v_exp_f32 v188, v188
    v_exp_f32 v189, v189
    v_exp_f32 v190, v190
    v_exp_f32 v191, v191
    v_exp_f32 v220, v220
    v_exp_f32 v221, v221
    v_exp_f32 v222, v222
    v_exp_f32 v223, v223
    v_pk_fma_f32 v[188:189], v[188:189], v[20:21], v[20:21] op_sel:[0,1,1] op_sel_hi:[1,1,1]
    v_pk_fma_f32 v[190:191], v[190:191], v[20:21], v[20:21] op_sel:[0,1,1] op_sel_hi:[1,1,1]
    v_pk_fma_f32 v[220:221], v[220:221], v[20:21], v[20:21] op_sel:[0,1,1] op_sel_hi:[1,1,1]
    v_pk_fma_f32 v[222:223], v[222:223], v[20:21], v[20:21] op_sel:[0,1,1] op_sel_hi:[1,1,1]
    v_rcp_f32 v188, v188
    v_rcp_f32 v189, v189
    v_rcp_f32 v190, v190
    v_rcp_f32 v191, v191
    v_rcp_f32 v220, v220
    v_rcp_f32 v221, v221
    v_rcp_f32 v222, v222
    v_rcp_f32 v223, v223
    v_pk_mul_f32 v[204:205], v[204:205], v[188:189]
    v_pk_mul_f32 v[206:207], v[206:207], v[190:191]
    v_pk_mul_f32 v[236:237], v[236:237], v[220:221]
    v_pk_mul_f32 v[238:239], v[238:239], v[222:223]
    v_cvt_pk_bf16_f32 v188, v204, v205
    v_cvt_pk_bf16_f32 v189, v206, v207
    v_cvt_pk_bf16_f32 v190, v236, v237
    v_cvt_pk_bf16_f32 v191, v238, v239
    buffer_store_dwordx4 v[188:191], v4, s[24:27], s45 offen offset:0 sc1
    v_pk_mul_f32 v[192:193], v[192:193], v[22:23] op_sel_hi:[1,0]
    v_pk_mul_f32 v[194:195], v[194:195], v[22:23] op_sel_hi:[1,0]
    v_pk_mul_f32 v[224:225], v[224:225], v[22:23] op_sel_hi:[1,0]
    v_pk_mul_f32 v[226:227], v[226:227], v[22:23] op_sel_hi:[1,0]
    v_exp_f32 v192, v192
    v_exp_f32 v193, v193
    v_exp_f32 v194, v194
    v_exp_f32 v195, v195
    v_exp_f32 v224, v224
    v_exp_f32 v225, v225
    v_exp_f32 v226, v226
    v_exp_f32 v227, v227
    v_pk_fma_f32 v[192:193], v[192:193], v[22:23], v[22:23] op_sel:[0,1,1] op_sel_hi:[1,1,1]
    v_pk_fma_f32 v[194:195], v[194:195], v[22:23], v[22:23] op_sel:[0,1,1] op_sel_hi:[1,1,1]
    v_pk_fma_f32 v[224:225], v[224:225], v[22:23], v[22:23] op_sel:[0,1,1] op_sel_hi:[1,1,1]
    v_pk_fma_f32 v[226:227], v[226:227], v[22:23], v[22:23] op_sel:[0,1,1] op_sel_hi:[1,1,1]
    v_rcp_f32 v192, v192
    v_rcp_f32 v193, v193
    v_rcp_f32 v194, v194
    v_rcp_f32 v195, v195
    v_rcp_f32 v224, v224
    v_rcp_f32 v225, v225
    v_rcp_f32 v226, v226
    v_rcp_f32 v227, v227
    v_pk_mul_f32 v[208:209], v[208:209], v[192:193]
    v_pk_mul_f32 v[210:211], v[210:211], v[194:195]
    v_pk_mul_f32 v[240:241], v[240:241], v[224:225]
    v_pk_mul_f32 v[242:243], v[242:243], v[226:227]
    v_cvt_pk_bf16_f32 v192, v208, v209
    v_cvt_pk_bf16_f32 v193, v210, v211
    v_cvt_pk_bf16_f32 v194, v240, v241
    v_cvt_pk_bf16_f32 v195, v242, v243
    buffer_store_dwordx4 v[192:195], v4, s[24:27], s45 offen offset:1024 sc1
    v_pk_mul_f32 v[196:197], v[196:197], v[24:25] op_sel_hi:[1,0]
    v_pk_mul_f32 v[198:199], v[198:199], v[24:25] op_sel_hi:[1,0]
    v_pk_mul_f32 v[228:229], v[228:229], v[24:25] op_sel_hi:[1,0]
    v_pk_mul_f32 v[230:231], v[230:231], v[24:25] op_sel_hi:[1,0]
    v_exp_f32 v196, v196
    v_exp_f32 v197, v197
    v_exp_f32 v198, v198
    v_exp_f32 v199, v199
    v_exp_f32 v228, v228
    v_exp_f32 v229, v229
    v_exp_f32 v230, v230
    v_exp_f32 v231, v231
    v_pk_fma_f32 v[196:197], v[196:197], v[24:25], v[24:25] op_sel:[0,1,1] op_sel_hi:[1,1,1]
    v_pk_fma_f32 v[198:199], v[198:199], v[24:25], v[24:25] op_sel:[0,1,1] op_sel_hi:[1,1,1]
    v_pk_fma_f32 v[228:229], v[228:229], v[24:25], v[24:25] op_sel:[0,1,1] op_sel_hi:[1,1,1]
    v_pk_fma_f32 v[230:231], v[230:231], v[24:25], v[24:25] op_sel:[0,1,1] op_sel_hi:[1,1,1]
    v_rcp_f32 v196, v196
    v_rcp_f32 v197, v197
    v_rcp_f32 v198, v198
    v_rcp_f32 v199, v199
    v_rcp_f32 v228, v228
    v_rcp_f32 v229, v229
    v_rcp_f32 v230, v230
    v_rcp_f32 v231, v231
    v_pk_mul_f32 v[212:213], v[212:213], v[196:197]
    v_pk_mul_f32 v[214:215], v[214:215], v[198:199]
    v_pk_mul_f32 v[244:245], v[244:245], v[228:229]
    v_pk_mul_f32 v[246:247], v[246:247], v[230:231]
    v_cvt_pk_bf16_f32 v196, v212, v213
    v_cvt_pk_bf16_f32 v197, v214, v215
    v_cvt_pk_bf16_f32 v198, v244, v245
    v_cvt_pk_bf16_f32 v199, v246, v247
    buffer_store_dwordx4 v[196:199], v4, s[24:27], s45 offen offset:2048 sc1
    v_pk_mul_f32 v[200:201], v[200:201], v[26:27] op_sel_hi:[1,0]
    v_pk_mul_f32 v[202:203], v[202:203], v[26:27] op_sel_hi:[1,0]
    v_pk_mul_f32 v[232:233], v[232:233], v[26:27] op_sel_hi:[1,0]
    v_pk_mul_f32 v[234:235], v[234:235], v[26:27] op_sel_hi:[1,0]
    v_exp_f32 v200, v200
    v_exp_f32 v201, v201
    v_exp_f32 v202, v202
    v_exp_f32 v203, v203
    v_exp_f32 v232, v232
    v_exp_f32 v233, v233
    v_exp_f32 v234, v234
    v_exp_f32 v235, v235
    v_pk_fma_f32 v[200:201], v[200:201], v[26:27], v[26:27] op_sel:[0,1,1] op_sel_hi:[1,1,1]
    v_pk_fma_f32 v[202:203], v[202:203], v[26:27], v[26:27] op_sel:[0,1,1] op_sel_hi:[1,1,1]
    v_pk_fma_f32 v[232:233], v[232:233], v[26:27], v[26:27] op_sel:[0,1,1] op_sel_hi:[1,1,1]
    v_pk_fma_f32 v[234:235], v[234:235], v[26:27], v[26:27] op_sel:[0,1,1] op_sel_hi:[1,1,1]
    v_rcp_f32 v200, v200
    v_rcp_f32 v201, v201
    v_rcp_f32 v202, v202
    v_rcp_f32 v203, v203
    v_rcp_f32 v232, v232
    v_rcp_f32 v233, v233
    v_rcp_f32 v234, v234
    v_rcp_f32 v235, v235
    v_pk_mul_f32 v[216:217], v[216:217], v[200:201]
    v_pk_mul_f32 v[218:219], v[218:219], v[202:203]
    v_pk_mul_f32 v[248:249], v[248:249], v[232:233]
    v_pk_mul_f32 v[250:251], v[250:251], v[234:235]
    v_cvt_pk_bf16_f32 v200, v216, v217
    v_cvt_pk_bf16_f32 v201, v218, v219
    v_cvt_pk_bf16_f32 v202, v248, v249
    v_cvt_pk_bf16_f32 v203, v250, v251
    buffer_store_dwordx4 v[200:203], v4, s[24:27], s45 offen offset:3072 sc1
    s_waitcnt lgkmcnt(4)
    v_mfma_f32_16x16x32_bf16 v[28:31], a[128:131], a[0:3], v[28:31]
    ds_read_b64_tr_b16 a[160:161], v13 offset:32
    v_lshrrev_b32 v232, 3, v0
    v_mfma_f32_16x16x32_bf16 v[28:31], a[132:135], a[16:19], v[28:31]
    ds_read_b64_tr_b16 a[162:163], v13 offset:1568
    v_lshl_add_u32 v216, v232, 11, v252
    v_mfma_f32_16x16x32_bf16 v[32:35], a[132:135], a[20:23], v[32:35]
    ds_read_b64_tr_b16 a[164:165], v13 offset:4128
    s_lshl_b32 s14, s48, 7
    v_mfma_f32_16x16x32_bf16 v[32:35], a[128:131], a[4:7], v[32:35]
    ds_read_b64_tr_b16 a[166:167], v13 offset:5664
    v_add_u32 v216, s14, v216
    v_mfma_f32_16x16x32_bf16 v[36:39], a[128:131], a[8:11], v[36:39]
    v_xor_b32 v220, 128, v216
    v_add_u32 v217, 15360, v216
    v_mfma_f32_16x16x32_bf16 v[36:39], a[132:135], a[24:27], v[36:39]
    v_add_u32 v221, 15360, v220
    v_add_u32 v218, 30720, v216
    v_mfma_f32_16x16x32_bf16 v[40:43], a[132:135], a[28:31], v[40:43]
    v_add_u32 v222, 30720, v220
    v_add_u32 v219, 46080, v216
    v_mfma_f32_16x16x32_bf16 v[40:43], a[128:131], a[12:15], v[40:43]
    v_add_u32 v223, 46080, v220
    s_waitcnt lgkmcnt(4)
    v_mfma_f32_16x16x32_bf16 v[56:59], a[144:147], a[12:15], v[56:59]
    ds_read_b64_tr_b16 a[176:177], v13 offset:8224
    v_add_u32 v227, 0x10000, v14
    v_mfma_f32_16x16x32_bf16 v[56:59], a[148:151], a[28:31], v[56:59]
    ds_read_b64_tr_b16 a[178:179], v13 offset:9760
    v_add_u32 v228, 0x10000, v15
    v_mfma_f32_16x16x32_bf16 v[52:55], a[148:151], a[24:27], v[52:55]
    ds_read_b64_tr_b16 a[180:181], v13 offset:12320
    v_add_u32 v229, 0x10000, v16
    v_mfma_f32_16x16x32_bf16 v[52:55], a[144:147], a[8:11], v[52:55]
    ds_read_b64_tr_b16 a[182:183], v13 offset:13856
    v_add_u32 v230, 0x10000, v17
    v_mfma_f32_16x16x32_bf16 v[48:51], a[144:147], a[4:7], v[48:51]
    s_lshl_b32 s14, s47, 2
    s_add_u32 s14, s14, s3
    v_mfma_f32_16x16x32_bf16 v[48:51], a[148:151], a[20:23], v[48:51]
    s_lshl_b32 s14, s14, 11
    v_lshl_add_u32 v212, v0, 4, s14
    v_mfma_f32_16x16x32_bf16 v[44:47], a[148:151], a[16:19], v[44:47]
    v_add_u32 v213, 0x20000, v212
    v_add_u32 v214, 0x40000, v212
    v_mfma_f32_16x16x32_bf16 v[44:47], a[144:147], a[0:3], v[44:47]
    v_add_u32 v215, 0x60000, v212
    s_waitcnt lgkmcnt(4)
    v_mfma_f32_16x16x32_bf16 v[60:63], a[160:163], a[0:3], v[60:63]
    ds_read_b64_tr_b16 a[128:129], v13 offset:64
    v_mov_b32 v132, 0
    v_mfma_f32_16x16x32_bf16 v[60:63], a[164:167], a[16:19], v[60:63]
    ds_read_b64_tr_b16 a[130:131], v13 offset:1600
    v_mov_b32 v133, 0
    v_mfma_f32_16x16x32_bf16 v[64:67], a[164:167], a[20:23], v[64:67]
    ds_read_b64_tr_b16 a[132:133], v13 offset:4160
    v_mov_b32 v134, 0
    v_mfma_f32_16x16x32_bf16 v[64:67], a[160:163], a[4:7], v[64:67]
    ds_read_b64_tr_b16 a[134:135], v13 offset:5696
    v_mov_b32 v135, 0
    v_mfma_f32_16x16x32_bf16 v[68:71], a[160:163], a[8:11], v[68:71]
    v_mov_b32 v136, 0
    v_mov_b32 v137, 0
    v_mfma_f32_16x16x32_bf16 v[68:71], a[164:167], a[24:27], v[68:71]
    v_mov_b32 v138, 0
    v_mov_b32 v139, 0
    v_mfma_f32_16x16x32_bf16 v[72:75], a[164:167], a[28:31], v[72:75]
    v_mov_b32 v140, 0
    v_mov_b32 v141, 0
    v_mfma_f32_16x16x32_bf16 v[72:75], a[160:163], a[12:15], v[72:75]
    v_mov_b32 v142, 0
    s_waitcnt lgkmcnt(4)
    v_mfma_f32_16x16x32_bf16 v[88:91], a[176:179], a[12:15], v[88:91]
    ds_read_b64_tr_b16 a[144:145], v13 offset:8256
    v_mov_b32 v143, 0
    v_mfma_f32_16x16x32_bf16 v[88:91], a[180:183], a[28:31], v[88:91]
    ds_read_b64_tr_b16 a[146:147], v13 offset:9792
    v_mov_b32 v144, 0
    v_mfma_f32_16x16x32_bf16 v[84:87], a[180:183], a[24:27], v[84:87]
    ds_read_b64_tr_b16 a[148:149], v13 offset:12352
    v_mov_b32 v145, 0
    v_mfma_f32_16x16x32_bf16 v[84:87], a[176:179], a[8:11], v[84:87]
    ds_read_b64_tr_b16 a[150:151], v13 offset:13888
    v_mov_b32 v146, 0
    v_mfma_f32_16x16x32_bf16 v[80:83], a[176:179], a[4:7], v[80:83]
    v_mov_b32 v147, 0
    v_mov_b32 v148, 0
    v_mfma_f32_16x16x32_bf16 v[80:83], a[180:183], a[20:23], v[80:83]
    v_mov_b32 v149, 0
    v_mov_b32 v150, 0
    v_mfma_f32_16x16x32_bf16 v[76:79], a[180:183], a[16:19], v[76:79]
    v_mov_b32 v151, 0
    v_mov_b32 v152, 0
    v_mfma_f32_16x16x32_bf16 v[76:79], a[176:179], a[0:3], v[76:79]
    v_mov_b32 v153, 0
    s_waitcnt lgkmcnt(4)
    v_mfma_f32_16x16x32_bf16 v[92:95], a[128:131], a[0:3], v[92:95]
    s_waitcnt vmcnt(63)
    s_barrier
    ds_read_b64_tr_b16 a[160:161], v13 offset:16384
    v_mfma_f32_16x16x32_bf16 v[92:95], a[132:135], a[16:19], v[92:95]
    ds_read_b64_tr_b16 a[162:163], v13 offset:17920
    v_mov_b32 v154, 0
    v_mfma_f32_16x16x32_bf16 v[96:99], a[132:135], a[20:23], v[96:99]
    ds_read_b64_tr_b16 a[164:165], v13 offset:20480
    v_mov_b32 v155, 0
    v_mfma_f32_16x16x32_bf16 v[96:99], a[128:131], a[4:7], v[96:99]
    ds_read_b64_tr_b16 a[166:167], v13 offset:22016
    v_mov_b32 v156, 0
    v_mfma_f32_16x16x32_bf16 v[100:103], a[128:131], a[8:11], v[100:103]
    v_mov_b32 v157, 0
    v_mov_b32 v158, 0
    v_mfma_f32_16x16x32_bf16 v[100:103], a[132:135], a[24:27], v[100:103]
    v_mov_b32 v159, 0
    v_mov_b32 v160, 0
    v_mfma_f32_16x16x32_bf16 v[104:107], a[132:135], a[28:31], v[104:107]
    v_mov_b32 v161, 0
    v_mov_b32 v162, 0
    v_mfma_f32_16x16x32_bf16 v[104:107], a[128:131], a[12:15], v[104:107]
    v_mov_b32 v163, 0
    s_waitcnt lgkmcnt(4)
    v_mfma_f32_16x16x32_bf16 v[120:123], a[144:147], a[12:15], v[120:123]
    ds_read_b64_tr_b16 a[176:177], v13 offset:24576
    v_and_b32 v225, 31, v0
    v_mfma_f32_16x16x32_bf16 v[120:123], a[148:151], a[28:31], v[120:123]
    ds_read_b64_tr_b16 a[178:179], v13 offset:26112
    s_lshr_b32 s14, s47, 1
    v_mfma_f32_16x16x32_bf16 v[116:119], a[148:151], a[24:27], v[116:119]
    ds_read_b64_tr_b16 a[180:181], v13 offset:28672
    s_lshl_b32 s14, s14, 12
    v_mfma_f32_16x16x32_bf16 v[116:119], a[144:147], a[8:11], v[116:119]
    ds_read_b64_tr_b16 a[182:183], v13 offset:30208
    s_add_u32 s14, s14, 0x10000
    v_mfma_f32_16x16x32_bf16 v[112:115], a[144:147], a[4:7], v[112:115]
    s_and_b32 s15, s47, 1
    s_lshl_b32 s15, s15, 20
    v_mfma_f32_16x16x32_bf16 v[112:115], a[148:151], a[20:23], v[112:115]
    s_add_u32 s14, s14, s15
    s_and_b32 s15, s3, 2
    v_mfma_f32_16x16x32_bf16 v[108:111], a[148:151], a[16:19], v[108:111]
    s_lshl_b32 s15, s15, 18
    s_add_u32 s14, s14, s15
    v_mfma_f32_16x16x32_bf16 v[108:111], a[144:147], a[0:3], v[108:111]
    v_lshl_add_u32 v225, v225, 7, s14
    s_waitcnt lgkmcnt(4)
    v_mfma_f32_16x16x32_bf16 v[28:31], a[160:163], a[32:35], v[28:31]
    ds_read_b64_tr_b16 a[128:129], v13 offset:16416
    v_accvgpr_read_b32 v165, a232
    v_mfma_f32_16x16x32_bf16 v[28:31], a[164:167], a[48:51], v[28:31]
    ds_read_b64_tr_b16 a[130:131], v13 offset:17952
    v_lshlrev_b32 v164, 16, v165
    v_mfma_f32_16x16x32_bf16 v[32:35], a[164:167], a[52:55], v[32:35]
    ds_read_b64_tr_b16 a[132:133], v13 offset:20512
    v_and_b32 v165, 0xffff0000, v165
    v_mfma_f32_16x16x32_bf16 v[32:35], a[160:163], a[36:39], v[32:35]
    ds_read_b64_tr_b16 a[134:135], v13 offset:22048
    v_accvgpr_read_b32 v167, a233
    v_mfma_f32_16x16x32_bf16 v[36:39], a[160:163], a[40:43], v[36:39]
    v_lshlrev_b32 v166, 16, v167
    v_and_b32 v167, 0xffff0000, v167
    v_mfma_f32_16x16x32_bf16 v[36:39], a[164:167], a[56:59], v[36:39]
    v_accvgpr_read_b32 v173, a234
    v_lshlrev_b32 v172, 16, v173
    v_mfma_f32_16x16x32_bf16 v[40:43], a[164:167], a[60:63], v[40:43]
    v_and_b32 v173, 0xffff0000, v173
    v_accvgpr_read_b32 v175, a235
    v_mfma_f32_16x16x32_bf16 v[40:43], a[160:163], a[44:47], v[40:43]
    v_lshlrev_b32 v174, 16, v175
    s_waitcnt lgkmcnt(4)
    v_mfma_f32_16x16x32_bf16 v[56:59], a[176:179], a[44:47], v[56:59]
    ds_read_b64_tr_b16 a[144:145], v13 offset:24608
    v_and_b32 v175, 0xffff0000, v175
    v_mfma_f32_16x16x32_bf16 v[56:59], a[180:183], a[60:63], v[56:59]
    ds_read_b64_tr_b16 a[146:147], v13 offset:26144
    v_accvgpr_read_b32 v181, a236
    v_mfma_f32_16x16x32_bf16 v[52:55], a[180:183], a[56:59], v[52:55]
    ds_read_b64_tr_b16 a[148:149], v13 offset:28704
    v_lshlrev_b32 v180, 16, v181
    v_mfma_f32_16x16x32_bf16 v[52:55], a[176:179], a[40:43], v[52:55]
    ds_read_b64_tr_b16 a[150:151], v13 offset:30240
    v_and_b32 v181, 0xffff0000, v181
    v_mfma_f32_16x16x32_bf16 v[48:51], a[176:179], a[36:39], v[48:51]
    v_accvgpr_read_b32 v183, a237
    v_lshlrev_b32 v182, 16, v183
    v_mfma_f32_16x16x32_bf16 v[48:51], a[180:183], a[52:55], v[48:51]
    v_and_b32 v183, 0xffff0000, v183
    v_accvgpr_read_b32 v189, a238
    v_mfma_f32_16x16x32_bf16 v[44:47], a[180:183], a[48:51], v[44:47]
    v_lshlrev_b32 v188, 16, v189
    v_and_b32 v189, 0xffff0000, v189
    v_mfma_f32_16x16x32_bf16 v[44:47], a[176:179], a[32:35], v[44:47]
    v_accvgpr_read_b32 v191, a239
    s_waitcnt lgkmcnt(4)
    v_mfma_f32_16x16x32_bf16 v[60:63], a[128:131], a[32:35], v[60:63]
    ds_read_b64_tr_b16 a[160:161], v13 offset:16448
    v_lshlrev_b32 v190, 16, v191
    v_mfma_f32_16x16x32_bf16 v[60:63], a[132:135], a[48:51], v[60:63]
    ds_read_b64_tr_b16 a[162:163], v13 offset:17984
    v_and_b32 v191, 0xffff0000, v191
    v_mfma_f32_16x16x32_bf16 v[64:67], a[132:135], a[52:55], v[64:67]
    ds_read_b64_tr_b16 a[164:165], v13 offset:20544
    v_accvgpr_read_b32 v169, a240
    v_mfma_f32_16x16x32_bf16 v[64:67], a[128:131], a[36:39], v[64:67]
    ds_read_b64_tr_b16 a[166:167], v13 offset:22080
    v_lshlrev_b32 v168, 16, v169
    v_mfma_f32_16x16x32_bf16 v[68:71], a[128:131], a[40:43], v[68:71]
    v_and_b32 v169, 0xffff0000, v169
    v_accvgpr_read_b32 v171, a241
    v_mfma_f32_16x16x32_bf16 v[68:71], a[132:135], a[56:59], v[68:71]
    v_lshlrev_b32 v170, 16, v171
    v_and_b32 v171, 0xffff0000, v171
    v_mfma_f32_16x16x32_bf16 v[72:75], a[132:135], a[60:63], v[72:75]
    v_accvgpr_read_b32 v177, a242
    v_lshlrev_b32 v176, 16, v177
    v_mfma_f32_16x16x32_bf16 v[72:75], a[128:131], a[44:47], v[72:75]
    v_and_b32 v177, 0xffff0000, v177
    s_waitcnt lgkmcnt(4)
    v_mfma_f32_16x16x32_bf16 v[88:91], a[144:147], a[44:47], v[88:91]
    ds_read_b64_tr_b16 a[176:177], v13 offset:24640
    v_accvgpr_read_b32 v179, a243
    v_mfma_f32_16x16x32_bf16 v[88:91], a[148:151], a[60:63], v[88:91]
    ds_read_b64_tr_b16 a[178:179], v13 offset:26176
    v_lshlrev_b32 v178, 16, v179
    v_mfma_f32_16x16x32_bf16 v[84:87], a[148:151], a[56:59], v[84:87]
    ds_read_b64_tr_b16 a[180:181], v13 offset:28736
    v_and_b32 v179, 0xffff0000, v179
    v_mfma_f32_16x16x32_bf16 v[84:87], a[144:147], a[40:43], v[84:87]
    ds_read_b64_tr_b16 a[182:183], v13 offset:30272
    v_accvgpr_read_b32 v185, a244
    v_mfma_f32_16x16x32_bf16 v[80:83], a[144:147], a[36:39], v[80:83]
    v_lshlrev_b32 v184, 16, v185
    v_and_b32 v185, 0xffff0000, v185
    v_mfma_f32_16x16x32_bf16 v[80:83], a[148:151], a[52:55], v[80:83]
    v_accvgpr_read_b32 v187, a245
    v_lshlrev_b32 v186, 16, v187
    v_mfma_f32_16x16x32_bf16 v[76:79], a[148:151], a[48:51], v[76:79]
    v_and_b32 v187, 0xffff0000, v187
    v_accvgpr_read_b32 v193, a246
    v_mfma_f32_16x16x32_bf16 v[76:79], a[144:147], a[32:35], v[76:79]
    v_lshlrev_b32 v192, 16, v193
    s_waitcnt lgkmcnt(4)
    v_mfma_f32_16x16x32_bf16 v[92:95], a[160:163], a[32:35], v[92:95]
    s_waitcnt vmcnt(0)
    v_mov_b32 v1, s100
    s_mov_b64 exec, 1
    buffer_store_dword v1, v0, s[76:79], s75 offen offset:0 sc1
    s_mov_b64 exec, -1
    s_barrier
    ds_read_b64_tr_b16 a[128:129], v13 offset:32768
    v_mfma_f32_16x16x32_bf16 v[92:95], a[164:167], a[48:51], v[92:95]
    ds_read_b64_tr_b16 a[130:131], v13 offset:34304
    s_add_u32 m0, s40, 65536
    v_mfma_f32_16x16x32_bf16 v[96:99], a[164:167], a[52:55], v[96:99]
    ds_read_b64_tr_b16 a[132:133], v13 offset:36864
    v_and_b32 v193, 0xffff0000, v193
    v_mfma_f32_16x16x32_bf16 v[96:99], a[160:163], a[36:39], v[96:99]
    ds_read_b64_tr_b16 a[134:135], v13 offset:38400
    v_accvgpr_read_b32 v195, a247
    v_mfma_f32_16x16x32_bf16 v[100:103], a[160:163], a[40:43], v[100:103]
    buffer_load_dwordx4 v220, s[32:35], s52 offen offset:0 lds
    v_mfma_f32_16x16x32_bf16 v[100:103], a[164:167], a[56:59], v[100:103]
    v_readlane_b32 s51, v18, s46
    v_lshlrev_b32 v194, 16, v195
    v_mfma_f32_16x16x32_bf16 v[104:107], a[164:167], a[60:63], v[104:107]
    buffer_load_dwordx4 v221, s[32:35], s52 offen offset:1024 lds
    v_mfma_f32_16x16x32_bf16 v[104:107], a[160:163], a[44:47], v[104:107]
    v_readlane_b32 s53, v19, s46
    s_waitcnt lgkmcnt(4)
    v_mfma_f32_16x16x32_bf16 v[120:123], a[176:179], a[44:47], v[120:123]
    ds_read_b64_tr_b16 a[144:145], v13 offset:40960
    v_and_b32 v195, 0xffff0000, v195
    v_mfma_f32_16x16x32_bf16 v[120:123], a[180:183], a[60:63], v[120:123]
    ds_read_b64_tr_b16 a[146:147], v13 offset:42496
    v_and_b32 v236, 15, v0
    v_mfma_f32_16x16x32_bf16 v[116:119], a[180:183], a[56:59], v[116:119]
    ds_read_b64_tr_b16 a[148:149], v13 offset:45056
    v_lshrrev_b32 v232, 1, v236
    v_mfma_f32_16x16x32_bf16 v[116:119], a[176:179], a[40:43], v[116:119]
    ds_read_b64_tr_b16 a[150:151], v13 offset:46592
    v_lshrrev_b32 v233, 5, v0
    v_mfma_f32_16x16x32_bf16 v[112:115], a[176:179], a[36:39], v[112:115]
    buffer_load_dwordx4 v222, s[32:35], s52 offen offset:2048 lds
    v_mfma_f32_16x16x32_bf16 v[112:115], a[180:183], a[52:55], v[112:115]
    s_add_u32 s46, s46, 1
    v_xor_b32 v232, v232, v233
    v_mfma_f32_16x16x32_bf16 v[108:111], a[180:183], a[48:51], v[108:111]
    v_lshlrev_b32 v236, 7, v236
    v_lshl_add_u32 v236, v232, 4, v236
    v_mfma_f32_16x16x32_bf16 v[108:111], a[176:179], a[32:35], v[108:111]
    v_bfe_u32 v232, v0, 4, 1
    s_waitcnt lgkmcnt(4)
    v_mfma_f32_16x16x32_bf16 v[28:31], a[128:131], a[64:67], v[28:31]
    ds_read_b64_tr_b16 a[160:161], v13 offset:32800
    v_lshl_add_u32 v236, v232, 3, v236
    v_mfma_f32_16x16x32_bf16 v[28:31], a[132:135], a[80:83], v[28:31]
    ds_read_b64_tr_b16 a[162:163], v13 offset:34336
    s_add_u32 s15, s40, 147456
    v_mfma_f32_16x16x32_bf16 v[32:35], a[132:135], a[84:87], v[32:35]
    ds_read_b64_tr_b16 a[164:165], v13 offset:36896
    v_add_u32 v236, s15, v236
    v_mfma_f32_16x16x32_bf16 v[32:35], a[128:131], a[68:71], v[32:35]
    ds_read_b64_tr_b16 a[166:167], v13 offset:38432
    v_xor_b32 v237, 32, v236
    v_mfma_f32_16x16x32_bf16 v[36:39], a[128:131], a[72:75], v[36:39]
    buffer_load_dwordx4 v223, s[32:35], s52 offen offset:3072 lds
    v_mfma_f32_16x16x32_bf16 v[36:39], a[132:135], a[88:91], v[36:39]
    v_xor_b32 v238, 64, v236
    v_xor_b32 v239, 96, v236
    v_mfma_f32_16x16x32_bf16 v[40:43], a[132:135], a[92:95], v[40:43]
    v_lshrrev_b32 v232, 4, v0
    v_and_b32 v233, 7, v0
    v_mfma_f32_16x16x32_bf16 v[40:43], a[128:131], a[76:79], v[40:43]
    s_add_u32 m0, s40, 0
    s_waitcnt lgkmcnt(4)
    v_mfma_f32_16x16x32_bf16 v[56:59], a[144:147], a[76:79], v[56:59]
    ds_read_b64_tr_b16 a[176:177], v13 offset:40992
    v_xor_b32 v232, v232, v233
    v_mfma_f32_16x16x32_bf16 v[56:59], a[148:151], a[92:95], v[56:59]
    ds_read_b64_tr_b16 a[178:179], v13 offset:42528
    v_lshrrev_b32 v234, 3, v0
    v_mfma_f32_16x16x32_bf16 v[52:55], a[148:151], a[88:91], v[52:55]
    ds_read_b64_tr_b16 a[180:181], v13 offset:45088
    v_lshlrev_b32 v240, 7, v234
    v_mfma_f32_16x16x32_bf16 v[52:55], a[144:147], a[72:75], v[52:55]
    ds_read_b64_tr_b16 a[182:183], v13 offset:46624
    v_lshl_add_u32 v240, v232, 4, v240
    v_mfma_f32_16x16x32_bf16 v[48:51], a[144:147], a[68:71], v[48:51]
    buffer_load_dwordx4 v216, s[32:35], s52 offen offset:0 lds
    v_mfma_f32_16x16x32_bf16 v[48:51], a[148:151], a[84:87], v[48:51]
    buffer_load_dwordx4 v217, s[32:35], s52 offen offset:1024 lds
    v_mfma_f32_16x16x32_bf16 v[44:47], a[148:151], a[80:83], v[44:47]
    v_add_u32 v240, s15, v240
    v_xor_b32 v241, 64, v240
    v_mfma_f32_16x16x32_bf16 v[44:47], a[144:147], a[64:67], v[44:47]
    s_lshl_b32 s14, s47, 7
    s_waitcnt lgkmcnt(4)
    v_mfma_f32_16x16x32_bf16 v[60:63], a[160:163], a[64:67], v[60:63]
    ds_read_b64_tr_b16 a[128:129], v13 offset:32832
    s_and_b32 s15, s3, 1
    v_mfma_f32_16x16x32_bf16 v[60:63], a[164:167], a[80:83], v[60:63]
    ds_read_b64_tr_b16 a[130:131], v13 offset:34368
    s_lshl_b32 s15, s15, 6
    v_mfma_f32_16x16x32_bf16 v[64:67], a[164:167], a[84:87], v[64:67]
    ds_read_b64_tr_b16 a[132:133], v13 offset:36928
    s_add_u32 s14, s14, s15
    v_mfma_f32_16x16x32_bf16 v[64:67], a[160:163], a[68:71], v[64:67]
    ds_read_b64_tr_b16 a[134:135], v13 offset:38464
    s_lshr_b32 s15, s3, 1
    v_mfma_f32_16x16x32_bf16 v[68:71], a[160:163], a[72:75], v[68:71]
    buffer_load_dwordx4 v218, s[32:35], s52 offen offset:2048 lds
    v_mfma_f32_16x16x32_bf16 v[68:71], a[164:167], a[88:91], v[68:71]
    s_add_u32 s14, s14, s15
    s_lshl_b32 s14, s14, 11
    v_mfma_f32_16x16x32_bf16 v[72:75], a[164:167], a[92:95], v[72:75]
    s_lshl_b32 s15, s48, 7
    s_add_u32 s14, s14, s15
    v_mfma_f32_16x16x32_bf16 v[72:75], a[160:163], a[76:79], v[72:75]
    v_lshlrev_b32 v224, 12, v234
    s_waitcnt lgkmcnt(4)
    v_mfma_f32_16x16x32_bf16 v[88:91], a[176:179], a[76:79], v[88:91]
    ds_read_b64_tr_b16 a[144:145], v13 offset:41024
    v_lshl_add_u32 v224, v233, 4, v224
    v_mfma_f32_16x16x32_bf16 v[88:91], a[180:183], a[92:95], v[88:91]
    ds_read_b64_tr_b16 a[146:147], v13 offset:42560
    v_add_u32 v224, s14, v224
    v_mfma_f32_16x16x32_bf16 v[84:87], a[180:183], a[88:91], v[84:87]
    ds_read_b64_tr_b16 a[148:149], v13 offset:45120
    v_add_u32 v242, 0x8000, v224
    v_mfma_f32_16x16x32_bf16 v[84:87], a[176:179], a[72:75], v[84:87]
    ds_read_b64_tr_b16 a[150:151], v13 offset:46656
    v_bfe_u32 v232, v0, 4, 1
    v_mfma_f32_16x16x32_bf16 v[80:83], a[176:179], a[68:71], v[80:83]
    buffer_load_dwordx4 v219, s[32:35], s52 offen offset:3072 lds
    v_mfma_f32_16x16x32_bf16 v[80:83], a[180:183], a[84:87], v[80:83]
    v_lshrrev_b32 v233, 5, v0
    v_sub_u32 v234, v232, v233
    v_mfma_f32_16x16x32_bf16 v[76:79], a[180:183], a[80:83], v[76:79]
    v_lshl_add_u32 v243, v234, 8, v4
    v_lshl_add_u32 v244, v232, 9, v243
    v_mfma_f32_16x16x32_bf16 v[76:79], a[176:179], a[64:67], v[76:79]
    s_waitcnt lgkmcnt(4)
    v_mfma_f32_16x16x32_bf16 v[92:95], a[128:131], a[64:67], v[92:95]
    s_waitcnt vmcnt(63)
    s_barrier
    ds_read_b64_tr_b16 a[160:161], v13 offset:49152
    v_mfma_f32_16x16x32_bf16 v[92:95], a[132:135], a[80:83], v[92:95]
    ds_read_b64_tr_b16 a[162:163], v13 offset:50688
    s_add_u32 m0, s40, 81920
    v_mfma_f32_16x16x32_bf16 v[96:99], a[132:135], a[84:87], v[96:99]
    ds_read_b64_tr_b16 a[164:165], v13 offset:53248
    v_mfma_f32_16x16x32_bf16 v[96:99], a[128:131], a[68:71], v[96:99]
    ds_read_b64_tr_b16 a[166:167], v13 offset:54784
    v_mfma_f32_16x16x32_bf16 v[100:103], a[128:131], a[72:75], v[100:103]
    buffer_load_dwordx4 v220, s[32:35], s53 offen offset:0 lds
    v_mfma_f32_16x16x32_bf16 v[100:103], a[132:135], a[88:91], v[100:103]
    v_readlane_b32 s50, v18, s46
    v_mfma_f32_16x16x32_bf16 v[104:107], a[132:135], a[92:95], v[104:107]
    buffer_load_dwordx4 v221, s[32:35], s53 offen offset:1024 lds
    v_mfma_f32_16x16x32_bf16 v[104:107], a[128:131], a[76:79], v[104:107]
    v_readlane_b32 s52, v19, s46
    s_waitcnt lgkmcnt(4)
    v_mfma_f32_16x16x32_bf16 v[120:123], a[144:147], a[76:79], v[120:123]
    ds_read_b64_tr_b16 a[176:177], v13 offset:57344
    v_mfma_f32_16x16x32_bf16 v[120:123], a[148:151], a[92:95], v[120:123]
    ds_read_b64_tr_b16 a[178:179], v13 offset:58880
    v_mfma_f32_16x16x32_bf16 v[116:119], a[148:151], a[88:91], v[116:119]
    ds_read_b64_tr_b16 a[180:181], v13 offset:61440
    v_mfma_f32_16x16x32_bf16 v[116:119], a[144:147], a[72:75], v[116:119]
    ds_read_b64_tr_b16 a[182:183], v13 offset:62976
    v_mfma_f32_16x16x32_bf16 v[112:115], a[144:147], a[68:71], v[112:115]
    buffer_load_dwordx4 v222, s[32:35], s53 offen offset:2048 lds
    v_mfma_f32_16x16x32_bf16 v[112:115], a[148:151], a[84:87], v[112:115]
    s_add_u32 s46, s46, 1
    v_mfma_f32_16x16x32_bf16 v[108:111], a[148:151], a[80:83], v[108:111]
    v_mfma_f32_16x16x32_bf16 v[108:111], a[144:147], a[64:67], v[108:111]
    s_waitcnt lgkmcnt(4)
    v_mfma_f32_16x16x32_bf16 v[28:31], a[160:163], a[96:99], v[28:31]
    ds_read_b64_tr_b16 a[128:129], v13 offset:49184
    v_mfma_f32_16x16x32_bf16 v[28:31], a[164:167], a[112:115], v[28:31]
    ds_read_b64_tr_b16 a[130:131], v13 offset:50720
    v_mfma_f32_16x16x32_bf16 v[32:35], a[164:167], a[116:119], v[32:35]
    ds_read_b64_tr_b16 a[132:133], v13 offset:53280
    v_mfma_f32_16x16x32_bf16 v[32:35], a[160:163], a[100:103], v[32:35]
    ds_read_b64_tr_b16 a[134:135], v13 offset:54816
    v_mfma_f32_16x16x32_bf16 v[36:39], a[160:163], a[104:107], v[36:39]
    buffer_load_dwordx4 v223, s[32:35], s53 offen offset:3072 lds
    v_mfma_f32_16x16x32_bf16 v[36:39], a[164:167], a[120:123], v[36:39]
    v_mfma_f32_16x16x32_bf16 v[40:43], a[164:167], a[124:127], v[40:43]
    v_mfma_f32_16x16x32_bf16 v[40:43], a[160:163], a[108:111], v[40:43]
    s_add_u32 m0, s40, 16384
    s_waitcnt lgkmcnt(4)
    v_mfma_f32_16x16x32_bf16 v[56:59], a[176:179], a[108:111], v[56:59]
    ds_read_b64_tr_b16 a[144:145], v13 offset:57376
    v_mfma_f32_16x16x32_bf16 v[56:59], a[180:183], a[124:127], v[56:59]
    ds_read_b64_tr_b16 a[146:147], v13 offset:58912
    v_mfma_f32_16x16x32_bf16 v[52:55], a[180:183], a[120:123], v[52:55]
    ds_read_b64_tr_b16 a[148:149], v13 offset:61472
    v_mfma_f32_16x16x32_bf16 v[52:55], a[176:179], a[104:107], v[52:55]
    ds_read_b64_tr_b16 a[150:151], v13 offset:63008
    v_mfma_f32_16x16x32_bf16 v[48:51], a[176:179], a[100:103], v[48:51]
    buffer_load_dwordx4 v216, s[32:35], s53 offen offset:0 lds
    v_mfma_f32_16x16x32_bf16 v[48:51], a[180:183], a[116:119], v[48:51]
    buffer_load_dwordx4 v217, s[32:35], s53 offen offset:1024 lds
    v_mfma_f32_16x16x32_bf16 v[44:47], a[180:183], a[112:115], v[44:47]
    v_mfma_f32_16x16x32_bf16 v[44:47], a[176:179], a[96:99], v[44:47]
    s_waitcnt lgkmcnt(4)
    v_mfma_f32_16x16x32_bf16 v[60:63], a[128:131], a[96:99], v[60:63]
    ds_read_b64_tr_b16 a[160:161], v13 offset:49216
    v_mfma_f32_16x16x32_bf16 v[60:63], a[132:135], a[112:115], v[60:63]
    ds_read_b64_tr_b16 a[162:163], v13 offset:50752
    v_mfma_f32_16x16x32_bf16 v[64:67], a[132:135], a[116:119], v[64:67]
    ds_read_b64_tr_b16 a[164:165], v13 offset:53312
    v_mfma_f32_16x16x32_bf16 v[64:67], a[128:131], a[100:103], v[64:67]
    ds_read_b64_tr_b16 a[166:167], v13 offset:54848
    v_mfma_f32_16x16x32_bf16 v[68:71], a[128:131], a[104:107], v[68:71]
    buffer_load_dwordx4 v218, s[32:35], s53 offen offset:2048 lds
    v_mfma_f32_16x16x32_bf16 v[68:71], a[132:135], a[120:123], v[68:71]
    v_mfma_f32_16x16x32_bf16 v[72:75], a[132:135], a[124:127], v[72:75]
    v_mfma_f32_16x16x32_bf16 v[72:75], a[128:131], a[108:111], v[72:75]
    s_waitcnt lgkmcnt(4)
    v_mfma_f32_16x16x32_bf16 v[88:91], a[144:147], a[108:111], v[88:91]
    ds_read_b64_tr_b16 a[176:177], v13 offset:57408
    v_mfma_f32_16x16x32_bf16 v[88:91], a[148:151], a[124:127], v[88:91]
    ds_read_b64_tr_b16 a[178:179], v13 offset:58944
    v_mfma_f32_16x16x32_bf16 v[84:87], a[148:151], a[120:123], v[84:87]
    ds_read_b64_tr_b16 a[180:181], v13 offset:61504
    v_mfma_f32_16x16x32_bf16 v[84:87], a[144:147], a[104:107], v[84:87]
    ds_read_b64_tr_b16 a[182:183], v13 offset:63040
    v_mfma_f32_16x16x32_bf16 v[80:83], a[144:147], a[100:103], v[80:83]
    buffer_load_dwordx4 v219, s[32:35], s53 offen offset:3072 lds
    v_mfma_f32_16x16x32_bf16 v[80:83], a[148:151], a[116:119], v[80:83]
    v_mfma_f32_16x16x32_bf16 v[76:79], a[148:151], a[112:115], v[76:79]
    v_mfma_f32_16x16x32_bf16 v[76:79], a[144:147], a[96:99], v[76:79]
    s_waitcnt lgkmcnt(4)
    v_mfma_f32_16x16x32_bf16 v[92:95], a[160:163], a[96:99], v[92:95]
    s_waitcnt vmcnt(8)
    s_barrier
    ds_read_b64_tr_b16 a[128:129], v227 offset:0
    v_mfma_f32_16x16x32_bf16 v[92:95], a[164:167], a[112:115], v[92:95]
    ds_read_b64_tr_b16 a[130:131], v227 offset:2048
    s_add_u32 m0, s40, 98304
    v_mfma_f32_16x16x32_bf16 v[96:99], a[164:167], a[116:119], v[96:99]
    ds_read_b64_tr_b16 a[132:133], v227 offset:4096
    v_mfma_f32_16x16x32_bf16 v[96:99], a[160:163], a[100:103], v[96:99]
    ds_read_b64_tr_b16 a[134:135], v227 offset:6144
    v_mfma_f32_16x16x32_bf16 v[100:103], a[160:163], a[104:107], v[100:103]
    buffer_load_dwordx4 v220, s[32:35], s52 offen offset:0 lds
    v_mfma_f32_16x16x32_bf16 v[100:103], a[164:167], a[120:123], v[100:103]
    v_readlane_b32 s51, v18, s46
    v_mfma_f32_16x16x32_bf16 v[104:107], a[164:167], a[124:127], v[104:107]
    v_mfma_f32_16x16x32_bf16 v[104:107], a[160:163], a[108:111], v[104:107]
    s_waitcnt lgkmcnt(4)
    v_mfma_f32_16x16x32_bf16 v[120:123], a[176:179], a[108:111], v[120:123]
    ds_read_b64_tr_b16 a[144:145], v228 offset:0
    v_mfma_f32_16x16x32_bf16 v[120:123], a[180:183], a[124:127], v[120:123]
    ds_read_b64_tr_b16 a[146:147], v228 offset:2048
    v_mfma_f32_16x16x32_bf16 v[116:119], a[180:183], a[120:123], v[116:119]
    ds_read_b64_tr_b16 a[148:149], v228 offset:4096
    v_mfma_f32_16x16x32_bf16 v[116:119], a[176:179], a[104:107], v[116:119]
    ds_read_b64_tr_b16 a[150:151], v228 offset:6144
    v_mfma_f32_16x16x32_bf16 v[112:115], a[176:179], a[100:103], v[112:115]
    buffer_load_dwordx4 v221, s[32:35], s52 offen offset:1024 lds
    v_mfma_f32_16x16x32_bf16 v[112:115], a[180:183], a[116:119], v[112:115]
    v_readlane_b32 s53, v19, s46
    v_mfma_f32_16x16x32_bf16 v[108:111], a[180:183], a[112:115], v[108:111]
    v_mfma_f32_16x16x32_bf16 v[108:111], a[176:179], a[96:99], v[108:111]
    buffer_load_dwordx4 v222, s[32:35], s52 offen offset:2048 lds
    s_add_u32 s46, s46, 1
    buffer_load_dwordx4 v223, s[32:35], s52 offen offset:3072 lds
    s_add_u32 m0, s40, 32768
    s_nop 0
    buffer_load_dwordx4 v216, s[32:35], s52 offen offset:0 lds
    buffer_load_dwordx4 v217, s[32:35], s52 offen offset:1024 lds
    buffer_load_dwordx4 v218, s[32:35], s52 offen offset:2048 lds
    buffer_load_dwordx4 v219, s[32:35], s52 offen offset:3072 lds
    buffer_load_dword v226, v225, s[76:79], 0 offen offset:0 sc1
    v_pk_mul_f32 v[28:29], v[28:29], v[20:21] op_sel_hi:[1,0]
    v_pk_mul_f32 v[30:31], v[30:31], v[20:21] op_sel_hi:[1,0]
    v_pk_mul_f32 v[60:61], v[60:61], v[20:21] op_sel_hi:[1,0]
    v_pk_mul_f32 v[62:63], v[62:63], v[20:21] op_sel_hi:[1,0]
    v_exp_f32 v28, v28
    v_exp_f32 v29, v29
    v_exp_f32 v30, v30
    v_exp_f32 v31, v31
    v_exp_f32 v60, v60
    v_exp_f32 v61, v61
    v_exp_f32 v62, v62
    v_exp_f32 v63, v63
    v_pk_fma_f32 v[28:29], v[28:29], v[20:21], v[20:21] op_sel:[0,1,1] op_sel_hi:[1,1,1]
    v_pk_fma_f32 v[30:31], v[30:31], v[20:21], v[20:21] op_sel:[0,1,1] op_sel_hi:[1,1,1]
    v_pk_fma_f32 v[60:61], v[60:61], v[20:21], v[20:21] op_sel:[0,1,1] op_sel_hi:[1,1,1]
    v_pk_fma_f32 v[62:63], v[62:63], v[20:21], v[20:21] op_sel:[0,1,1] op_sel_hi:[1,1,1]
    v_rcp_f32 v28, v28
    v_rcp_f32 v29, v29
    v_rcp_f32 v30, v30
    v_rcp_f32 v31, v31
    v_rcp_f32 v60, v60
    v_rcp_f32 v61, v61
    v_rcp_f32 v62, v62
    v_rcp_f32 v63, v63
    v_pk_mul_f32 v[44:45], v[44:45], v[28:29]
    v_pk_mul_f32 v[46:47], v[46:47], v[30:31]
    v_pk_mul_f32 v[76:77], v[76:77], v[60:61]
    v_pk_mul_f32 v[78:79], v[78:79], v[62:63]
    v_cvt_pk_bf16_f32 v28, v44, v45
    v_cvt_pk_bf16_f32 v29, v46, v47
    v_cvt_pk_bf16_f32 v30, v76, v77
    v_cvt_pk_bf16_f32 v31, v78, v79
    s_nop 0
    v_permlane16_swap_b32 v28, v30
    v_permlane16_swap_b32 v29, v31
    buffer_store_dwordx4 v[28:31], v243, s[24:27], s42 offen offset:0 sc1
    v_pk_mul_f32 v[32:33], v[32:33], v[22:23] op_sel_hi:[1,0]
    v_pk_mul_f32 v[34:35], v[34:35], v[22:23] op_sel_hi:[1,0]
    v_pk_mul_f32 v[64:65], v[64:65], v[22:23] op_sel_hi:[1,0]
    v_pk_mul_f32 v[66:67], v[66:67], v[22:23] op_sel_hi:[1,0]
    v_exp_f32 v32, v32
    v_exp_f32 v33, v33
    v_exp_f32 v34, v34
    v_exp_f32 v35, v35
    v_exp_f32 v64, v64
    v_exp_f32 v65, v65
    v_exp_f32 v66, v66
    v_exp_f32 v67, v67
    v_pk_fma_f32 v[32:33], v[32:33], v[22:23], v[22:23] op_sel:[0,1,1] op_sel_hi:[1,1,1]
    v_pk_fma_f32 v[34:35], v[34:35], v[22:23], v[22:23] op_sel:[0,1,1] op_sel_hi:[1,1,1]
    v_pk_fma_f32 v[64:65], v[64:65], v[22:23], v[22:23] op_sel:[0,1,1] op_sel_hi:[1,1,1]
    v_pk_fma_f32 v[66:67], v[66:67], v[22:23], v[22:23] op_sel:[0,1,1] op_sel_hi:[1,1,1]
    v_rcp_f32 v32, v32
    v_rcp_f32 v33, v33
    v_rcp_f32 v34, v34
    v_rcp_f32 v35, v35
    v_rcp_f32 v64, v64
    v_rcp_f32 v65, v65
    v_rcp_f32 v66, v66
    v_rcp_f32 v67, v67
    v_pk_mul_f32 v[48:49], v[48:49], v[32:33]
    v_pk_mul_f32 v[50:51], v[50:51], v[34:35]
    v_pk_mul_f32 v[80:81], v[80:81], v[64:65]
    v_pk_mul_f32 v[82:83], v[82:83], v[66:67]
    v_readlane_b32 s58, v18, 16
    v_readlane_b32 s59, v18, 17
    v_readlane_b32 s60, v18, 18
    s_mov_b32 s15, 0
    s_lshr_b32 s14, s58, 18
    s_lshl_b32 s14, 3, s14
    s_or_b32 s15, s15, s14
    s_lshr_b32 s14, s59, 18
    s_lshl_b32 s14, 3, s14
    s_or_b32 s15, s15, s14
    s_lshr_b32 s14, s60, 18
    s_lshl_b32 s14, 3, s14
    s_or_b32 s15, s15, s14
    s_mov_b32 exec_lo, s15
    s_mov_b32 exec_hi, 0
    s_waitcnt vmcnt(1)
    s_mov_b32 s13, 0x40000
L_pa_chk:
    v_cmp_ne_u32 vcc, s100, v226
    s_nop 0
    s_cmp_eq_u64 vcc, 0
    s_cbranch_scc1 L_pa_ok
    s_mov_b64 exec, vcc
    buffer_load_dword v226, v225, s[76:79], 0 offen offset:0 sc1
    s_waitcnt vmcnt(0)
    s_sub_u32 s13, s13, 1
    s_cmp_lg_u32 s13, 0
    s_cbranch_scc1 L_pa_chk
L_pa_ok:
    s_mov_b64 exec, -1
    buffer_load_dwordx4 a[0:3], v212, s[24:27], s58 offen offset:0 sc1
    buffer_load_dwordx4 a[4:7], v212, s[24:27], s58 offen offset:1024 sc1
    buffer_load_dwordx4 a[8:11], v213, s[24:27], s58 offen offset:0 sc1
    buffer_load_dwordx4 a[12:15], v213, s[24:27], s58 offen offset:1024 sc1
    buffer_load_dwordx4 a[16:19], v214, s[24:27], s58 offen offset:0 sc1
    buffer_load_dwordx4 a[20:23], v214, s[24:27], s58 offen offset:1024 sc1
    buffer_load_dwordx4 a[24:27], v215, s[24:27], s58 offen offset:0 sc1
    buffer_load_dwordx4 a[28:31], v215, s[24:27], s58 offen offset:1024 sc1
    v_cvt_pk_bf16_f32 v32, v48, v49
    buffer_load_dwordx4 a[32:35], v212, s[24:27], s59 offen offset:0 sc1
    v_cvt_pk_bf16_f32 v33, v50, v51
    v_cvt_pk_bf16_f32 v34, v80, v81
    v_cvt_pk_bf16_f32 v35, v82, v83
    s_nop 0
    v_permlane16_swap_b32 v32, v34
    v_permlane16_swap_b32 v33, v35
    buffer_store_dwordx4 v[32:35], v243, s[24:27], s42 offen offset:1024 sc1
    v_pk_mul_f32 v[36:37], v[36:37], v[24:25] op_sel_hi:[1,0]
    buffer_load_dwordx4 a[36:39], v212, s[24:27], s59 offen offset:1024 sc1
    v_pk_mul_f32 v[38:39], v[38:39], v[24:25] op_sel_hi:[1,0]
    v_pk_mul_f32 v[68:69], v[68:69], v[24:25] op_sel_hi:[1,0]
    v_pk_mul_f32 v[70:71], v[70:71], v[24:25] op_sel_hi:[1,0]
    v_exp_f32 v36, v36
    v_exp_f32 v37, v37
    v_exp_f32 v38, v38
    v_exp_f32 v39, v39
    buffer_load_dwordx4 a[40:43], v213, s[24:27], s59 offen offset:0 sc1
    v_exp_f32 v68, v68
    v_exp_f32 v69, v69
    v_exp_f32 v70, v70
    v_exp_f32 v71, v71
    v_pk_fma_f32 v[36:37], v[36:37], v[24:25], v[24:25] op_sel:[0,1,1] op_sel_hi:[1,1,1]
    v_pk_fma_f32 v[38:39], v[38:39], v[24:25], v[24:25] op_sel:[0,1,1] op_sel_hi:[1,1,1]
    v_pk_fma_f32 v[68:69], v[68:69], v[24:25], v[24:25] op_sel:[0,1,1] op_sel_hi:[1,1,1]
    buffer_load_dwordx4 a[44:47], v213, s[24:27], s59 offen offset:1024 sc1
    v_pk_fma_f32 v[70:71], v[70:71], v[24:25], v[24:25] op_sel:[0,1,1] op_sel_hi:[1,1,1]
    v_rcp_f32 v36, v36
    v_rcp_f32 v37, v37
    v_rcp_f32 v38, v38
    v_rcp_f32 v39, v39
    v_rcp_f32 v68, v68
    v_rcp_f32 v69, v69
    buffer_load_dwordx4 a[48:51], v214, s[24:27], s59 offen offset:0 sc1
    v_rcp_f32 v70, v70
    v_rcp_f32 v71, v71
    v_pk_mul_f32 v[52:53], v[52:53], v[36:37]
    v_pk_mul_f32 v[54:55], v[54:55], v[38:39]
    v_pk_mul_f32 v[84:85], v[84:85], v[68:69]
    v_pk_mul_f32 v[86:87], v[86:87], v[70:71]
    v_cvt_pk_bf16_f32 v36, v52, v53
    buffer_load_dwordx4 a[52:55], v214, s[24:27], s59 offen offset:1024 sc1
    v_cvt_pk_bf16_f32 v37, v54, v55
    v_cvt_pk_bf16_f32 v38, v84, v85
    v_cvt_pk_bf16_f32 v39, v86, v87
    s_nop 0
    v_permlane16_swap_b32 v36, v38
    v_permlane16_swap_b32 v37, v39
    buffer_store_dwordx4 v[36:39], v243, s[24:27], s42 offen offset:2048 sc1
    v_pk_mul_f32 v[40:41], v[40:41], v[26:27] op_sel_hi:[1,0]
    buffer_load_dwordx4 a[56:59], v215, s[24:27], s59 offen offset:0 sc1
    v_pk_mul_f32 v[42:43], v[42:43], v[26:27] op_sel_hi:[1,0]
    v_pk_mul_f32 v[72:73], v[72:73], v[26:27] op_sel_hi:[1,0]
    v_pk_mul_f32 v[74:75], v[74:75], v[26:27] op_sel_hi:[1,0]
    v_exp_f32 v40, v40
    v_exp_f32 v41, v41
    v_exp_f32 v42, v42
    v_exp_f32 v43, v43
    buffer_load_dwordx4 a[60:63], v215, s[24:27], s59 offen offset:1024 sc1
    v_exp_f32 v72, v72
    v_exp_f32 v73, v73
    v_exp_f32 v74, v74
    v_exp_f32 v75, v75
    v_pk_fma_f32 v[40:41], v[40:41], v[26:27], v[26:27] op_sel:[0,1,1] op_sel_hi:[1,1,1]
    v_pk_fma_f32 v[42:43], v[42:43], v[26:27], v[26:27] op_sel:[0,1,1] op_sel_hi:[1,1,1]
    v_pk_fma_f32 v[72:73], v[72:73], v[26:27], v[26:27] op_sel:[0,1,1] op_sel_hi:[1,1,1]
    v_pk_fma_f32 v[74:75], v[74:75], v[26:27], v[26:27] op_sel:[0,1,1] op_sel_hi:[1,1,1]
    v_rcp_f32 v40, v40
    v_rcp_f32 v41, v41
    v_rcp_f32 v42, v42
    v_rcp_f32 v43, v43
    v_rcp_f32 v72, v72
    v_rcp_f32 v73, v73
    v_rcp_f32 v74, v74
    v_rcp_f32 v75, v75
    v_pk_mul_f32 v[56:57], v[56:57], v[40:41]
    v_pk_mul_f32 v[58:59], v[58:59], v[42:43]
    v_pk_mul_f32 v[88:89], v[88:89], v[72:73]
    v_pk_mul_f32 v[90:91], v[90:91], v[74:75]
    v_cvt_pk_bf16_f32 v40, v56, v57
    v_cvt_pk_bf16_f32 v41, v58, v59
    v_cvt_pk_bf16_f32 v42, v88, v89
    v_cvt_pk_bf16_f32 v43, v90, v91
    s_nop 0
    v_permlane16_swap_b32 v40, v42
    v_permlane16_swap_b32 v41, v43
    buffer_store_dwordx4 v[40:43], v243, s[24:27], s42 offen offset:3072 sc1
    v_pk_mul_f32 v[92:93], v[92:93], v[20:21] op_sel_hi:[1,0]
    v_pk_mul_f32 v[94:95], v[94:95], v[20:21] op_sel_hi:[1,0]
    v_exp_f32 v92, v92
    v_exp_f32 v93, v93
    v_exp_f32 v94, v94
    v_exp_f32 v95, v95
    v_pk_fma_f32 v[92:93], v[92:93], v[20:21], v[20:21] op_sel:[0,1,1] op_sel_hi:[1,1,1]
    v_pk_fma_f32 v[94:95], v[94:95], v[20:21], v[20:21] op_sel:[0,1,1] op_sel_hi:[1,1,1]
    v_rcp_f32 v92, v92
    v_rcp_f32 v93, v93
    v_rcp_f32 v94, v94
    v_rcp_f32 v95, v95
    v_pk_mul_f32 v[108:109], v[108:109], v[92:93]
    v_pk_mul_f32 v[110:111], v[110:111], v[94:95]
    v_cvt_pk_bf16_f32 v92, v108, v109
    v_cvt_pk_bf16_f32 v93, v110, v111
    v_pk_mul_f32 v[96:97], v[96:97], v[22:23] op_sel_hi:[1,0]
    v_pk_mul_f32 v[98:99], v[98:99], v[22:23] op_sel_hi:[1,0]
    v_exp_f32 v96, v96
    v_exp_f32 v97, v97
    v_exp_f32 v98, v98
    v_exp_f32 v99, v99
    v_pk_fma_f32 v[96:97], v[96:97], v[22:23], v[22:23] op_sel:[0,1,1] op_sel_hi:[1,1,1]
    v_pk_fma_f32 v[98:99], v[98:99], v[22:23], v[22:23] op_sel:[0,1,1] op_sel_hi:[1,1,1]
    v_rcp_f32 v96, v96
    v_rcp_f32 v97, v97
    v_rcp_f32 v98, v98
    v_rcp_f32 v99, v99
    v_pk_mul_f32 v[112:113], v[112:113], v[96:97]
    v_pk_mul_f32 v[114:115], v[114:115], v[98:99]
    v_cvt_pk_bf16_f32 v94, v112, v113
    v_cvt_pk_bf16_f32 v95, v114, v115
    s_nop 0
    v_permlane16_swap_b32 v92, v94
    v_permlane16_swap_b32 v93, v95
    buffer_store_dwordx4 v[92:95], v244, s[24:27], s43 offen offset:0 sc1
    v_pk_mul_f32 v[100:101], v[100:101], v[24:25] op_sel_hi:[1,0]
    v_pk_mul_f32 v[102:103], v[102:103], v[24:25] op_sel_hi:[1,0]
    v_exp_f32 v100, v100
    v_exp_f32 v101, v101
    v_exp_f32 v102, v102
    v_exp_f32 v103, v103
    v_pk_fma_f32 v[100:101], v[100:101], v[24:25], v[24:25] op_sel:[0,1,1] op_sel_hi:[1,1,1]
    v_pk_fma_f32 v[102:103], v[102:103], v[24:25], v[24:25] op_sel:[0,1,1] op_sel_hi:[1,1,1]
    v_rcp_f32 v100, v100
    v_rcp_f32 v101, v101
    v_rcp_f32 v102, v102
    v_rcp_f32 v103, v103
    v_pk_mul_f32 v[116:117], v[116:117], v[100:101]
    v_pk_mul_f32 v[118:119], v[118:119], v[102:103]
    v_cvt_pk_bf16_f32 v100, v116, v117
    v_cvt_pk_bf16_f32 v101, v118, v119
    v_pk_mul_f32 v[104:105], v[104:105], v[26:27] op_sel_hi:[1,0]
    v_pk_mul_f32 v[106:107], v[106:107], v[26:27] op_sel_hi:[1,0]
    v_exp_f32 v104, v104
    v_exp_f32 v105, v105
    v_exp_f32 v106, v106
    v_exp_f32 v107, v107
    v_pk_fma_f32 v[104:105], v[104:105], v[26:27], v[26:27] op_sel:[0,1,1] op_sel_hi:[1,1,1]
    v_pk_fma_f32 v[106:107], v[106:107], v[26:27], v[26:27] op_sel:[0,1,1] op_sel_hi:[1,1,1]
    v_rcp_f32 v104, v104
    v_rcp_f32 v105, v105
    v_rcp_f32 v106, v106
    v_rcp_f32 v107, v107
    v_pk_mul_f32 v[120:121], v[120:121], v[104:105]
    v_pk_mul_f32 v[122:123], v[122:123], v[106:107]
    v_cvt_pk_bf16_f32 v102, v120, v121
    v_cvt_pk_bf16_f32 v103, v122, v123
    s_nop 0
    v_permlane16_swap_b32 v100, v102
    v_permlane16_swap_b32 v101, v103
    buffer_store_dwordx4 v[100:103], v244, s[24:27], s43 offen offset:2048 sc1
    buffer_load_dword v226, v225, s[76:79], 0 offen offset:0 sc1
    s_waitcnt vmcnt(14)
    s_waitcnt lgkmcnt(4)
    v_mfma_f32_16x16x32_bf16 v[132:135], a[128:131], a[0:3], v[132:135]
    ds_read_b64_tr_b16 a[160:161], v229 offset:0
    buffer_load_dwordx4 a[64:67], v212, s[24:27], s60 offen offset:0 sc1
    v_mfma_f32_16x16x32_bf16 v[132:135], a[132:135], a[8:11], v[132:135]
    ds_read_b64_tr_b16 a[162:163], v229 offset:2048
    v_mfma_f32_16x16x32_bf16 v[136:139], a[132:135], a[12:15], v[136:139]
    ds_read_b64_tr_b16 a[164:165], v229 offset:4096
    v_mfma_f32_16x16x32_bf16 v[136:139], a[128:131], a[4:7], v[136:139]
    ds_read_b64_tr_b16 a[166:167], v229 offset:6144
    s_waitcnt lgkmcnt(4)
    v_mfma_f32_16x16x32_bf16 v[144:147], a[144:147], a[4:7], v[144:147]
    ds_read_b64_tr_b16 a[176:177], v230 offset:0
    v_mfma_f32_16x16x32_bf16 v[144:147], a[148:151], a[12:15], v[144:147]
    ds_read_b64_tr_b16 a[178:179], v230 offset:2048
    v_mfma_f32_16x16x32_bf16 v[140:143], a[148:151], a[8:11], v[140:143]
    ds_read_b64_tr_b16 a[180:181], v230 offset:4096
    buffer_load_dwordx4 a[68:71], v212, s[24:27], s60 offen offset:1024 sc1
    v_mfma_f32_16x16x32_bf16 v[140:143], a[144:147], a[0:3], v[140:143]
    ds_read_b64_tr_b16 a[182:183], v230 offset:6144
    s_waitcnt lgkmcnt(4)
    v_mfma_f32_16x16x32_bf16 v[148:151], a[160:163], a[0:3], v[148:151]
    ds_read_b64_tr_b16 a[128:129], v14 offset:0
    v_mfma_f32_16x16x32_bf16 v[148:151], a[164:167], a[8:11], v[148:151]
    ds_read_b64_tr_b16 a[130:131], v14 offset:2048
    v_mfma_f32_16x16x32_bf16 v[152:155], a[164:167], a[12:15], v[152:155]
    ds_read_b64_tr_b16 a[132:133], v14 offset:4096
    v_mfma_f32_16x16x32_bf16 v[152:155], a[160:163], a[4:7], v[152:155]
    ds_read_b64_tr_b16 a[134:135], v14 offset:6144
    s_waitcnt lgkmcnt(4)
    v_mfma_f32_16x16x32_bf16 v[160:163], a[176:179], a[4:7], v[160:163]
    ds_read_b64_tr_b16 a[144:145], v15 offset:0
    buffer_load_dwordx4 a[72:75], v213, s[24:27], s60 offen offset:0 sc1
    v_mfma_f32_16x16x32_bf16 v[160:163], a[180:183], a[12:15], v[160:163]
    ds_read_b64_tr_b16 a[146:147], v15 offset:2048
    v_mfma_f32_16x16x32_bf16 v[156:159], a[180:183], a[8:11], v[156:159]
    ds_read_b64_tr_b16 a[148:149], v15 offset:4096
    v_mfma_f32_16x16x32_bf16 v[156:159], a[176:179], a[0:3], v[156:159]
    ds_read_b64_tr_b16 a[150:151], v15 offset:6144
    s_waitcnt lgkmcnt(4)
    v_mfma_f32_16x16x32_bf16 v[164:167], a[128:131], a[0:3], v[164:167]
    ds_read_b64_tr_b16 a[160:161], v16 offset:0
    v_mfma_f32_16x16x32_bf16 v[164:167], a[132:135], a[8:11], v[164:167]
    ds_read_b64_tr_b16 a[162:163], v16 offset:2048
    v_mfma_f32_16x16x32_bf16 v[168:171], a[132:135], a[12:15], v[168:171]
    ds_read_b64_tr_b16 a[164:165], v16 offset:4096
    buffer_load_dwordx4 a[76:79], v213, s[24:27], s60 offen offset:1024 sc1
    v_mfma_f32_16x16x32_bf16 v[168:171], a[128:131], a[4:7], v[168:171]
    ds_read_b64_tr_b16 a[166:167], v16 offset:6144
    s_waitcnt lgkmcnt(4)
    v_mfma_f32_16x16x32_bf16 v[176:179], a[144:147], a[4:7], v[176:179]
    ds_read_b64_tr_b16 a[176:177], v17 offset:0
    v_mfma_f32_16x16x32_bf16 v[176:179], a[148:151], a[12:15], v[176:179]
    ds_read_b64_tr_b16 a[178:179], v17 offset:2048
    v_mfma_f32_16x16x32_bf16 v[172:175], a[148:151], a[8:11], v[172:175]
    ds_read_b64_tr_b16 a[180:181], v17 offset:4096
    v_mfma_f32_16x16x32_bf16 v[172:175], a[144:147], a[0:3], v[172:175]
    ds_read_b64_tr_b16 a[182:183], v17 offset:6144
    s_waitcnt lgkmcnt(4)
    v_mfma_f32_16x16x32_bf16 v[180:183], a[160:163], a[0:3], v[180:183]
    ds_read_b64_tr_b16 a[128:129], v227 offset:8192
    buffer_load_dwordx4 a[80:83], v214, s[24:27], s60 offen offset:0 sc1
    v_mfma_f32_16x16x32_bf16 v[180:183], a[164:167], a[8:11], v[180:183]
    ds_read_b64_tr_b16 a[130:131], v227 offset:10240
    v_mfma_f32_16x16x32_bf16 v[184:187], a[164:167], a[12:15], v[184:187]
    ds_read_b64_tr_b16 a[132:133], v227 offset:12288
    v_mfma_f32_16x16x32_bf16 v[184:187], a[160:163], a[4:7], v[184:187]
    ds_read_b64_tr_b16 a[134:135], v227 offset:14336
    s_waitcnt lgkmcnt(4)
    v_mfma_f32_16x16x32_bf16 v[192:195], a[176:179], a[4:7], v[192:195]
    ds_read_b64_tr_b16 a[144:145], v228 offset:8192
    v_mfma_f32_16x16x32_bf16 v[192:195], a[180:183], a[12:15], v[192:195]
    ds_read_b64_tr_b16 a[146:147], v228 offset:10240
    v_mfma_f32_16x16x32_bf16 v[188:191], a[180:183], a[8:11], v[188:191]
    ds_read_b64_tr_b16 a[148:149], v228 offset:12288
    buffer_load_dwordx4 a[84:87], v214, s[24:27], s60 offen offset:1024 sc1
    v_mfma_f32_16x16x32_bf16 v[188:191], a[176:179], a[0:3], v[188:191]
    ds_read_b64_tr_b16 a[150:151], v228 offset:14336
    s_waitcnt lgkmcnt(4)
    v_mfma_f32_16x16x32_bf16 v[132:135], a[128:131], a[16:19], v[132:135]
    ds_read_b64_tr_b16 a[160:161], v229 offset:8192
    v_mfma_f32_16x16x32_bf16 v[132:135], a[132:135], a[24:27], v[132:135]
    ds_read_b64_tr_b16 a[162:163], v229 offset:10240
    v_mfma_f32_16x16x32_bf16 v[136:139], a[132:135], a[28:31], v[136:139]
    ds_read_b64_tr_b16 a[164:165], v229 offset:12288
    v_mfma_f32_16x16x32_bf16 v[136:139], a[128:131], a[20:23], v[136:139]
    ds_read_b64_tr_b16 a[166:167], v229 offset:14336
    s_waitcnt lgkmcnt(4)
    v_mfma_f32_16x16x32_bf16 v[144:147], a[144:147], a[20:23], v[144:147]
    ds_read_b64_tr_b16 a[176:177], v230 offset:8192
    buffer_load_dwordx4 a[88:91], v215, s[24:27], s60 offen offset:0 sc1
    v_mfma_f32_16x16x32_bf16 v[144:147], a[148:151], a[28:31], v[144:147]
    ds_read_b64_tr_b16 a[178:179], v230 offset:10240
    v_mfma_f32_16x16x32_bf16 v[140:143], a[148:151], a[24:27], v[140:143]
    ds_read_b64_tr_b16 a[180:181], v230 offset:12288
    v_mfma_f32_16x16x32_bf16 v[140:143], a[144:147], a[16:19], v[140:143]
    ds_read_b64_tr_b16 a[182:183], v230 offset:14336
    s_waitcnt lgkmcnt(4)
    v_mfma_f32_16x16x32_bf16 v[148:151], a[160:163], a[16:19], v[148:151]
    ds_read_b64_tr_b16 a[128:129], v14 offset:8192
    v_mfma_f32_16x16x32_bf16 v[148:151], a[164:167], a[24:27], v[148:151]
    ds_read_b64_tr_b16 a[130:131], v14 offset:10240
    v_mfma_f32_16x16x32_bf16 v[152:155], a[164:167], a[28:31], v[152:155]
    ds_read_b64_tr_b16 a[132:133], v14 offset:12288
    buffer_load_dwordx4 a[92:95], v215, s[24:27], s60 offen offset:1024 sc1
    v_mfma_f32_16x16x32_bf16 v[152:155], a[160:163], a[20:23], v[152:155]
    ds_read_b64_tr_b16 a[134:135], v14 offset:14336
    s_waitcnt lgkmcnt(4)
    v_mfma_f32_16x16x32_bf16 v[160:163], a[176:179], a[20:23], v[160:163]
    ds_read_b64_tr_b16 a[144:145], v15 offset:8192
    v_mfma_f32_16x16x32_bf16 v[160:163], a[180:183], a[28:31], v[160:163]
    ds_read_b64_tr_b16 a[146:147], v15 offset:10240
    v_mfma_f32_16x16x32_bf16 v[156:159], a[180:183], a[24:27], v[156:159]
    ds_read_b64_tr_b16 a[148:149], v15 offset:12288
    v_mfma_f32_16x16x32_bf16 v[156:159], a[176:179], a[16:19], v[156:159]
    ds_read_b64_tr_b16 a[150:151], v15 offset:14336
    s_waitcnt lgkmcnt(4)
    v_mfma_f32_16x16x32_bf16 v[164:167], a[128:131], a[16:19], v[164:167]
    ds_read_b64_tr_b16 a[160:161], v16 offset:8192
    v_mfma_f32_16x16x32_bf16 v[164:167], a[132:135], a[24:27], v[164:167]
    ds_read_b64_tr_b16 a[162:163], v16 offset:10240
    v_mfma_f32_16x16x32_bf16 v[168:171], a[132:135], a[28:31], v[168:171]
    ds_read_b64_tr_b16 a[164:165], v16 offset:12288
    v_mfma_f32_16x16x32_bf16 v[168:171], a[128:131], a[20:23], v[168:171]
    ds_read_b64_tr_b16 a[166:167], v16 offset:14336
    s_waitcnt lgkmcnt(4)
    v_mfma_f32_16x16x32_bf16 v[176:179], a[144:147], a[20:23], v[176:179]
    ds_read_b64_tr_b16 a[176:177], v17 offset:8192
    v_mfma_f32_16x16x32_bf16 v[176:179], a[148:151], a[28:31], v[176:179]
    ds_read_b64_tr_b16 a[178:179], v17 offset:10240
    v_mfma_f32_16x16x32_bf16 v[172:175], a[148:151], a[24:27], v[172:175]
    ds_read_b64_tr_b16 a[180:181], v17 offset:12288
    v_mfma_f32_16x16x32_bf16 v[172:175], a[144:147], a[16:19], v[172:175]
    ds_read_b64_tr_b16 a[182:183], v17 offset:14336
    s_waitcnt lgkmcnt(4)
    v_mfma_f32_16x16x32_bf16 v[180:183], a[160:163], a[16:19], v[180:183]
    s_waitcnt vmcnt(8)
    s_mov_b32 s13, 0x40000
L_paall_chk:
    v_cmp_ne_u32 vcc, s100, v226
    s_nop 0
    s_cmp_eq_u64 vcc, 0
    s_cbranch_scc1 L_paall_ok
    s_mov_b64 exec, vcc
    buffer_load_dword v226, v225, s[76:79], 0 offen offset:0 sc1
    s_waitcnt vmcnt(0)
    s_sub_u32 s13, s13, 1
    s_cmp_lg_u32 s13, 0
    s_cbranch_scc1 L_paall_chk
L_paall_ok:
    s_mov_b64 exec, -1
    s_barrier
    ds_read_b64_tr_b16 a[128:129], v227 offset:16384
    v_mfma_f32_16x16x32_bf16 v[180:183], a[164:167], a[24:27], v[180:183]
    ds_read_b64_tr_b16 a[130:131], v227 offset:18432
    s_add_u32 m0, s40, 114688
    v_mfma_f32_16x16x32_bf16 v[184:187], a[164:167], a[28:31], v[184:187]
    ds_read_b64_tr_b16 a[132:133], v227 offset:20480
    buffer_load_dwordx4 v220, s[32:35], s53 offen offset:0 lds
    v_mfma_f32_16x16x32_bf16 v[184:187], a[160:163], a[20:23], v[184:187]
    ds_read_b64_tr_b16 a[134:135], v227 offset:22528
    v_readlane_b32 s50, v18, s46
    s_waitcnt lgkmcnt(4)
    v_mfma_f32_16x16x32_bf16 v[192:195], a[176:179], a[20:23], v[192:195]
    ds_read_b64_tr_b16 a[144:145], v228 offset:16384
    buffer_load_dwordx4 a[96:99], v212, s[24:27], s51 offen offset:0 sc1
    v_mfma_f32_16x16x32_bf16 v[192:195], a[180:183], a[28:31], v[192:195]
    ds_read_b64_tr_b16 a[146:147], v228 offset:18432
    v_readlane_b32 s52, v19, s46
    v_mfma_f32_16x16x32_bf16 v[188:191], a[180:183], a[24:27], v[188:191]
    ds_read_b64_tr_b16 a[148:149], v228 offset:20480
    v_mfma_f32_16x16x32_bf16 v[188:191], a[176:179], a[16:19], v[188:191]
    ds_read_b64_tr_b16 a[150:151], v228 offset:22528
    s_getpc_b64 s[72:73]
L_cp6:
    s_lshr_b32 s74, s2, 3
    s_lshl2_add_u32 s74, s74, s3
    s_lshl_b32 s74, s74, 7
    s_add_u32 s74, s74, 4096
    s_min_u32 s74, s74, L_end-L_cp6
    s_add_u32 s72, s72, s74
    s_addc_u32 s73, s73, 0
    v_and_b32 v254, 0, v0
    v_lshlrev_b32 v254, 7, v254
    v_mov_b32 v255, s73
    v_add_co_u32 v254, vcc, s72, v254
    s_nop 1
    v_addc_co_u32 v255, vcc, 0, v255, vcc
    global_load_dword a251, v[254:255], off
    s_waitcnt lgkmcnt(4)
    v_mfma_f32_16x16x32_bf16 v[132:135], a[128:131], a[32:35], v[132:135]
    ds_read_b64_tr_b16 a[160:161], v229 offset:16384
    buffer_load_dwordx4 v221, s[32:35], s53 offen offset:1024 lds
    v_mfma_f32_16x16x32_bf16 v[132:135], a[132:135], a[40:43], v[132:135]
    ds_read_b64_tr_b16 a[162:163], v229 offset:18432
    s_add_u32 s46, s46, 1
    v_mfma_f32_16x16x32_bf16 v[136:139], a[132:135], a[44:47], v[136:139]
    ds_read_b64_tr_b16 a[164:165], v229 offset:20480
    v_mfma_f32_16x16x32_bf16 v[136:139], a[128:131], a[36:39], v[136:139]
    ds_read_b64_tr_b16 a[166:167], v229 offset:22528
    s_waitcnt lgkmcnt(4)
    v_mfma_f32_16x16x32_bf16 v[144:147], a[144:147], a[36:39], v[144:147]
    ds_read_b64_tr_b16 a[176:177], v230 offset:16384
    buffer_load_dwordx4 a[100:103], v212, s[24:27], s51 offen offset:1024 sc1
    v_mfma_f32_16x16x32_bf16 v[144:147], a[148:151], a[44:47], v[144:147]
    ds_read_b64_tr_b16 a[178:179], v230 offset:18432
    v_mfma_f32_16x16x32_bf16 v[140:143], a[148:151], a[40:43], v[140:143]
    ds_read_b64_tr_b16 a[180:181], v230 offset:20480
    v_mfma_f32_16x16x32_bf16 v[140:143], a[144:147], a[32:35], v[140:143]
    ds_read_b64_tr_b16 a[182:183], v230 offset:22528
    s_waitcnt lgkmcnt(4)
    v_mfma_f32_16x16x32_bf16 v[148:151], a[160:163], a[32:35], v[148:151]
    ds_read_b64_tr_b16 a[128:129], v14 offset:16384
    buffer_load_dwordx4 v222, s[32:35], s53 offen offset:2048 lds
    v_mfma_f32_16x16x32_bf16 v[148:151], a[164:167], a[40:43], v[148:151]
    ds_read_b64_tr_b16 a[130:131], v14 offset:18432
    v_mfma_f32_16x16x32_bf16 v[152:155], a[164:167], a[44:47], v[152:155]
    ds_read_b64_tr_b16 a[132:133], v14 offset:20480
    v_mfma_f32_16x16x32_bf16 v[152:155], a[160:163], a[36:39], v[152:155]
    ds_read_b64_tr_b16 a[134:135], v14 offset:22528
    s_waitcnt lgkmcnt(4)
    v_mfma_f32_16x16x32_bf16 v[160:163], a[176:179], a[36:39], v[160:163]
    ds_read_b64_tr_b16 a[144:145], v15 offset:16384
    buffer_load_dwordx4 a[104:107], v213, s[24:27], s51 offen offset:0 sc1
    v_mfma_f32_16x16x32_bf16 v[160:163], a[180:183], a[44:47], v[160:163]
    ds_read_b64_tr_b16 a[146:147], v15 offset:18432
    v_mfma_f32_16x16x32_bf16 v[156:159], a[180:183], a[40:43], v[156:159]
    ds_read_b64_tr_b16 a[148:149], v15 offset:20480
    v_mfma_f32_16x16x32_bf16 v[156:159], a[176:179], a[32:35], v[156:159]
    ds_read_b64_tr_b16 a[150:151], v15 offset:22528
    s_waitcnt lgkmcnt(4)
    v_mfma_f32_16x16x32_bf16 v[164:167], a[128:131], a[32:35], v[164:167]
    ds_read_b64_tr_b16 a[160:161], v16 offset:16384
    buffer_load_dwordx4 v223, s[32:35], s53 offen offset:3072 lds
    v_mfma_f32_16x16x32_bf16 v[164:167], a[132:135], a[40:43], v[164:167]
    ds_read_b64_tr_b16 a[162:163], v16 offset:18432
    v_mfma_f32_16x16x32_bf16 v[168:171], a[132:135], a[44:47], v[168:171]
    ds_read_b64_tr_b16 a[164:165], v16 offset:20480
    v_mfma_f32_16x16x32_bf16 v[168:171], a[128:131], a[36:39], v[168:171]
    ds_read_b64_tr_b16 a[166:167], v16 offset:22528
    s_waitcnt lgkmcnt(4)
    v_mfma_f32_16x16x32_bf16 v[176:179], a[144:147], a[36:39], v[176:179]
    ds_read_b64_tr_b16 a[176:177], v17 offset:16384
    buffer_load_dwordx4 a[108:111], v213, s[24:27], s51 offen offset:1024 sc1
    v_mfma_f32_16x16x32_bf16 v[176:179], a[148:151], a[44:47], v[176:179]
    ds_read_b64_tr_b16 a[178:179], v17 offset:18432
    v_mfma_f32_16x16x32_bf16 v[172:175], a[148:151], a[40:43], v[172:175]
    ds_read_b64_tr_b16 a[180:181], v17 offset:20480
    v_mfma_f32_16x16x32_bf16 v[172:175], a[144:147], a[32:35], v[172:175]
    ds_read_b64_tr_b16 a[182:183], v17 offset:22528
    s_waitcnt lgkmcnt(4)
    v_mfma_f32_16x16x32_bf16 v[180:183], a[160:163], a[32:35], v[180:183]
    ds_read_b64_tr_b16 a[128:129], v227 offset:24576
    s_add_u32 m0, s40, 49152
    v_mfma_f32_16x16x32_bf16 v[180:183], a[164:167], a[40:43], v[180:183]
    ds_read_b64_tr_b16 a[130:131], v227 offset:26624
    buffer_load_dwordx4 v216, s[32:35], s53 offen offset:0 lds
    v_mfma_f32_16x16x32_bf16 v[184:187], a[164:167], a[44:47], v[184:187]
    ds_read_b64_tr_b16 a[132:133], v227 offset:28672
    v_mfma_f32_16x16x32_bf16 v[184:187], a[160:163], a[36:39], v[184:187]
    ds_read_b64_tr_b16 a[134:135], v227 offset:30720
    s_waitcnt lgkmcnt(4)
    v_mfma_f32_16x16x32_bf16 v[192:195], a[176:179], a[36:39], v[192:195]
    ds_read_b64_tr_b16 a[144:145], v228 offset:24576
    buffer_load_dwordx4 a[112:115], v214, s[24:27], s51 offen offset:0 sc1
    v_mfma_f32_16x16x32_bf16 v[192:195], a[180:183], a[44:47], v[192:195]
    ds_read_b64_tr_b16 a[146:147], v228 offset:26624
    v_mfma_f32_16x16x32_bf16 v[188:191], a[180:183], a[40:43], v[188:191]
    ds_read_b64_tr_b16 a[148:149], v228 offset:28672
    v_mfma_f32_16x16x32_bf16 v[188:191], a[176:179], a[32:35], v[188:191]
    ds_read_b64_tr_b16 a[150:151], v228 offset:30720
    s_waitcnt lgkmcnt(4)
    v_mfma_f32_16x16x32_bf16 v[132:135], a[128:131], a[48:51], v[132:135]
    ds_read_b64_tr_b16 a[160:161], v229 offset:24576
    buffer_load_dwordx4 v217, s[32:35], s53 offen offset:1024 lds
    v_mfma_f32_16x16x32_bf16 v[132:135], a[132:135], a[56:59], v[132:135]
    ds_read_b64_tr_b16 a[162:163], v229 offset:26624
    v_mfma_f32_16x16x32_bf16 v[136:139], a[132:135], a[60:63], v[136:139]
    ds_read_b64_tr_b16 a[164:165], v229 offset:28672
    v_mfma_f32_16x16x32_bf16 v[136:139], a[128:131], a[52:55], v[136:139]
    ds_read_b64_tr_b16 a[166:167], v229 offset:30720
    s_waitcnt lgkmcnt(4)
    v_mfma_f32_16x16x32_bf16 v[144:147], a[144:147], a[52:55], v[144:147]
    ds_read_b64_tr_b16 a[176:177], v230 offset:24576
    buffer_load_dwordx4 a[116:119], v214, s[24:27], s51 offen offset:1024 sc1
    v_mfma_f32_16x16x32_bf16 v[144:147], a[148:151], a[60:63], v[144:147]
    ds_read_b64_tr_b16 a[178:179], v230 offset:26624
    v_mfma_f32_16x16x32_bf16 v[140:143], a[148:151], a[56:59], v[140:143]
    ds_read_b64_tr_b16 a[180:181], v230 offset:28672
    v_mfma_f32_16x16x32_bf16 v[140:143], a[144:147], a[48:51], v[140:143]
    ds_read_b64_tr_b16 a[182:183], v230 offset:30720
    s_waitcnt lgkmcnt(4)
    v_mfma_f32_16x16x32_bf16 v[148:151], a[160:163], a[48:51], v[148:151]
    ds_read_b64_tr_b16 a[128:129], v14 offset:24576
    buffer_load_dwordx4 v218, s[32:35], s53 offen offset:2048 lds
    v_mfma_f32_16x16x32_bf16 v[148:151], a[164:167], a[56:59], v[148:151]
    ds_read_b64_tr_b16 a[130:131], v14 offset:26624
    v_mfma_f32_16x16x32_bf16 v[152:155], a[164:167], a[60:63], v[152:155]
    ds_read_b64_tr_b16 a[132:133], v14 offset:28672
    v_mfma_f32_16x16x32_bf16 v[152:155], a[160:163], a[52:55], v[152:155]
    ds_read_b64_tr_b16 a[134:135], v14 offset:30720
    s_waitcnt lgkmcnt(4)
    v_mfma_f32_16x16x32_bf16 v[160:163], a[176:179], a[52:55], v[160:163]
    ds_read_b64_tr_b16 a[144:145], v15 offset:24576
    buffer_load_dwordx4 a[120:123], v215, s[24:27], s51 offen offset:0 sc1
    v_mfma_f32_16x16x32_bf16 v[160:163], a[180:183], a[60:63], v[160:163]
    ds_read_b64_tr_b16 a[146:147], v15 offset:26624
    v_mfma_f32_16x16x32_bf16 v[156:159], a[180:183], a[56:59], v[156:159]
    ds_read_b64_tr_b16 a[148:149], v15 offset:28672
    v_mfma_f32_16x16x32_bf16 v[156:159], a[176:179], a[48:51], v[156:159]
    ds_read_b64_tr_b16 a[150:151], v15 offset:30720
    s_waitcnt lgkmcnt(4)
    v_mfma_f32_16x16x32_bf16 v[164:167], a[128:131], a[48:51], v[164:167]
    ds_read_b64_tr_b16 a[160:161], v16 offset:24576
    buffer_load_dwordx4 v219, s[32:35], s53 offen offset:3072 lds
    v_mfma_f32_16x16x32_bf16 v[164:167], a[132:135], a[56:59], v[164:167]
    ds_read_b64_tr_b16 a[162:163], v16 offset:26624
    v_mfma_f32_16x16x32_bf16 v[168:171], a[132:135], a[60:63], v[168:171]
    ds_read_b64_tr_b16 a[164:165], v16 offset:28672
    v_mfma_f32_16x16x32_bf16 v[168:171], a[128:131], a[52:55], v[168:171]
    ds_read_b64_tr_b16 a[166:167], v16 offset:30720
    s_waitcnt lgkmcnt(4)
    v_mfma_f32_16x16x32_bf16 v[176:179], a[144:147], a[52:55], v[176:179]
    ds_read_b64_tr_b16 a[176:177], v17 offset:24576
    buffer_load_dwordx4 a[124:127], v215, s[24:27], s51 offen offset:1024 sc1
    v_mfma_f32_16x16x32_bf16 v[176:179], a[148:151], a[60:63], v[176:179]
    ds_read_b64_tr_b16 a[178:179], v17 offset:26624
    v_mfma_f32_16x16x32_bf16 v[172:175], a[148:151], a[56:59], v[172:175]
    ds_read_b64_tr_b16 a[180:181], v17 offset:28672
    v_mfma_f32_16x16x32_bf16 v[172:175], a[144:147], a[48:51], v[172:175]
    ds_read_b64_tr_b16 a[182:183], v17 offset:30720
    s_waitcnt lgkmcnt(4)
    v_mfma_f32_16x16x32_bf16 v[180:183], a[160:163], a[48:51], v[180:183]
    s_waitcnt vmcnt(17)
    v_mov_b32 v1, s100
    s_mov_b64 exec, 1
    buffer_store_dword v1, v0, s[76:79], s75 offen offset:16 sc1
    s_mov_b64 exec, -1
    s_barrier
    ds_read_b64_tr_b16 a[128:129], v227 offset:32768
    v_mfma_f32_16x16x32_bf16 v[180:183], a[164:167], a[56:59], v[180:183]
    ds_read_b64_tr_b16 a[130:131], v227 offset:34816
    s_add_u32 m0, s40, 65536
    v_mfma_f32_16x16x32_bf16 v[184:187], a[164:167], a[60:63], v[184:187]
    ds_read_b64_tr_b16 a[132:133], v227 offset:36864
    buffer_load_dwordx4 v220, s[32:35], s52 offen offset:0 lds
    v_mfma_f32_16x16x32_bf16 v[184:187], a[160:163], a[52:55], v[184:187]
    ds_read_b64_tr_b16 a[134:135], v227 offset:38912
    v_readlane_b32 s51, v18, s46
    s_waitcnt lgkmcnt(4)
    v_mfma_f32_16x16x32_bf16 v[192:195], a[176:179], a[52:55], v[192:195]
    ds_read_b64_tr_b16 a[144:145], v228 offset:32768
    buffer_load_dwordx4 a[0:3], v212, s[24:27], s50 offen offset:0 sc1
    v_mfma_f32_16x16x32_bf16 v[192:195], a[180:183], a[60:63], v[192:195]
    ds_read_b64_tr_b16 a[146:147], v228 offset:34816
    v_readlane_b32 s53, v19, s46
    v_mfma_f32_16x16x32_bf16 v[188:191], a[180:183], a[56:59], v[188:191]
    ds_read_b64_tr_b16 a[148:149], v228 offset:36864
    v_mfma_f32_16x16x32_bf16 v[188:191], a[176:179], a[48:51], v[188:191]
    ds_read_b64_tr_b16 a[150:151], v228 offset:38912
    s_waitcnt lgkmcnt(4)
    v_mfma_f32_16x16x32_bf16 v[132:135], a[128:131], a[64:67], v[132:135]
    ds_read_b64_tr_b16 a[160:161], v229 offset:32768
    buffer_load_dwordx4 v221, s[32:35], s52 offen offset:1024 lds
    v_mfma_f32_16x16x32_bf16 v[132:135], a[132:135], a[72:75], v[132:135]
    ds_read_b64_tr_b16 a[162:163], v229 offset:34816
    s_add_u32 s46, s46, 1
    v_mfma_f32_16x16x32_bf16 v[136:139], a[132:135], a[76:79], v[136:139]
    ds_read_b64_tr_b16 a[164:165], v229 offset:36864
    v_mfma_f32_16x16x32_bf16 v[136:139], a[128:131], a[68:71], v[136:139]
    ds_read_b64_tr_b16 a[166:167], v229 offset:38912
    s_waitcnt lgkmcnt(4)
    v_mfma_f32_16x16x32_bf16 v[144:147], a[144:147], a[68:71], v[144:147]
    ds_read_b64_tr_b16 a[176:177], v230 offset:32768
    buffer_load_dwordx4 a[4:7], v212, s[24:27], s50 offen offset:1024 sc1
    v_mfma_f32_16x16x32_bf16 v[144:147], a[148:151], a[76:79], v[144:147]
    ds_read_b64_tr_b16 a[178:179], v230 offset:34816
    v_mfma_f32_16x16x32_bf16 v[140:143], a[148:151], a[72:75], v[140:143]
    ds_read_b64_tr_b16 a[180:181], v230 offset:36864
    v_mfma_f32_16x16x32_bf16 v[140:143], a[144:147], a[64:67], v[140:143]
    ds_read_b64_tr_b16 a[182:183], v230 offset:38912
    s_waitcnt lgkmcnt(4)
    v_mfma_f32_16x16x32_bf16 v[148:151], a[160:163], a[64:67], v[148:151]
    ds_read_b64_tr_b16 a[128:129], v14 offset:32768
    buffer_load_dwordx4 v222, s[32:35], s52 offen offset:2048 lds
    v_mfma_f32_16x16x32_bf16 v[148:151], a[164:167], a[72:75], v[148:151]
    ds_read_b64_tr_b16 a[130:131], v14 offset:34816
    v_mfma_f32_16x16x32_bf16 v[152:155], a[164:167], a[76:79], v[152:155]
    ds_read_b64_tr_b16 a[132:133], v14 offset:36864
    v_mfma_f32_16x16x32_bf16 v[152:155], a[160:163], a[68:71], v[152:155]
    ds_read_b64_tr_b16 a[134:135], v14 offset:38912
    s_waitcnt lgkmcnt(4)
    v_mfma_f32_16x16x32_bf16 v[160:163], a[176:179], a[68:71], v[160:163]
    ds_read_b64_tr_b16 a[144:145], v15 offset:32768
    buffer_load_dwordx4 a[8:11], v213, s[24:27], s50 offen offset:0 sc1
    v_mfma_f32_16x16x32_bf16 v[160:163], a[180:183], a[76:79], v[160:163]
    ds_read_b64_tr_b16 a[146:147], v15 offset:34816
    v_mfma_f32_16x16x32_bf16 v[156:159], a[180:183], a[72:75], v[156:159]
    ds_read_b64_tr_b16 a[148:149], v15 offset:36864
    v_mfma_f32_16x16x32_bf16 v[156:159], a[176:179], a[64:67], v[156:159]
    ds_read_b64_tr_b16 a[150:151], v15 offset:38912
    s_waitcnt lgkmcnt(4)
    v_mfma_f32_16x16x32_bf16 v[164:167], a[128:131], a[64:67], v[164:167]
    ds_read_b64_tr_b16 a[160:161], v16 offset:32768
    buffer_load_dwordx4 v223, s[32:35], s52 offen offset:3072 lds
    v_mfma_f32_16x16x32_bf16 v[164:167], a[132:135], a[72:75], v[164:167]
    ds_read_b64_tr_b16 a[162:163], v16 offset:34816
    v_mfma_f32_16x16x32_bf16 v[168:171], a[132:135], a[76:79], v[168:171]
    ds_read_b64_tr_b16 a[164:165], v16 offset:36864
    v_mfma_f32_16x16x32_bf16 v[168:171], a[128:131], a[68:71], v[168:171]
    ds_read_b64_tr_b16 a[166:167], v16 offset:38912
    s_waitcnt lgkmcnt(4)
    v_mfma_f32_16x16x32_bf16 v[176:179], a[144:147], a[68:71], v[176:179]
    ds_read_b64_tr_b16 a[176:177], v17 offset:32768
    buffer_load_dwordx4 a[12:15], v213, s[24:27], s50 offen offset:1024 sc1
    v_mfma_f32_16x16x32_bf16 v[176:179], a[148:151], a[76:79], v[176:179]
    ds_read_b64_tr_b16 a[178:179], v17 offset:34816
    v_mfma_f32_16x16x32_bf16 v[172:175], a[148:151], a[72:75], v[172:175]
    ds_read_b64_tr_b16 a[180:181], v17 offset:36864
    v_mfma_f32_16x16x32_bf16 v[172:175], a[144:147], a[64:67], v[172:175]
    ds_read_b64_tr_b16 a[182:183], v17 offset:38912
    s_waitcnt lgkmcnt(4)
    v_mfma_f32_16x16x32_bf16 v[180:183], a[160:163], a[64:67], v[180:183]
    ds_read_b64_tr_b16 a[128:129], v227 offset:40960
    s_add_u32 m0, s40, 0
    v_mfma_f32_16x16x32_bf16 v[180:183], a[164:167], a[72:75], v[180:183]
    ds_read_b64_tr_b16 a[130:131], v227 offset:43008
    buffer_load_dwordx4 v216, s[32:35], s52 offen offset:0 lds
    v_mfma_f32_16x16x32_bf16 v[184:187], a[164:167], a[76:79], v[184:187]
    ds_read_b64_tr_b16 a[132:133], v227 offset:45056
    v_mfma_f32_16x16x32_bf16 v[184:187], a[160:163], a[68:71], v[184:187]
    ds_read_b64_tr_b16 a[134:135], v227 offset:47104
    s_waitcnt lgkmcnt(4)
    v_mfma_f32_16x16x32_bf16 v[192:195], a[176:179], a[68:71], v[192:195]
    ds_read_b64_tr_b16 a[144:145], v228 offset:40960
    buffer_load_dwordx4 a[16:19], v214, s[24:27], s50 offen offset:0 sc1
    v_mfma_f32_16x16x32_bf16 v[192:195], a[180:183], a[76:79], v[192:195]
    ds_read_b64_tr_b16 a[146:147], v228 offset:43008
    v_mfma_f32_16x16x32_bf16 v[188:191], a[180:183], a[72:75], v[188:191]
    ds_read_b64_tr_b16 a[148:149], v228 offset:45056
    v_mfma_f32_16x16x32_bf16 v[188:191], a[176:179], a[64:67], v[188:191]
    ds_read_b64_tr_b16 a[150:151], v228 offset:47104
    s_waitcnt lgkmcnt(4)
    v_mfma_f32_16x16x32_bf16 v[132:135], a[128:131], a[80:83], v[132:135]
    ds_read_b64_tr_b16 a[160:161], v229 offset:40960
    buffer_load_dwordx4 v217, s[32:35], s52 offen offset:1024 lds
    v_mfma_f32_16x16x32_bf16 v[132:135], a[132:135], a[88:91], v[132:135]
    ds_read_b64_tr_b16 a[162:163], v229 offset:43008
    v_mfma_f32_16x16x32_bf16 v[136:139], a[132:135], a[92:95], v[136:139]
    ds_read_b64_tr_b16 a[164:165], v229 offset:45056
    v_mfma_f32_16x16x32_bf16 v[136:139], a[128:131], a[84:87], v[136:139]
    ds_read_b64_tr_b16 a[166:167], v229 offset:47104
    s_waitcnt lgkmcnt(4)
    v_mfma_f32_16x16x32_bf16 v[144:147], a[144:147], a[84:87], v[144:147]
    ds_read_b64_tr_b16 a[176:177], v230 offset:40960
    buffer_load_dwordx4 a[20:23], v214, s[24:27], s50 offen offset:1024 sc1
    v_mfma_f32_16x16x32_bf16 v[144:147], a[148:151], a[92:95], v[144:147]
    ds_read_b64_tr_b16 a[178:179], v230 offset:43008
    v_mfma_f32_16x16x32_bf16 v[140:143], a[148:151], a[88:91], v[140:143]
    ds_read_b64_tr_b16 a[180:181], v230 offset:45056
    v_mfma_f32_16x16x32_bf16 v[140:143], a[144:147], a[80:83], v[140:143]
    ds_read_b64_tr_b16 a[182:183], v230 offset:47104
    s_waitcnt lgkmcnt(4)
    v_mfma_f32_16x16x32_bf16 v[148:151], a[160:163], a[80:83], v[148:151]
    ds_read_b64_tr_b16 a[128:129], v14 offset:40960
    buffer_load_dwordx4 v218, s[32:35], s52 offen offset:2048 lds
    v_mfma_f32_16x16x32_bf16 v[148:151], a[164:167], a[88:91], v[148:151]
    ds_read_b64_tr_b16 a[130:131], v14 offset:43008
    v_mfma_f32_16x16x32_bf16 v[152:155], a[164:167], a[92:95], v[152:155]
    ds_read_b64_tr_b16 a[132:133], v14 offset:45056
    v_mfma_f32_16x16x32_bf16 v[152:155], a[160:163], a[84:87], v[152:155]
    ds_read_b64_tr_b16 a[134:135], v14 offset:47104
    s_waitcnt lgkmcnt(4)
    v_mfma_f32_16x16x32_bf16 v[160:163], a[176:179], a[84:87], v[160:163]
    ds_read_b64_tr_b16 a[144:145], v15 offset:40960
    buffer_load_dwordx4 a[24:27], v215, s[24:27], s50 offen offset:0 sc1
    v_mfma_f32_16x16x32_bf16 v[160:163], a[180:183], a[92:95], v[160:163]
    ds_read_b64_tr_b16 a[146:147], v15 offset:43008
    v_mfma_f32_16x16x32_bf16 v[156:159], a[180:183], a[88:91], v[156:159]
    ds_read_b64_tr_b16 a[148:149], v15 offset:45056
    v_mfma_f32_16x16x32_bf16 v[156:159], a[176:179], a[80:83], v[156:159]
    ds_read_b64_tr_b16 a[150:151], v15 offset:47104
    s_waitcnt lgkmcnt(4)
    v_mfma_f32_16x16x32_bf16 v[164:167], a[128:131], a[80:83], v[164:167]
    ds_read_b64_tr_b16 a[160:161], v16 offset:40960
    buffer_load_dwordx4 v219, s[32:35], s52 offen offset:3072 lds
    v_mfma_f32_16x16x32_bf16 v[164:167], a[132:135], a[88:91], v[164:167]
    ds_read_b64_tr_b16 a[162:163], v16 offset:43008
    v_mfma_f32_16x16x32_bf16 v[168:171], a[132:135], a[92:95], v[168:171]
    ds_read_b64_tr_b16 a[164:165], v16 offset:45056
    v_mfma_f32_16x16x32_bf16 v[168:171], a[128:131], a[84:87], v[168:171]
    ds_read_b64_tr_b16 a[166:167], v16 offset:47104
    s_waitcnt lgkmcnt(4)
    v_mfma_f32_16x16x32_bf16 v[176:179], a[144:147], a[84:87], v[176:179]
    ds_read_b64_tr_b16 a[176:177], v17 offset:40960
    buffer_load_dwordx4 a[28:31], v215, s[24:27], s50 offen offset:1024 sc1
    v_mfma_f32_16x16x32_bf16 v[176:179], a[148:151], a[92:95], v[176:179]
    ds_read_b64_tr_b16 a[178:179], v17 offset:43008
    v_mfma_f32_16x16x32_bf16 v[172:175], a[148:151], a[88:91], v[172:175]
    ds_read_b64_tr_b16 a[180:181], v17 offset:45056
    v_mfma_f32_16x16x32_bf16 v[172:175], a[144:147], a[80:83], v[172:175]
    ds_read_b64_tr_b16 a[182:183], v17 offset:47104
    s_waitcnt lgkmcnt(4)
    v_mfma_f32_16x16x32_bf16 v[180:183], a[160:163], a[80:83], v[180:183]
    s_waitcnt vmcnt(17)
    s_barrier
    ds_read_b64_tr_b16 a[128:129], v227 offset:49152
    v_mfma_f32_16x16x32_bf16 v[180:183], a[164:167], a[88:91], v[180:183]
    ds_read_b64_tr_b16 a[130:131], v227 offset:51200
    s_add_u32 m0, s40, 81920
    v_mfma_f32_16x16x32_bf16 v[184:187], a[164:167], a[92:95], v[184:187]
    ds_read_b64_tr_b16 a[132:133], v227 offset:53248
    buffer_load_dwordx4 v220, s[32:35], s53 offen offset:0 lds
    v_mfma_f32_16x16x32_bf16 v[184:187], a[160:163], a[84:87], v[184:187]
    ds_read_b64_tr_b16 a[134:135], v227 offset:55296
    v_readlane_b32 s50, v18, s46
    s_waitcnt lgkmcnt(4)
    v_mfma_f32_16x16x32_bf16 v[192:195], a[176:179], a[84:87], v[192:195]
    ds_read_b64_tr_b16 a[144:145], v228 offset:49152
    buffer_load_dwordx4 a[32:35], v212, s[24:27], s51 offen offset:0 sc1
    v_mfma_f32_16x16x32_bf16 v[192:195], a[180:183], a[92:95], v[192:195]
    ds_read_b64_tr_b16 a[146:147], v228 offset:51200
    v_readlane_b32 s52, v19, s46
    v_mfma_f32_16x16x32_bf16 v[188:191], a[180:183], a[88:91], v[188:191]
    ds_read_b64_tr_b16 a[148:149], v228 offset:53248
    v_mfma_f32_16x16x32_bf16 v[188:191], a[176:179], a[80:83], v[188:191]
    ds_read_b64_tr_b16 a[150:151], v228 offset:55296
    s_waitcnt lgkmcnt(4)
    v_mfma_f32_16x16x32_bf16 v[132:135], a[128:131], a[96:99], v[132:135]
    ds_read_b64_tr_b16 a[160:161], v229 offset:49152
    buffer_load_dwordx4 v221, s[32:35], s53 offen offset:1024 lds
    v_mfma_f32_16x16x32_bf16 v[132:135], a[132:135], a[104:107], v[132:135]
    ds_read_b64_tr_b16 a[162:163], v229 offset:51200
    s_add_u32 s46, s46, 1
    v_mfma_f32_16x16x32_bf16 v[136:139], a[132:135], a[108:111], v[136:139]
    ds_read_b64_tr_b16 a[164:165], v229 offset:53248
    v_mfma_f32_16x16x32_bf16 v[136:139], a[128:131], a[100:103], v[136:139]
    ds_read_b64_tr_b16 a[166:167], v229 offset:55296
    s_waitcnt lgkmcnt(4)
    v_mfma_f32_16x16x32_bf16 v[144:147], a[144:147], a[100:103], v[144:147]
    ds_read_b64_tr_b16 a[176:177], v230 offset:49152
    buffer_load_dwordx4 a[36:39], v212, s[24:27], s51 offen offset:1024 sc1
    v_mfma_f32_16x16x32_bf16 v[144:147], a[148:151], a[108:111], v[144:147]
    ds_read_b64_tr_b16 a[178:179], v230 offset:51200
    v_mfma_f32_16x16x32_bf16 v[140:143], a[148:151], a[104:107], v[140:143]
    ds_read_b64_tr_b16 a[180:181], v230 offset:53248
    v_mfma_f32_16x16x32_bf16 v[140:143], a[144:147], a[96:99], v[140:143]
    ds_read_b64_tr_b16 a[182:183], v230 offset:55296
    s_waitcnt lgkmcnt(4)
    v_mfma_f32_16x16x32_bf16 v[148:151], a[160:163], a[96:99], v[148:151]
    ds_read_b64_tr_b16 a[128:129], v14 offset:49152
    buffer_load_dwordx4 v222, s[32:35], s53 offen offset:2048 lds
    v_mfma_f32_16x16x32_bf16 v[148:151], a[164:167], a[104:107], v[148:151]
    ds_read_b64_tr_b16 a[130:131], v14 offset:51200
    v_mfma_f32_16x16x32_bf16 v[152:155], a[164:167], a[108:111], v[152:155]
    ds_read_b64_tr_b16 a[132:133], v14 offset:53248
    v_mfma_f32_16x16x32_bf16 v[152:155], a[160:163], a[100:103], v[152:155]
    ds_read_b64_tr_b16 a[134:135], v14 offset:55296
    s_waitcnt lgkmcnt(4)
    v_mfma_f32_16x16x32_bf16 v[160:163], a[176:179], a[100:103], v[160:163]
    ds_read_b64_tr_b16 a[144:145], v15 offset:49152
    buffer_load_dwordx4 a[40:43], v213, s[24:27], s51 offen offset:0 sc1
    v_mfma_f32_16x16x32_bf16 v[160:163], a[180:183], a[108:111], v[160:163]
    ds_read_b64_tr_b16 a[146:147], v15 offset:51200
    v_mfma_f32_16x16x32_bf16 v[156:159], a[180:183], a[104:107], v[156:159]
    ds_read_b64_tr_b16 a[148:149], v15 offset:53248
    v_mfma_f32_16x16x32_bf16 v[156:159], a[176:179], a[96:99], v[156:159]
    ds_read_b64_tr_b16 a[150:151], v15 offset:55296
    s_waitcnt lgkmcnt(4)
    v_mfma_f32_16x16x32_bf16 v[164:167], a[128:131], a[96:99], v[164:167]
    ds_read_b64_tr_b16 a[160:161], v16 offset:49152
    buffer_load_dwordx4 v223, s[32:35], s53 offen offset:3072 lds
    v_mfma_f32_16x16x32_bf16 v[164:167], a[132:135], a[104:107], v[164:167]
    ds_read_b64_tr_b16 a[162:163], v16 offset:51200
    v_mfma_f32_16x16x32_bf16 v[168:171], a[132:135], a[108:111], v[168:171]
    ds_read_b64_tr_b16 a[164:165], v16 offset:53248
    v_mfma_f32_16x16x32_bf16 v[168:171], a[128:131], a[100:103], v[168:171]
    ds_read_b64_tr_b16 a[166:167], v16 offset:55296
    s_waitcnt lgkmcnt(4)
    v_mfma_f32_16x16x32_bf16 v[176:179], a[144:147], a[100:103], v[176:179]
    ds_read_b64_tr_b16 a[176:177], v17 offset:49152
    buffer_load_dwordx4 a[44:47], v213, s[24:27], s51 offen offset:1024 sc1
    v_mfma_f32_16x16x32_bf16 v[176:179], a[148:151], a[108:111], v[176:179]
    ds_read_b64_tr_b16 a[178:179], v17 offset:51200
    v_mfma_f32_16x16x32_bf16 v[172:175], a[148:151], a[104:107], v[172:175]
    ds_read_b64_tr_b16 a[180:181], v17 offset:53248
    v_mfma_f32_16x16x32_bf16 v[172:175], a[144:147], a[96:99], v[172:175]
    ds_read_b64_tr_b16 a[182:183], v17 offset:55296
    s_waitcnt lgkmcnt(4)
    v_mfma_f32_16x16x32_bf16 v[180:183], a[160:163], a[96:99], v[180:183]
    ds_read_b64_tr_b16 a[128:129], v227 offset:57344
    s_add_u32 m0, s40, 16384
    v_mfma_f32_16x16x32_bf16 v[180:183], a[164:167], a[104:107], v[180:183]
    ds_read_b64_tr_b16 a[130:131], v227 offset:59392
    buffer_load_dwordx4 v216, s[32:35], s53 offen offset:0 lds
    v_mfma_f32_16x16x32_bf16 v[184:187], a[164:167], a[108:111], v[184:187]
    ds_read_b64_tr_b16 a[132:133], v227 offset:61440
    v_mfma_f32_16x16x32_bf16 v[184:187], a[160:163], a[100:103], v[184:187]
    ds_read_b64_tr_b16 a[134:135], v227 offset:63488
    s_waitcnt lgkmcnt(4)
    v_mfma_f32_16x16x32_bf16 v[192:195], a[176:179], a[100:103], v[192:195]
    ds_read_b64_tr_b16 a[144:145], v228 offset:57344
    buffer_load_dwordx4 a[48:51], v214, s[24:27], s51 offen offset:0 sc1
    v_mfma_f32_16x16x32_bf16 v[192:195], a[180:183], a[108:111], v[192:195]
    ds_read_b64_tr_b16 a[146:147], v228 offset:59392
    v_mfma_f32_16x16x32_bf16 v[188:191], a[180:183], a[104:107], v[188:191]
    ds_read_b64_tr_b16 a[148:149], v228 offset:61440
    v_mfma_f32_16x16x32_bf16 v[188:191], a[176:179], a[96:99], v[188:191]
    ds_read_b64_tr_b16 a[150:151], v228 offset:63488
    s_waitcnt lgkmcnt(4)
    v_mfma_f32_16x16x32_bf16 v[132:135], a[128:131], a[112:115], v[132:135]
    ds_read_b64_tr_b16 a[160:161], v229 offset:57344
    buffer_load_dwordx4 v217, s[32:35], s53 offen offset:1024 lds
    v_mfma_f32_16x16x32_bf16 v[132:135], a[132:135], a[120:123], v[132:135]
    ds_read_b64_tr_b16 a[162:163], v229 offset:59392
    v_mfma_f32_16x16x32_bf16 v[136:139], a[132:135], a[124:127], v[136:139]
    ds_read_b64_tr_b16 a[164:165], v229 offset:61440
    v_mfma_f32_16x16x32_bf16 v[136:139], a[128:131], a[116:119], v[136:139]
    ds_read_b64_tr_b16 a[166:167], v229 offset:63488
    s_waitcnt lgkmcnt(4)
    v_mfma_f32_16x16x32_bf16 v[144:147], a[144:147], a[116:119], v[144:147]
    ds_read_b64_tr_b16 a[176:177], v230 offset:57344
    buffer_load_dwordx4 a[52:55], v214, s[24:27], s51 offen offset:1024 sc1
    v_mfma_f32_16x16x32_bf16 v[144:147], a[148:151], a[124:127], v[144:147]
    ds_read_b64_tr_b16 a[178:179], v230 offset:59392
    v_mfma_f32_16x16x32_bf16 v[140:143], a[148:151], a[120:123], v[140:143]
    ds_read_b64_tr_b16 a[180:181], v230 offset:61440
    v_mfma_f32_16x16x32_bf16 v[140:143], a[144:147], a[112:115], v[140:143]
    ds_read_b64_tr_b16 a[182:183], v230 offset:63488
    s_waitcnt lgkmcnt(4)
    v_mfma_f32_16x16x32_bf16 v[148:151], a[160:163], a[112:115], v[148:151]
    ds_read_b64_tr_b16 a[128:129], v14 offset:57344
    buffer_load_dwordx4 v218, s[32:35], s53 offen offset:2048 lds
    v_mfma_f32_16x16x32_bf16 v[148:151], a[164:167], a[120:123], v[148:151]
    ds_read_b64_tr_b16 a[130:131], v14 offset:59392
    v_mfma_f32_16x16x32_bf16 v[152:155], a[164:167], a[124:127], v[152:155]
    ds_read_b64_tr_b16 a[132:133], v14 offset:61440
    v_mfma_f32_16x16x32_bf16 v[152:155], a[160:163], a[116:119], v[152:155]
    ds_read_b64_tr_b16 a[134:135], v14 offset:63488
    s_waitcnt lgkmcnt(4)
    v_mfma_f32_16x16x32_bf16 v[160:163], a[176:179], a[116:119], v[160:163]
    ds_read_b64_tr_b16 a[144:145], v15 offset:57344
    buffer_load_dwordx4 a[56:59], v215, s[24:27], s51 offen offset:0 sc1
    v_mfma_f32_16x16x32_bf16 v[160:163], a[180:183], a[124:127], v[160:163]
    ds_read_b64_tr_b16 a[146:147], v15 offset:59392
    v_mfma_f32_16x16x32_bf16 v[156:159], a[180:183], a[120:123], v[156:159]
    ds_read_b64_tr_b16 a[148:149], v15 offset:61440
    v_mfma_f32_16x16x32_bf16 v[156:159], a[176:179], a[112:115], v[156:159]
    ds_read_b64_tr_b16 a[150:151], v15 offset:63488
    s_waitcnt lgkmcnt(4)
    v_mfma_f32_16x16x32_bf16 v[164:167], a[128:131], a[112:115], v[164:167]
    ds_read_b64_tr_b16 a[160:161], v16 offset:57344
    buffer_load_dwordx4 v219, s[32:35], s53 offen offset:3072 lds
    v_mfma_f32_16x16x32_bf16 v[164:167], a[132:135], a[120:123], v[164:167]
    ds_read_b64_tr_b16 a[162:163], v16 offset:59392
    v_mfma_f32_16x16x32_bf16 v[168:171], a[132:135], a[124:127], v[168:171]
    ds_read_b64_tr_b16 a[164:165], v16 offset:61440
    v_mfma_f32_16x16x32_bf16 v[168:171], a[128:131], a[116:119], v[168:171]
    ds_read_b64_tr_b16 a[166:167], v16 offset:63488
    s_waitcnt lgkmcnt(4)
    v_mfma_f32_16x16x32_bf16 v[176:179], a[144:147], a[116:119], v[176:179]
    ds_read_b64_tr_b16 a[176:177], v17 offset:57344
    buffer_load_dwordx4 a[60:63], v215, s[24:27], s51 offen offset:1024 sc1
    v_mfma_f32_16x16x32_bf16 v[176:179], a[148:151], a[124:127], v[176:179]
    ds_read_b64_tr_b16 a[178:179], v17 offset:59392
    v_mfma_f32_16x16x32_bf16 v[172:175], a[148:151], a[120:123], v[172:175]
    ds_read_b64_tr_b16 a[180:181], v17 offset:61440
    v_mfma_f32_16x16x32_bf16 v[172:175], a[144:147], a[112:115], v[172:175]
    ds_read_b64_tr_b16 a[182:183], v17 offset:63488
    s_waitcnt lgkmcnt(4)
    v_mfma_f32_16x16x32_bf16 v[180:183], a[160:163], a[112:115], v[180:183]
    s_waitcnt vmcnt(16)
    s_barrier
    ds_read_b64_tr_b16 a[128:129], v227 offset:0
    v_mfma_f32_16x16x32_bf16 v[180:183], a[164:167], a[120:123], v[180:183]
    ds_read_b64_tr_b16 a[130:131], v227 offset:2048
    s_add_u32 m0, s40, 98304
    v_mfma_f32_16x16x32_bf16 v[184:187], a[164:167], a[124:127], v[184:187]
    ds_read_b64_tr_b16 a[132:133], v227 offset:4096
    buffer_load_dwordx4 v220, s[32:35], s52 offen offset:0 lds
    v_mfma_f32_16x16x32_bf16 v[184:187], a[160:163], a[116:119], v[184:187]
    ds_read_b64_tr_b16 a[134:135], v227 offset:6144
    v_readlane_b32 s51, v18, s46
    s_waitcnt lgkmcnt(4)
    v_mfma_f32_16x16x32_bf16 v[192:195], a[176:179], a[116:119], v[192:195]
    ds_read_b64_tr_b16 a[144:145], v228 offset:0
    buffer_load_dwordx4 a[64:67], v212, s[24:27], s50 offen offset:0 sc1
    v_mfma_f32_16x16x32_bf16 v[192:195], a[180:183], a[124:127], v[192:195]
    ds_read_b64_tr_b16 a[146:147], v228 offset:2048
    v_readlane_b32 s53, v19, s46
    v_mfma_f32_16x16x32_bf16 v[188:191], a[180:183], a[120:123], v[188:191]
    ds_read_b64_tr_b16 a[148:149], v228 offset:4096
    v_mfma_f32_16x16x32_bf16 v[188:191], a[176:179], a[112:115], v[188:191]
    ds_read_b64_tr_b16 a[150:151], v228 offset:6144
    s_waitcnt lgkmcnt(4)
    v_mfma_f32_16x16x32_bf16 v[132:135], a[128:131], a[0:3], v[132:135]
    ds_read_b64_tr_b16 a[160:161], v229 offset:0
    buffer_load_dwordx4 v221, s[32:35], s52 offen offset:1024 lds
    buffer_load_dword v226, v225, s[76:79], 0 offen offset:16 sc1
    v_mfma_f32_16x16x32_bf16 v[132:135], a[132:135], a[8:11], v[132:135]
    ds_read_b64_tr_b16 a[162:163], v229 offset:2048
    s_add_u32 s46, s46, 1
    v_mfma_f32_16x16x32_bf16 v[136:139], a[132:135], a[12:15], v[136:139]
    ds_read_b64_tr_b16 a[164:165], v229 offset:4096
    v_mfma_f32_16x16x32_bf16 v[136:139], a[128:131], a[4:7], v[136:139]
    ds_read_b64_tr_b16 a[166:167], v229 offset:6144
    s_waitcnt lgkmcnt(4)
    v_mfma_f32_16x16x32_bf16 v[144:147], a[144:147], a[4:7], v[144:147]
    ds_read_b64_tr_b16 a[176:177], v230 offset:0
    buffer_load_dwordx4 a[68:71], v212, s[24:27], s50 offen offset:1024 sc1
    v_mfma_f32_16x16x32_bf16 v[144:147], a[148:151], a[12:15], v[144:147]
    ds_read_b64_tr_b16 a[178:179], v230 offset:2048
    v_mfma_f32_16x16x32_bf16 v[140:143], a[148:151], a[8:11], v[140:143]
    ds_read_b64_tr_b16 a[180:181], v230 offset:4096
    v_mfma_f32_16x16x32_bf16 v[140:143], a[144:147], a[0:3], v[140:143]
    ds_read_b64_tr_b16 a[182:183], v230 offset:6144
    s_waitcnt lgkmcnt(4)
    v_mfma_f32_16x16x32_bf16 v[148:151], a[160:163], a[0:3], v[148:151]
    ds_read_b64_tr_b16 a[128:129], v14 offset:0
    buffer_load_dwordx4 v222, s[32:35], s52 offen offset:2048 lds
    v_mfma_f32_16x16x32_bf16 v[148:151], a[164:167], a[8:11], v[148:151]
    ds_read_b64_tr_b16 a[130:131], v14 offset:2048
    v_mfma_f32_16x16x32_bf16 v[152:155], a[164:167], a[12:15], v[152:155]
    ds_read_b64_tr_b16 a[132:133], v14 offset:4096
    v_mfma_f32_16x16x32_bf16 v[152:155], a[160:163], a[4:7], v[152:155]
    ds_read_b64_tr_b16 a[134:135], v14 offset:6144
    s_waitcnt lgkmcnt(4)
    v_mfma_f32_16x16x32_bf16 v[160:163], a[176:179], a[4:7], v[160:163]
    ds_read_b64_tr_b16 a[144:145], v15 offset:0
    buffer_load_dwordx4 a[72:75], v213, s[24:27], s50 offen offset:0 sc1
    v_mfma_f32_16x16x32_bf16 v[160:163], a[180:183], a[12:15], v[160:163]
    ds_read_b64_tr_b16 a[146:147], v15 offset:2048
    v_mfma_f32_16x16x32_bf16 v[156:159], a[180:183], a[8:11], v[156:159]
    ds_read_b64_tr_b16 a[148:149], v15 offset:4096
    v_mfma_f32_16x16x32_bf16 v[156:159], a[176:179], a[0:3], v[156:159]
    ds_read_b64_tr_b16 a[150:151], v15 offset:6144
    s_waitcnt lgkmcnt(4)
    v_mfma_f32_16x16x32_bf16 v[164:167], a[128:131], a[0:3], v[164:167]
    ds_read_b64_tr_b16 a[160:161], v16 offset:0
    buffer_load_dwordx4 v223, s[32:35], s52 offen offset:3072 lds
    v_mfma_f32_16x16x32_bf16 v[164:167], a[132:135], a[8:11], v[164:167]
    ds_read_b64_tr_b16 a[162:163], v16 offset:2048
    v_mfma_f32_16x16x32_bf16 v[168:171], a[132:135], a[12:15], v[168:171]
    ds_read_b64_tr_b16 a[164:165], v16 offset:4096
    v_mfma_f32_16x16x32_bf16 v[168:171], a[128:131], a[4:7], v[168:171]
    ds_read_b64_tr_b16 a[166:167], v16 offset:6144
    s_waitcnt lgkmcnt(4)
    v_mfma_f32_16x16x32_bf16 v[176:179], a[144:147], a[4:7], v[176:179]
    ds_read_b64_tr_b16 a[176:177], v17 offset:0
    buffer_load_dwordx4 a[76:79], v213, s[24:27], s50 offen offset:1024 sc1
    v_mfma_f32_16x16x32_bf16 v[176:179], a[148:151], a[12:15], v[176:179]
    ds_read_b64_tr_b16 a[178:179], v17 offset:2048
    v_mfma_f32_16x16x32_bf16 v[172:175], a[148:151], a[8:11], v[172:175]
    ds_read_b64_tr_b16 a[180:181], v17 offset:4096
    v_mfma_f32_16x16x32_bf16 v[172:175], a[144:147], a[0:3], v[172:175]
    ds_read_b64_tr_b16 a[182:183], v17 offset:6144
    s_waitcnt lgkmcnt(4)
    v_mfma_f32_16x16x32_bf16 v[180:183], a[160:163], a[0:3], v[180:183]
    ds_read_b64_tr_b16 a[128:129], v227 offset:8192
    s_add_u32 m0, s40, 32768
    v_mfma_f32_16x16x32_bf16 v[180:183], a[164:167], a[8:11], v[180:183]
    ds_read_b64_tr_b16 a[130:131], v227 offset:10240
    buffer_load_dwordx4 v216, s[32:35], s52 offen offset:0 lds
    v_mfma_f32_16x16x32_bf16 v[184:187], a[164:167], a[12:15], v[184:187]
    ds_read_b64_tr_b16 a[132:133], v227 offset:12288
    v_mfma_f32_16x16x32_bf16 v[184:187], a[160:163], a[4:7], v[184:187]
    ds_read_b64_tr_b16 a[134:135], v227 offset:14336
    s_waitcnt lgkmcnt(4)
    v_mfma_f32_16x16x32_bf16 v[192:195], a[176:179], a[4:7], v[192:195]
    ds_read_b64_tr_b16 a[144:145], v228 offset:8192
    buffer_load_dwordx4 a[80:83], v214, s[24:27], s50 offen offset:0 sc1
    v_mfma_f32_16x16x32_bf16 v[192:195], a[180:183], a[12:15], v[192:195]
    ds_read_b64_tr_b16 a[146:147], v228 offset:10240
    v_mfma_f32_16x16x32_bf16 v[188:191], a[180:183], a[8:11], v[188:191]
    ds_read_b64_tr_b16 a[148:149], v228 offset:12288
    v_mfma_f32_16x16x32_bf16 v[188:191], a[176:179], a[0:3], v[188:191]
    ds_read_b64_tr_b16 a[150:151], v228 offset:14336
    s_waitcnt lgkmcnt(4)
    v_mfma_f32_16x16x32_bf16 v[132:135], a[128:131], a[16:19], v[132:135]
    ds_read_b64_tr_b16 a[160:161], v229 offset:8192
    buffer_load_dwordx4 v217, s[32:35], s52 offen offset:1024 lds
    v_mfma_f32_16x16x32_bf16 v[132:135], a[132:135], a[24:27], v[132:135]
    ds_read_b64_tr_b16 a[162:163], v229 offset:10240
    v_mfma_f32_16x16x32_bf16 v[136:139], a[132:135], a[28:31], v[136:139]
    ds_read_b64_tr_b16 a[164:165], v229 offset:12288
    v_mfma_f32_16x16x32_bf16 v[136:139], a[128:131], a[20:23], v[136:139]
    ds_read_b64_tr_b16 a[166:167], v229 offset:14336
    s_waitcnt lgkmcnt(4)
    v_mfma_f32_16x16x32_bf16 v[144:147], a[144:147], a[20:23], v[144:147]
    ds_read_b64_tr_b16 a[176:177], v230 offset:8192
    buffer_load_dwordx4 a[84:87], v214, s[24:27], s50 offen offset:1024 sc1
    v_mfma_f32_16x16x32_bf16 v[144:147], a[148:151], a[28:31], v[144:147]
    ds_read_b64_tr_b16 a[178:179], v230 offset:10240
    v_mfma_f32_16x16x32_bf16 v[140:143], a[148:151], a[24:27], v[140:143]
    ds_read_b64_tr_b16 a[180:181], v230 offset:12288
    v_mfma_f32_16x16x32_bf16 v[140:143], a[144:147], a[16:19], v[140:143]
    ds_read_b64_tr_b16 a[182:183], v230 offset:14336
    s_waitcnt lgkmcnt(4)
    v_mfma_f32_16x16x32_bf16 v[148:151], a[160:163], a[16:19], v[148:151]
    ds_read_b64_tr_b16 a[128:129], v14 offset:8192
    buffer_load_dwordx4 v218, s[32:35], s52 offen offset:2048 lds
    v_mfma_f32_16x16x32_bf16 v[148:151], a[164:167], a[24:27], v[148:151]
    ds_read_b64_tr_b16 a[130:131], v14 offset:10240
    v_mfma_f32_16x16x32_bf16 v[152:155], a[164:167], a[28:31], v[152:155]
    ds_read_b64_tr_b16 a[132:133], v14 offset:12288
    v_mfma_f32_16x16x32_bf16 v[152:155], a[160:163], a[20:23], v[152:155]
    ds_read_b64_tr_b16 a[134:135], v14 offset:14336
    s_waitcnt lgkmcnt(4)
    v_mfma_f32_16x16x32_bf16 v[160:163], a[176:179], a[20:23], v[160:163]
    ds_read_b64_tr_b16 a[144:145], v15 offset:8192
    buffer_load_dwordx4 a[88:91], v215, s[24:27], s50 offen offset:0 sc1
    v_mfma_f32_16x16x32_bf16 v[160:163], a[180:183], a[28:31], v[160:163]
    ds_read_b64_tr_b16 a[146:147], v15 offset:10240
    v_mfma_f32_16x16x32_bf16 v[156:159], a[180:183], a[24:27], v[156:159]
    ds_read_b64_tr_b16 a[148:149], v15 offset:12288
    v_mfma_f32_16x16x32_bf16 v[156:159], a[176:179], a[16:19], v[156:159]
    ds_read_b64_tr_b16 a[150:151], v15 offset:14336
    s_waitcnt lgkmcnt(4)
    v_mfma_f32_16x16x32_bf16 v[164:167], a[128:131], a[16:19], v[164:167]
    ds_read_b64_tr_b16 a[160:161], v16 offset:8192
    buffer_load_dwordx4 v219, s[32:35], s52 offen offset:3072 lds
    v_mfma_f32_16x16x32_bf16 v[164:167], a[132:135], a[24:27], v[164:167]
    ds_read_b64_tr_b16 a[162:163], v16 offset:10240
    v_mfma_f32_16x16x32_bf16 v[168:171], a[132:135], a[28:31], v[168:171]
    ds_read_b64_tr_b16 a[164:165], v16 offset:12288
    v_mfma_f32_16x16x32_bf16 v[168:171], a[128:131], a[20:23], v[168:171]
    ds_read_b64_tr_b16 a[166:167], v16 offset:14336
    s_waitcnt lgkmcnt(4)
    v_mfma_f32_16x16x32_bf16 v[176:179], a[144:147], a[20:23], v[176:179]
    ds_read_b64_tr_b16 a[176:177], v17 offset:8192
    buffer_load_dwordx4 a[92:95], v215, s[24:27], s50 offen offset:1024 sc1
    v_mfma_f32_16x16x32_bf16 v[176:179], a[148:151], a[28:31], v[176:179]
    ds_read_b64_tr_b16 a[178:179], v17 offset:10240
    v_mfma_f32_16x16x32_bf16 v[172:175], a[148:151], a[24:27], v[172:175]
    ds_read_b64_tr_b16 a[180:181], v17 offset:12288
    v_mfma_f32_16x16x32_bf16 v[172:175], a[144:147], a[16:19], v[172:175]
    ds_read_b64_tr_b16 a[182:183], v17 offset:14336
    s_waitcnt lgkmcnt(4)
    v_mfma_f32_16x16x32_bf16 v[180:183], a[160:163], a[16:19], v[180:183]
    s_waitcnt vmcnt(17)
    s_barrier
    ds_read_b64_tr_b16 a[128:129], v227 offset:16384
    v_mfma_f32_16x16x32_bf16 v[180:183], a[164:167], a[24:27], v[180:183]
    ds_read_b64_tr_b16 a[130:131], v227 offset:18432
    s_add_u32 m0, s40, 114688
    v_mfma_f32_16x16x32_bf16 v[184:187], a[164:167], a[28:31], v[184:187]
    ds_read_b64_tr_b16 a[132:133], v227 offset:20480
    buffer_load_dwordx4 v220, s[32:35], s53 offen offset:0 lds
    v_mfma_f32_16x16x32_bf16 v[184:187], a[160:163], a[20:23], v[184:187]
    ds_read_b64_tr_b16 a[134:135], v227 offset:22528
    v_readlane_b32 s50, v18, s46
    s_waitcnt lgkmcnt(4)
    v_mfma_f32_16x16x32_bf16 v[192:195], a[176:179], a[20:23], v[192:195]
    ds_read_b64_tr_b16 a[144:145], v228 offset:16384
    buffer_load_dwordx4 a[96:99], v212, s[24:27], s51 offen offset:0 sc1
    v_mfma_f32_16x16x32_bf16 v[192:195], a[180:183], a[28:31], v[192:195]
    ds_read_b64_tr_b16 a[146:147], v228 offset:18432
    v_readlane_b32 s52, v19, s46
    v_mfma_f32_16x16x32_bf16 v[188:191], a[180:183], a[24:27], v[188:191]
    ds_read_b64_tr_b16 a[148:149], v228 offset:20480
    v_mfma_f32_16x16x32_bf16 v[188:191], a[176:179], a[16:19], v[188:191]
    ds_read_b64_tr_b16 a[150:151], v228 offset:22528
    s_waitcnt lgkmcnt(4)
    v_mfma_f32_16x16x32_bf16 v[132:135], a[128:131], a[32:35], v[132:135]
    ds_read_b64_tr_b16 a[160:161], v229 offset:16384
    buffer_load_dwordx4 v221, s[32:35], s53 offen offset:1024 lds
    v_mfma_f32_16x16x32_bf16 v[132:135], a[132:135], a[40:43], v[132:135]
    ds_read_b64_tr_b16 a[162:163], v229 offset:18432
    s_add_u32 s46, s46, 1
    v_mfma_f32_16x16x32_bf16 v[136:139], a[132:135], a[44:47], v[136:139]
    ds_read_b64_tr_b16 a[164:165], v229 offset:20480
    v_mfma_f32_16x16x32_bf16 v[136:139], a[128:131], a[36:39], v[136:139]
    ds_read_b64_tr_b16 a[166:167], v229 offset:22528
    s_waitcnt lgkmcnt(4)
    v_mfma_f32_16x16x32_bf16 v[144:147], a[144:147], a[36:39], v[144:147]
    ds_read_b64_tr_b16 a[176:177], v230 offset:16384
    buffer_load_dwordx4 a[100:103], v212, s[24:27], s51 offen offset:1024 sc1
    v_mfma_f32_16x16x32_bf16 v[144:147], a[148:151], a[44:47], v[144:147]
    ds_read_b64_tr_b16 a[178:179], v230 offset:18432
    v_mfma_f32_16x16x32_bf16 v[140:143], a[148:151], a[40:43], v[140:143]
    ds_read_b64_tr_b16 a[180:181], v230 offset:20480
    v_mfma_f32_16x16x32_bf16 v[140:143], a[144:147], a[32:35], v[140:143]
    ds_read_b64_tr_b16 a[182:183], v230 offset:22528
    s_waitcnt lgkmcnt(4)
    v_mfma_f32_16x16x32_bf16 v[148:151], a[160:163], a[32:35], v[148:151]
    ds_read_b64_tr_b16 a[128:129], v14 offset:16384
    buffer_load_dwordx4 v222, s[32:35], s53 offen offset:2048 lds
    v_mfma_f32_16x16x32_bf16 v[148:151], a[164:167], a[40:43], v[148:151]
    ds_read_b64_tr_b16 a[130:131], v14 offset:18432
    v_mfma_f32_16x16x32_bf16 v[152:155], a[164:167], a[44:47], v[152:155]
    ds_read_b64_tr_b16 a[132:133], v14 offset:20480
    v_mfma_f32_16x16x32_bf16 v[152:155], a[160:163], a[36:39], v[152:155]
    ds_read_b64_tr_b16 a[134:135], v14 offset:22528
    s_waitcnt lgkmcnt(4)
    v_mfma_f32_16x16x32_bf16 v[160:163], a[176:179], a[36:39], v[160:163]
    ds_read_b64_tr_b16 a[144:145], v15 offset:16384
    buffer_load_dwordx4 a[104:107], v213, s[24:27], s51 offen offset:0 sc1
    v_mfma_f32_16x16x32_bf16 v[160:163], a[180:183], a[44:47], v[160:163]
    ds_read_b64_tr_b16 a[146:147], v15 offset:18432
    v_mfma_f32_16x16x32_bf16 v[156:159], a[180:183], a[40:43], v[156:159]
    ds_read_b64_tr_b16 a[148:149], v15 offset:20480
    v_mfma_f32_16x16x32_bf16 v[156:159], a[176:179], a[32:35], v[156:159]
    ds_read_b64_tr_b16 a[150:151], v15 offset:22528
    s_waitcnt lgkmcnt(4)
    v_mfma_f32_16x16x32_bf16 v[164:167], a[128:131], a[32:35], v[164:167]
    ds_read_b64_tr_b16 a[160:161], v16 offset:16384
    buffer_load_dwordx4 v223, s[32:35], s53 offen offset:3072 lds
    v_mfma_f32_16x16x32_bf16 v[164:167], a[132:135], a[40:43], v[164:167]
    ds_read_b64_tr_b16 a[162:163], v16 offset:18432
    v_mfma_f32_16x16x32_bf16 v[168:171], a[132:135], a[44:47], v[168:171]
    ds_read_b64_tr_b16 a[164:165], v16 offset:20480
    v_mfma_f32_16x16x32_bf16 v[168:171], a[128:131], a[36:39], v[168:171]
    ds_read_b64_tr_b16 a[166:167], v16 offset:22528
    s_waitcnt lgkmcnt(4)
    v_mfma_f32_16x16x32_bf16 v[176:179], a[144:147], a[36:39], v[176:179]
    ds_read_b64_tr_b16 a[176:177], v17 offset:16384
    buffer_load_dwordx4 a[108:111], v213, s[24:27], s51 offen offset:1024 sc1
    v_mfma_f32_16x16x32_bf16 v[176:179], a[148:151], a[44:47], v[176:179]
    ds_read_b64_tr_b16 a[178:179], v17 offset:18432
    v_mfma_f32_16x16x32_bf16 v[172:175], a[148:151], a[40:43], v[172:175]
    ds_read_b64_tr_b16 a[180:181], v17 offset:20480
    v_mfma_f32_16x16x32_bf16 v[172:175], a[144:147], a[32:35], v[172:175]
    ds_read_b64_tr_b16 a[182:183], v17 offset:22528
    s_waitcnt lgkmcnt(4)
    v_mfma_f32_16x16x32_bf16 v[180:183], a[160:163], a[32:35], v[180:183]
    ds_read_b64_tr_b16 a[128:129], v227 offset:24576
    s_add_u32 m0, s40, 49152
    v_mfma_f32_16x16x32_bf16 v[180:183], a[164:167], a[40:43], v[180:183]
    ds_read_b64_tr_b16 a[130:131], v227 offset:26624
    buffer_load_dwordx4 v216, s[32:35], s53 offen offset:0 lds
    v_mfma_f32_16x16x32_bf16 v[184:187], a[164:167], a[44:47], v[184:187]
    ds_read_b64_tr_b16 a[132:133], v227 offset:28672
    v_mfma_f32_16x16x32_bf16 v[184:187], a[160:163], a[36:39], v[184:187]
    ds_read_b64_tr_b16 a[134:135], v227 offset:30720
    s_waitcnt lgkmcnt(4)
    v_mfma_f32_16x16x32_bf16 v[192:195], a[176:179], a[36:39], v[192:195]
    ds_read_b64_tr_b16 a[144:145], v228 offset:24576
    buffer_load_dwordx4 a[112:115], v214, s[24:27], s51 offen offset:0 sc1
    v_mfma_f32_16x16x32_bf16 v[192:195], a[180:183], a[44:47], v[192:195]
    ds_read_b64_tr_b16 a[146:147], v228 offset:26624
    v_mfma_f32_16x16x32_bf16 v[188:191], a[180:183], a[40:43], v[188:191]
    ds_read_b64_tr_b16 a[148:149], v228 offset:28672
    v_mfma_f32_16x16x32_bf16 v[188:191], a[176:179], a[32:35], v[188:191]
    ds_read_b64_tr_b16 a[150:151], v228 offset:30720
    s_waitcnt lgkmcnt(4)
    v_mfma_f32_16x16x32_bf16 v[132:135], a[128:131], a[48:51], v[132:135]
    ds_read_b64_tr_b16 a[160:161], v229 offset:24576
    buffer_load_dwordx4 v217, s[32:35], s53 offen offset:1024 lds
    v_mfma_f32_16x16x32_bf16 v[132:135], a[132:135], a[56:59], v[132:135]
    ds_read_b64_tr_b16 a[162:163], v229 offset:26624
    v_mfma_f32_16x16x32_bf16 v[136:139], a[132:135], a[60:63], v[136:139]
    ds_read_b64_tr_b16 a[164:165], v229 offset:28672
    v_mfma_f32_16x16x32_bf16 v[136:139], a[128:131], a[52:55], v[136:139]
    ds_read_b64_tr_b16 a[166:167], v229 offset:30720
    s_waitcnt lgkmcnt(4)
    v_mfma_f32_16x16x32_bf16 v[144:147], a[144:147], a[52:55], v[144:147]
    ds_read_b64_tr_b16 a[176:177], v230 offset:24576
    buffer_load_dwordx4 a[116:119], v214, s[24:27], s51 offen offset:1024 sc1
    v_mfma_f32_16x16x32_bf16 v[144:147], a[148:151], a[60:63], v[144:147]
    ds_read_b64_tr_b16 a[178:179], v230 offset:26624
    v_mfma_f32_16x16x32_bf16 v[140:143], a[148:151], a[56:59], v[140:143]
    ds_read_b64_tr_b16 a[180:181], v230 offset:28672
    v_mfma_f32_16x16x32_bf16 v[140:143], a[144:147], a[48:51], v[140:143]
    ds_read_b64_tr_b16 a[182:183], v230 offset:30720
    s_waitcnt lgkmcnt(4)
    v_mfma_f32_16x16x32_bf16 v[148:151], a[160:163], a[48:51], v[148:151]
    ds_read_b64_tr_b16 a[128:129], v14 offset:24576
    buffer_load_dwordx4 v218, s[32:35], s53 offen offset:2048 lds
    v_mfma_f32_16x16x32_bf16 v[148:151], a[164:167], a[56:59], v[148:151]
    ds_read_b64_tr_b16 a[130:131], v14 offset:26624
    v_mfma_f32_16x16x32_bf16 v[152:155], a[164:167], a[60:63], v[152:155]
    ds_read_b64_tr_b16 a[132:133], v14 offset:28672
    v_mfma_f32_16x16x32_bf16 v[152:155], a[160:163], a[52:55], v[152:155]
    ds_read_b64_tr_b16 a[134:135], v14 offset:30720
    s_waitcnt lgkmcnt(4)
    v_mfma_f32_16x16x32_bf16 v[160:163], a[176:179], a[52:55], v[160:163]
    ds_read_b64_tr_b16 a[144:145], v15 offset:24576
    buffer_load_dwordx4 a[120:123], v215, s[24:27], s51 offen offset:0 sc1
    v_mfma_f32_16x16x32_bf16 v[160:163], a[180:183], a[60:63], v[160:163]
    ds_read_b64_tr_b16 a[146:147], v15 offset:26624
    v_mfma_f32_16x16x32_bf16 v[156:159], a[180:183], a[56:59], v[156:159]
    ds_read_b64_tr_b16 a[148:149], v15 offset:28672
    v_mfma_f32_16x16x32_bf16 v[156:159], a[176:179], a[48:51], v[156:159]
    ds_read_b64_tr_b16 a[150:151], v15 offset:30720
    s_waitcnt lgkmcnt(4)
    v_mfma_f32_16x16x32_bf16 v[164:167], a[128:131], a[48:51], v[164:167]
    ds_read_b64_tr_b16 a[160:161], v16 offset:24576
    buffer_load_dwordx4 v219, s[32:35], s53 offen offset:3072 lds
    v_mfma_f32_16x16x32_bf16 v[164:167], a[132:135], a[56:59], v[164:167]
    ds_read_b64_tr_b16 a[162:163], v16 offset:26624
    v_mfma_f32_16x16x32_bf16 v[168:171], a[132:135], a[60:63], v[168:171]
    ds_read_b64_tr_b16 a[164:165], v16 offset:28672
    v_mfma_f32_16x16x32_bf16 v[168:171], a[128:131], a[52:55], v[168:171]
    ds_read_b64_tr_b16 a[166:167], v16 offset:30720
    s_waitcnt lgkmcnt(4)
    v_mfma_f32_16x16x32_bf16 v[176:179], a[144:147], a[52:55], v[176:179]
    ds_read_b64_tr_b16 a[176:177], v17 offset:24576
    buffer_load_dwordx4 a[124:127], v215, s[24:27], s51 offen offset:1024 sc1
    v_mfma_f32_16x16x32_bf16 v[176:179], a[148:151], a[60:63], v[176:179]
    ds_read_b64_tr_b16 a[178:179], v17 offset:26624
    v_mfma_f32_16x16x32_bf16 v[172:175], a[148:151], a[56:59], v[172:175]
    ds_read_b64_tr_b16 a[180:181], v17 offset:28672
    v_mfma_f32_16x16x32_bf16 v[172:175], a[144:147], a[48:51], v[172:175]
    ds_read_b64_tr_b16 a[182:183], v17 offset:30720
    s_waitcnt lgkmcnt(4)
    v_mfma_f32_16x16x32_bf16 v[180:183], a[160:163], a[48:51], v[180:183]
    s_waitcnt vmcnt(16)
    s_mov_b32 s13, 0x40000
L_pb_chk:
    v_cmp_ne_u32 vcc, s100, v226
    s_nop 0
    s_cmp_eq_u64 vcc, 0
    s_cbranch_scc1 L_pb_ok
    s_mov_b64 exec, vcc
    buffer_load_dword v226, v225, s[76:79], 0 offen offset:16 sc1
    s_waitcnt vmcnt(0)
    s_sub_u32 s13, s13, 1
    s_cmp_lg_u32 s13, 0
    s_cbranch_scc1 L_pb_chk
L_pb_ok:
    s_mov_b64 exec, -1
    v_lshrrev_b32 v232, 5, v0
    v_lshl_add_u32 v216, v232, 13, v216
    v_add_u32 v217, 31744, v216
    v_add_u32 v218, 6144, v216
    v_add_u32 v219, 37888, v216
    v_lshl_add_u32 v220, v232, 13, v220
    v_add_u32 v221, 31744, v220
    v_add_u32 v222, 6144, v220
    v_add_u32 v223, 37888, v220
    s_barrier
    ds_read_b64_tr_b16 a[128:129], v227 offset:32768
    v_mfma_f32_16x16x32_bf16 v[180:183], a[164:167], a[56:59], v[180:183]
    ds_read_b64_tr_b16 a[130:131], v227 offset:34816
    s_add_u32 m0, s40, 65536
    v_mfma_f32_16x16x32_bf16 v[184:187], a[164:167], a[60:63], v[184:187]
    ds_read_b64_tr_b16 a[132:133], v227 offset:36864
    buffer_load_dwordx4 v220, s[32:35], s52 offen offset:0 lds
    v_mfma_f32_16x16x32_bf16 v[184:187], a[160:163], a[52:55], v[184:187]
    ds_read_b64_tr_b16 a[134:135], v227 offset:38912
    v_readlane_b32 s51, v18, s46
    s_waitcnt lgkmcnt(4)
    v_mfma_f32_16x16x32_bf16 v[192:195], a[176:179], a[52:55], v[192:195]
    ds_read_b64_tr_b16 a[144:145], v228 offset:32768
    buffer_load_dwordx4 a[0:3], v212, s[24:27], s50 offen offset:0 sc1
    v_mfma_f32_16x16x32_bf16 v[192:195], a[180:183], a[60:63], v[192:195]
    ds_read_b64_tr_b16 a[146:147], v228 offset:34816
    v_readlane_b32 s53, v19, s46
    v_mfma_f32_16x16x32_bf16 v[188:191], a[180:183], a[56:59], v[188:191]
    ds_read_b64_tr_b16 a[148:149], v228 offset:36864
    v_mfma_f32_16x16x32_bf16 v[188:191], a[176:179], a[48:51], v[188:191]
    ds_read_b64_tr_b16 a[150:151], v228 offset:38912
    s_waitcnt lgkmcnt(4)
    v_mfma_f32_16x16x32_bf16 v[132:135], a[128:131], a[64:67], v[132:135]
    ds_read_b64_tr_b16 a[160:161], v229 offset:32768
    buffer_load_dwordx4 v221, s[32:35], s52 offen offset:1024 lds
    v_mfma_f32_16x16x32_bf16 v[132:135], a[132:135], a[72:75], v[132:135]
    ds_read_b64_tr_b16 a[162:163], v229 offset:34816
    s_add_u32 s46, s46, 1
    v_mfma_f32_16x16x32_bf16 v[136:139], a[132:135], a[76:79], v[136:139]
    ds_read_b64_tr_b16 a[164:165], v229 offset:36864
    v_mfma_f32_16x16x32_bf16 v[136:139], a[128:131], a[68:71], v[136:139]
    ds_read_b64_tr_b16 a[166:167], v229 offset:38912
    s_waitcnt lgkmcnt(4)
    v_mfma_f32_16x16x32_bf16 v[144:147], a[144:147], a[68:71], v[144:147]
    ds_read_b64_tr_b16 a[176:177], v230 offset:32768
    buffer_load_dwordx4 a[4:7], v212, s[24:27], s50 offen offset:1024 sc1
    v_mfma_f32_16x16x32_bf16 v[144:147], a[148:151], a[76:79], v[144:147]
    ds_read_b64_tr_b16 a[178:179], v230 offset:34816
    v_mfma_f32_16x16x32_bf16 v[140:143], a[148:151], a[72:75], v[140:143]
    ds_read_b64_tr_b16 a[180:181], v230 offset:36864
    v_mfma_f32_16x16x32_bf16 v[140:143], a[144:147], a[64:67], v[140:143]
    ds_read_b64_tr_b16 a[182:183], v230 offset:38912
    s_waitcnt lgkmcnt(4)
    v_mfma_f32_16x16x32_bf16 v[148:151], a[160:163], a[64:67], v[148:151]
    ds_read_b64_tr_b16 a[128:129], v14 offset:32768
    buffer_load_dwordx4 v222, s[32:35], s52 offen offset:2048 lds
    v_mfma_f32_16x16x32_bf16 v[148:151], a[164:167], a[72:75], v[148:151]
    ds_read_b64_tr_b16 a[130:131], v14 offset:34816
    v_mfma_f32_16x16x32_bf16 v[152:155], a[164:167], a[76:79], v[152:155]
    ds_read_b64_tr_b16 a[132:133], v14 offset:36864
    v_mfma_f32_16x16x32_bf16 v[152:155], a[160:163], a[68:71], v[152:155]
    ds_read_b64_tr_b16 a[134:135], v14 offset:38912
    s_waitcnt lgkmcnt(4)
    v_mfma_f32_16x16x32_bf16 v[160:163], a[176:179], a[68:71], v[160:163]
    ds_read_b64_tr_b16 a[144:145], v15 offset:32768
    buffer_load_dwordx4 a[8:11], v213, s[24:27], s50 offen offset:0 sc1
    v_mfma_f32_16x16x32_bf16 v[160:163], a[180:183], a[76:79], v[160:163]
    ds_read_b64_tr_b16 a[146:147], v15 offset:34816
    v_mfma_f32_16x16x32_bf16 v[156:159], a[180:183], a[72:75], v[156:159]
    ds_read_b64_tr_b16 a[148:149], v15 offset:36864
    v_mfma_f32_16x16x32_bf16 v[156:159], a[176:179], a[64:67], v[156:159]
    ds_read_b64_tr_b16 a[150:151], v15 offset:38912
    s_waitcnt lgkmcnt(4)
    v_mfma_f32_16x16x32_bf16 v[164:167], a[128:131], a[64:67], v[164:167]
    ds_read_b64_tr_b16 a[160:161], v16 offset:32768
    buffer_load_dwordx4 v223, s[32:35], s52 offen offset:3072 lds
    v_mfma_f32_16x16x32_bf16 v[164:167], a[132:135], a[72:75], v[164:167]
    ds_read_b64_tr_b16 a[162:163], v16 offset:34816
    v_mfma_f32_16x16x32_bf16 v[168:171], a[132:135], a[76:79], v[168:171]
    ds_read_b64_tr_b16 a[164:165], v16 offset:36864
    v_mfma_f32_16x16x32_bf16 v[168:171], a[128:131], a[68:71], v[168:171]
    ds_read_b64_tr_b16 a[166:167], v16 offset:38912
    s_waitcnt lgkmcnt(4)
    v_mfma_f32_16x16x32_bf16 v[176:179], a[144:147], a[68:71], v[176:179]
    ds_read_b64_tr_b16 a[176:177], v17 offset:32768
    buffer_load_dwordx4 a[12:15], v213, s[24:27], s50 offen offset:1024 sc1
    v_mfma_f32_16x16x32_bf16 v[176:179], a[148:151], a[76:79], v[176:179]
    ds_read_b64_tr_b16 a[178:179], v17 offset:34816
    v_mfma_f32_16x16x32_bf16 v[172:175], a[148:151], a[72:75], v[172:175]
    ds_read_b64_tr_b16 a[180:181], v17 offset:36864
    v_mfma_f32_16x16x32_bf16 v[172:175], a[144:147], a[64:67], v[172:175]
    ds_read_b64_tr_b16 a[182:183], v17 offset:38912
    s_waitcnt lgkmcnt(4)
    v_mfma_f32_16x16x32_bf16 v[180:183], a[160:163], a[64:67], v[180:183]
    ds_read_b64_tr_b16 a[128:129], v227 offset:40960
    s_add_u32 m0, s40, 0
    v_mfma_f32_16x16x32_bf16 v[180:183], a[164:167], a[72:75], v[180:183]
    ds_read_b64_tr_b16 a[130:131], v227 offset:43008
    buffer_load_dwordx4 v216, s[32:35], s52 offen offset:0 lds
    v_mfma_f32_16x16x32_bf16 v[184:187], a[164:167], a[76:79], v[184:187]
    ds_read_b64_tr_b16 a[132:133], v227 offset:45056
    v_mfma_f32_16x16x32_bf16 v[184:187], a[160:163], a[68:71], v[184:187]
    ds_read_b64_tr_b16 a[134:135], v227 offset:47104
    s_waitcnt lgkmcnt(4)
    v_mfma_f32_16x16x32_bf16 v[192:195], a[176:179], a[68:71], v[192:195]
    ds_read_b64_tr_b16 a[144:145], v228 offset:40960
    buffer_load_dwordx4 a[16:19], v214, s[24:27], s50 offen offset:0 sc1
    v_mfma_f32_16x16x32_bf16 v[192:195], a[180:183], a[76:79], v[192:195]
    ds_read_b64_tr_b16 a[146:147], v228 offset:43008
    v_mfma_f32_16x16x32_bf16 v[188:191], a[180:183], a[72:75], v[188:191]
    ds_read_b64_tr_b16 a[148:149], v228 offset:45056
    v_mfma_f32_16x16x32_bf16 v[188:191], a[176:179], a[64:67], v[188:191]
    ds_read_b64_tr_b16 a[150:151], v228 offset:47104
    s_waitcnt lgkmcnt(4)
    v_mfma_f32_16x16x32_bf16 v[132:135], a[128:131], a[80:83], v[132:135]
    ds_read_b64_tr_b16 a[160:161], v229 offset:40960
    buffer_load_dwordx4 v217, s[32:35], s52 offen offset:1024 lds
    v_mfma_f32_16x16x32_bf16 v[132:135], a[132:135], a[88:91], v[132:135]
    ds_read_b64_tr_b16 a[162:163], v229 offset:43008
    v_mfma_f32_16x16x32_bf16 v[136:139], a[132:135], a[92:95], v[136:139]
    ds_read_b64_tr_b16 a[164:165], v229 offset:45056
    v_mfma_f32_16x16x32_bf16 v[136:139], a[128:131], a[84:87], v[136:139]
    ds_read_b64_tr_b16 a[166:167], v229 offset:47104
    s_waitcnt lgkmcnt(4)
    v_mfma_f32_16x16x32_bf16 v[144:147], a[144:147], a[84:87], v[144:147]
    ds_read_b64_tr_b16 a[176:177], v230 offset:40960
    buffer_load_dwordx4 a[20:23], v214, s[24:27], s50 offen offset:1024 sc1
    v_mfma_f32_16x16x32_bf16 v[144:147], a[148:151], a[92:95], v[144:147]
    ds_read_b64_tr_b16 a[178:179], v230 offset:43008
    v_mfma_f32_16x16x32_bf16 v[140:143], a[148:151], a[88:91], v[140:143]
    ds_read_b64_tr_b16 a[180:181], v230 offset:45056
    v_mfma_f32_16x16x32_bf16 v[140:143], a[144:147], a[80:83], v[140:143]
    ds_read_b64_tr_b16 a[182:183], v230 offset:47104
    s_waitcnt lgkmcnt(4)
    v_mfma_f32_16x16x32_bf16 v[148:151], a[160:163], a[80:83], v[148:151]
    ds_read_b64_tr_b16 a[128:129], v14 offset:40960
    buffer_load_dwordx4 v218, s[32:35], s52 offen offset:2048 lds
    v_mfma_f32_16x16x32_bf16 v[148:151], a[164:167], a[88:91], v[148:151]
    ds_read_b64_tr_b16 a[130:131], v14 offset:43008
    v_mfma_f32_16x16x32_bf16 v[152:155], a[164:167], a[92:95], v[152:155]
    ds_read_b64_tr_b16 a[132:133], v14 offset:45056
    v_mfma_f32_16x16x32_bf16 v[152:155], a[160:163], a[84:87], v[152:155]
    ds_read_b64_tr_b16 a[134:135], v14 offset:47104
    s_waitcnt lgkmcnt(4)
    v_mfma_f32_16x16x32_bf16 v[160:163], a[176:179], a[84:87], v[160:163]
    ds_read_b64_tr_b16 a[144:145], v15 offset:40960
    buffer_load_dwordx4 a[24:27], v215, s[24:27], s50 offen offset:0 sc1
    v_mfma_f32_16x16x32_bf16 v[160:163], a[180:183], a[92:95], v[160:163]
    ds_read_b64_tr_b16 a[146:147], v15 offset:43008
    v_mfma_f32_16x16x32_bf16 v[156:159], a[180:183], a[88:91], v[156:159]
    ds_read_b64_tr_b16 a[148:149], v15 offset:45056
    v_mfma_f32_16x16x32_bf16 v[156:159], a[176:179], a[80:83], v[156:159]
    ds_read_b64_tr_b16 a[150:151], v15 offset:47104
    s_waitcnt lgkmcnt(4)
    v_mfma_f32_16x16x32_bf16 v[164:167], a[128:131], a[80:83], v[164:167]
    ds_read_b64_tr_b16 a[160:161], v16 offset:40960
    buffer_load_dwordx4 v219, s[32:35], s52 offen offset:3072 lds
    v_mfma_f32_16x16x32_bf16 v[164:167], a[132:135], a[88:91], v[164:167]
    ds_read_b64_tr_b16 a[162:163], v16 offset:43008
    v_mfma_f32_16x16x32_bf16 v[168:171], a[132:135], a[92:95], v[168:171]
    ds_read_b64_tr_b16 a[164:165], v16 offset:45056
    v_mfma_f32_16x16x32_bf16 v[168:171], a[128:131], a[84:87], v[168:171]
    ds_read_b64_tr_b16 a[166:167], v16 offset:47104
    s_waitcnt lgkmcnt(4)
    v_mfma_f32_16x16x32_bf16 v[176:179], a[144:147], a[84:87], v[176:179]
    ds_read_b64_tr_b16 a[176:177], v17 offset:40960
    buffer_load_dwordx4 a[28:31], v215, s[24:27], s50 offen offset:1024 sc1
    v_mfma_f32_16x16x32_bf16 v[176:179], a[148:151], a[92:95], v[176:179]
    ds_read_b64_tr_b16 a[178:179], v17 offset:43008
    v_mfma_f32_16x16x32_bf16 v[172:175], a[148:151], a[88:91], v[172:175]
    ds_read_b64_tr_b16 a[180:181], v17 offset:45056
    v_mfma_f32_16x16x32_bf16 v[172:175], a[144:147], a[80:83], v[172:175]
    ds_read_b64_tr_b16 a[182:183], v17 offset:47104
    s_waitcnt lgkmcnt(4)
    v_mfma_f32_16x16x32_bf16 v[180:183], a[160:163], a[80:83], v[180:183]
    s_waitcnt vmcnt(16)
    s_barrier
    ds_read_b64_tr_b16 a[128:129], v227 offset:49152
    v_mfma_f32_16x16x32_bf16 v[180:183], a[164:167], a[88:91], v[180:183]
    ds_read_b64_tr_b16 a[130:131], v227 offset:51200
    s_add_u32 m0, s40, 81920
    v_mfma_f32_16x16x32_bf16 v[184:187], a[164:167], a[92:95], v[184:187]
    ds_read_b64_tr_b16 a[132:133], v227 offset:53248
    buffer_load_dwordx4 v220, s[32:35], s53 offen offset:0 lds
    v_mfma_f32_16x16x32_bf16 v[184:187], a[160:163], a[84:87], v[184:187]
    ds_read_b64_tr_b16 a[134:135], v227 offset:55296
    v_readlane_b32 s50, v18, s46
    s_waitcnt lgkmcnt(4)
    v_mfma_f32_16x16x32_bf16 v[192:195], a[176:179], a[84:87], v[192:195]
    ds_read_b64_tr_b16 a[144:145], v228 offset:49152
    buffer_load_dwordx4 a[32:35], v212, s[24:27], s51 offen offset:0 sc1
    v_mfma_f32_16x16x32_bf16 v[192:195], a[180:183], a[92:95], v[192:195]
    ds_read_b64_tr_b16 a[146:147], v228 offset:51200
    v_readlane_b32 s52, v19, s46
    v_mfma_f32_16x16x32_bf16 v[188:191], a[180:183], a[88:91], v[188:191]
    ds_read_b64_tr_b16 a[148:149], v228 offset:53248
    v_mfma_f32_16x16x32_bf16 v[188:191], a[176:179], a[80:83], v[188:191]
    ds_read_b64_tr_b16 a[150:151], v228 offset:55296
    s_getpc_b64 s[72:73]
L_cp7:
    s_lshr_b32 s74, s2, 3
    s_lshl2_add_u32 s74, s74, s3
    s_lshl_b32 s74, s74, 7
    s_add_u32 s74, s74, 4096
    s_min_u32 s74, s74, L_end-L_cp7
    s_add_u32 s72, s72, s74
    s_addc_u32 s73, s73, 0
    v_and_b32 v254, 0, v0
    v_lshlrev_b32 v254, 7, v254
    v_mov_b32 v255, s73
    v_add_co_u32 v254, vcc, s72, v254
    s_nop 1
    v_addc_co_u32 v255, vcc, 0, v255, vcc
    global_load_dword a251, v[254:255], off
    s_waitcnt lgkmcnt(4)
    v_mfma_f32_16x16x32_bf16 v[132:135], a[128:131], a[96:99], v[132:135]
    ds_read_b64_tr_b16 a[160:161], v229 offset:49152
    buffer_load_dwordx4 v221, s[32:35], s53 offen offset:1024 lds
    v_mfma_f32_16x16x32_bf16 v[132:135], a[132:135], a[104:107], v[132:135]
    ds_read_b64_tr_b16 a[162:163], v229 offset:51200
    s_add_u32 s46, s46, 1
    v_mfma_f32_16x16x32_bf16 v[136:139], a[132:135], a[108:111], v[136:139]
    ds_read_b64_tr_b16 a[164:165], v229 offset:53248
    v_mfma_f32_16x16x32_bf16 v[136:139], a[128:131], a[100:103], v[136:139]
    ds_read_b64_tr_b16 a[166:167], v229 offset:55296
    s_waitcnt lgkmcnt(4)
    v_mfma_f32_16x16x32_bf16 v[144:147], a[144:147], a[100:103], v[144:147]
    ds_read_b64_tr_b16 a[176:177], v230 offset:49152
    buffer_load_dwordx4 a[36:39], v212, s[24:27], s51 offen offset:1024 sc1
    v_mfma_f32_16x16x32_bf16 v[144:147], a[148:151], a[108:111], v[144:147]
    ds_read_b64_tr_b16 a[178:179], v230 offset:51200
    v_mfma_f32_16x16x32_bf16 v[140:143], a[148:151], a[104:107], v[140:143]
    ds_read_b64_tr_b16 a[180:181], v230 offset:53248
    v_mfma_f32_16x16x32_bf16 v[140:143], a[144:147], a[96:99], v[140:143]
    ds_read_b64_tr_b16 a[182:183], v230 offset:55296
    s_waitcnt lgkmcnt(4)
    v_mfma_f32_16x16x32_bf16 v[148:151], a[160:163], a[96:99], v[148:151]
    ds_read_b64_tr_b16 a[128:129], v14 offset:49152
    buffer_load_dwordx4 v222, s[32:35], s53 offen offset:2048 lds
    v_mfma_f32_16x16x32_bf16 v[148:151], a[164:167], a[104:107], v[148:151]
    ds_read_b64_tr_b16 a[130:131], v14 offset:51200
    v_mfma_f32_16x16x32_bf16 v[152:155], a[164:167], a[108:111], v[152:155]
    ds_read_b64_tr_b16 a[132:133], v14 offset:53248
    v_mfma_f32_16x16x32_bf16 v[152:155], a[160:163], a[100:103], v[152:155]
    ds_read_b64_tr_b16 a[134:135], v14 offset:55296
    s_waitcnt lgkmcnt(4)
    v_mfma_f32_16x16x32_bf16 v[160:163], a[176:179], a[100:103], v[160:163]
    ds_read_b64_tr_b16 a[144:145], v15 offset:49152
    buffer_load_dwordx4 a[40:43], v213, s[24:27], s51 offen offset:0 sc1
    v_mfma_f32_16x16x32_bf16 v[160:163], a[180:183], a[108:111], v[160:163]
    ds_read_b64_tr_b16 a[146:147], v15 offset:51200
    v_mfma_f32_16x16x32_bf16 v[156:159], a[180:183], a[104:107], v[156:159]
    ds_read_b64_tr_b16 a[148:149], v15 offset:53248
    v_mfma_f32_16x16x32_bf16 v[156:159], a[176:179], a[96:99], v[156:159]
    ds_read_b64_tr_b16 a[150:151], v15 offset:55296
    s_waitcnt lgkmcnt(4)
    v_mfma_f32_16x16x32_bf16 v[164:167], a[128:131], a[96:99], v[164:167]
    ds_read_b64_tr_b16 a[160:161], v16 offset:49152
    buffer_load_dwordx4 v223, s[32:35], s53 offen offset:3072 lds
    v_mfma_f32_16x16x32_bf16 v[164:167], a[132:135], a[104:107], v[164:167]
    ds_read_b64_tr_b16 a[162:163], v16 offset:51200
    v_mfma_f32_16x16x32_bf16 v[168:171], a[132:135], a[108:111], v[168:171]
    ds_read_b64_tr_b16 a[164:165], v16 offset:53248
    v_mfma_f32_16x16x32_bf16 v[168:171], a[128:131], a[100:103], v[168:171]
    ds_read_b64_tr_b16 a[166:167], v16 offset:55296
    s_waitcnt lgkmcnt(4)
    v_mfma_f32_16x16x32_bf16 v[176:179], a[144:147], a[100:103], v[176:179]
    ds_read_b64_tr_b16 a[176:177], v17 offset:49152
    buffer_load_dwordx4 a[44:47], v213, s[24:27], s51 offen offset:1024 sc1
    v_mfma_f32_16x16x32_bf16 v[176:179], a[148:151], a[108:111], v[176:179]
    ds_read_b64_tr_b16 a[178:179], v17 offset:51200
    v_mfma_f32_16x16x32_bf16 v[172:175], a[148:151], a[104:107], v[172:175]
    ds_read_b64_tr_b16 a[180:181], v17 offset:53248
    v_mfma_f32_16x16x32_bf16 v[172:175], a[144:147], a[96:99], v[172:175]
    ds_read_b64_tr_b16 a[182:183], v17 offset:55296
    s_waitcnt lgkmcnt(4)
    v_mfma_f32_16x16x32_bf16 v[180:183], a[160:163], a[96:99], v[180:183]
    ds_read_b64_tr_b16 a[128:129], v227 offset:57344
    s_add_u32 m0, s40, 16384
    v_mfma_f32_16x16x32_bf16 v[180:183], a[164:167], a[104:107], v[180:183]
    ds_read_b64_tr_b16 a[130:131], v227 offset:59392
    buffer_load_dwordx4 v216, s[32:35], s53 offen offset:0 lds
    v_mfma_f32_16x16x32_bf16 v[184:187], a[164:167], a[108:111], v[184:187]
    ds_read_b64_tr_b16 a[132:133], v227 offset:61440
    v_mfma_f32_16x16x32_bf16 v[184:187], a[160:163], a[100:103], v[184:187]
    ds_read_b64_tr_b16 a[134:135], v227 offset:63488
    s_waitcnt lgkmcnt(4)
    v_mfma_f32_16x16x32_bf16 v[192:195], a[176:179], a[100:103], v[192:195]
    ds_read_b64_tr_b16 a[144:145], v228 offset:57344
    buffer_load_dwordx4 a[48:51], v214, s[24:27], s51 offen offset:0 sc1
    v_mfma_f32_16x16x32_bf16 v[192:195], a[180:183], a[108:111], v[192:195]
    ds_read_b64_tr_b16 a[146:147], v228 offset:59392
    v_mfma_f32_16x16x32_bf16 v[188:191], a[180:183], a[104:107], v[188:191]
    ds_read_b64_tr_b16 a[148:149], v228 offset:61440
    v_mfma_f32_16x16x32_bf16 v[188:191], a[176:179], a[96:99], v[188:191]
    ds_read_b64_tr_b16 a[150:151], v228 offset:63488
    s_waitcnt lgkmcnt(4)
    v_mfma_f32_16x16x32_bf16 v[132:135], a[128:131], a[112:115], v[132:135]
    ds_read_b64_tr_b16 a[160:161], v229 offset:57344
    buffer_load_dwordx4 v217, s[32:35], s53 offen offset:1024 lds
    v_mfma_f32_16x16x32_bf16 v[132:135], a[132:135], a[120:123], v[132:135]
    ds_read_b64_tr_b16 a[162:163], v229 offset:59392
    v_mfma_f32_16x16x32_bf16 v[136:139], a[132:135], a[124:127], v[136:139]
    ds_read_b64_tr_b16 a[164:165], v229 offset:61440
    v_mfma_f32_16x16x32_bf16 v[136:139], a[128:131], a[116:119], v[136:139]
    ds_read_b64_tr_b16 a[166:167], v229 offset:63488
    s_waitcnt lgkmcnt(4)
    v_mfma_f32_16x16x32_bf16 v[144:147], a[144:147], a[116:119], v[144:147]
    ds_read_b64_tr_b16 a[176:177], v230 offset:57344
    buffer_load_dwordx4 a[52:55], v214, s[24:27], s51 offen offset:1024 sc1
    v_mfma_f32_16x16x32_bf16 v[144:147], a[148:151], a[124:127], v[144:147]
    ds_read_b64_tr_b16 a[178:179], v230 offset:59392
    v_mfma_f32_16x16x32_bf16 v[140:143], a[148:151], a[120:123], v[140:143]
    ds_read_b64_tr_b16 a[180:181], v230 offset:61440
    v_mfma_f32_16x16x32_bf16 v[140:143], a[144:147], a[112:115], v[140:143]
    ds_read_b64_tr_b16 a[182:183], v230 offset:63488
    s_waitcnt lgkmcnt(4)
    v_mfma_f32_16x16x32_bf16 v[148:151], a[160:163], a[112:115], v[148:151]
    ds_read_b64_tr_b16 a[128:129], v14 offset:57344
    buffer_load_dwordx4 v218, s[32:35], s53 offen offset:2048 lds
    v_mfma_f32_16x16x32_bf16 v[148:151], a[164:167], a[120:123], v[148:151]
    ds_read_b64_tr_b16 a[130:131], v14 offset:59392
    v_mfma_f32_16x16x32_bf16 v[152:155], a[164:167], a[124:127], v[152:155]
    ds_read_b64_tr_b16 a[132:133], v14 offset:61440
    v_mfma_f32_16x16x32_bf16 v[152:155], a[160:163], a[116:119], v[152:155]
    ds_read_b64_tr_b16 a[134:135], v14 offset:63488
    s_waitcnt lgkmcnt(4)
    v_mfma_f32_16x16x32_bf16 v[160:163], a[176:179], a[116:119], v[160:163]
    ds_read_b64_tr_b16 a[144:145], v15 offset:57344
    buffer_load_dwordx4 a[56:59], v215, s[24:27], s51 offen offset:0 sc1
    v_mfma_f32_16x16x32_bf16 v[160:163], a[180:183], a[124:127], v[160:163]
    ds_read_b64_tr_b16 a[146:147], v15 offset:59392
    v_mfma_f32_16x16x32_bf16 v[156:159], a[180:183], a[120:123], v[156:159]
    ds_read_b64_tr_b16 a[148:149], v15 offset:61440
    v_mfma_f32_16x16x32_bf16 v[156:159], a[176:179], a[112:115], v[156:159]
    ds_read_b64_tr_b16 a[150:151], v15 offset:63488
    s_waitcnt lgkmcnt(4)
    v_mfma_f32_16x16x32_bf16 v[164:167], a[128:131], a[112:115], v[164:167]
    ds_read_b64_tr_b16 a[160:161], v16 offset:57344
    buffer_load_dwordx4 v219, s[32:35], s53 offen offset:3072 lds
    v_mfma_f32_16x16x32_bf16 v[164:167], a[132:135], a[120:123], v[164:167]
    ds_read_b64_tr_b16 a[162:163], v16 offset:59392
    v_mfma_f32_16x16x32_bf16 v[168:171], a[132:135], a[124:127], v[168:171]
    ds_read_b64_tr_b16 a[164:165], v16 offset:61440
    v_mfma_f32_16x16x32_bf16 v[168:171], a[128:131], a[116:119], v[168:171]
    ds_read_b64_tr_b16 a[166:167], v16 offset:63488
    s_waitcnt lgkmcnt(4)
    v_mfma_f32_16x16x32_bf16 v[176:179], a[144:147], a[116:119], v[176:179]
    ds_read_b64_tr_b16 a[176:177], v17 offset:57344
    buffer_load_dwordx4 a[60:63], v215, s[24:27], s51 offen offset:1024 sc1
    v_mfma_f32_16x16x32_bf16 v[176:179], a[148:151], a[124:127], v[176:179]
    ds_read_b64_tr_b16 a[178:179], v17 offset:59392
    v_mfma_f32_16x16x32_bf16 v[172:175], a[148:151], a[120:123], v[172:175]
    ds_read_b64_tr_b16 a[180:181], v17 offset:61440
    v_mfma_f32_16x16x32_bf16 v[172:175], a[144:147], a[112:115], v[172:175]
    ds_read_b64_tr_b16 a[182:183], v17 offset:63488
    s_waitcnt lgkmcnt(4)
    v_mfma_f32_16x16x32_bf16 v[180:183], a[160:163], a[112:115], v[180:183]
    s_waitcnt vmcnt(17)
    s_barrier
    ds_read_b64_tr_b16 a[128:129], v227 offset:0
    v_mfma_f32_16x16x32_bf16 v[180:183], a[164:167], a[120:123], v[180:183]
    ds_read_b64_tr_b16 a[130:131], v227 offset:2048
    s_add_u32 m0, s40, 98304
    v_mfma_f32_16x16x32_bf16 v[184:187], a[164:167], a[124:127], v[184:187]
    ds_read_b64_tr_b16 a[132:133], v227 offset:4096
    buffer_load_dwordx4 v220, s[32:35], s52 offen offset:0 lds
    v_mfma_f32_16x16x32_bf16 v[184:187], a[160:163], a[116:119], v[184:187]
    ds_read_b64_tr_b16 a[134:135], v227 offset:6144
    v_readlane_b32 s51, v18, s46
    s_waitcnt lgkmcnt(4)
    v_mfma_f32_16x16x32_bf16 v[192:195], a[176:179], a[116:119], v[192:195]
    ds_read_b64_tr_b16 a[144:145], v228 offset:0
    buffer_load_dwordx4 a[64:67], v212, s[24:27], s50 offen offset:0 sc1
    v_mfma_f32_16x16x32_bf16 v[192:195], a[180:183], a[124:127], v[192:195]
    ds_read_b64_tr_b16 a[146:147], v228 offset:2048
    v_readlane_b32 s53, v19, s46
    v_mfma_f32_16x16x32_bf16 v[188:191], a[180:183], a[120:123], v[188:191]
    ds_read_b64_tr_b16 a[148:149], v228 offset:4096
    v_mfma_f32_16x16x32_bf16 v[188:191], a[176:179], a[112:115], v[188:191]
    ds_read_b64_tr_b16 a[150:151], v228 offset:6144
    s_waitcnt lgkmcnt(4)
    v_mfma_f32_16x16x32_bf16 v[132:135], a[128:131], a[0:3], v[132:135]
    ds_read_b64_tr_b16 a[160:161], v229 offset:0
    buffer_load_dwordx4 v221, s[32:35], s52 offen offset:1024 lds
    s_add_u32 s20, s98, 0x2000000
    s_addc_u32 s21, s99, 0
    v_mfma_f32_16x16x32_bf16 v[132:135], a[132:135], a[8:11], v[132:135]
    ds_read_b64_tr_b16 a[162:163], v229 offset:2048
    s_add_u32 s46, s46, 1
    v_mfma_f32_16x16x32_bf16 v[136:139], a[132:135], a[12:15], v[136:139]
    ds_read_b64_tr_b16 a[164:165], v229 offset:4096
    s_mov_b32 s22, 0x800000
    s_mov_b32 s23, 0x00020000
    v_mfma_f32_16x16x32_bf16 v[136:139], a[128:131], a[4:7], v[136:139]
    ds_read_b64_tr_b16 a[166:167], v229 offset:6144
    s_lshl_b32 s14, s47, 4
    s_waitcnt lgkmcnt(4)
    v_mfma_f32_16x16x32_bf16 v[144:147], a[144:147], a[4:7], v[144:147]
    ds_read_b64_tr_b16 a[176:177], v230 offset:0
    buffer_load_dwordx4 a[68:71], v212, s[24:27], s50 offen offset:1024 sc1
    s_add_u32 s14, s14, s48
    v_mfma_f32_16x16x32_bf16 v[144:147], a[148:151], a[12:15], v[144:147]
    ds_read_b64_tr_b16 a[178:179], v230 offset:2048
    s_lshl_b32 s75, s14, 7
    s_add_u32 s75, s75, 0x8010
    v_mfma_f32_16x16x32_bf16 v[140:143], a[148:151], a[8:11], v[140:143]
    ds_read_b64_tr_b16 a[180:181], v230 offset:4096
    s_lshl_b32 s14, s14, 2
    s_add_u32 s14, s14, s3
    v_mfma_f32_16x16x32_bf16 v[140:143], a[144:147], a[0:3], v[140:143]
    ds_read_b64_tr_b16 a[182:183], v230 offset:6144
    s_lshl_b32 s42, s14, 13
    s_waitcnt lgkmcnt(4)
    v_mfma_f32_16x16x32_bf16 v[148:151], a[160:163], a[0:3], v[148:151]
    ds_read_b64_tr_b16 a[128:129], v14 offset:0
    buffer_load_dwordx4 v222, s[32:35], s52 offen offset:2048 lds
    s_add_u32 s43, s42, 4096
    v_mfma_f32_16x16x32_bf16 v[148:151], a[164:167], a[8:11], v[148:151]
    ds_read_b64_tr_b16 a[130:131], v14 offset:2048
    s_xor_b32 s44, s42, 0x8000
    s_add_u32 s45, s44, 4096
    v_mfma_f32_16x16x32_bf16 v[152:155], a[164:167], a[12:15], v[152:155]
    ds_read_b64_tr_b16 a[132:133], v14 offset:4096
    v_lshlrev_b32 v231, 4, v0
    s_lshl_b32 s15, s3, 19
    v_mfma_f32_16x16x32_bf16 v[152:155], a[160:163], a[4:7], v[152:155]
    ds_read_b64_tr_b16 a[134:135], v14 offset:6144
    s_add_u32 s75, s75, s15
    s_waitcnt lgkmcnt(4)
    v_mfma_f32_16x16x32_bf16 v[160:163], a[176:179], a[4:7], v[160:163]
    ds_read_b64_tr_b16 a[144:145], v15 offset:0
    buffer_load_dwordx4 a[72:75], v213, s[24:27], s50 offen offset:0 sc1
    s_xor_b32 s14, s75, 128
    v_mfma_f32_16x16x32_bf16 v[160:163], a[180:183], a[12:15], v[160:163]
    ds_read_b64_tr_b16 a[146:147], v15 offset:2048
    v_mov_b32 v225, s14
    v_mfma_f32_16x16x32_bf16 v[156:159], a[180:183], a[8:11], v[156:159]
    ds_read_b64_tr_b16 a[148:149], v15 offset:4096
    v_mfma_f32_16x16x32_bf16 v[156:159], a[176:179], a[0:3], v[156:159]
    ds_read_b64_tr_b16 a[150:151], v15 offset:6144
    s_waitcnt lgkmcnt(4)
    v_mfma_f32_16x16x32_bf16 v[164:167], a[128:131], a[0:3], v[164:167]
    ds_read_b64_tr_b16 a[160:161], v16 offset:0
    buffer_load_dwordx4 v223, s[32:35], s52 offen offset:3072 lds
    v_mfma_f32_16x16x32_bf16 v[164:167], a[132:135], a[8:11], v[164:167]
    ds_read_b64_tr_b16 a[162:163], v16 offset:2048
    v_mfma_f32_16x16x32_bf16 v[168:171], a[132:135], a[12:15], v[168:171]
    ds_read_b64_tr_b16 a[164:165], v16 offset:4096
    v_mfma_f32_16x16x32_bf16 v[168:171], a[128:131], a[4:7], v[168:171]
    ds_read_b64_tr_b16 a[166:167], v16 offset:6144
    s_waitcnt lgkmcnt(4)
    v_mfma_f32_16x16x32_bf16 v[176:179], a[144:147], a[4:7], v[176:179]
    ds_read_b64_tr_b16 a[176:177], v17 offset:0
    buffer_load_dwordx4 a[76:79], v213, s[24:27], s50 offen offset:1024 sc1
    v_mfma_f32_16x16x32_bf16 v[176:179], a[148:151], a[12:15], v[176:179]
    ds_read_b64_tr_b16 a[178:179], v17 offset:2048
    v_mfma_f32_16x16x32_bf16 v[172:175], a[148:151], a[8:11], v[172:175]
    ds_read_b64_tr_b16 a[180:181], v17 offset:4096
    v_mfma_f32_16x16x32_bf16 v[172:175], a[144:147], a[0:3], v[172:175]
    ds_read_b64_tr_b16 a[182:183], v17 offset:6144
    s_waitcnt lgkmcnt(4)
    v_mfma_f32_16x16x32_bf16 v[180:183], a[160:163], a[0:3], v[180:183]
    ds_read_b64_tr_b16 a[128:129], v227 offset:8192
    s_add_u32 m0, s40, 32768
    v_mfma_f32_16x16x32_bf16 v[180:183], a[164:167], a[8:11], v[180:183]
    ds_read_b64_tr_b16 a[130:131], v227 offset:10240
    buffer_load_dwordx4 v216, s[32:35], s52 offen offset:0 lds
    v_mfma_f32_16x16x32_bf16 v[184:187], a[164:167], a[12:15], v[184:187]
    ds_read_b64_tr_b16 a[132:133], v227 offset:12288
    v_mfma_f32_16x16x32_bf16 v[184:187], a[160:163], a[4:7], v[184:187]
    ds_read_b64_tr_b16 a[134:135], v227 offset:14336
    s_waitcnt lgkmcnt(4)
    v_mfma_f32_16x16x32_bf16 v[192:195], a[176:179], a[4:7], v[192:195]
    ds_read_b64_tr_b16 a[144:145], v228 offset:8192
    buffer_load_dwordx4 a[80:83], v214, s[24:27], s50 offen offset:0 sc1
    v_mfma_f32_16x16x32_bf16 v[192:195], a[180:183], a[12:15], v[192:195]
    ds_read_b64_tr_b16 a[146:147], v228 offset:10240
    v_mfma_f32_16x16x32_bf16 v[188:191], a[180:183], a[8:11], v[188:191]
    ds_read_b64_tr_b16 a[148:149], v228 offset:12288
    v_mfma_f32_16x16x32_bf16 v[188:191], a[176:179], a[0:3], v[188:191]
    ds_read_b64_tr_b16 a[150:151], v228 offset:14336
    s_waitcnt lgkmcnt(4)
    v_mfma_f32_16x16x32_bf16 v[132:135], a[128:131], a[16:19], v[132:135]
    ds_read_b64_tr_b16 a[160:161], v229 offset:8192
    buffer_load_dwordx4 v217, s[32:35], s52 offen offset:1024 lds
    v_mfma_f32_16x16x32_bf16 v[132:135], a[132:135], a[24:27], v[132:135]
    ds_read_b64_tr_b16 a[162:163], v229 offset:10240
    v_mfma_f32_16x16x32_bf16 v[136:139], a[132:135], a[28:31], v[136:139]
    ds_read_b64_tr_b16 a[164:165], v229 offset:12288
    v_mfma_f32_16x16x32_bf16 v[136:139], a[128:131], a[20:23], v[136:139]
    ds_read_b64_tr_b16 a[166:167], v229 offset:14336
    s_waitcnt lgkmcnt(4)
    v_mfma_f32_16x16x32_bf16 v[144:147], a[144:147], a[20:23], v[144:147]
    ds_read_b64_tr_b16 a[176:177], v230 offset:8192
    buffer_load_dwordx4 a[84:87], v214, s[24:27], s50 offen offset:1024 sc1
    v_mfma_f32_16x16x32_bf16 v[144:147], a[148:151], a[28:31], v[144:147]
    ds_read_b64_tr_b16 a[178:179], v230 offset:10240
    v_mfma_f32_16x16x32_bf16 v[140:143], a[148:151], a[24:27], v[140:143]
    ds_read_b64_tr_b16 a[180:181], v230 offset:12288
    v_mfma_f32_16x16x32_bf16 v[140:143], a[144:147], a[16:19], v[140:143]
    ds_read_b64_tr_b16 a[182:183], v230 offset:14336
    s_waitcnt lgkmcnt(4)
    v_mfma_f32_16x16x32_bf16 v[148:151], a[160:163], a[16:19], v[148:151]
    ds_read_b64_tr_b16 a[128:129], v14 offset:8192
    buffer_load_dwordx4 v218, s[32:35], s52 offen offset:2048 lds
    v_mfma_f32_16x16x32_bf16 v[148:151], a[164:167], a[24:27], v[148:151]
    ds_read_b64_tr_b16 a[130:131], v14 offset:10240
    v_mfma_f32_16x16x32_bf16 v[152:155], a[164:167], a[28:31], v[152:155]
    ds_read_b64_tr_b16 a[132:133], v14 offset:12288
    v_mfma_f32_16x16x32_bf16 v[152:155], a[160:163], a[20:23], v[152:155]
    ds_read_b64_tr_b16 a[134:135], v14 offset:14336
    s_waitcnt lgkmcnt(4)
    v_mfma_f32_16x16x32_bf16 v[160:163], a[176:179], a[20:23], v[160:163]
    ds_read_b64_tr_b16 a[144:145], v15 offset:8192
    buffer_load_dwordx4 a[88:91], v215, s[24:27], s50 offen offset:0 sc1
    v_mfma_f32_16x16x32_bf16 v[160:163], a[180:183], a[28:31], v[160:163]
    ds_read_b64_tr_b16 a[146:147], v15 offset:10240
    v_mfma_f32_16x16x32_bf16 v[156:159], a[180:183], a[24:27], v[156:159]
    ds_read_b64_tr_b16 a[148:149], v15 offset:12288
    v_mfma_f32_16x16x32_bf16 v[156:159], a[176:179], a[16:19], v[156:159]
    ds_read_b64_tr_b16 a[150:151], v15 offset:14336
    s_waitcnt lgkmcnt(4)
    v_mfma_f32_16x16x32_bf16 v[164:167], a[128:131], a[16:19], v[164:167]
    ds_read_b64_tr_b16 a[160:161], v16 offset:8192
    buffer_load_dwordx4 v219, s[32:35], s52 offen offset:3072 lds
    v_mfma_f32_16x16x32_bf16 v[164:167], a[132:135], a[24:27], v[164:167]
    ds_read_b64_tr_b16 a[162:163], v16 offset:10240
    v_mfma_f32_16x16x32_bf16 v[168:171], a[132:135], a[28:31], v[168:171]
    ds_read_b64_tr_b16 a[164:165], v16 offset:12288
    v_mfma_f32_16x16x32_bf16 v[168:171], a[128:131], a[20:23], v[168:171]
    ds_read_b64_tr_b16 a[166:167], v16 offset:14336
    s_waitcnt lgkmcnt(4)
    v_mfma_f32_16x16x32_bf16 v[176:179], a[144:147], a[20:23], v[176:179]
    ds_read_b64_tr_b16 a[176:177], v17 offset:8192
    buffer_load_dwordx4 a[92:95], v215, s[24:27], s50 offen offset:1024 sc1
    v_mfma_f32_16x16x32_bf16 v[176:179], a[148:151], a[28:31], v[176:179]
    ds_read_b64_tr_b16 a[178:179], v17 offset:10240
    v_mfma_f32_16x16x32_bf16 v[172:175], a[148:151], a[24:27], v[172:175]
    ds_read_b64_tr_b16 a[180:181], v17 offset:12288
    v_mfma_f32_16x16x32_bf16 v[172:175], a[144:147], a[16:19], v[172:175]
    ds_read_b64_tr_b16 a[182:183], v17 offset:14336
    s_waitcnt lgkmcnt(4)
    v_mfma_f32_16x16x32_bf16 v[180:183], a[160:163], a[16:19], v[180:183]
    s_waitcnt vmcnt(16)
    s_barrier
    ds_read_b64_tr_b16 a[128:129], v227 offset:16384
    v_mfma_f32_16x16x32_bf16 v[180:183], a[164:167], a[24:27], v[180:183]
    ds_read_b64_tr_b16 a[130:131], v227 offset:18432
    s_add_u32 m0, s40, 114688
    v_mfma_f32_16x16x32_bf16 v[184:187], a[164:167], a[28:31], v[184:187]
    ds_read_b64_tr_b16 a[132:133], v227 offset:20480
    buffer_load_dwordx4 v220, s[32:35], s53 offen offset:0 lds
    v_mfma_f32_16x16x32_bf16 v[184:187], a[160:163], a[20:23], v[184:187]
    ds_read_b64_tr_b16 a[134:135], v227 offset:22528
    v_readlane_b32 s50, v18, s46
    s_waitcnt lgkmcnt(4)
    v_mfma_f32_16x16x32_bf16 v[192:195], a[176:179], a[20:23], v[192:195]
    ds_read_b64_tr_b16 a[144:145], v228 offset:16384
    buffer_load_dwordx4 a[96:99], v212, s[24:27], s51 offen offset:0 sc1
    v_mfma_f32_16x16x32_bf16 v[192:195], a[180:183], a[28:31], v[192:195]
    ds_read_b64_tr_b16 a[146:147], v228 offset:18432
    v_readlane_b32 s52, v19, s46
    v_mfma_f32_16x16x32_bf16 v[188:191], a[180:183], a[24:27], v[188:191]
    ds_read_b64_tr_b16 a[148:149], v228 offset:20480
    v_mfma_f32_16x16x32_bf16 v[188:191], a[176:179], a[16:19], v[188:191]
    ds_read_b64_tr_b16 a[150:151], v228 offset:22528
    s_waitcnt lgkmcnt(4)
    v_mfma_f32_16x16x32_bf16 v[132:135], a[128:131], a[32:35], v[132:135]
    ds_read_b64_tr_b16 a[160:161], v229 offset:16384
    buffer_load_dwordx4 v221, s[32:35], s53 offen offset:1024 lds
    v_mfma_f32_16x16x32_bf16 v[132:135], a[132:135], a[40:43], v[132:135]
    ds_read_b64_tr_b16 a[162:163], v229 offset:18432
    s_add_u32 s46, s46, 1
    v_mfma_f32_16x16x32_bf16 v[136:139], a[132:135], a[44:47], v[136:139]
    ds_read_b64_tr_b16 a[164:165], v229 offset:20480
    v_mfma_f32_16x16x32_bf16 v[136:139], a[128:131], a[36:39], v[136:139]
    ds_read_b64_tr_b16 a[166:167], v229 offset:22528
    s_waitcnt lgkmcnt(4)
    v_mfma_f32_16x16x32_bf16 v[144:147], a[144:147], a[36:39], v[144:147]
    ds_read_b64_tr_b16 a[176:177], v230 offset:16384
    buffer_load_dwordx4 a[100:103], v212, s[24:27], s51 offen offset:1024 sc1
    v_mfma_f32_16x16x32_bf16 v[144:147], a[148:151], a[44:47], v[144:147]
    ds_read_b64_tr_b16 a[178:179], v230 offset:18432
    v_mfma_f32_16x16x32_bf16 v[140:143], a[148:151], a[40:43], v[140:143]
    ds_read_b64_tr_b16 a[180:181], v230 offset:20480
    v_mfma_f32_16x16x32_bf16 v[140:143], a[144:147], a[32:35], v[140:143]
    ds_read_b64_tr_b16 a[182:183], v230 offset:22528
    s_waitcnt lgkmcnt(4)
    v_mfma_f32_16x16x32_bf16 v[148:151], a[160:163], a[32:35], v[148:151]
    ds_read_b64_tr_b16 a[128:129], v14 offset:16384
    buffer_load_dwordx4 v222, s[32:35], s53 offen offset:2048 lds
    v_mfma_f32_16x16x32_bf16 v[148:151], a[164:167], a[40:43], v[148:151]
    ds_read_b64_tr_b16 a[130:131], v14 offset:18432
    v_mfma_f32_16x16x32_bf16 v[152:155], a[164:167], a[44:47], v[152:155]
    ds_read_b64_tr_b16 a[132:133], v14 offset:20480
    v_mfma_f32_16x16x32_bf16 v[152:155], a[160:163], a[36:39], v[152:155]
    ds_read_b64_tr_b16 a[134:135], v14 offset:22528
    s_waitcnt lgkmcnt(4)
    v_mfma_f32_16x16x32_bf16 v[160:163], a[176:179], a[36:39], v[160:163]
    ds_read_b64_tr_b16 a[144:145], v15 offset:16384
    buffer_load_dwordx4 a[104:107], v213, s[24:27], s51 offen offset:0 sc1
    v_mfma_f32_16x16x32_bf16 v[160:163], a[180:183], a[44:47], v[160:163]
    ds_read_b64_tr_b16 a[146:147], v15 offset:18432
    v_mfma_f32_16x16x32_bf16 v[156:159], a[180:183], a[40:43], v[156:159]
    ds_read_b64_tr_b16 a[148:149], v15 offset:20480
    v_mfma_f32_16x16x32_bf16 v[156:159], a[176:179], a[32:35], v[156:159]
    ds_read_b64_tr_b16 a[150:151], v15 offset:22528
    s_waitcnt lgkmcnt(4)
    v_mfma_f32_16x16x32_bf16 v[164:167], a[128:131], a[32:35], v[164:167]
    ds_read_b64_tr_b16 a[160:161], v16 offset:16384
    buffer_load_dwordx4 v223, s[32:35], s53 offen offset:3072 lds
    v_mfma_f32_16x16x32_bf16 v[164:167], a[132:135], a[40:43], v[164:167]
    ds_read_b64_tr_b16 a[162:163], v16 offset:18432
    v_mfma_f32_16x16x32_bf16 v[168:171], a[132:135], a[44:47], v[168:171]
    ds_read_b64_tr_b16 a[164:165], v16 offset:20480
    v_mfma_f32_16x16x32_bf16 v[168:171], a[128:131], a[36:39], v[168:171]
    ds_read_b64_tr_b16 a[166:167], v16 offset:22528
    s_waitcnt lgkmcnt(4)
    v_mfma_f32_16x16x32_bf16 v[176:179], a[144:147], a[36:39], v[176:179]
    ds_read_b64_tr_b16 a[176:177], v17 offset:16384
    buffer_load_dwordx4 a[108:111], v213, s[24:27], s51 offen offset:1024 sc1
    v_mfma_f32_16x16x32_bf16 v[176:179], a[148:151], a[44:47], v[176:179]
    ds_read_b64_tr_b16 a[178:179], v17 offset:18432
    v_mfma_f32_16x16x32_bf16 v[172:175], a[148:151], a[40:43], v[172:175]
    ds_read_b64_tr_b16 a[180:181], v17 offset:20480
    v_mfma_f32_16x16x32_bf16 v[172:175], a[144:147], a[32:35], v[172:175]
    ds_read_b64_tr_b16 a[182:183], v17 offset:22528
    s_waitcnt lgkmcnt(4)
    v_mfma_f32_16x16x32_bf16 v[180:183], a[160:163], a[32:35], v[180:183]
    ds_read_b64_tr_b16 a[128:129], v227 offset:24576
    s_add_u32 m0, s40, 49152
    v_mfma_f32_16x16x32_bf16 v[180:183], a[164:167], a[40:43], v[180:183]
    ds_read_b64_tr_b16 a[130:131], v227 offset:26624
    buffer_load_dwordx4 v216, s[32:35], s53 offen offset:0 lds
    v_mfma_f32_16x16x32_bf16 v[184:187], a[164:167], a[44:47], v[184:187]
    ds_read_b64_tr_b16 a[132:133], v227 offset:28672
    v_mfma_f32_16x16x32_bf16 v[184:187], a[160:163], a[36:39], v[184:187]
    ds_read_b64_tr_b16 a[134:135], v227 offset:30720
    s_waitcnt lgkmcnt(4)
    v_mfma_f32_16x16x32_bf16 v[192:195], a[176:179], a[36:39], v[192:195]
    ds_read_b64_tr_b16 a[144:145], v228 offset:24576
    buffer_load_dwordx4 a[112:115], v214, s[24:27], s51 offen offset:0 sc1
    v_mfma_f32_16x16x32_bf16 v[192:195], a[180:183], a[44:47], v[192:195]
    ds_read_b64_tr_b16 a[146:147], v228 offset:26624
    v_mfma_f32_16x16x32_bf16 v[188:191], a[180:183], a[40:43], v[188:191]
    ds_read_b64_tr_b16 a[148:149], v228 offset:28672
    v_mfma_f32_16x16x32_bf16 v[188:191], a[176:179], a[32:35], v[188:191]
    ds_read_b64_tr_b16 a[150:151], v228 offset:30720
    s_waitcnt lgkmcnt(4)
    v_mfma_f32_16x16x32_bf16 v[132:135], a[128:131], a[48:51], v[132:135]
    ds_read_b64_tr_b16 a[160:161], v229 offset:24576
    buffer_load_dwordx4 v217, s[32:35], s53 offen offset:1024 lds
    v_mfma_f32_16x16x32_bf16 v[132:135], a[132:135], a[56:59], v[132:135]
    ds_read_b64_tr_b16 a[162:163], v229 offset:26624
    v_mfma_f32_16x16x32_bf16 v[136:139], a[132:135], a[60:63], v[136:139]
    ds_read_b64_tr_b16 a[164:165], v229 offset:28672
    v_mfma_f32_16x16x32_bf16 v[136:139], a[128:131], a[52:55], v[136:139]
    ds_read_b64_tr_b16 a[166:167], v229 offset:30720
    s_waitcnt lgkmcnt(4)
    v_mfma_f32_16x16x32_bf16 v[144:147], a[144:147], a[52:55], v[144:147]
    ds_read_b64_tr_b16 a[176:177], v230 offset:24576
    buffer_load_dwordx4 a[116:119], v214, s[24:27], s51 offen offset:1024 sc1
    v_mfma_f32_16x16x32_bf16 v[144:147], a[148:151], a[60:63], v[144:147]
    ds_read_b64_tr_b16 a[178:179], v230 offset:26624
    v_mfma_f32_16x16x32_bf16 v[140:143], a[148:151], a[56:59], v[140:143]
    ds_read_b64_tr_b16 a[180:181], v230 offset:28672
    v_mfma_f32_16x16x32_bf16 v[140:143], a[144:147], a[48:51], v[140:143]
    ds_read_b64_tr_b16 a[182:183], v230 offset:30720
    s_waitcnt lgkmcnt(4)
    v_mfma_f32_16x16x32_bf16 v[148:151], a[160:163], a[48:51], v[148:151]
    ds_read_b64_tr_b16 a[128:129], v14 offset:24576
    buffer_load_dwordx4 v218, s[32:35], s53 offen offset:2048 lds
    v_mfma_f32_16x16x32_bf16 v[148:151], a[164:167], a[56:59], v[148:151]
    ds_read_b64_tr_b16 a[130:131], v14 offset:26624
    v_mfma_f32_16x16x32_bf16 v[152:155], a[164:167], a[60:63], v[152:155]
    ds_read_b64_tr_b16 a[132:133], v14 offset:28672
    v_mfma_f32_16x16x32_bf16 v[152:155], a[160:163], a[52:55], v[152:155]
    ds_read_b64_tr_b16 a[134:135], v14 offset:30720
    s_waitcnt lgkmcnt(4)
    v_mfma_f32_16x16x32_bf16 v[160:163], a[176:179], a[52:55], v[160:163]
    ds_read_b64_tr_b16 a[144:145], v15 offset:24576
    buffer_load_dwordx4 a[120:123], v215, s[24:27], s51 offen offset:0 sc1
    v_mfma_f32_16x16x32_bf16 v[160:163], a[180:183], a[60:63], v[160:163]
    ds_read_b64_tr_b16 a[146:147], v15 offset:26624
    v_mfma_f32_16x16x32_bf16 v[156:159], a[180:183], a[56:59], v[156:159]
    ds_read_b64_tr_b16 a[148:149], v15 offset:28672
    v_mfma_f32_16x16x32_bf16 v[156:159], a[176:179], a[48:51], v[156:159]
    ds_read_b64_tr_b16 a[150:151], v15 offset:30720
    s_waitcnt lgkmcnt(4)
    v_mfma_f32_16x16x32_bf16 v[164:167], a[128:131], a[48:51], v[164:167]
    ds_read_b64_tr_b16 a[160:161], v16 offset:24576
    buffer_load_dwordx4 v219, s[32:35], s53 offen offset:3072 lds
    v_mfma_f32_16x16x32_bf16 v[164:167], a[132:135], a[56:59], v[164:167]
    ds_read_b64_tr_b16 a[162:163], v16 offset:26624
    v_mfma_f32_16x16x32_bf16 v[168:171], a[132:135], a[60:63], v[168:171]
    ds_read_b64_tr_b16 a[164:165], v16 offset:28672
    v_mfma_f32_16x16x32_bf16 v[168:171], a[128:131], a[52:55], v[168:171]
    ds_read_b64_tr_b16 a[166:167], v16 offset:30720
    s_waitcnt lgkmcnt(4)
    v_mfma_f32_16x16x32_bf16 v[176:179], a[144:147], a[52:55], v[176:179]
    ds_read_b64_tr_b16 a[176:177], v17 offset:24576
    buffer_load_dwordx4 a[124:127], v215, s[24:27], s51 offen offset:1024 sc1
    v_mfma_f32_16x16x32_bf16 v[176:179], a[148:151], a[60:63], v[176:179]
    ds_read_b64_tr_b16 a[178:179], v17 offset:26624
    v_mfma_f32_16x16x32_bf16 v[172:175], a[148:151], a[56:59], v[172:175]
    ds_read_b64_tr_b16 a[180:181], v17 offset:28672
    v_mfma_f32_16x16x32_bf16 v[172:175], a[144:147], a[48:51], v[172:175]
    ds_read_b64_tr_b16 a[182:183], v17 offset:30720
    s_waitcnt lgkmcnt(4)
    v_mfma_f32_16x16x32_bf16 v[180:183], a[160:163], a[48:51], v[180:183]
    s_waitcnt vmcnt(16)
    s_barrier
    ds_read_b64_tr_b16 a[128:129], v227 offset:32768
    v_mfma_f32_16x16x32_bf16 v[180:183], a[164:167], a[56:59], v[180:183]
    ds_read_b64_tr_b16 a[130:131], v227 offset:34816
    s_add_u32 m0, s40, 65536
    v_mfma_f32_16x16x32_bf16 v[184:187], a[164:167], a[60:63], v[184:187]
    ds_read_b64_tr_b16 a[132:133], v227 offset:36864
    buffer_load_dwordx4 v220, s[32:35], s52 offen offset:0 lds
    v_mfma_f32_16x16x32_bf16 v[184:187], a[160:163], a[52:55], v[184:187]
    ds_read_b64_tr_b16 a[134:135], v227 offset:38912
    v_readlane_b32 s51, v18, s46
    s_waitcnt lgkmcnt(4)
    v_mfma_f32_16x16x32_bf16 v[192:195], a[176:179], a[52:55], v[192:195]
    ds_read_b64_tr_b16 a[144:145], v228 offset:32768
    buffer_load_dwordx4 a[0:3], v212, s[24:27], s50 offen offset:0 sc1
    v_mfma_f32_16x16x32_bf16 v[192:195], a[180:183], a[60:63], v[192:195]
    ds_read_b64_tr_b16 a[146:147], v228 offset:34816
    v_readlane_b32 s53, v19, s46
    v_mfma_f32_16x16x32_bf16 v[188:191], a[180:183], a[56:59], v[188:191]
    ds_read_b64_tr_b16 a[148:149], v228 offset:36864
    buffer_load_dwordx4 v221, s[32:35], s52 offen offset:1024 lds
    v_mfma_f32_16x16x32_bf16 v[188:191], a[176:179], a[48:51], v[188:191]
    ds_read_b64_tr_b16 a[150:151], v228 offset:38912
    s_add_u32 s46, s46, 1
    s_waitcnt lgkmcnt(4)
    v_mfma_f32_16x16x32_bf16 v[132:135], a[128:131], a[64:67], v[132:135]
    ds_read_b64_tr_b16 a[160:161], v229 offset:32768
    buffer_load_dwordx4 a[4:7], v212, s[24:27], s50 offen offset:1024 sc1
    v_mfma_f32_16x16x32_bf16 v[132:135], a[132:135], a[72:75], v[132:135]
    ds_read_b64_tr_b16 a[162:163], v229 offset:34816
    buffer_load_dwordx4 v222, s[32:35], s52 offen offset:2048 lds
    v_mfma_f32_16x16x32_bf16 v[136:139], a[132:135], a[76:79], v[136:139]
    ds_read_b64_tr_b16 a[164:165], v229 offset:36864
    buffer_load_dwordx4 a[8:11], v213, s[24:27], s50 offen offset:0 sc1
    v_mfma_f32_16x16x32_bf16 v[136:139], a[128:131], a[68:71], v[136:139]
    ds_read_b64_tr_b16 a[166:167], v229 offset:38912
    s_waitcnt lgkmcnt(4)
    v_mfma_f32_16x16x32_bf16 v[144:147], a[144:147], a[68:71], v[144:147]
    ds_read_b64_tr_b16 a[176:177], v230 offset:32768
    buffer_load_dwordx4 v223, s[32:35], s52 offen offset:3072 lds
    v_mfma_f32_16x16x32_bf16 v[144:147], a[148:151], a[76:79], v[144:147]
    ds_read_b64_tr_b16 a[178:179], v230 offset:34816
    v_mfma_f32_16x16x32_bf16 v[140:143], a[148:151], a[72:75], v[140:143]
    ds_read_b64_tr_b16 a[180:181], v230 offset:36864
    buffer_load_dwordx4 a[12:15], v213, s[24:27], s50 offen offset:1024 sc1
    v_mfma_f32_16x16x32_bf16 v[140:143], a[144:147], a[64:67], v[140:143]
    ds_read_b64_tr_b16 a[182:183], v230 offset:38912
    s_waitcnt lgkmcnt(4)
    v_mfma_f32_16x16x32_bf16 v[148:151], a[160:163], a[64:67], v[148:151]
    ds_read_b64_tr_b16 a[128:129], v227 offset:40960
    s_add_u32 m0, s40, 0
    v_mfma_f32_16x16x32_bf16 v[148:151], a[164:167], a[72:75], v[148:151]
    ds_read_b64_tr_b16 a[130:131], v227 offset:43008
    buffer_load_dwordx4 v216, s[32:35], s52 offen offset:0 lds
    v_mfma_f32_16x16x32_bf16 v[152:155], a[164:167], a[76:79], v[152:155]
    ds_read_b64_tr_b16 a[132:133], v227 offset:45056
    buffer_load_dwordx4 a[16:19], v214, s[24:27], s50 offen offset:0 sc1
    v_mfma_f32_16x16x32_bf16 v[152:155], a[160:163], a[68:71], v[152:155]
    ds_read_b64_tr_b16 a[134:135], v227 offset:47104
    s_waitcnt lgkmcnt(4)
    v_mfma_f32_16x16x32_bf16 v[160:163], a[176:179], a[68:71], v[160:163]
    ds_read_b64_tr_b16 a[144:145], v228 offset:40960
    buffer_load_dwordx4 v217, s[32:35], s52 offen offset:1024 lds
    v_mfma_f32_16x16x32_bf16 v[160:163], a[180:183], a[76:79], v[160:163]
    ds_read_b64_tr_b16 a[146:147], v228 offset:43008
    buffer_load_dwordx4 a[20:23], v214, s[24:27], s50 offen offset:1024 sc1
    v_mfma_f32_16x16x32_bf16 v[156:159], a[180:183], a[72:75], v[156:159]
    ds_read_b64_tr_b16 a[148:149], v228 offset:45056
    v_mfma_f32_16x16x32_bf16 v[156:159], a[176:179], a[64:67], v[156:159]
    ds_read_b64_tr_b16 a[150:151], v228 offset:47104
    s_waitcnt lgkmcnt(4)
    v_mfma_f32_16x16x32_bf16 v[132:135], a[128:131], a[80:83], v[132:135]
    ds_read_b64_tr_b16 a[160:161], v229 offset:40960
    buffer_load_dwordx4 v218, s[32:35], s52 offen offset:2048 lds
    v_mfma_f32_16x16x32_bf16 v[132:135], a[132:135], a[88:91], v[132:135]
    ds_read_b64_tr_b16 a[162:163], v229 offset:43008
    buffer_load_dwordx4 a[24:27], v215, s[24:27], s50 offen offset:0 sc1
    v_mfma_f32_16x16x32_bf16 v[136:139], a[132:135], a[92:95], v[136:139]
    ds_read_b64_tr_b16 a[164:165], v229 offset:45056
    v_mfma_f32_16x16x32_bf16 v[136:139], a[128:131], a[84:87], v[136:139]
    ds_read_b64_tr_b16 a[166:167], v229 offset:47104
    s_waitcnt lgkmcnt(4)
    v_mfma_f32_16x16x32_bf16 v[144:147], a[144:147], a[84:87], v[144:147]
    ds_read_b64_tr_b16 a[176:177], v230 offset:40960
    buffer_load_dwordx4 v219, s[32:35], s52 offen offset:3072 lds
    v_mfma_f32_16x16x32_bf16 v[144:147], a[148:151], a[92:95], v[144:147]
    ds_read_b64_tr_b16 a[178:179], v230 offset:43008
    buffer_load_dwordx4 a[28:31], v215, s[24:27], s50 offen offset:1024 sc1
    v_mfma_f32_16x16x32_bf16 v[140:143], a[148:151], a[88:91], v[140:143]
    ds_read_b64_tr_b16 a[180:181], v230 offset:45056
    v_mfma_f32_16x16x32_bf16 v[140:143], a[144:147], a[80:83], v[140:143]
    ds_read_b64_tr_b16 a[182:183], v230 offset:47104
    s_waitcnt lgkmcnt(4)
    v_mfma_f32_16x16x32_bf16 v[148:151], a[160:163], a[80:83], v[148:151]
    s_waitcnt vmcnt(16)
    s_barrier
    ds_read_b64_tr_b16 a[128:129], v227 offset:49152
    v_mfma_f32_16x16x32_bf16 v[148:151], a[164:167], a[88:91], v[148:151]
    ds_read_b64_tr_b16 a[130:131], v227 offset:51200
    s_add_u32 m0, s40, 81920
    v_mfma_f32_16x16x32_bf16 v[152:155], a[164:167], a[92:95], v[152:155]
    ds_read_b64_tr_b16 a[132:133], v227 offset:53248
    buffer_load_dwordx4 v220, s[32:35], s53 offen offset:0 lds
    v_mfma_f32_16x16x32_bf16 v[152:155], a[160:163], a[84:87], v[152:155]
    ds_read_b64_tr_b16 a[134:135], v227 offset:55296
    v_readlane_b32 s50, v18, s46
    s_waitcnt lgkmcnt(4)
    v_mfma_f32_16x16x32_bf16 v[160:163], a[176:179], a[84:87], v[160:163]
    ds_read_b64_tr_b16 a[144:145], v228 offset:49152
    buffer_load_dwordx4 a[32:35], v212, s[24:27], s51 offen offset:0 sc1
    v_mfma_f32_16x16x32_bf16 v[160:163], a[180:183], a[92:95], v[160:163]
    ds_read_b64_tr_b16 a[146:147], v228 offset:51200
    v_readlane_b32 s52, v19, s46
    v_mfma_f32_16x16x32_bf16 v[156:159], a[180:183], a[88:91], v[156:159]
    ds_read_b64_tr_b16 a[148:149], v228 offset:53248
    buffer_load_dwordx4 v221, s[32:35], s53 offen offset:1024 lds
    v_mfma_f32_16x16x32_bf16 v[156:159], a[176:179], a[80:83], v[156:159]
    ds_read_b64_tr_b16 a[150:151], v228 offset:55296
    s_add_u32 s46, s46, 1
    s_waitcnt lgkmcnt(4)
    v_mfma_f32_16x16x32_bf16 v[132:135], a[128:131], a[96:99], v[132:135]
    ds_read_b64_tr_b16 a[160:161], v229 offset:49152
    buffer_load_dwordx4 a[36:39], v212, s[24:27], s51 offen offset:1024 sc1
    v_mfma_f32_16x16x32_bf16 v[132:135], a[132:135], a[104:107], v[132:135]
    ds_read_b64_tr_b16 a[162:163], v229 offset:51200
    buffer_load_dwordx4 v222, s[32:35], s53 offen offset:2048 lds
    v_mfma_f32_16x16x32_bf16 v[136:139], a[132:135], a[108:111], v[136:139]
    ds_read_b64_tr_b16 a[164:165], v229 offset:53248
    buffer_load_dwordx4 a[40:43], v213, s[24:27], s51 offen offset:0 sc1
    v_mfma_f32_16x16x32_bf16 v[136:139], a[128:131], a[100:103], v[136:139]
    ds_read_b64_tr_b16 a[166:167], v229 offset:55296
    s_waitcnt lgkmcnt(4)
    v_mfma_f32_16x16x32_bf16 v[144:147], a[144:147], a[100:103], v[144:147]
    ds_read_b64_tr_b16 a[176:177], v230 offset:49152
    buffer_load_dwordx4 v223, s[32:35], s53 offen offset:3072 lds
    v_mfma_f32_16x16x32_bf16 v[144:147], a[148:151], a[108:111], v[144:147]
    ds_read_b64_tr_b16 a[178:179], v230 offset:51200
    v_mfma_f32_16x16x32_bf16 v[140:143], a[148:151], a[104:107], v[140:143]
    ds_read_b64_tr_b16 a[180:181], v230 offset:53248
    buffer_load_dwordx4 a[44:47], v213, s[24:27], s51 offen offset:1024 sc1
    v_mfma_f32_16x16x32_bf16 v[140:143], a[144:147], a[96:99], v[140:143]
    ds_read_b64_tr_b16 a[182:183], v230 offset:55296
    s_waitcnt lgkmcnt(4)
    v_mfma_f32_16x16x32_bf16 v[148:151], a[160:163], a[96:99], v[148:151]
    ds_read_b64_tr_b16 a[128:129], v227 offset:57344
    s_add_u32 m0, s40, 16384
    v_mfma_f32_16x16x32_bf16 v[148:151], a[164:167], a[104:107], v[148:151]
    ds_read_b64_tr_b16 a[130:131], v227 offset:59392
    buffer_load_dwordx4 v216, s[32:35], s53 offen offset:0 lds
    v_mfma_f32_16x16x32_bf16 v[152:155], a[164:167], a[108:111], v[152:155]
    ds_read_b64_tr_b16 a[132:133], v227 offset:61440
    buffer_load_dwordx4 a[48:51], v214, s[24:27], s51 offen offset:0 sc1
    v_mfma_f32_16x16x32_bf16 v[152:155], a[160:163], a[100:103], v[152:155]
    ds_read_b64_tr_b16 a[134:135], v227 offset:63488
    s_waitcnt lgkmcnt(4)
    v_mfma_f32_16x16x32_bf16 v[160:163], a[176:179], a[100:103], v[160:163]
    ds_read_b64_tr_b16 a[144:145], v228 offset:57344
    buffer_load_dwordx4 v217, s[32:35], s53 offen offset:1024 lds
    v_mfma_f32_16x16x32_bf16 v[160:163], a[180:183], a[108:111], v[160:163]
    ds_read_b64_tr_b16 a[146:147], v228 offset:59392
    buffer_load_dwordx4 a[52:55], v214, s[24:27], s51 offen offset:1024 sc1
    v_mfma_f32_16x16x32_bf16 v[156:159], a[180:183], a[104:107], v[156:159]
    ds_read_b64_tr_b16 a[148:149], v228 offset:61440
    v_mfma_f32_16x16x32_bf16 v[156:159], a[176:179], a[96:99], v[156:159]
    ds_read_b64_tr_b16 a[150:151], v228 offset:63488
    s_waitcnt lgkmcnt(4)
    v_mfma_f32_16x16x32_bf16 v[132:135], a[128:131], a[112:115], v[132:135]
    ds_read_b64_tr_b16 a[160:161], v229 offset:57344
    buffer_load_dwordx4 v218, s[32:35], s53 offen offset:2048 lds
    v_mfma_f32_16x16x32_bf16 v[132:135], a[132:135], a[120:123], v[132:135]
    ds_read_b64_tr_b16 a[162:163], v229 offset:59392
    buffer_load_dwordx4 a[56:59], v215, s[24:27], s51 offen offset:0 sc1
    v_mfma_f32_16x16x32_bf16 v[136:139], a[132:135], a[124:127], v[136:139]
    ds_read_b64_tr_b16 a[164:165], v229 offset:61440
    v_mfma_f32_16x16x32_bf16 v[136:139], a[128:131], a[116:119], v[136:139]
    ds_read_b64_tr_b16 a[166:167], v229 offset:63488
    s_waitcnt lgkmcnt(4)
    v_mfma_f32_16x16x32_bf16 v[144:147], a[144:147], a[116:119], v[144:147]
    ds_read_b64_tr_b16 a[176:177], v230 offset:57344
    buffer_load_dwordx4 v219, s[32:35], s53 offen offset:3072 lds
    v_mfma_f32_16x16x32_bf16 v[144:147], a[148:151], a[124:127], v[144:147]
    ds_read_b64_tr_b16 a[178:179], v230 offset:59392
    buffer_load_dwordx4 a[60:63], v215, s[24:27], s51 offen offset:1024 sc1
    v_mfma_f32_16x16x32_bf16 v[140:143], a[148:151], a[120:123], v[140:143]
    ds_read_b64_tr_b16 a[180:181], v230 offset:61440
    v_mfma_f32_16x16x32_bf16 v[140:143], a[144:147], a[112:115], v[140:143]
    ds_read_b64_tr_b16 a[182:183], v230 offset:63488
    s_waitcnt lgkmcnt(4)
    v_mfma_f32_16x16x32_bf16 v[148:151], a[160:163], a[112:115], v[148:151]
    s_waitcnt vmcnt(16)
    s_barrier
    ds_read_b64_tr_b16 a[128:129], v227 offset:0
    v_mfma_f32_16x16x32_bf16 v[148:151], a[164:167], a[120:123], v[148:151]
    ds_read_b64_tr_b16 a[130:131], v227 offset:2048
    v_mfma_f32_16x16x32_bf16 v[152:155], a[164:167], a[124:127], v[152:155]
    ds_read_b64_tr_b16 a[132:133], v227 offset:4096
    v_mfma_f32_16x16x32_bf16 v[152:155], a[160:163], a[116:119], v[152:155]
    ds_read_b64_tr_b16 a[134:135], v227 offset:6144
    s_waitcnt lgkmcnt(4)
    v_mfma_f32_16x16x32_bf16 v[160:163], a[176:179], a[116:119], v[160:163]
    ds_read_b64_tr_b16 a[144:145], v228 offset:0
    v_mfma_f32_16x16x32_bf16 v[160:163], a[180:183], a[124:127], v[160:163]
    ds_read_b64_tr_b16 a[146:147], v228 offset:2048
    v_mfma_f32_16x16x32_bf16 v[156:159], a[180:183], a[120:123], v[156:159]
    ds_read_b64_tr_b16 a[148:149], v228 offset:4096
    v_mfma_f32_16x16x32_bf16 v[156:159], a[176:179], a[112:115], v[156:159]
    ds_read_b64_tr_b16 a[150:151], v228 offset:6144
    s_waitcnt lgkmcnt(4)
    v_mfma_f32_16x16x32_bf16 v[132:135], a[128:131], a[0:3], v[132:135]
    ds_read_b64_tr_b16 a[160:161], v229 offset:0
    v_mfma_f32_16x16x32_bf16 v[132:135], a[132:135], a[8:11], v[132:135]
    ds_read_b64_tr_b16 a[162:163], v229 offset:2048
    v_mfma_f32_16x16x32_bf16 v[136:139], a[132:135], a[12:15], v[136:139]
    ds_read_b64_tr_b16 a[164:165], v229 offset:4096
    v_mfma_f32_16x16x32_bf16 v[136:139], a[128:131], a[4:7], v[136:139]
    ds_read_b64_tr_b16 a[166:167], v229 offset:6144
    s_waitcnt lgkmcnt(4)
    v_mfma_f32_16x16x32_bf16 v[144:147], a[144:147], a[4:7], v[144:147]
    ds_read_b64_tr_b16 a[176:177], v230 offset:0
    v_mfma_f32_16x16x32_bf16 v[144:147], a[148:151], a[12:15], v[144:147]
    ds_read_b64_tr_b16 a[178:179], v230 offset:2048
    v_mfma_f32_16x16x32_bf16 v[140:143], a[148:151], a[8:11], v[140:143]
    ds_read_b64_tr_b16 a[180:181], v230 offset:4096
    v_mfma_f32_16x16x32_bf16 v[140:143], a[144:147], a[0:3], v[140:143]
    ds_read_b64_tr_b16 a[182:183], v230 offset:6144
    s_waitcnt lgkmcnt(4)
    v_mfma_f32_16x16x32_bf16 v[148:151], a[160:163], a[0:3], v[148:151]
    ds_read_b64_tr_b16 a[128:129], v227 offset:8192
    v_mfma_f32_16x16x32_bf16 v[148:151], a[164:167], a[8:11], v[148:151]
    ds_read_b64_tr_b16 a[130:131], v227 offset:10240
    v_mfma_f32_16x16x32_bf16 v[152:155], a[164:167], a[12:15], v[152:155]
    ds_read_b64_tr_b16 a[132:133], v227 offset:12288
    v_mfma_f32_16x16x32_bf16 v[152:155], a[160:163], a[4:7], v[152:155]
    ds_read_b64_tr_b16 a[134:135], v227 offset:14336
    s_waitcnt lgkmcnt(4)
    v_mfma_f32_16x16x32_bf16 v[160:163], a[176:179], a[4:7], v[160:163]
    ds_read_b64_tr_b16 a[144:145], v228 offset:8192
    v_mfma_f32_16x16x32_bf16 v[160:163], a[180:183], a[12:15], v[160:163]
    ds_read_b64_tr_b16 a[146:147], v228 offset:10240
    v_mfma_f32_16x16x32_bf16 v[156:159], a[180:183], a[8:11], v[156:159]
    ds_read_b64_tr_b16 a[148:149], v228 offset:12288
    v_mfma_f32_16x16x32_bf16 v[156:159], a[176:179], a[0:3], v[156:159]
    ds_read_b64_tr_b16 a[150:151], v228 offset:14336
    s_waitcnt lgkmcnt(4)
    v_mfma_f32_16x16x32_bf16 v[132:135], a[128:131], a[16:19], v[132:135]
    ds_read_b64_tr_b16 a[160:161], v229 offset:8192
    v_mfma_f32_16x16x32_bf16 v[132:135], a[132:135], a[24:27], v[132:135]
    ds_read_b64_tr_b16 a[162:163], v229 offset:10240
    v_mfma_f32_16x16x32_bf16 v[136:139], a[132:135], a[28:31], v[136:139]
    ds_read_b64_tr_b16 a[164:165], v229 offset:12288
    v_mfma_f32_16x16x32_bf16 v[136:139], a[128:131], a[20:23], v[136:139]
    ds_read_b64_tr_b16 a[166:167], v229 offset:14336
    s_waitcnt lgkmcnt(4)
    v_mfma_f32_16x16x32_bf16 v[144:147], a[144:147], a[20:23], v[144:147]
    ds_read_b64_tr_b16 a[176:177], v230 offset:8192
    v_mfma_f32_16x16x32_bf16 v[144:147], a[148:151], a[28:31], v[144:147]
    ds_read_b64_tr_b16 a[178:179], v230 offset:10240
    v_mfma_f32_16x16x32_bf16 v[140:143], a[148:151], a[24:27], v[140:143]
    ds_read_b64_tr_b16 a[180:181], v230 offset:12288
    v_mfma_f32_16x16x32_bf16 v[140:143], a[144:147], a[16:19], v[140:143]
    ds_read_b64_tr_b16 a[182:183], v230 offset:14336
    s_waitcnt lgkmcnt(4)
    v_mfma_f32_16x16x32_bf16 v[148:151], a[160:163], a[16:19], v[148:151]
    s_waitcnt vmcnt(0)
    s_barrier
    ds_read_b64_tr_b16 a[128:129], v227 offset:16384
    v_mfma_f32_16x16x32_bf16 v[148:151], a[164:167], a[24:27], v[148:151]
    ds_read_b64_tr_b16 a[130:131], v227 offset:18432
    v_mfma_f32_16x16x32_bf16 v[152:155], a[164:167], a[28:31], v[152:155]
    ds_read_b64_tr_b16 a[132:133], v227 offset:20480
    v_mfma_f32_16x16x32_bf16 v[152:155], a[160:163], a[20:23], v[152:155]
    ds_read_b64_tr_b16 a[134:135], v227 offset:22528
    s_waitcnt lgkmcnt(4)
    v_mfma_f32_16x16x32_bf16 v[160:163], a[176:179], a[20:23], v[160:163]
    ds_read_b64_tr_b16 a[144:145], v228 offset:16384
    v_mfma_f32_16x16x32_bf16 v[160:163], a[180:183], a[28:31], v[160:163]
    ds_read_b64_tr_b16 a[146:147], v228 offset:18432
    v_mfma_f32_16x16x32_bf16 v[156:159], a[180:183], a[24:27], v[156:159]
    ds_read_b64_tr_b16 a[148:149], v228 offset:20480
    v_mfma_f32_16x16x32_bf16 v[156:159], a[176:179], a[16:19], v[156:159]
    ds_read_b64_tr_b16 a[150:151], v228 offset:22528
    s_waitcnt lgkmcnt(4)
    v_mfma_f32_16x16x32_bf16 v[132:135], a[128:131], a[32:35], v[132:135]
    ds_read_b64_tr_b16 a[160:161], v229 offset:16384
    v_mfma_f32_16x16x32_bf16 v[132:135], a[132:135], a[40:43], v[132:135]
    ds_read_b64_tr_b16 a[162:163], v229 offset:18432
    v_mfma_f32_16x16x32_bf16 v[136:139], a[132:135], a[44:47], v[136:139]
    ds_read_b64_tr_b16 a[164:165], v229 offset:20480
    v_mfma_f32_16x16x32_bf16 v[136:139], a[128:131], a[36:39], v[136:139]
    ds_read_b64_tr_b16 a[166:167], v229 offset:22528
    s_waitcnt lgkmcnt(4)
    v_mfma_f32_16x16x32_bf16 v[144:147], a[144:147], a[36:39], v[144:147]
    ds_read_b64_tr_b16 a[176:177], v230 offset:16384
    v_mfma_f32_16x16x32_bf16 v[144:147], a[148:151], a[44:47], v[144:147]
    ds_read_b64_tr_b16 a[178:179], v230 offset:18432
    v_mfma_f32_16x16x32_bf16 v[140:143], a[148:151], a[40:43], v[140:143]
    ds_read_b64_tr_b16 a[180:181], v230 offset:20480
    v_mfma_f32_16x16x32_bf16 v[140:143], a[144:147], a[32:35], v[140:143]
    ds_read_b64_tr_b16 a[182:183], v230 offset:22528
    s_waitcnt lgkmcnt(4)
    v_mfma_f32_16x16x32_bf16 v[148:151], a[160:163], a[32:35], v[148:151]
    ds_read_b64_tr_b16 a[128:129], v227 offset:24576
    v_mfma_f32_16x16x32_bf16 v[148:151], a[164:167], a[40:43], v[148:151]
    ds_read_b64_tr_b16 a[130:131], v227 offset:26624
    v_mfma_f32_16x16x32_bf16 v[152:155], a[164:167], a[44:47], v[152:155]
    ds_read_b64_tr_b16 a[132:133], v227 offset:28672
    v_mfma_f32_16x16x32_bf16 v[152:155], a[160:163], a[36:39], v[152:155]
    ds_read_b64_tr_b16 a[134:135], v227 offset:30720
    s_waitcnt lgkmcnt(4)
    v_mfma_f32_16x16x32_bf16 v[160:163], a[176:179], a[36:39], v[160:163]
    ds_read_b64_tr_b16 a[144:145], v228 offset:24576
    v_mfma_f32_16x16x32_bf16 v[160:163], a[180:183], a[44:47], v[160:163]
    ds_read_b64_tr_b16 a[146:147], v228 offset:26624
    v_mfma_f32_16x16x32_bf16 v[156:159], a[180:183], a[40:43], v[156:159]
    ds_read_b64_tr_b16 a[148:149], v228 offset:28672
    v_mfma_f32_16x16x32_bf16 v[156:159], a[176:179], a[32:35], v[156:159]
    ds_read_b64_tr_b16 a[150:151], v228 offset:30720
    s_waitcnt lgkmcnt(4)
    v_mfma_f32_16x16x32_bf16 v[132:135], a[128:131], a[48:51], v[132:135]
    ds_read_b64_tr_b16 a[160:161], v229 offset:24576
    v_mfma_f32_16x16x32_bf16 v[132:135], a[132:135], a[56:59], v[132:135]
    ds_read_b64_tr_b16 a[162:163], v229 offset:26624
    v_mfma_f32_16x16x32_bf16 v[136:139], a[132:135], a[60:63], v[136:139]
    ds_read_b64_tr_b16 a[164:165], v229 offset:28672
    v_mfma_f32_16x16x32_bf16 v[136:139], a[128:131], a[52:55], v[136:139]
    ds_read_b64_tr_b16 a[166:167], v229 offset:30720
    s_waitcnt lgkmcnt(4)
    v_mfma_f32_16x16x32_bf16 v[144:147], a[144:147], a[52:55], v[144:147]
    ds_read_b64_tr_b16 a[176:177], v230 offset:24576
    v_mfma_f32_16x16x32_bf16 v[144:147], a[148:151], a[60:63], v[144:147]
    ds_read_b64_tr_b16 a[178:179], v230 offset:26624
    v_mfma_f32_16x16x32_bf16 v[140:143], a[148:151], a[56:59], v[140:143]
    ds_read_b64_tr_b16 a[180:181], v230 offset:28672
    v_mfma_f32_16x16x32_bf16 v[140:143], a[144:147], a[48:51], v[140:143]
    ds_read_b64_tr_b16 a[182:183], v230 offset:30720
    s_waitcnt lgkmcnt(4)
    v_mfma_f32_16x16x32_bf16 v[148:151], a[160:163], a[48:51], v[148:151]
    s_waitcnt vmcnt(63)
    s_barrier
    ds_read_b64_tr_b16 a[128:129], v14 offset:32768
    v_mfma_f32_16x16x32_bf16 v[148:151], a[164:167], a[56:59], v[148:151]
    ds_read_b64_tr_b16 a[130:131], v14 offset:34816
    v_mfma_f32_16x16x32_bf16 v[152:155], a[164:167], a[60:63], v[152:155]
    ds_read_b64_tr_b16 a[132:133], v14 offset:36864
    v_mfma_f32_16x16x32_bf16 v[152:155], a[160:163], a[52:55], v[152:155]
    ds_read_b64_tr_b16 a[134:135], v14 offset:38912
    s_waitcnt lgkmcnt(4)
    v_mfma_f32_16x16x32_bf16 v[160:163], a[176:179], a[52:55], v[160:163]
    ds_read_b64_tr_b16 a[144:145], v15 offset:32768
    v_mfma_f32_16x16x32_bf16 v[160:163], a[180:183], a[60:63], v[160:163]
    ds_read_b64_tr_b16 a[146:147], v15 offset:34816
    v_mfma_f32_16x16x32_bf16 v[156:159], a[180:183], a[56:59], v[156:159]
    ds_read_b64_tr_b16 a[148:149], v15 offset:36864
    v_mfma_f32_16x16x32_bf16 v[156:159], a[176:179], a[48:51], v[156:159]
    ds_read_b64_tr_b16 a[150:151], v15 offset:38912
    s_waitcnt lgkmcnt(4)
    v_mfma_f32_16x16x32_bf16 v[164:167], a[128:131], a[64:67], v[164:167]
    ds_read_b64_tr_b16 a[160:161], v16 offset:32768
    buffer_store_dwordx4 v[132:135], v231, s[20:23], s42 offen offset:0 sc1
    buffer_store_dwordx4 v[136:139], v231, s[20:23], s42 offen offset:1024 sc1
    v_mfma_f32_16x16x32_bf16 v[164:167], a[132:135], a[72:75], v[164:167]
    ds_read_b64_tr_b16 a[162:163], v16 offset:34816
    buffer_store_dwordx4 v[140:143], v231, s[20:23], s42 offen offset:2048 sc1
    buffer_store_dwordx4 v[144:147], v231, s[20:23], s42 offen offset:3072 sc1
    v_mfma_f32_16x16x32_bf16 v[168:171], a[132:135], a[76:79], v[168:171]
    ds_read_b64_tr_b16 a[164:165], v16 offset:36864
    buffer_store_dwordx4 v[148:151], v231, s[20:23], s43 offen offset:0 sc1
    buffer_store_dwordx4 v[152:155], v231, s[20:23], s43 offen offset:1024 sc1
    v_mfma_f32_16x16x32_bf16 v[168:171], a[128:131], a[68:71], v[168:171]
    ds_read_b64_tr_b16 a[166:167], v16 offset:38912
    buffer_store_dwordx4 v[156:159], v231, s[20:23], s43 offen offset:2048 sc1
    s_waitcnt lgkmcnt(4)
    v_mfma_f32_16x16x32_bf16 v[176:179], a[144:147], a[68:71], v[176:179]
    ds_read_b64_tr_b16 a[176:177], v17 offset:32768
    buffer_store_dwordx4 v[160:163], v231, s[20:23], s43 offen offset:3072 sc1
    v_mfma_f32_16x16x32_bf16 v[176:179], a[148:151], a[76:79], v[176:179]
    ds_read_b64_tr_b16 a[178:179], v17 offset:34816
    v_mfma_f32_16x16x32_bf16 v[172:175], a[148:151], a[72:75], v[172:175]
    ds_read_b64_tr_b16 a[180:181], v17 offset:36864
    v_mfma_f32_16x16x32_bf16 v[172:175], a[144:147], a[64:67], v[172:175]
    ds_read_b64_tr_b16 a[182:183], v17 offset:38912
    s_waitcnt lgkmcnt(4)
    v_mfma_f32_16x16x32_bf16 v[180:183], a[160:163], a[64:67], v[180:183]
    ds_read_b64_tr_b16 a[128:129], v14 offset:40960
    v_mfma_f32_16x16x32_bf16 v[180:183], a[164:167], a[72:75], v[180:183]
    ds_read_b64_tr_b16 a[130:131], v14 offset:43008
    v_mfma_f32_16x16x32_bf16 v[184:187], a[164:167], a[76:79], v[184:187]
    ds_read_b64_tr_b16 a[132:133], v14 offset:45056
    v_mfma_f32_16x16x32_bf16 v[184:187], a[160:163], a[68:71], v[184:187]
    ds_read_b64_tr_b16 a[134:135], v14 offset:47104
    s_waitcnt lgkmcnt(4)
    v_mfma_f32_16x16x32_bf16 v[192:195], a[176:179], a[68:71], v[192:195]
    ds_read_b64_tr_b16 a[144:145], v15 offset:40960
    v_mfma_f32_16x16x32_bf16 v[192:195], a[180:183], a[76:79], v[192:195]
    ds_read_b64_tr_b16 a[146:147], v15 offset:43008
    v_mfma_f32_16x16x32_bf16 v[188:191], a[180:183], a[72:75], v[188:191]
    ds_read_b64_tr_b16 a[148:149], v15 offset:45056
    v_mfma_f32_16x16x32_bf16 v[188:191], a[176:179], a[64:67], v[188:191]
    ds_read_b64_tr_b16 a[150:151], v15 offset:47104
    s_waitcnt lgkmcnt(4)
    v_mfma_f32_16x16x32_bf16 v[164:167], a[128:131], a[80:83], v[164:167]
    ds_read_b64_tr_b16 a[160:161], v16 offset:40960
    v_mfma_f32_16x16x32_bf16 v[164:167], a[132:135], a[88:91], v[164:167]
    ds_read_b64_tr_b16 a[162:163], v16 offset:43008
    v_mfma_f32_16x16x32_bf16 v[168:171], a[132:135], a[92:95], v[168:171]
    ds_read_b64_tr_b16 a[164:165], v16 offset:45056
    v_mfma_f32_16x16x32_bf16 v[168:171], a[128:131], a[84:87], v[168:171]
    ds_read_b64_tr_b16 a[166:167], v16 offset:47104
    s_waitcnt lgkmcnt(4)
    v_mfma_f32_16x16x32_bf16 v[176:179], a[144:147], a[84:87], v[176:179]
    ds_read_b64_tr_b16 a[176:177], v17 offset:40960
    v_mfma_f32_16x16x32_bf16 v[176:179], a[148:151], a[92:95], v[176:179]
    ds_read_b64_tr_b16 a[178:179], v17 offset:43008
    v_mfma_f32_16x16x32_bf16 v[172:175], a[148:151], a[88:91], v[172:175]
    ds_read_b64_tr_b16 a[180:181], v17 offset:45056
    v_mfma_f32_16x16x32_bf16 v[172:175], a[144:147], a[80:83], v[172:175]
    ds_read_b64_tr_b16 a[182:183], v17 offset:47104
    s_waitcnt lgkmcnt(4)
    v_mfma_f32_16x16x32_bf16 v[180:183], a[160:163], a[80:83], v[180:183]
    s_waitcnt vmcnt(63)
    s_barrier
    ds_read_b64_tr_b16 a[128:129], v14 offset:49152
    v_mfma_f32_16x16x32_bf16 v[180:183], a[164:167], a[88:91], v[180:183]
    ds_read_b64_tr_b16 a[130:131], v14 offset:51200
    v_mfma_f32_16x16x32_bf16 v[184:187], a[164:167], a[92:95], v[184:187]
    ds_read_b64_tr_b16 a[132:133], v14 offset:53248
    v_mfma_f32_16x16x32_bf16 v[184:187], a[160:163], a[84:87], v[184:187]
    ds_read_b64_tr_b16 a[134:135], v14 offset:55296
    s_waitcnt lgkmcnt(4)
    v_mfma_f32_16x16x32_bf16 v[192:195], a[176:179], a[84:87], v[192:195]
    ds_read_b64_tr_b16 a[144:145], v15 offset:49152
    v_mfma_f32_16x16x32_bf16 v[192:195], a[180:183], a[92:95], v[192:195]
    ds_read_b64_tr_b16 a[146:147], v15 offset:51200
    v_mfma_f32_16x16x32_bf16 v[188:191], a[180:183], a[88:91], v[188:191]
    ds_read_b64_tr_b16 a[148:149], v15 offset:53248
    v_mfma_f32_16x16x32_bf16 v[188:191], a[176:179], a[80:83], v[188:191]
    ds_read_b64_tr_b16 a[150:151], v15 offset:55296
    s_waitcnt lgkmcnt(4)
    v_mfma_f32_16x16x32_bf16 v[164:167], a[128:131], a[96:99], v[164:167]
    ds_read_b64_tr_b16 a[160:161], v16 offset:49152
    v_mfma_f32_16x16x32_bf16 v[164:167], a[132:135], a[104:107], v[164:167]
    ds_read_b64_tr_b16 a[162:163], v16 offset:51200
    v_mfma_f32_16x16x32_bf16 v[168:171], a[132:135], a[108:111], v[168:171]
    ds_read_b64_tr_b16 a[164:165], v16 offset:53248
    v_mfma_f32_16x16x32_bf16 v[168:171], a[128:131], a[100:103], v[168:171]
    ds_read_b64_tr_b16 a[166:167], v16 offset:55296
    s_waitcnt lgkmcnt(4)
    v_mfma_f32_16x16x32_bf16 v[176:179], a[144:147], a[100:103], v[176:179]
    ds_read_b64_tr_b16 a[176:177], v17 offset:49152
    v_mfma_f32_16x16x32_bf16 v[176:179], a[148:151], a[108:111], v[176:179]
    ds_read_b64_tr_b16 a[178:179], v17 offset:51200
    v_mfma_f32_16x16x32_bf16 v[172:175], a[148:151], a[104:107], v[172:175]
    ds_read_b64_tr_b16 a[180:181], v17 offset:53248
    v_mfma_f32_16x16x32_bf16 v[172:175], a[144:147], a[96:99], v[172:175]
    ds_read_b64_tr_b16 a[182:183], v17 offset:55296
    s_waitcnt lgkmcnt(4)
    v_mfma_f32_16x16x32_bf16 v[180:183], a[160:163], a[96:99], v[180:183]
    ds_read_b64_tr_b16 a[128:129], v14 offset:57344
    v_mfma_f32_16x16x32_bf16 v[180:183], a[164:167], a[104:107], v[180:183]
    ds_read_b64_tr_b16 a[130:131], v14 offset:59392
    v_mfma_f32_16x16x32_bf16 v[184:187], a[164:167], a[108:111], v[184:187]
    ds_read_b64_tr_b16 a[132:133], v14 offset:61440
    v_mfma_f32_16x16x32_bf16 v[184:187], a[160:163], a[100:103], v[184:187]
    ds_read_b64_tr_b16 a[134:135], v14 offset:63488
    s_waitcnt lgkmcnt(4)
    v_mfma_f32_16x16x32_bf16 v[192:195], a[176:179], a[100:103], v[192:195]
    ds_read_b64_tr_b16 a[144:145], v15 offset:57344
    v_mfma_f32_16x16x32_bf16 v[192:195], a[180:183], a[108:111], v[192:195]
    ds_read_b64_tr_b16 a[146:147], v15 offset:59392
    v_mfma_f32_16x16x32_bf16 v[188:191], a[180:183], a[104:107], v[188:191]
    ds_read_b64_tr_b16 a[148:149], v15 offset:61440
    v_mfma_f32_16x16x32_bf16 v[188:191], a[176:179], a[96:99], v[188:191]
    ds_read_b64_tr_b16 a[150:151], v15 offset:63488
    s_waitcnt lgkmcnt(4)
    v_mfma_f32_16x16x32_bf16 v[164:167], a[128:131], a[112:115], v[164:167]
    ds_read_b64_tr_b16 a[160:161], v16 offset:57344
    v_mfma_f32_16x16x32_bf16 v[164:167], a[132:135], a[120:123], v[164:167]
    ds_read_b64_tr_b16 a[162:163], v16 offset:59392
    v_mfma_f32_16x16x32_bf16 v[168:171], a[132:135], a[124:127], v[168:171]
    ds_read_b64_tr_b16 a[164:165], v16 offset:61440
    v_mfma_f32_16x16x32_bf16 v[168:171], a[128:131], a[116:119], v[168:171]
    ds_read_b64_tr_b16 a[166:167], v16 offset:63488
    s_waitcnt lgkmcnt(4)
    v_mfma_f32_16x16x32_bf16 v[176:179], a[144:147], a[116:119], v[176:179]
    ds_read_b64_tr_b16 a[176:177], v17 offset:57344
    v_mfma_f32_16x16x32_bf16 v[176:179], a[148:151], a[124:127], v[176:179]
    ds_read_b64_tr_b16 a[178:179], v17 offset:59392
    v_mfma_f32_16x16x32_bf16 v[172:175], a[148:151], a[120:123], v[172:175]
    ds_read_b64_tr_b16 a[180:181], v17 offset:61440
    v_mfma_f32_16x16x32_bf16 v[172:175], a[144:147], a[112:115], v[172:175]
    ds_read_b64_tr_b16 a[182:183], v17 offset:63488
    s_waitcnt lgkmcnt(4)
    v_mfma_f32_16x16x32_bf16 v[180:183], a[160:163], a[112:115], v[180:183]
    s_waitcnt vmcnt(0)
    v_mov_b32 v1, s100
    s_mov_b64 exec, 1
    buffer_store_dword v1, v0, s[76:79], s75 offen offset:0 sc1
    s_mov_b64 exec, -1
    s_barrier
    ds_read_b64_tr_b16 a[128:129], v14 offset:0
    v_mfma_f32_16x16x32_bf16 v[180:183], a[164:167], a[120:123], v[180:183]
    ds_read_b64_tr_b16 a[130:131], v14 offset:2048
    v_mfma_f32_16x16x32_bf16 v[184:187], a[164:167], a[124:127], v[184:187]
    ds_read_b64_tr_b16 a[132:133], v14 offset:4096
    v_mfma_f32_16x16x32_bf16 v[184:187], a[160:163], a[116:119], v[184:187]
    ds_read_b64_tr_b16 a[134:135], v14 offset:6144
    s_waitcnt lgkmcnt(4)
    v_mfma_f32_16x16x32_bf16 v[192:195], a[176:179], a[116:119], v[192:195]
    ds_read_b64_tr_b16 a[144:145], v15 offset:0
    v_mfma_f32_16x16x32_bf16 v[192:195], a[180:183], a[124:127], v[192:195]
    ds_read_b64_tr_b16 a[146:147], v15 offset:2048
    v_mfma_f32_16x16x32_bf16 v[188:191], a[180:183], a[120:123], v[188:191]
    ds_read_b64_tr_b16 a[148:149], v15 offset:4096
    v_mfma_f32_16x16x32_bf16 v[188:191], a[176:179], a[112:115], v[188:191]
    ds_read_b64_tr_b16 a[150:151], v15 offset:6144
    s_waitcnt lgkmcnt(4)
    v_mfma_f32_16x16x32_bf16 v[164:167], a[128:131], a[0:3], v[164:167]
    ds_read_b64_tr_b16 a[160:161], v16 offset:0
    v_mfma_f32_16x16x32_bf16 v[164:167], a[132:135], a[8:11], v[164:167]
    ds_read_b64_tr_b16 a[162:163], v16 offset:2048
    v_mfma_f32_16x16x32_bf16 v[168:171], a[132:135], a[12:15], v[168:171]
    ds_read_b64_tr_b16 a[164:165], v16 offset:4096
    v_mfma_f32_16x16x32_bf16 v[168:171], a[128:131], a[4:7], v[168:171]
    ds_read_b64_tr_b16 a[166:167], v16 offset:6144
    s_waitcnt lgkmcnt(4)
    v_mfma_f32_16x16x32_bf16 v[176:179], a[144:147], a[4:7], v[176:179]
    ds_read_b64_tr_b16 a[176:177], v17 offset:0
    v_mfma_f32_16x16x32_bf16 v[176:179], a[148:151], a[12:15], v[176:179]
    ds_read_b64_tr_b16 a[178:179], v17 offset:2048
    v_mfma_f32_16x16x32_bf16 v[172:175], a[148:151], a[8:11], v[172:175]
    ds_read_b64_tr_b16 a[180:181], v17 offset:4096
    v_mfma_f32_16x16x32_bf16 v[172:175], a[144:147], a[0:3], v[172:175]
    ds_read_b64_tr_b16 a[182:183], v17 offset:6144
    s_waitcnt lgkmcnt(4)
    v_mfma_f32_16x16x32_bf16 v[180:183], a[160:163], a[0:3], v[180:183]
    ds_read_b64_tr_b16 a[128:129], v14 offset:8192
    v_mfma_f32_16x16x32_bf16 v[180:183], a[164:167], a[8:11], v[180:183]
    ds_read_b64_tr_b16 a[130:131], v14 offset:10240
    v_mfma_f32_16x16x32_bf16 v[184:187], a[164:167], a[12:15], v[184:187]
    ds_read_b64_tr_b16 a[132:133], v14 offset:12288
    v_mfma_f32_16x16x32_bf16 v[184:187], a[160:163], a[4:7], v[184:187]
    ds_read_b64_tr_b16 a[134:135], v14 offset:14336
    s_waitcnt lgkmcnt(4)
    v_mfma_f32_16x16x32_bf16 v[192:195], a[176:179], a[4:7], v[192:195]
    ds_read_b64_tr_b16 a[144:145], v15 offset:8192
    v_mfma_f32_16x16x32_bf16 v[192:195], a[180:183], a[12:15], v[192:195]
    ds_read_b64_tr_b16 a[146:147], v15 offset:10240
    v_mfma_f32_16x16x32_bf16 v[188:191], a[180:183], a[8:11], v[188:191]
    ds_read_b64_tr_b16 a[148:149], v15 offset:12288
    v_mfma_f32_16x16x32_bf16 v[188:191], a[176:179], a[0:3], v[188:191]
    ds_read_b64_tr_b16 a[150:151], v15 offset:14336
    s_waitcnt lgkmcnt(4)
    v_mfma_f32_16x16x32_bf16 v[164:167], a[128:131], a[16:19], v[164:167]
    ds_read_b64_tr_b16 a[160:161], v16 offset:8192
    v_mfma_f32_16x16x32_bf16 v[164:167], a[132:135], a[24:27], v[164:167]
    ds_read_b64_tr_b16 a[162:163], v16 offset:10240
    v_mfma_f32_16x16x32_bf16 v[168:171], a[132:135], a[28:31], v[168:171]
    ds_read_b64_tr_b16 a[164:165], v16 offset:12288
    v_mfma_f32_16x16x32_bf16 v[168:171], a[128:131], a[20:23], v[168:171]
    ds_read_b64_tr_b16 a[166:167], v16 offset:14336
    s_waitcnt lgkmcnt(4)
    v_mfma_f32_16x16x32_bf16 v[176:179], a[144:147], a[20:23], v[176:179]
    ds_read_b64_tr_b16 a[176:177], v17 offset:8192
    v_mfma_f32_16x16x32_bf16 v[176:179], a[148:151], a[28:31], v[176:179]
    ds_read_b64_tr_b16 a[178:179], v17 offset:10240
    v_mfma_f32_16x16x32_bf16 v[172:175], a[148:151], a[24:27], v[172:175]
    ds_read_b64_tr_b16 a[180:181], v17 offset:12288
    v_mfma_f32_16x16x32_bf16 v[172:175], a[144:147], a[16:19], v[172:175]
    ds_read_b64_tr_b16 a[182:183], v17 offset:14336
    s_waitcnt lgkmcnt(4)
    v_mfma_f32_16x16x32_bf16 v[180:183], a[160:163], a[16:19], v[180:183]
    s_waitcnt vmcnt(63)
    s_barrier
    ds_read_b64_tr_b16 a[128:129], v14 offset:16384
    v_mfma_f32_16x16x32_bf16 v[180:183], a[164:167], a[24:27], v[180:183]
    ds_read_b64_tr_b16 a[130:131], v14 offset:18432
    v_mfma_f32_16x16x32_bf16 v[184:187], a[164:167], a[28:31], v[184:187]
    ds_read_b64_tr_b16 a[132:133], v14 offset:20480
    v_mfma_f32_16x16x32_bf16 v[184:187], a[160:163], a[20:23], v[184:187]
    ds_read_b64_tr_b16 a[134:135], v14 offset:22528
    s_waitcnt lgkmcnt(4)
    v_mfma_f32_16x16x32_bf16 v[192:195], a[176:179], a[20:23], v[192:195]
    ds_read_b64_tr_b16 a[144:145], v15 offset:16384
    v_mfma_f32_16x16x32_bf16 v[192:195], a[180:183], a[28:31], v[192:195]
    ds_read_b64_tr_b16 a[146:147], v15 offset:18432
    v_mfma_f32_16x16x32_bf16 v[188:191], a[180:183], a[24:27], v[188:191]
    ds_read_b64_tr_b16 a[148:149], v15 offset:20480
    v_mfma_f32_16x16x32_bf16 v[188:191], a[176:179], a[16:19], v[188:191]
    ds_read_b64_tr_b16 a[150:151], v15 offset:22528
    s_waitcnt lgkmcnt(4)
    v_mfma_f32_16x16x32_bf16 v[164:167], a[128:131], a[32:35], v[164:167]
    ds_read_b64_tr_b16 a[160:161], v16 offset:16384
    buffer_load_dword v226, v225, s[76:79], 0 offen offset:0 sc1
    v_mfma_f32_16x16x32_bf16 v[164:167], a[132:135], a[40:43], v[164:167]
    ds_read_b64_tr_b16 a[162:163], v16 offset:18432
    v_mfma_f32_16x16x32_bf16 v[168:171], a[132:135], a[44:47], v[168:171]
    ds_read_b64_tr_b16 a[164:165], v16 offset:20480
    v_mfma_f32_16x16x32_bf16 v[168:171], a[128:131], a[36:39], v[168:171]
    ds_read_b64_tr_b16 a[166:167], v16 offset:22528
    s_waitcnt lgkmcnt(4)
    v_mfma_f32_16x16x32_bf16 v[176:179], a[144:147], a[36:39], v[176:179]
    ds_read_b64_tr_b16 a[176:177], v17 offset:16384
    v_mfma_f32_16x16x32_bf16 v[176:179], a[148:151], a[44:47], v[176:179]
    ds_read_b64_tr_b16 a[178:179], v17 offset:18432
    v_mfma_f32_16x16x32_bf16 v[172:175], a[148:151], a[40:43], v[172:175]
    ds_read_b64_tr_b16 a[180:181], v17 offset:20480
    v_mfma_f32_16x16x32_bf16 v[172:175], a[144:147], a[32:35], v[172:175]
    ds_read_b64_tr_b16 a[182:183], v17 offset:22528
    s_waitcnt lgkmcnt(4)
    v_mfma_f32_16x16x32_bf16 v[180:183], a[160:163], a[32:35], v[180:183]
    ds_read_b64_tr_b16 a[128:129], v14 offset:24576
    v_mfma_f32_16x16x32_bf16 v[180:183], a[164:167], a[40:43], v[180:183]
    ds_read_b64_tr_b16 a[130:131], v14 offset:26624
    v_mfma_f32_16x16x32_bf16 v[184:187], a[164:167], a[44:47], v[184:187]
    ds_read_b64_tr_b16 a[132:133], v14 offset:28672
    v_mfma_f32_16x16x32_bf16 v[184:187], a[160:163], a[36:39], v[184:187]
    ds_read_b64_tr_b16 a[134:135], v14 offset:30720
    s_waitcnt lgkmcnt(4)
    v_mfma_f32_16x16x32_bf16 v[192:195], a[176:179], a[36:39], v[192:195]
    ds_read_b64_tr_b16 a[144:145], v15 offset:24576
    v_mfma_f32_16x16x32_bf16 v[192:195], a[180:183], a[44:47], v[192:195]
    ds_read_b64_tr_b16 a[146:147], v15 offset:26624
    v_mfma_f32_16x16x32_bf16 v[188:191], a[180:183], a[40:43], v[188:191]
    ds_read_b64_tr_b16 a[148:149], v15 offset:28672
    v_mfma_f32_16x16x32_bf16 v[188:191], a[176:179], a[32:35], v[188:191]
    ds_read_b64_tr_b16 a[150:151], v15 offset:30720
    s_waitcnt lgkmcnt(4)
    v_mfma_f32_16x16x32_bf16 v[164:167], a[128:131], a[48:51], v[164:167]
    ds_read_b64_tr_b16 a[160:161], v16 offset:24576
    v_mfma_f32_16x16x32_bf16 v[164:167], a[132:135], a[56:59], v[164:167]
    ds_read_b64_tr_b16 a[162:163], v16 offset:26624
    v_mfma_f32_16x16x32_bf16 v[168:171], a[132:135], a[60:63], v[168:171]
    ds_read_b64_tr_b16 a[164:165], v16 offset:28672
    v_mfma_f32_16x16x32_bf16 v[168:171], a[128:131], a[52:55], v[168:171]
    ds_read_b64_tr_b16 a[166:167], v16 offset:30720
    s_waitcnt lgkmcnt(4)
    v_mfma_f32_16x16x32_bf16 v[176:179], a[144:147], a[52:55], v[176:179]
    ds_read_b64_tr_b16 a[176:177], v17 offset:24576
    v_mfma_f32_16x16x32_bf16 v[176:179], a[148:151], a[60:63], v[176:179]
    ds_read_b64_tr_b16 a[178:179], v17 offset:26624
    v_mfma_f32_16x16x32_bf16 v[172:175], a[148:151], a[56:59], v[172:175]
    ds_read_b64_tr_b16 a[180:181], v17 offset:28672
    v_mfma_f32_16x16x32_bf16 v[172:175], a[144:147], a[48:51], v[172:175]
    ds_read_b64_tr_b16 a[182:183], v17 offset:30720
    s_waitcnt lgkmcnt(4)
    v_mfma_f32_16x16x32_bf16 v[180:183], a[160:163], a[48:51], v[180:183]
    v_mfma_f32_16x16x32_bf16 v[180:183], a[164:167], a[56:59], v[180:183]
    v_mfma_f32_16x16x32_bf16 v[184:187], a[164:167], a[60:63], v[184:187]
    v_mfma_f32_16x16x32_bf16 v[184:187], a[160:163], a[52:55], v[184:187]
    s_waitcnt lgkmcnt(0)
    v_mfma_f32_16x16x32_bf16 v[192:195], a[176:179], a[52:55], v[192:195]
    v_mfma_f32_16x16x32_bf16 v[192:195], a[180:183], a[60:63], v[192:195]
    v_mfma_f32_16x16x32_bf16 v[188:191], a[180:183], a[56:59], v[188:191]
    v_mfma_f32_16x16x32_bf16 v[188:191], a[176:179], a[48:51], v[188:191]
    s_waitcnt vmcnt(0)
    s_mov_b32 s13, 0x40000
L_ex_poll_chk:
    v_cmp_ne_u32 vcc, s100, v226
    s_nop 0
    s_cmp_eq_u64 vcc, 0
    s_cbranch_scc1 L_ex_poll_ok
    s_mov_b64 exec, vcc
    buffer_load_dword v226, v225, s[76:79], 0 offen offset:0 sc1
    s_waitcnt vmcnt(0)
    s_sub_u32 s13, s13, 1
    s_cmp_lg_u32 s13, 0
    s_cbranch_scc1 L_ex_poll_chk
L_ex_poll_ok:
    s_mov_b64 exec, -1
    buffer_load_dwordx4 v[132:135], v231, s[20:23], s44 offen offset:0 sc1
    buffer_load_dwordx4 v[136:139], v231, s[20:23], s44 offen offset:1024 sc1
    buffer_load_dwordx4 v[140:143], v231, s[20:23], s44 offen offset:2048 sc1
    buffer_load_dwordx4 v[144:147], v231, s[20:23], s44 offen offset:3072 sc1
    buffer_load_dwordx4 v[148:151], v231, s[20:23], s45 offen offset:0 sc1
    buffer_load_dwordx4 v[152:155], v231, s[20:23], s45 offen offset:1024 sc1
    buffer_load_dwordx4 v[156:159], v231, s[20:23], s45 offen offset:2048 sc1
    buffer_load_dwordx4 v[160:163], v231, s[20:23], s45 offen offset:3072 sc1
    s_waitcnt vmcnt(7)
    v_pk_add_f32 v[132:133], v[132:133], v[164:165]
    v_pk_add_f32 v[134:135], v[134:135], v[166:167]
    v_cvt_pk_bf16_f32 v132, v132, v133
    v_cvt_pk_bf16_f32 v133, v134, v135
    ds_write_b64 v236, v[132:133] offset:0
    s_waitcnt vmcnt(6)
    v_pk_add_f32 v[136:137], v[136:137], v[168:169]
    v_pk_add_f32 v[138:139], v[138:139], v[170:171]
    v_cvt_pk_bf16_f32 v136, v136, v137
    v_cvt_pk_bf16_f32 v137, v138, v139
    ds_write_b64 v236, v[136:137] offset:2048
    s_waitcnt vmcnt(5)
    v_pk_add_f32 v[140:141], v[140:141], v[172:173]
    v_pk_add_f32 v[142:143], v[142:143], v[174:175]
    v_cvt_pk_bf16_f32 v140, v140, v141
    v_cvt_pk_bf16_f32 v141, v142, v143
    ds_write_b64 v237, v[140:141] offset:0
    s_waitcnt vmcnt(4)
    v_pk_add_f32 v[144:145], v[144:145], v[176:177]
    v_pk_add_f32 v[146:147], v[146:147], v[178:179]
    v_cvt_pk_bf16_f32 v144, v144, v145
    v_cvt_pk_bf16_f32 v145, v146, v147
    ds_write_b64 v237, v[144:145] offset:2048
    s_waitcnt vmcnt(3)
    v_pk_add_f32 v[148:149], v[148:149], v[180:181]
    v_pk_add_f32 v[150:151], v[150:151], v[182:183]
    v_cvt_pk_bf16_f32 v148, v148, v149
    v_cvt_pk_bf16_f32 v149, v150, v151
    ds_write_b64 v238, v[148:149] offset:0
    s_waitcnt vmcnt(2)
    v_pk_add_f32 v[152:153], v[152:153], v[184:185]
    v_pk_add_f32 v[154:155], v[154:155], v[186:187]
    v_cvt_pk_bf16_f32 v152, v152, v153
    v_cvt_pk_bf16_f32 v153, v154, v155
    ds_write_b64 v238, v[152:153] offset:2048
    s_waitcnt vmcnt(1)
    v_pk_add_f32 v[156:157], v[156:157], v[188:189]
    v_pk_add_f32 v[158:159], v[158:159], v[190:191]
    v_cvt_pk_bf16_f32 v156, v156, v157
    v_cvt_pk_bf16_f32 v157, v158, v159
    ds_write_b64 v239, v[156:157] offset:0
    s_waitcnt vmcnt(0)
    v_pk_add_f32 v[160:161], v[160:161], v[192:193]
    v_pk_add_f32 v[162:163], v[162:163], v[194:195]
    v_cvt_pk_bf16_f32 v160, v160, v161
    v_cvt_pk_bf16_f32 v161, v162, v163
    ds_write_b64 v239, v[160:161] offset:2048
    s_waitcnt lgkmcnt(0)
    ds_read_b128 v[196:199], v240 offset:0
    ds_read_b128 v[200:203], v241 offset:1024
    ds_read_b128 v[204:207], v240 offset:2048
    ds_read_b128 v[208:211], v241 offset:3072
    s_waitcnt lgkmcnt(3)
    buffer_store_dwordx4 v[196:199], v224, s[36:39], 0 offen sc1
    s_waitcnt lgkmcnt(2)
    buffer_store_dwordx4 v[200:203], v242, s[36:39], 0 offen sc1
    s_waitcnt lgkmcnt(1)
    buffer_store_dwordx4 v[204:207], v224, s[36:39], s49 offen sc1
    s_waitcnt lgkmcnt(0)
    buffer_store_dwordx4 v[208:211], v242, s[36:39], s49 offen sc1
L_end:
    s_endpgm
    .fill 512, 4, 0xbf800000

.section .rodata,"a"
.p2align 6
.amdhsa_kernel sequential_preLN__sliding_local_dilated__glu_gated_glu__prompt_kernel
  .amdhsa_next_free_vgpr 508
  .amdhsa_next_free_sgpr 101
  .amdhsa_accum_offset 256
  .amdhsa_group_segment_fixed_size 0
  .amdhsa_kernarg_size 80
  .amdhsa_user_sgpr_count 2
  .amdhsa_user_sgpr_kernarg_segment_ptr 1
  .amdhsa_system_sgpr_workgroup_id_x 1
.end_amdhsa_kernel
```
